```python
import torch

def _softmax(x, axis=-1):
    return torch.softmax(x, dim=axis)

def _gelu(x):
    return torch.nn.functional.gelu(x, approximate='tanh')

def _silu(x):
    return torch.nn.functional.silu(x)

def _sigmoid(x):
    return torch.sigmoid(x)

def _layernorm(x, axis=-1, eps=1e-05):
    m = x.mean(dim=axis, keepdim=True)
    v = x.var(dim=axis, keepdim=True, unbiased=False)
    return (x - m) / torch.sqrt(v + eps)

def _scatter_add(tgt, idx, src, axis=0):
    return tgt.clone().index_add_(axis, idx, src)

def _segment_sum(src, seg, n):
    out = torch.zeros((n,) + src.shape[1:], dtype=src.dtype)
    return out.index_add_(0, seg, src)

def _pad(x, pw):
    flat = tuple((v for pair in reversed(pw) for v in pair))
    return torch.nn.functional.pad(x, flat)
kernel_name = 'recurrent_scan__memory_aug_recurrent_mem_tr__mixer_channel_mlp__prompt'

def setup_inputs():

    _w = lambda a: (lambda t: t.to(torch.bfloat16) if t.is_floating_point() else t)(torch.as_tensor(a))

    def _A_setup():
        B, S, Dm = (1, 2048, 640)
        H, Dh = (32, 192)
        M, seg = (8, 32)
        seg = min(seg, S)
        S = S // seg * seg
        return {'x': _w((lambda *s: torch.randn(*s, dtype=torch.bfloat16) * 0.05)(B, S, Dm)), 'mem0': _w((lambda *s: torch.randn(*s, dtype=torch.bfloat16) * 0.8)(B, M, Dm)), 'Wq': _w((lambda *s: torch.randn(*s, dtype=torch.bfloat16) * 0.8)(Dm, H, Dh) * Dm ** (-0.5)), 'Wk': _w((lambda *s: torch.randn(*s, dtype=torch.bfloat16) * 0.8)(Dm, H, Dh) * Dm ** (-0.5)), 'Wv': _w((lambda *s: torch.randn(*s, dtype=torch.bfloat16) * 0.8)(Dm, H, Dh) * Dm ** (-0.5)), 'Wo': _w((lambda *s: torch.randn(*s, dtype=torch.bfloat16) * 0.8)(H, Dh, Dm) * (H * Dh) ** (-0.5)), 'seg_len': seg}
    _A_in = _A_setup()

    def _B_setup():
        B, S, D, F = (1, 2048, 640, 1536)
        return {'x': _w((lambda *s: torch.randn(*s, dtype=torch.bfloat16) * 0.05)(B, S, D)), 'w1': _w((lambda *s: torch.randn(*s, dtype=torch.bfloat16) * 1.6)(D, F) * D ** (-0.5)), 'b1': _w((lambda *s: torch.randn(*s, dtype=torch.bfloat16) * 0.4)(F)), 'w2': _w((lambda *s: torch.randn(*s, dtype=torch.bfloat16) * 0.2)(F, D) * F ** (-0.5)), 'b2': _w((lambda *s: torch.randn(*s, dtype=torch.bfloat16) * 0.2)(D))}
    _B_in = _B_setup()
    return {'A_x': _A_in['x'], 'A_mem0': _A_in['mem0'], 'A_Wq': _A_in['Wq'], 'A_Wk': _A_in['Wk'], 'A_Wv': _A_in['Wv'], 'A_Wo': _A_in['Wo'], 'A_seg_len': _A_in['seg_len'], 'B_x': _B_in['x'], 'B_w1': _B_in['w1'], 'B_b1': _B_in['b1'], 'B_w2': _B_in['w2'], 'B_b2': _B_in['b2']}

def reference(A_x, A_mem0, A_Wq, A_Wk, A_Wv, A_Wo, A_seg_len, B_x, B_w1, B_b1, B_w2, B_b2):

    def _A_ref(x, mem0, Wq, Wk, Wv, Wo, seg_len):
        B, S, Dm = x.shape
        H, Dh = (Wq.shape[1], Wq.shape[2])
        M = mem0.shape[1]
        scale = Dh ** (-0.5)
        n_seg = S // seg_len
        L = M + seg_len
        idx = torch.arange(L)
        mask = (idx[:, None] < M) | (idx[:, None] >= idx[None, :])
        mem = mem0
        outs = []
        for s in range(n_seg):
            xs = x[:, s * seg_len:(s + 1) * seg_len, :].clone()
            h = torch.concatenate([mem, xs], axis=1)
            q = torch.einsum('btd,dhe->bhte', h, Wq)
            k = torch.einsum('btd,dhe->bhte', h, Wk)
            v = torch.einsum('btd,dhe->bhte', h, Wv)
            scores = torch.einsum('bhqe,bhke->bhqk', q, k) * scale
            scores = torch.where(mask[None, None], scores, -1000000000.0)
            p = _softmax(scores, axis=-1)
            o = torch.einsum('bhqk,bhke->bhqe', p, v)
            o = torch.einsum('bhte,hed->btd', o, Wo)
            mem = o[:, :M, :].clone()
            outs.append(o[:, M:, :])
        return torch.concatenate(outs, axis=1)

    def _B_ref(x, w1, b1, w2, b2):
        y = _layernorm(x, axis=-1)
        h = _gelu(torch.einsum('bsd,df->bsf', y, w1) + b1)
        return torch.einsum('bsf,fd->bsd', h, w2) + b2
    x = A_x
    xn = _layernorm(x, axis=-1)
    s = _A_ref(xn, A_mem0, A_Wq, A_Wk, A_Wv, A_Wo, A_seg_len)
    g = _silu(_B_ref(xn, B_w1, B_b1, B_w2, B_b2))
    return x + s * g
```

```asm
; @launch kernel=recurrent_scan__memory_aug_recurrent_mem_tr__mixer_channel_mlp__prompt_kernel grid=(256,1,1) block=(256,1,1) lds=141312
.amdgcn_target "amdgcn-amd-amdhsa--gfx950"
.text
.p2align 8
.globl recurrent_scan__memory_aug_recurrent_mem_tr__mixer_channel_mlp__prompt_kernel
.type recurrent_scan__memory_aug_recurrent_mem_tr__mixer_channel_mlp__prompt_kernel,@function
recurrent_scan__memory_aug_recurrent_mem_tr__mixer_channel_mlp__prompt_kernel:
    s_cmp_ge_u32 s2, 256
    s_cbranch_scc1 rec_done
    s_load_dwordx2 s[8:9], s[0:1], 104
    s_waitcnt lgkmcnt(0)
    s_and_b32 s9, s9, 0xffff
    s_mov_b32 s10, 0x100
    s_mov_b32 s11, 0x00020000
    s_getpc_b64 s[4:5]
Lpc0:
    s_sub_u32 s4, s4, Lpc0-recurrent_scan__memory_aug_recurrent_mem_tr__mixer_channel_mlp__prompt_kernel
    s_subb_u32 s5, s5, 0
    s_and_b32 s5, s5, 0xffff
    s_mov_b32 s6, code_end-recurrent_scan__memory_aug_recurrent_mem_tr__mixer_channel_mlp__prompt_kernel
    s_mov_b32 s7, 0x00020000
    v_lshlrev_b32 v3, 4, v0
    s_lshr_b32 s3, s2, 3
    s_lshl_b32 s3, s3, 12
    buffer_load_dwordx4 v[4:7], v3, s[4:7], s3 offen
    s_cmp_lg_u32 s2, 0
    s_cbranch_scc1 m_rot
    s_getreg_b32 s3, hwreg(HW_REG_XCC_ID)
    s_and_b32 s3, s3, 7
    s_add_u32 s3, s3, 1
    v_mov_b32 v1, 0x7f000000
    v_cmp_eq_u32 vcc, 0, v0
    s_nop 1
    v_cndmask_b32 v1, v1, v0, vcc
    v_mov_b32 v2, s3
    buffer_store_dword v2, v1, s[8:11], 0 offen offset:128 sc1
    s_nop 0
m_rot:
    v_mov_b32 v1, 0
    s_mov_b32 s3, 0
    s_nop 0
wc_1:
    buffer_load_dword v2, v1, s[8:11], 0 offen offset:128 sc1
    s_add_u32 s3, s3, 1
    s_cmp_gt_u32 s3, 2097152
    s_cbranch_scc1 rec_fail
    s_waitcnt vmcnt(0)
    v_cmp_gt_u32 vcc, 1, v2
    s_cbranch_vccz wcd_2
    s_sleep 1
    s_branch wc_1
    s_nop 1
wcd_2:
    v_readfirstlane_b32 s3, v2
    s_nop 0
    s_add_u32 s3, s3, s2
    s_sub_u32 s3, s3, 1
    s_and_b32 s3, s3, 7
    s_andn2_b32 s2, s2, 7
    s_or_b32 s2, s2, s3
    s_and_b32 s100, s2, 3
    s_lshr_b32 s101, s2, 3
    s_mov_b32 s96, 0
    s_mov_b32 s97, -1
    s_mov_b32 s99, -1
    s_lshl_b32 s98, s2, 10
    s_add_u32 s98, s98, 0xe400000
    s_mov_b32 s87, 0
    s_mov_b32 s86, 0
    s_mov_b32 s85, 0
    s_mov_b32 s80, 0
    s_movk_i32 s81, 0xff
    s_bitcmp1_b32 s2, 2
    s_cbranch_scc0 m_iod0
    s_mov_b32 s77, 0
    s_mov_b32 s79, 0
    s_lshr_b32 s3, s101, 3
    s_cmp_eq_u32 s3, 0
    s_cbranch_scc0 Lskip_3
    s_mov_b32 s82, 0x18144405
    s_mov_b32 s83, 0x3a120228
    s_mov_b32 s84, 0xffffffff
    s_mov_b32 s78, 0x0
Lskip_3:
    s_cmp_eq_u32 s3, 1
    s_cbranch_scc0 Lskip_4
    s_mov_b32 s82, 0x2c1c8405
    s_mov_b32 s83, 0x321a0320
    s_mov_b32 s84, 0xffffffff
    s_mov_b32 s78, 0x0
Lskip_4:
    s_cmp_eq_u32 s3, 2
    s_cbranch_scc0 Lskip_5
    s_mov_b32 s82, 0x1e0e0605
    s_mov_b32 s83, 0x29211911
    s_mov_b32 s84, 0xff223931
    s_mov_b32 s78, 0x0
Lskip_5:
    s_cmp_eq_u32 s3, 3
    s_cbranch_scc0 Lskip_6
    s_mov_b32 s82, 0x24160c05
    s_mov_b32 s83, 0x2a0a3830
    s_mov_b32 s84, 0xffffffff
    s_mov_b32 s78, 0x0
Lskip_6:
    s_branch w_loop
m_iod0:
    s_lshl_b32 s97, s101, 2
    s_add_u32 s97, s97, s100
    s_cmp_lt_u32 s101, 28
    s_cbranch_scc1 rec_entry
    s_sub_u32 s101, s97, 112
    s_mov_b32 s97, -3
    s_branch m_loop
w_next:
    s_cmp_lt_u32 s97, 112
    s_cbranch_scc1 rec_entry
    s_add_u32 s96, s96, 1
    s_cmp_eq_u32 s97, -3
    s_cbranch_scc0 w_loop
m_loop:
    s_mov_b32 s87, 0
    s_cmp_ge_u32 s96, 4
    s_cbranch_scc1 rec_done
    s_and_b32 s3, s101, 7
    s_lshl_b32 s4, s96, 3
    s_add_u32 s5, s3, s4
    s_cmp_lt_u32 s101, 8
    s_cbranch_scc0 m_hi
    s_add_u32 s2, s5, 1016
    s_cmp_eq_u32 s96, 0
    s_cbranch_scc0 Lskip_7
    s_add_u32 s2, s3, 768
Lskip_7:
    s_mov_b32 s99, s2
    s_branch g_common
m_hi:
    s_add_u32 s2, s5, 776
    s_cmp_eq_u32 s96, 3
    s_cbranch_scc0 Lskip_8
    s_add_u32 s2, s3, 1048
Lskip_8:
    s_mov_b32 s99, s2
    s_branch g_common
w_loop:
    s_cmp_eq_u32 s77, 0
    s_cbranch_scc1 w_ent
    s_sub_u32 s77, s77, 1
    s_branch w_d4
w_ent:
    s_and_b32 s3, s82, 0xff
    s_lshr_b64 s[82:83], s[82:83], 8
    s_lshl_b32 s4, s84, 24
    s_or_b32 s83, s83, s4
    s_lshr_b32 s84, s84, 8
    s_or_b32 s84, s84, 0xff000000
    s_and_b32 s81, s82, 0xff
    s_cmp_eq_u32 s3, 0xff
    s_cbranch_scc1 w_d4
    s_and_b32 s77, s78, 3
    s_lshr_b32 s78, s78, 2
    s_cmp_lg_u32 s77, 0
    s_cselect_b32 s81, 0xff, s81
    s_lshl_b32 s5, s100, 3
    s_and_b32 s4, s101, 7
    s_add_u32 s5, s5, s4
    s_lshr_b32 s87, s3, 6
    s_bfe_u32 s4, s3, 0x30003
    s_lshl_b32 s4, s4, 5
    s_add_u32 s2, s5, s4
    s_mov_b32 s85, 0
    s_and_b32 s3, s3, 7
    s_cmp_ge_u32 s3, 3
    s_cbranch_scc1 w_oth
    s_lshl_b32 s4, s3, 8
    s_add_u32 s2, s2, s4
    s_mov_b32 s99, s2
    s_cmp_eq_u32 s80, 1
    s_cbranch_scc1 g_warm
    s_branch g_common
w_oth:
    s_cmp_eq_u32 s3, 5
    s_cbranch_scc1 w_ln
    s_add_u32 s2, s5, 800
    s_mov_b32 s99, s2
    s_cmp_eq_u32 s3, 3
    s_cbranch_scc1 g_common
    s_bfe_u32 s85, s4, 0x10005
    s_add_u32 s85, s85, 1
    s_lshr_b32 s4, s4, 6
    s_lshl_b32 s4, s4, 5
    s_sub_u32 s3, s3, 4
    s_lshl_b32 s3, s3, 7
    s_add_u32 s2, s5, s3
    s_add_u32 s2, s2, s4
    s_mov_b32 s99, s2
    s_branch g_common
w_ln:
    s_lshr_b32 s3, s101, 3
    s_cmp_ge_u32 s3, 2
    s_cselect_b32 s4, 1, 0
    s_xor_b32 s3, s3, s4
    s_lshl_b32 s3, s3, 5
    s_add_u32 s2, s3, s5
    s_add_u32 s99, s2, 8192
    s_branch ln_entry
w_skip:
    s_add_u32 s96, s96, 1
    s_branch w_loop
w_d4:
    s_lshl_b32 s3, s100, 5
    s_add_u32 s3, s3, s101
    s_mov_b32 s4, s79
    s_add_u32 s79, s79, 1
    s_mul_i32 s4, s4, 128
    s_add_u32 s3, s3, s4
    s_cmp_lt_u32 s3, 1152
    s_cbranch_scc0 w_last
    s_mul_i32 s4, s3, 3641
    s_lshr_b32 s4, s4, 16
    s_mul_i32 s5, s4, 18
    s_sub_u32 s5, s3, s5
    s_cmp_lt_u32 s5, 8
    s_cbranch_scc0 w_pb
    s_cmp_ge_u32 s4, 57
    s_cbranch_scc1 w_skip
    s_lshl_b32 s2, s4, 3
    s_add_u32 s2, s2, s5
    s_add_u32 s99, s2, 2048
    s_branch pa_entry
w_pb:
    s_cmp_lt_u32 s4, 7
    s_cbranch_scc1 w_skip
    s_mul_i32 s2, s4, 10
    s_add_u32 s2, s2, s5
    s_sub_u32 s2, s2, 78
    s_add_u32 s99, s2, 4096
    s_branch pb_entry
w_last:
    s_sub_u32 s3, s3, 1152
w_last2:
    s_cmp_lt_u32 s3, 126
    s_cbranch_scc0 rec_done
    s_add_u32 s2, s3, 456
    s_add_u32 s99, s2, 2048
    s_cmp_lt_u32 s3, 56
    s_cbranch_scc1 pa_entry
    s_add_u32 s2, s3, 514
    s_add_u32 s99, s2, 4096
    s_branch pb_entry
g_common:
    s_mov_b32 s80, 0
    s_load_dwordx2 s[24:25], s[0:1], 16
    s_load_dwordx2 s[26:27], s[0:1], 24
    s_load_dwordx2 s[28:29], s[0:1], 32
    s_load_dwordx2 s[30:31], s[0:1], 64
    s_load_dwordx2 s[32:33], s[0:1], 80
    s_load_dwordx2 s[34:35], s[0:1], 72
    s_load_dwordx2 s[36:37], s[0:1], 88
    s_load_dwordx2 s[8:9], s[0:1], 112
    s_load_dwordx2 s[16:17], s[0:1], 40
    s_load_dwordx2 s[64:65], s[0:1], 104
    s_waitcnt lgkmcnt(0)
    s_and_b32 s9, s9, 0xffff
    s_mov_b32 s10, 0x10000000
    s_mov_b32 s11, 0x00020000
    s_and_b32 s17, s17, 0xffff
    s_mov_b32 s18, 0x780000
    s_mov_b32 s19, 0x00020000
    s_and_b32 s65, s65, 0xffff
    s_mov_b32 s66, 0x100
    s_mov_b32 s67, 0x00020000
    s_mov_b32 s15, 0x00020000
    s_mov_b32 s23, 0x00020000
    s_mov_b32 s63, 0x00020000
    v_and_b32 v1, 63, v0
    v_lshrrev_b32 v2, 6, v0
    s_nop 0
    v_readfirstlane_b32 s55, v2
    s_and_b32 s53, s2, 255
    s_and_b32 s41, s53, 31
    s_lshr_b32 s42, s53, 5
    s_lshr_b32 s40, s2, 8
    s_mov_b32 s43, 12288
    s_mov_b32 s14, 0x780000
    s_mov_b32 s59, 20
    s_mov_b32 s49, 0x0
    s_mov_b32 s57, 0x7f000000
    s_mov_b64 s[20:21], s[34:35]
    s_mov_b32 s22, 0xc00
    s_mov_b64 s[12:13], s[28:29]
    s_mul_i32 s58, s41, 384
    s_cmp_eq_u32 s40, 0
    s_cbranch_scc0 g_dec1
    s_mul_i32 s57, s41, 245760
    s_branch g_dec_done
g_dec1:
    s_mov_b64 s[12:13], s[26:27]
    s_cmp_eq_u32 s40, 1
    s_cbranch_scc1 g_dec_done
    s_mov_b64 s[12:13], s[24:25]
    s_cmp_eq_u32 s40, 2
    s_cbranch_scc1 g_dec_done
    s_cmp_ge_u32 s2, 1024
    s_cbranch_scc1 g_dec_mb
    s_cmp_ge_u32 s2, 832
    s_cbranch_scc1 g_dec_vm
    s_mov_b32 s40, 3
    s_and_b32 s41, s2, 7
    s_bfe_u32 s42, s2, 0x30003
    s_mul_i32 s58, s41, 384
    s_mov_b32 s43, 3072
    s_mov_b64 s[12:13], s[30:31]
    s_mov_b32 s14, 0x1e0000
    s_mov_b32 s49, 0x280000
    s_branch g_dec_done
g_dec_mb:
    s_mov_b32 s40, 5
    s_and_b32 s41, s2, 3
    s_bfe_u32 s42, s2, 0x30002
    s_mul_i32 s58, s41, 384
    s_min_u32 s58, s58, 896
    s_mov_b32 s43, 1280
    s_mov_b64 s[12:13], s[32:33]
    s_mov_b32 s14, 0x1e0000
    s_mov_b32 s49, 0x800000
    s_mov_b32 s59, 48
    s_mov_b64 s[20:21], s[36:37]
    s_mov_b32 s22, 0x500
    v_and_b32 v4, 7, v0
    v_lshlrev_b32 v4, 2, v4
    s_lshl_b32 s53, s42, 7
    s_add_u32 s53, s53, 0xe281800
    s_mov_b32 s54, 0
wf_9:
    buffer_load_dword v5, v4, s[8:11], s53 offen sc1
    s_add_u32 s54, s54, 1
    s_cmp_gt_u32 s54, 2097152
    s_cbranch_scc1 rec_fail
    s_waitcnt vmcnt(0)
    v_cmp_eq_u32 vcc, 0, v5
    s_cbranch_vccz wfd_10
    s_sleep 4
    s_branch wf_9
    s_nop 1
wfd_10:
    s_branch g_dec_done
g_dec_vm:
    s_mov_b32 s40, 4
    s_sub_u32 s53, s2, 832
    s_and_b32 s41, s53, 31
    s_lshr_b32 s42, s53, 5
    s_mul_i32 s58, s41, 384
    s_mov_b64 s[12:13], s[28:29]
    s_mul_i32 s57, s41, 245760
g_dec_done:
    s_and_b32 s13, s13, 0xffff
    s_and_b32 s21, s21, 0xffff
    v_lshrrev_b32 v24, 4, v1
    v_bfe_u32 v25, v1, 2, 2
    v_and_b32 v26, 3, v1
    v_lshl_add_u32 v27, v24, 2, v25
    v_bfe_u32 v28, v27, 1, 2
    v_xor_b32 v29, 0, v28
    v_lshlrev_b32 v29, 5, v29
    v_lshl_add_u32 v29, v26, 3, v29
    v_mul_u32_u24 v30, 384, v27
    v_add_u32 v4, v29, v30
    v_lshl_add_u32 v8, v27, 7, v29
    v_xor_b32 v29, 1, v28
    v_lshlrev_b32 v29, 5, v29
    v_lshl_add_u32 v29, v26, 3, v29
    v_mul_u32_u24 v30, 384, v27
    v_add_u32 v5, v29, v30
    v_lshl_add_u32 v9, v27, 7, v29
    v_xor_b32 v29, 2, v28
    v_lshlrev_b32 v29, 5, v29
    v_lshl_add_u32 v29, v26, 3, v29
    v_mul_u32_u24 v30, 384, v27
    v_add_u32 v6, v29, v30
    v_lshl_add_u32 v10, v27, 7, v29
    v_xor_b32 v29, 3, v28
    v_lshlrev_b32 v29, 5, v29
    v_lshl_add_u32 v29, v26, 3, v29
    v_mul_u32_u24 v30, 384, v27
    v_add_u32 v7, v29, v30
    v_lshl_add_u32 v11, v27, 7, v29
    v_add_u32 v29, 0, v0
    v_mul_u32_u24 v30, 2731, v29
    v_lshrrev_b32 v30, 16, v30
    v_mul_u32_u24 v31, 24, v30
    v_sub_u32 v31, v29, v31
    v_lshrrev_b32 v32, 1, v31
    v_bfe_u32 v33, v30, 1, 2
    v_xor_b32 v32, v32, v33
    v_lshlrev_b32 v32, 5, v32
    v_and_b32 v31, 1, v31
    v_lshl_add_u32 v32, v31, 4, v32
    v_mul_lo_u32 v30, v30, s43
    v_add_u32 v12, v30, v32
    v_mov_b32 v56, v12
    v_add_u32 v29, 256, v0
    v_mul_u32_u24 v30, 2731, v29
    v_lshrrev_b32 v30, 16, v30
    v_mul_u32_u24 v31, 24, v30
    v_sub_u32 v31, v29, v31
    v_lshrrev_b32 v32, 1, v31
    v_bfe_u32 v33, v30, 1, 2
    v_xor_b32 v32, v32, v33
    v_lshlrev_b32 v32, 5, v32
    v_and_b32 v31, 1, v31
    v_lshl_add_u32 v32, v31, 4, v32
    v_mul_lo_u32 v30, v30, s43
    v_add_u32 v13, v30, v32
    v_mov_b32 v57, v13
    v_add_u32 v29, 512, v0
    v_mul_u32_u24 v30, 2731, v29
    v_lshrrev_b32 v30, 16, v30
    v_mul_u32_u24 v31, 24, v30
    v_sub_u32 v31, v29, v31
    v_lshrrev_b32 v32, 1, v31
    v_bfe_u32 v33, v30, 1, 2
    v_xor_b32 v32, v32, v33
    v_lshlrev_b32 v32, 5, v32
    v_and_b32 v31, 1, v31
    v_lshl_add_u32 v32, v31, 4, v32
    v_mul_lo_u32 v30, v30, s43
    v_add_u32 v14, v30, v32
    v_mov_b32 v58, v14
    v_lshrrev_b32 v29, 3, v0
    v_mul_u32_u24 v29, 1280, v29
    v_bfe_u32 v30, v1, 1, 2
    v_xor_b32 v30, v30, v24
    v_lshl_add_u32 v29, v30, 5, v29
    v_and_b32 v30, 1, v1
    v_lshl_add_u32 v15, v30, 4, v29
    v_lshlrev_b32 v3, 4, v1
    s_lshl_b32 s53, s59, 10
    v_mov_b32 v16, v3
    v_add_u32 v17, s53, v16
    v_add_u32 v18, s53, v17
    v_add_u32 v19, s53, v18
    v_mov_b32 v20, v3
    v_add_u32 v21, 1310720, v3
    s_cmp_eq_u32 s85, 0
    s_cselect_b32 s68, 2, 1
    s_lshl_b32 s69, s42, 4
    s_cmp_eq_u32 s85, 2
    s_cselect_b32 s53, 8, 0
    s_add_u32 s69, s69, s53
    s_lshl_b32 s54, s55, s68
    s_add_u32 s69, s69, s54
    s_lshl_b32 s53, s59, 10
    s_mul_i32 s54, s69, s53
    s_add_u32 s49, s49, s54
    s_add_u32 s71, s49, s53
    s_lshl_b32 s50, s69, 4
    s_add_u32 s50, s50, s41
    s_mul_i32 s50, s50, 40960
    s_add_u32 s50, s50, 0x4000000
    s_mov_b32 s51, 0x7f000000
    s_mul_i32 s57, s41, 245760
    s_mov_b32 s56, 5
    s_cmp_eq_u32 s87, 1
    s_cselect_b32 s56, 3, s56
    s_cmp_eq_u32 s87, 2
    s_cbranch_scc0 Lskip_11
    s_mov_b32 s56, 2
    s_add_u32 s57, s57, 768
    s_add_u32 s50, s50, 24576
Lskip_11:
    s_lshl_b32 s74, s56, 1
    s_cmp_eq_u32 s40, 0
    s_cselect_b32 s74, s74, 0
    s_lshr_b32 s44, s59, 2
    s_mov_b32 s70, 0
    s_lshl_b32 s52, s55, 10
    s_mov_b32 s60, s12
    s_mov_b32 s61, s13
    s_mov_b32 s62, s14
    s_mov_b32 s45, s58
    s_lshl_b32 s46, s43, 5
    s_lshl_b32 s47, s43, 6
    s_lshr_b32 s48, s59, 1
    s_and_b32 s73, s81, 7
    s_cmp_gt_u32 s40, 2
    s_cselect_b32 s73, 7, s73
    s_cmp_lg_u32 s85, 0
    s_cselect_b32 s73, 7, s73
    s_bfe_u32 s53, s81, 0x30003
    s_lshl_b32 s53, s53, 4
    s_lshl_b32 s54, s55, 2
    s_add_u32 s53, s53, s54
    s_mul_i32 s72, s53, 20480
    s_nop 0
    s_cmp_lt_u32 s73, 3
    s_cbranch_scc0 Lnx_12
    s_mov_b64 s[12:13], s[28:29]
    s_cmp_eq_u32 s73, 1
    s_cselect_b64 s[12:13], s[26:27], s[12:13]
    s_cmp_eq_u32 s73, 2
    s_cselect_b64 s[12:13], s[24:25], s[12:13]
    s_and_b32 s13, s13, 0xffff
Lnx_12:
    s_cmp_lg_u32 s48, 0
    s_cbranch_scc1 Lsw_13
    s_cmp_lg_u32 s74, 0
    s_cbranch_scc0 Lsw2_14
    v_mov_b32 v12, v15
    v_add_u32 v13, 40960, v15
    v_add_u32 v14, 81920, v15
    s_mov_b32 s60, s16
    s_mov_b32 s61, s17
    s_mov_b32 s62, s18
    s_mov_b32 s45, s57
    s_mov_b32 s46, 122880
    s_mov_b32 s47, 128
    s_mov_b32 s48, s74
    s_mov_b32 s74, 0
    s_branch Lsw_13
Lsw2_14:
    v_mov_b32 v12, v56
    v_mov_b32 v13, v57
    v_mov_b32 v14, v58
    s_mov_b32 s60, s12
    s_mov_b32 s61, s13
    s_mov_b32 s62, s14
    s_cmp_lt_u32 s73, 3
    s_cselect_b32 s45, s58, 0x7f000000
    s_mov_b32 s46, 393216
    s_mov_b32 s47, 786432
    s_mov_b32 s48, 10
Lsw_13:
    s_add_u32 s53, s45, s46
    s_mov_b32 m0, s52
    s_nop 0
    buffer_load_dwordx4 v12, s[60:63], s45 offen lds
    s_add_u32 m0, m0, 4096
    s_nop 0
    buffer_load_dwordx4 v13, s[60:63], s45 offen lds
    s_add_u32 m0, m0, 4096
    s_nop 0
    buffer_load_dwordx4 v14, s[60:63], s45 offen lds
    s_add_u32 m0, m0, 4096
    s_nop 0
    buffer_load_dwordx4 v12, s[60:63], s53 offen lds
    s_add_u32 m0, m0, 4096
    s_nop 0
    buffer_load_dwordx4 v13, s[60:63], s53 offen lds
    s_add_u32 m0, m0, 4096
    s_nop 0
    buffer_load_dwordx4 v14, s[60:63], s53 offen lds
    s_add_u32 s45, s45, s47
    s_sub_u32 s48, s48, 1
    s_add_u32 s52, s52, 24576
    s_cmp_ge_u32 s52, 98304
    s_cselect_b32 s53, 98304, 0
    s_sub_u32 s52, s52, s53
    s_cmp_lg_u32 s48, 0
    s_cbranch_scc1 Lsw_15
    s_cmp_lg_u32 s74, 0
    s_cbranch_scc0 Lsw2_16
    v_mov_b32 v12, v15
    v_add_u32 v13, 40960, v15
    v_add_u32 v14, 81920, v15
    s_mov_b32 s60, s16
    s_mov_b32 s61, s17
    s_mov_b32 s62, s18
    s_mov_b32 s45, s57
    s_mov_b32 s46, 122880
    s_mov_b32 s47, 128
    s_mov_b32 s48, s74
    s_mov_b32 s74, 0
    s_branch Lsw_15
Lsw2_16:
    v_mov_b32 v12, v56
    v_mov_b32 v13, v57
    v_mov_b32 v14, v58
    s_mov_b32 s60, s12
    s_mov_b32 s61, s13
    s_mov_b32 s62, s14
    s_cmp_lt_u32 s73, 3
    s_cselect_b32 s45, s58, 0x7f000000
    s_mov_b32 s46, 393216
    s_mov_b32 s47, 786432
    s_mov_b32 s48, 10
Lsw_15:
    s_add_u32 s53, s45, s46
    s_mov_b32 m0, s52
    s_nop 0
    buffer_load_dwordx4 v12, s[60:63], s45 offen lds
    s_add_u32 m0, m0, 4096
    s_nop 0
    buffer_load_dwordx4 v13, s[60:63], s45 offen lds
    s_add_u32 m0, m0, 4096
    s_nop 0
    buffer_load_dwordx4 v14, s[60:63], s45 offen lds
    s_add_u32 m0, m0, 4096
    s_nop 0
    buffer_load_dwordx4 v12, s[60:63], s53 offen lds
    s_add_u32 m0, m0, 4096
    s_nop 0
    buffer_load_dwordx4 v13, s[60:63], s53 offen lds
    s_add_u32 m0, m0, 4096
    s_nop 0
    buffer_load_dwordx4 v14, s[60:63], s53 offen lds
    s_add_u32 s45, s45, s47
    s_sub_u32 s48, s48, 1
    s_add_u32 s52, s52, 24576
    s_cmp_ge_u32 s52, 98304
    s_cselect_b32 s53, 98304, 0
    s_sub_u32 s52, s52, s53
    s_cmp_lg_u32 s48, 0
    s_cbranch_scc1 Lsw_17
    s_cmp_lg_u32 s74, 0
    s_cbranch_scc0 Lsw2_18
    v_mov_b32 v12, v15
    v_add_u32 v13, 40960, v15
    v_add_u32 v14, 81920, v15
    s_mov_b32 s60, s16
    s_mov_b32 s61, s17
    s_mov_b32 s62, s18
    s_mov_b32 s45, s57
    s_mov_b32 s46, 122880
    s_mov_b32 s47, 128
    s_mov_b32 s48, s74
    s_mov_b32 s74, 0
    s_branch Lsw_17
Lsw2_18:
    v_mov_b32 v12, v56
    v_mov_b32 v13, v57
    v_mov_b32 v14, v58
    s_mov_b32 s60, s12
    s_mov_b32 s61, s13
    s_mov_b32 s62, s14
    s_cmp_lt_u32 s73, 3
    s_cselect_b32 s45, s58, 0x7f000000
    s_mov_b32 s46, 393216
    s_mov_b32 s47, 786432
    s_mov_b32 s48, 10
Lsw_17:
    s_add_u32 s53, s45, s46
    s_mov_b32 m0, s52
    s_nop 0
    buffer_load_dwordx4 v12, s[60:63], s45 offen lds
    s_add_u32 m0, m0, 4096
    s_nop 0
    buffer_load_dwordx4 v13, s[60:63], s45 offen lds
    s_add_u32 m0, m0, 4096
    s_nop 0
    buffer_load_dwordx4 v14, s[60:63], s45 offen lds
    s_add_u32 m0, m0, 4096
    s_nop 0
    buffer_load_dwordx4 v12, s[60:63], s53 offen lds
    s_add_u32 m0, m0, 4096
    s_nop 0
    buffer_load_dwordx4 v13, s[60:63], s53 offen lds
    s_add_u32 m0, m0, 4096
    s_nop 0
    buffer_load_dwordx4 v14, s[60:63], s53 offen lds
    s_add_u32 s45, s45, s47
    s_sub_u32 s48, s48, 1
    s_add_u32 s52, s52, 24576
    s_cmp_ge_u32 s52, 98304
    s_cselect_b32 s53, 98304, 0
    s_sub_u32 s52, s52, s53
    v_mov_b32 v64, 0
    v_mov_b32 v65, 0
    v_mov_b32 v66, 0
    v_mov_b32 v67, 0
    v_mov_b32 v68, 0
    v_mov_b32 v69, 0
    v_mov_b32 v70, 0
    v_mov_b32 v71, 0
    v_mov_b32 v72, 0
    v_mov_b32 v73, 0
    v_mov_b32 v74, 0
    v_mov_b32 v75, 0
    v_mov_b32 v76, 0
    v_mov_b32 v77, 0
    v_mov_b32 v78, 0
    v_mov_b32 v79, 0
    v_mov_b32 v80, 0
    v_mov_b32 v81, 0
    v_mov_b32 v82, 0
    v_mov_b32 v83, 0
    v_mov_b32 v84, 0
    v_mov_b32 v85, 0
    v_mov_b32 v86, 0
    v_mov_b32 v87, 0
    v_mov_b32 v88, 0
    v_mov_b32 v89, 0
    v_mov_b32 v90, 0
    v_mov_b32 v91, 0
    v_mov_b32 v92, 0
    v_mov_b32 v93, 0
    v_mov_b32 v94, 0
    v_mov_b32 v95, 0
    v_mov_b32 v96, 0
    v_mov_b32 v97, 0
    v_mov_b32 v98, 0
    v_mov_b32 v99, 0
    v_mov_b32 v100, 0
    v_mov_b32 v101, 0
    v_mov_b32 v102, 0
    v_mov_b32 v103, 0
    v_mov_b32 v104, 0
    v_mov_b32 v105, 0
    v_mov_b32 v106, 0
    v_mov_b32 v107, 0
    v_mov_b32 v108, 0
    v_mov_b32 v109, 0
    v_mov_b32 v110, 0
    v_mov_b32 v111, 0
    v_mov_b32 v112, 0
    v_mov_b32 v113, 0
    v_mov_b32 v114, 0
    v_mov_b32 v115, 0
    v_mov_b32 v116, 0
    v_mov_b32 v117, 0
    v_mov_b32 v118, 0
    v_mov_b32 v119, 0
    v_mov_b32 v120, 0
    v_mov_b32 v121, 0
    v_mov_b32 v122, 0
    v_mov_b32 v123, 0
    v_mov_b32 v124, 0
    v_mov_b32 v125, 0
    v_mov_b32 v126, 0
    v_mov_b32 v127, 0
    v_mov_b32 v128, 0
    v_mov_b32 v129, 0
    v_mov_b32 v130, 0
    v_mov_b32 v131, 0
    v_mov_b32 v132, 0
    v_mov_b32 v133, 0
    v_mov_b32 v134, 0
    v_mov_b32 v135, 0
    v_mov_b32 v136, 0
    v_mov_b32 v137, 0
    v_mov_b32 v138, 0
    v_mov_b32 v139, 0
    v_mov_b32 v140, 0
    v_mov_b32 v141, 0
    v_mov_b32 v142, 0
    v_mov_b32 v143, 0
    v_mov_b32 v144, 0
    v_mov_b32 v145, 0
    v_mov_b32 v146, 0
    v_mov_b32 v147, 0
    v_mov_b32 v148, 0
    v_mov_b32 v149, 0
    v_mov_b32 v150, 0
    v_mov_b32 v151, 0
    v_mov_b32 v152, 0
    v_mov_b32 v153, 0
    v_mov_b32 v154, 0
    v_mov_b32 v155, 0
    v_mov_b32 v156, 0
    v_mov_b32 v157, 0
    v_mov_b32 v158, 0
    v_mov_b32 v159, 0
    v_mov_b32 v160, 0
    v_mov_b32 v161, 0
    v_mov_b32 v162, 0
    v_mov_b32 v163, 0
    v_mov_b32 v164, 0
    v_mov_b32 v165, 0
    v_mov_b32 v166, 0
    v_mov_b32 v167, 0
    v_mov_b32 v168, 0
    v_mov_b32 v169, 0
    v_mov_b32 v170, 0
    v_mov_b32 v171, 0
    v_mov_b32 v172, 0
    v_mov_b32 v173, 0
    v_mov_b32 v174, 0
    v_mov_b32 v175, 0
    v_mov_b32 v176, 0
    v_mov_b32 v177, 0
    v_mov_b32 v178, 0
    v_mov_b32 v179, 0
    v_mov_b32 v180, 0
    v_mov_b32 v181, 0
    v_mov_b32 v182, 0
    v_mov_b32 v183, 0
    v_mov_b32 v184, 0
    v_mov_b32 v185, 0
    v_mov_b32 v186, 0
    v_mov_b32 v187, 0
    v_mov_b32 v188, 0
    v_mov_b32 v189, 0
    v_mov_b32 v190, 0
    v_mov_b32 v191, 0
    v_mov_b32 v192, 0
    v_mov_b32 v193, 0
    v_mov_b32 v194, 0
    v_mov_b32 v195, 0
    v_mov_b32 v196, 0
    v_mov_b32 v197, 0
    v_mov_b32 v198, 0
    v_mov_b32 v199, 0
    v_mov_b32 v200, 0
    v_mov_b32 v201, 0
    v_mov_b32 v202, 0
    v_mov_b32 v203, 0
    v_mov_b32 v204, 0
    v_mov_b32 v205, 0
    v_mov_b32 v206, 0
    v_mov_b32 v207, 0
    v_mov_b32 v208, 0
    v_mov_b32 v209, 0
    v_mov_b32 v210, 0
    v_mov_b32 v211, 0
    v_mov_b32 v212, 0
    v_mov_b32 v213, 0
    v_mov_b32 v214, 0
    v_mov_b32 v215, 0
    v_mov_b32 v216, 0
    v_mov_b32 v217, 0
    v_mov_b32 v218, 0
    v_mov_b32 v219, 0
    v_mov_b32 v220, 0
    v_mov_b32 v221, 0
    v_mov_b32 v222, 0
    v_mov_b32 v223, 0
    v_mov_b32 v224, 0
    v_mov_b32 v225, 0
    v_mov_b32 v226, 0
    v_mov_b32 v227, 0
    v_mov_b32 v228, 0
    v_mov_b32 v229, 0
    v_mov_b32 v230, 0
    v_mov_b32 v231, 0
    v_mov_b32 v232, 0
    v_mov_b32 v233, 0
    v_mov_b32 v234, 0
    v_mov_b32 v235, 0
    v_mov_b32 v236, 0
    v_mov_b32 v237, 0
    v_mov_b32 v238, 0
    v_mov_b32 v239, 0
    v_mov_b32 v240, 0
    v_mov_b32 v241, 0
    v_mov_b32 v242, 0
    v_mov_b32 v243, 0
    v_mov_b32 v244, 0
    v_mov_b32 v245, 0
    v_mov_b32 v246, 0
    v_mov_b32 v247, 0
    v_mov_b32 v248, 0
    v_mov_b32 v249, 0
    v_mov_b32 v250, 0
    v_mov_b32 v251, 0
    v_mov_b32 v252, 0
    v_mov_b32 v253, 0
    v_mov_b32 v254, 0
    v_mov_b32 v255, 0
    s_cmp_eq_u32 s40, 3
    s_cselect_b32 s53, 0x400, 0
    s_lshl_b32 s54, s42, 7
    s_add_u32 s53, s53, s54
    s_add_u32 s53, s53, 0xe28f000
    s_cmp_lg_u32 s86, 0
    s_cbranch_scc1 g_zok
    v_mov_b32 v29, 0
    s_mov_b32 s54, 0
    s_nop 0
wc_19:
    buffer_load_dword v30, v29, s[64:67], 0 offen offset:4 sc1
    s_add_u32 s54, s54, 1
    s_cmp_gt_u32 s54, 2097152
    s_cbranch_scc1 rec_fail
    s_waitcnt vmcnt(0)
    v_cmp_gt_u32 vcc, 16, v30
    s_cbranch_vccz wcd_20
    s_sleep 4
    s_branch wc_19
    s_nop 1
wcd_20:
    s_mov_b32 s86, 1
g_zok:
    v_and_b32 v29, 15, v0
    v_lshlrev_b32 v29, 2, v29
    s_mov_b32 s54, 0
    s_nop 0
wf_21:
    buffer_load_dword v30, v29, s[8:11], s53 offen sc1
    s_add_u32 s54, s54, 1
    s_cmp_gt_u32 s54, 2097152
    s_cbranch_scc1 rec_fail
    s_waitcnt vmcnt(0)
    v_cmp_eq_u32 vcc, 0, v30
    s_cbranch_vccz wfd_22
    s_sleep 3
    s_branch wf_21
    s_nop 1
wfd_22:
    s_cmp_lt_u32 s73, 3
    s_cbranch_scc0 g_lnok
    v_lshrrev_b32 v31, 4, v1
    v_lshl_add_u32 v29, v31, 7, v29
    s_mov_b32 s53, 0xe28f000
    s_mov_b32 s54, 0
wf_23:
    buffer_load_dword v30, v29, s[8:11], s53 offen sc1
    s_add_u32 s54, s54, 1
    s_cmp_gt_u32 s54, 2097152
    s_cbranch_scc1 rec_fail
    s_waitcnt vmcnt(0)
    v_cmp_eq_u32 vcc, 0, v30
    s_cbranch_vccz wfd_24
    s_sleep 3
    s_branch wf_23
    s_nop 1
wfd_24:
    s_mov_b32 s53, 0xe28f200
    s_mov_b32 s54, 0
wf_25:
    buffer_load_dword v30, v29, s[8:11], s53 offen sc1
    s_add_u32 s54, s54, 1
    s_cmp_gt_u32 s54, 2097152
    s_cbranch_scc1 rec_fail
    s_waitcnt vmcnt(0)
    v_cmp_eq_u32 vcc, 0, v30
    s_cbranch_vccz wfd_26
    s_sleep 3
    s_branch wf_25
    s_nop 1
wfd_26:
g_lnok:
    s_cmp_lg_u32 s85, 0
    s_cbranch_scc1 g_half
    buffer_load_dwordx4 a[32:35], v16, s[8:11], s49 offen sc1
    buffer_load_dwordx4 a[36:39], v17, s[8:11], s49 offen sc1
    buffer_load_dwordx4 a[40:43], v18, s[8:11], s49 offen sc1
    buffer_load_dwordx4 a[44:47], v19, s[8:11], s49 offen sc1
    s_add_u32 s49, s49, 1024
    s_cmp_eq_u32 s49, s71
    s_cselect_b32 s49, s72, s49
    buffer_load_dwordx4 a[48:51], v16, s[8:11], s49 offen sc1
    buffer_load_dwordx4 a[52:55], v17, s[8:11], s49 offen sc1
    buffer_load_dwordx4 a[56:59], v18, s[8:11], s49 offen sc1
    buffer_load_dwordx4 a[60:63], v19, s[8:11], s49 offen sc1
    s_add_u32 s49, s49, 1024
    s_cmp_eq_u32 s49, s71
    s_cselect_b32 s49, s72, s49
    buffer_load_dwordx4 a[64:67], v16, s[8:11], s49 offen sc1
    buffer_load_dwordx4 a[68:71], v17, s[8:11], s49 offen sc1
    buffer_load_dwordx4 a[72:75], v18, s[8:11], s49 offen sc1
    buffer_load_dwordx4 a[76:79], v19, s[8:11], s49 offen sc1
    s_add_u32 s49, s49, 1024
    s_cmp_eq_u32 s49, s71
    s_cselect_b32 s49, s72, s49
    s_waitcnt vmcnt(0)
    s_barrier
g_go4:
    v_and_b32 v4, 0x3fff, v4
    v_or_b32 v4, s70, v4
    v_and_b32 v5, 0x3fff, v5
    v_or_b32 v5, s70, v5
    v_and_b32 v6, 0x3fff, v6
    v_or_b32 v6, s70, v6
    v_and_b32 v7, 0x3fff, v7
    v_or_b32 v7, s70, v7
    ds_read_b64_tr_b16 a[0:1], v4 offset:0
    ds_read_b64_tr_b16 a[2:3], v4 offset:6144
    ds_read_b64_tr_b16 a[4:5], v5 offset:0
    ds_read_b64_tr_b16 a[6:7], v5 offset:6144
    ds_read_b64_tr_b16 a[8:9], v6 offset:0
    ds_read_b64_tr_b16 a[10:11], v6 offset:6144
    ds_read_b64_tr_b16 a[12:13], v7 offset:0
    ds_read_b64_tr_b16 a[14:15], v7 offset:6144
    ds_read_b64_tr_b16 a[16:17], v4 offset:128
    ds_read_b64_tr_b16 a[18:19], v4 offset:6272
    ds_read_b64_tr_b16 a[20:21], v5 offset:128
    ds_read_b64_tr_b16 a[22:23], v5 offset:6272
    s_and_b32 s53, s44, 1
    s_mul_i32 s53, s53, 0xc000
    s_xor_b32 s70, s70, s53
g_s1_loop4:
    s_waitcnt vmcnt(14) lgkmcnt(10)
    v_mfma_f32_16x16x32_bf16 v[64:67], a[0:3], a[32:35], v[64:67]
    ds_read_b64_tr_b16 a[24:25], v6 offset:128
    buffer_load_dwordx4 a[80:83], v16, s[8:11], s49 offen sc1
    v_mfma_f32_16x16x32_bf16 v[68:71], a[0:3], a[36:39], v[68:71]
    ds_read_b64_tr_b16 a[26:27], v6 offset:6272
    buffer_load_dwordx4 a[84:87], v17, s[8:11], s49 offen sc1
    v_mfma_f32_16x16x32_bf16 v[72:75], a[0:3], a[40:43], v[72:75]
    buffer_load_dwordx4 a[88:91], v18, s[8:11], s49 offen sc1
    buffer_load_dwordx4 a[92:95], v19, s[8:11], s49 offen sc1
    v_mfma_f32_16x16x32_bf16 v[76:79], a[0:3], a[44:47], v[76:79]
    s_add_u32 s49, s49, 1024
    s_waitcnt lgkmcnt(10)
    v_mfma_f32_16x16x32_bf16 v[80:83], a[4:7], a[32:35], v[80:83]
    ds_read_b64_tr_b16 a[28:29], v7 offset:128
    s_cmp_eq_u32 s49, s71
    v_mfma_f32_16x16x32_bf16 v[84:87], a[4:7], a[36:39], v[84:87]
    ds_read_b64_tr_b16 a[30:31], v7 offset:6272
    s_cselect_b32 s49, s72, s49
    v_mfma_f32_16x16x32_bf16 v[88:91], a[4:7], a[40:43], v[88:91]
    v_mfma_f32_16x16x32_bf16 v[92:95], a[4:7], a[44:47], v[92:95]
    s_waitcnt lgkmcnt(10)
    v_mfma_f32_16x16x32_bf16 v[96:99], a[8:11], a[32:35], v[96:99]
    ds_read_b64_tr_b16 a[0:1], v4 offset:256
    v_mfma_f32_16x16x32_bf16 v[100:103], a[8:11], a[36:39], v[100:103]
    ds_read_b64_tr_b16 a[2:3], v4 offset:6400
    v_mfma_f32_16x16x32_bf16 v[104:107], a[8:11], a[40:43], v[104:107]
    v_mfma_f32_16x16x32_bf16 v[108:111], a[8:11], a[44:47], v[108:111]
    s_waitcnt lgkmcnt(10)
    v_mfma_f32_16x16x32_bf16 v[112:115], a[12:15], a[32:35], v[112:115]
    ds_read_b64_tr_b16 a[4:5], v5 offset:256
    v_mfma_f32_16x16x32_bf16 v[116:119], a[12:15], a[36:39], v[116:119]
    ds_read_b64_tr_b16 a[6:7], v5 offset:6400
    v_mfma_f32_16x16x32_bf16 v[120:123], a[12:15], a[40:43], v[120:123]
    v_mfma_f32_16x16x32_bf16 v[124:127], a[12:15], a[44:47], v[124:127]
    s_waitcnt lgkmcnt(10)
    v_mfma_f32_16x16x32_bf16 v[128:131], a[16:19], a[32:35], v[128:131]
    ds_read_b64_tr_b16 a[8:9], v6 offset:256
    v_mfma_f32_16x16x32_bf16 v[132:135], a[16:19], a[36:39], v[132:135]
    ds_read_b64_tr_b16 a[10:11], v6 offset:6400
    v_mfma_f32_16x16x32_bf16 v[136:139], a[16:19], a[40:43], v[136:139]
    v_mfma_f32_16x16x32_bf16 v[140:143], a[16:19], a[44:47], v[140:143]
    s_waitcnt lgkmcnt(10)
    v_mfma_f32_16x16x32_bf16 v[144:147], a[20:23], a[32:35], v[144:147]
    ds_read_b64_tr_b16 a[12:13], v7 offset:256
    v_mfma_f32_16x16x32_bf16 v[148:151], a[20:23], a[36:39], v[148:151]
    ds_read_b64_tr_b16 a[14:15], v7 offset:6400
    v_mfma_f32_16x16x32_bf16 v[152:155], a[20:23], a[40:43], v[152:155]
    v_mfma_f32_16x16x32_bf16 v[156:159], a[20:23], a[44:47], v[156:159]
    s_waitcnt lgkmcnt(10)
    v_mfma_f32_16x16x32_bf16 v[160:163], a[24:27], a[32:35], v[160:163]
    ds_read_b64_tr_b16 a[16:17], v4 offset:12288
    v_mfma_f32_16x16x32_bf16 v[164:167], a[24:27], a[36:39], v[164:167]
    ds_read_b64_tr_b16 a[18:19], v4 offset:18432
    v_mfma_f32_16x16x32_bf16 v[168:171], a[24:27], a[40:43], v[168:171]
    v_mfma_f32_16x16x32_bf16 v[172:175], a[24:27], a[44:47], v[172:175]
    s_waitcnt lgkmcnt(10)
    v_mfma_f32_16x16x32_bf16 v[176:179], a[28:31], a[32:35], v[176:179]
    ds_read_b64_tr_b16 a[20:21], v5 offset:12288
    v_mfma_f32_16x16x32_bf16 v[180:183], a[28:31], a[36:39], v[180:183]
    ds_read_b64_tr_b16 a[22:23], v5 offset:18432
    v_mfma_f32_16x16x32_bf16 v[184:187], a[28:31], a[40:43], v[184:187]
    v_mfma_f32_16x16x32_bf16 v[188:191], a[28:31], a[44:47], v[188:191]
    s_waitcnt lgkmcnt(10)
    v_mfma_f32_16x16x32_bf16 v[192:195], a[0:3], a[32:35], v[192:195]
    ds_read_b64_tr_b16 a[24:25], v6 offset:12288
    v_mfma_f32_16x16x32_bf16 v[196:199], a[0:3], a[36:39], v[196:199]
    ds_read_b64_tr_b16 a[26:27], v6 offset:18432
    v_mfma_f32_16x16x32_bf16 v[200:203], a[0:3], a[40:43], v[200:203]
    v_mfma_f32_16x16x32_bf16 v[204:207], a[0:3], a[44:47], v[204:207]
    s_waitcnt lgkmcnt(10)
    v_mfma_f32_16x16x32_bf16 v[208:211], a[4:7], a[32:35], v[208:211]
    ds_read_b64_tr_b16 a[28:29], v7 offset:12288
    v_mfma_f32_16x16x32_bf16 v[212:215], a[4:7], a[36:39], v[212:215]
    ds_read_b64_tr_b16 a[30:31], v7 offset:18432
    v_mfma_f32_16x16x32_bf16 v[216:219], a[4:7], a[40:43], v[216:219]
    v_mfma_f32_16x16x32_bf16 v[220:223], a[4:7], a[44:47], v[220:223]
    s_waitcnt lgkmcnt(10)
    v_mfma_f32_16x16x32_bf16 v[224:227], a[8:11], a[32:35], v[224:227]
    ds_read_b64_tr_b16 a[0:1], v4 offset:12416
    v_mfma_f32_16x16x32_bf16 v[228:231], a[8:11], a[36:39], v[228:231]
    ds_read_b64_tr_b16 a[2:3], v4 offset:18560
    v_mfma_f32_16x16x32_bf16 v[232:235], a[8:11], a[40:43], v[232:235]
    v_mfma_f32_16x16x32_bf16 v[236:239], a[8:11], a[44:47], v[236:239]
    s_waitcnt lgkmcnt(10)
    v_mfma_f32_16x16x32_bf16 v[240:243], a[12:15], a[32:35], v[240:243]
    ds_read_b64_tr_b16 a[4:5], v5 offset:12416
    v_mfma_f32_16x16x32_bf16 v[244:247], a[12:15], a[36:39], v[244:247]
    ds_read_b64_tr_b16 a[6:7], v5 offset:18560
    v_mfma_f32_16x16x32_bf16 v[248:251], a[12:15], a[40:43], v[248:251]
    v_mfma_f32_16x16x32_bf16 v[252:255], a[12:15], a[44:47], v[252:255]
    s_barrier
    s_waitcnt vmcnt(14) lgkmcnt(10)
    v_mfma_f32_16x16x32_bf16 v[64:67], a[16:19], a[48:51], v[64:67]
    ds_read_b64_tr_b16 a[8:9], v6 offset:12416
    s_cmp_lg_u32 s48, 0
    s_cbranch_scc1 Lsw_27
    s_cmp_lg_u32 s74, 0
    s_cbranch_scc0 Lsw2_28
    v_mov_b32 v12, v15
    v_add_u32 v13, 40960, v15
    v_add_u32 v14, 81920, v15
    s_mov_b32 s60, s16
    s_mov_b32 s61, s17
    s_mov_b32 s62, s18
    s_mov_b32 s45, s57
    s_mov_b32 s46, 122880
    s_mov_b32 s47, 128
    s_mov_b32 s48, s74
    s_mov_b32 s74, 0
    s_branch Lsw_27
Lsw2_28:
    v_mov_b32 v12, v56
    v_mov_b32 v13, v57
    v_mov_b32 v14, v58
    s_mov_b32 s60, s12
    s_mov_b32 s61, s13
    s_mov_b32 s62, s14
    s_cmp_lt_u32 s73, 3
    s_cselect_b32 s45, s58, 0x7f000000
    s_mov_b32 s46, 393216
    s_mov_b32 s47, 786432
    s_mov_b32 s48, 10
Lsw_27:
    v_mfma_f32_16x16x32_bf16 v[68:71], a[16:19], a[52:55], v[68:71]
    ds_read_b64_tr_b16 a[10:11], v6 offset:18560
    s_add_u32 s53, s45, s46
    v_mfma_f32_16x16x32_bf16 v[72:75], a[16:19], a[56:59], v[72:75]
    s_mov_b32 m0, s52
    s_nop 0
    buffer_load_dwordx4 v12, s[60:63], s45 offen lds
    v_mfma_f32_16x16x32_bf16 v[76:79], a[16:19], a[60:63], v[76:79]
    s_add_u32 m0, m0, 4096
    s_waitcnt lgkmcnt(10)
    v_mfma_f32_16x16x32_bf16 v[80:83], a[20:23], a[48:51], v[80:83]
    ds_read_b64_tr_b16 a[12:13], v7 offset:12416
    buffer_load_dwordx4 v13, s[60:63], s45 offen lds
    v_mfma_f32_16x16x32_bf16 v[84:87], a[20:23], a[52:55], v[84:87]
    ds_read_b64_tr_b16 a[14:15], v7 offset:18560
    s_add_u32 m0, m0, 4096
    v_mfma_f32_16x16x32_bf16 v[88:91], a[20:23], a[56:59], v[88:91]
    buffer_load_dwordx4 v14, s[60:63], s45 offen lds
    s_add_u32 m0, m0, 4096
    v_mfma_f32_16x16x32_bf16 v[92:95], a[20:23], a[60:63], v[92:95]
    buffer_load_dwordx4 v12, s[60:63], s53 offen lds
    s_waitcnt lgkmcnt(10)
    v_mfma_f32_16x16x32_bf16 v[96:99], a[24:27], a[48:51], v[96:99]
    ds_read_b64_tr_b16 a[16:17], v4 offset:12544
    s_add_u32 m0, m0, 4096
    v_mfma_f32_16x16x32_bf16 v[100:103], a[24:27], a[52:55], v[100:103]
    ds_read_b64_tr_b16 a[18:19], v4 offset:18688
    buffer_load_dwordx4 v13, s[60:63], s53 offen lds
    v_mfma_f32_16x16x32_bf16 v[104:107], a[24:27], a[56:59], v[104:107]
    s_add_u32 m0, m0, 4096
    s_nop 0
    buffer_load_dwordx4 v14, s[60:63], s53 offen lds
    v_mfma_f32_16x16x32_bf16 v[108:111], a[24:27], a[60:63], v[108:111]
    s_add_u32 s45, s45, s47
    s_waitcnt lgkmcnt(10)
    v_mfma_f32_16x16x32_bf16 v[112:115], a[28:31], a[48:51], v[112:115]
    ds_read_b64_tr_b16 a[20:21], v5 offset:12544
    s_sub_u32 s48, s48, 1
    v_mfma_f32_16x16x32_bf16 v[116:119], a[28:31], a[52:55], v[116:119]
    ds_read_b64_tr_b16 a[22:23], v5 offset:18688
    s_add_u32 s52, s52, 24576
    v_mfma_f32_16x16x32_bf16 v[120:123], a[28:31], a[56:59], v[120:123]
    s_cmp_ge_u32 s52, 98304
    s_cselect_b32 s53, 98304, 0
    v_mfma_f32_16x16x32_bf16 v[124:127], a[28:31], a[60:63], v[124:127]
    s_sub_u32 s52, s52, s53
    s_waitcnt lgkmcnt(10)
    v_mfma_f32_16x16x32_bf16 v[128:131], a[0:3], a[48:51], v[128:131]
    ds_read_b64_tr_b16 a[24:25], v6 offset:12544
    buffer_load_dwordx4 a[32:35], v16, s[8:11], s49 offen sc1
    v_mfma_f32_16x16x32_bf16 v[132:135], a[0:3], a[52:55], v[132:135]
    ds_read_b64_tr_b16 a[26:27], v6 offset:18688
    buffer_load_dwordx4 a[36:39], v17, s[8:11], s49 offen sc1
    v_mfma_f32_16x16x32_bf16 v[136:139], a[0:3], a[56:59], v[136:139]
    buffer_load_dwordx4 a[40:43], v18, s[8:11], s49 offen sc1
    buffer_load_dwordx4 a[44:47], v19, s[8:11], s49 offen sc1
    v_mfma_f32_16x16x32_bf16 v[140:143], a[0:3], a[60:63], v[140:143]
    s_add_u32 s49, s49, 1024
    s_waitcnt lgkmcnt(10)
    v_mfma_f32_16x16x32_bf16 v[144:147], a[4:7], a[48:51], v[144:147]
    ds_read_b64_tr_b16 a[28:29], v7 offset:12544
    s_cmp_eq_u32 s49, s71
    v_mfma_f32_16x16x32_bf16 v[148:151], a[4:7], a[52:55], v[148:151]
    ds_read_b64_tr_b16 a[30:31], v7 offset:18688
    s_cselect_b32 s49, s72, s49
    v_mfma_f32_16x16x32_bf16 v[152:155], a[4:7], a[56:59], v[152:155]
    v_mfma_f32_16x16x32_bf16 v[156:159], a[4:7], a[60:63], v[156:159]
    s_waitcnt lgkmcnt(10)
    v_mfma_f32_16x16x32_bf16 v[160:163], a[8:11], a[48:51], v[160:163]
    ds_read_b64_tr_b16 a[0:1], v4 offset:24576
    v_mfma_f32_16x16x32_bf16 v[164:167], a[8:11], a[52:55], v[164:167]
    ds_read_b64_tr_b16 a[2:3], v4 offset:30720
    v_mfma_f32_16x16x32_bf16 v[168:171], a[8:11], a[56:59], v[168:171]
    v_mfma_f32_16x16x32_bf16 v[172:175], a[8:11], a[60:63], v[172:175]
    s_waitcnt lgkmcnt(10)
    v_mfma_f32_16x16x32_bf16 v[176:179], a[12:15], a[48:51], v[176:179]
    ds_read_b64_tr_b16 a[4:5], v5 offset:24576
    v_mfma_f32_16x16x32_bf16 v[180:183], a[12:15], a[52:55], v[180:183]
    ds_read_b64_tr_b16 a[6:7], v5 offset:30720
    v_mfma_f32_16x16x32_bf16 v[184:187], a[12:15], a[56:59], v[184:187]
    v_mfma_f32_16x16x32_bf16 v[188:191], a[12:15], a[60:63], v[188:191]
    s_waitcnt lgkmcnt(10)
    v_mfma_f32_16x16x32_bf16 v[192:195], a[16:19], a[48:51], v[192:195]
    ds_read_b64_tr_b16 a[8:9], v6 offset:24576
    v_mfma_f32_16x16x32_bf16 v[196:199], a[16:19], a[52:55], v[196:199]
    ds_read_b64_tr_b16 a[10:11], v6 offset:30720
    v_mfma_f32_16x16x32_bf16 v[200:203], a[16:19], a[56:59], v[200:203]
    v_mfma_f32_16x16x32_bf16 v[204:207], a[16:19], a[60:63], v[204:207]
    s_waitcnt lgkmcnt(10)
    v_mfma_f32_16x16x32_bf16 v[208:211], a[20:23], a[48:51], v[208:211]
    ds_read_b64_tr_b16 a[12:13], v7 offset:24576
    v_mfma_f32_16x16x32_bf16 v[212:215], a[20:23], a[52:55], v[212:215]
    ds_read_b64_tr_b16 a[14:15], v7 offset:30720
    v_mfma_f32_16x16x32_bf16 v[216:219], a[20:23], a[56:59], v[216:219]
    v_mfma_f32_16x16x32_bf16 v[220:223], a[20:23], a[60:63], v[220:223]
    s_waitcnt lgkmcnt(10)
    v_mfma_f32_16x16x32_bf16 v[224:227], a[24:27], a[48:51], v[224:227]
    ds_read_b64_tr_b16 a[16:17], v4 offset:24704
    v_mfma_f32_16x16x32_bf16 v[228:231], a[24:27], a[52:55], v[228:231]
    ds_read_b64_tr_b16 a[18:19], v4 offset:30848
    v_mfma_f32_16x16x32_bf16 v[232:235], a[24:27], a[56:59], v[232:235]
    v_mfma_f32_16x16x32_bf16 v[236:239], a[24:27], a[60:63], v[236:239]
    s_waitcnt lgkmcnt(10)
    v_mfma_f32_16x16x32_bf16 v[240:243], a[28:31], a[48:51], v[240:243]
    ds_read_b64_tr_b16 a[20:21], v5 offset:24704
    v_mfma_f32_16x16x32_bf16 v[244:247], a[28:31], a[52:55], v[244:247]
    ds_read_b64_tr_b16 a[22:23], v5 offset:30848
    v_mfma_f32_16x16x32_bf16 v[248:251], a[28:31], a[56:59], v[248:251]
    v_mfma_f32_16x16x32_bf16 v[252:255], a[28:31], a[60:63], v[252:255]
    s_waitcnt vmcnt(14) lgkmcnt(10)
    v_mfma_f32_16x16x32_bf16 v[64:67], a[0:3], a[64:67], v[64:67]
    ds_read_b64_tr_b16 a[24:25], v6 offset:24704
    buffer_load_dwordx4 a[48:51], v16, s[8:11], s49 offen sc1
    v_mfma_f32_16x16x32_bf16 v[68:71], a[0:3], a[68:71], v[68:71]
    ds_read_b64_tr_b16 a[26:27], v6 offset:30848
    buffer_load_dwordx4 a[52:55], v17, s[8:11], s49 offen sc1
    v_mfma_f32_16x16x32_bf16 v[72:75], a[0:3], a[72:75], v[72:75]
    buffer_load_dwordx4 a[56:59], v18, s[8:11], s49 offen sc1
    buffer_load_dwordx4 a[60:63], v19, s[8:11], s49 offen sc1
    v_mfma_f32_16x16x32_bf16 v[76:79], a[0:3], a[76:79], v[76:79]
    s_add_u32 s49, s49, 1024
    s_waitcnt lgkmcnt(10)
    v_mfma_f32_16x16x32_bf16 v[80:83], a[4:7], a[64:67], v[80:83]
    ds_read_b64_tr_b16 a[28:29], v7 offset:24704
    s_cmp_eq_u32 s49, s71
    v_mfma_f32_16x16x32_bf16 v[84:87], a[4:7], a[68:71], v[84:87]
    ds_read_b64_tr_b16 a[30:31], v7 offset:30848
    s_cselect_b32 s49, s72, s49
    v_mfma_f32_16x16x32_bf16 v[88:91], a[4:7], a[72:75], v[88:91]
    v_mfma_f32_16x16x32_bf16 v[92:95], a[4:7], a[76:79], v[92:95]
    s_waitcnt lgkmcnt(10)
    v_mfma_f32_16x16x32_bf16 v[96:99], a[8:11], a[64:67], v[96:99]
    ds_read_b64_tr_b16 a[0:1], v4 offset:24832
    v_mfma_f32_16x16x32_bf16 v[100:103], a[8:11], a[68:71], v[100:103]
    ds_read_b64_tr_b16 a[2:3], v4 offset:30976
    v_mfma_f32_16x16x32_bf16 v[104:107], a[8:11], a[72:75], v[104:107]
    v_mfma_f32_16x16x32_bf16 v[108:111], a[8:11], a[76:79], v[108:111]
    s_waitcnt lgkmcnt(10)
    v_mfma_f32_16x16x32_bf16 v[112:115], a[12:15], a[64:67], v[112:115]
    ds_read_b64_tr_b16 a[4:5], v5 offset:24832
    v_mfma_f32_16x16x32_bf16 v[116:119], a[12:15], a[68:71], v[116:119]
    ds_read_b64_tr_b16 a[6:7], v5 offset:30976
    v_mfma_f32_16x16x32_bf16 v[120:123], a[12:15], a[72:75], v[120:123]
    v_mfma_f32_16x16x32_bf16 v[124:127], a[12:15], a[76:79], v[124:127]
    s_waitcnt lgkmcnt(10)
    v_mfma_f32_16x16x32_bf16 v[128:131], a[16:19], a[64:67], v[128:131]
    ds_read_b64_tr_b16 a[8:9], v6 offset:24832
    v_mfma_f32_16x16x32_bf16 v[132:135], a[16:19], a[68:71], v[132:135]
    ds_read_b64_tr_b16 a[10:11], v6 offset:30976
    v_mfma_f32_16x16x32_bf16 v[136:139], a[16:19], a[72:75], v[136:139]
    v_mfma_f32_16x16x32_bf16 v[140:143], a[16:19], a[76:79], v[140:143]
    s_waitcnt lgkmcnt(10)
    v_mfma_f32_16x16x32_bf16 v[144:147], a[20:23], a[64:67], v[144:147]
    ds_read_b64_tr_b16 a[12:13], v7 offset:24832
    v_mfma_f32_16x16x32_bf16 v[148:151], a[20:23], a[68:71], v[148:151]
    ds_read_b64_tr_b16 a[14:15], v7 offset:30976
    v_mfma_f32_16x16x32_bf16 v[152:155], a[20:23], a[72:75], v[152:155]
    v_mfma_f32_16x16x32_bf16 v[156:159], a[20:23], a[76:79], v[156:159]
    s_waitcnt lgkmcnt(10)
    v_mfma_f32_16x16x32_bf16 v[160:163], a[24:27], a[64:67], v[160:163]
    ds_read_b64_tr_b16 a[16:17], v4 offset:36864
    v_mfma_f32_16x16x32_bf16 v[164:167], a[24:27], a[68:71], v[164:167]
    ds_read_b64_tr_b16 a[18:19], v4 offset:43008
    v_mfma_f32_16x16x32_bf16 v[168:171], a[24:27], a[72:75], v[168:171]
    v_mfma_f32_16x16x32_bf16 v[172:175], a[24:27], a[76:79], v[172:175]
    s_waitcnt lgkmcnt(10)
    v_mfma_f32_16x16x32_bf16 v[176:179], a[28:31], a[64:67], v[176:179]
    ds_read_b64_tr_b16 a[20:21], v5 offset:36864
    v_mfma_f32_16x16x32_bf16 v[180:183], a[28:31], a[68:71], v[180:183]
    ds_read_b64_tr_b16 a[22:23], v5 offset:43008
    v_mfma_f32_16x16x32_bf16 v[184:187], a[28:31], a[72:75], v[184:187]
    v_mfma_f32_16x16x32_bf16 v[188:191], a[28:31], a[76:79], v[188:191]
    s_waitcnt lgkmcnt(10)
    v_mfma_f32_16x16x32_bf16 v[192:195], a[0:3], a[64:67], v[192:195]
    ds_read_b64_tr_b16 a[24:25], v6 offset:36864
    v_mfma_f32_16x16x32_bf16 v[196:199], a[0:3], a[68:71], v[196:199]
    ds_read_b64_tr_b16 a[26:27], v6 offset:43008
    v_mfma_f32_16x16x32_bf16 v[200:203], a[0:3], a[72:75], v[200:203]
    v_mfma_f32_16x16x32_bf16 v[204:207], a[0:3], a[76:79], v[204:207]
    s_waitcnt lgkmcnt(10)
    v_mfma_f32_16x16x32_bf16 v[208:211], a[4:7], a[64:67], v[208:211]
    ds_read_b64_tr_b16 a[28:29], v7 offset:36864
    v_mfma_f32_16x16x32_bf16 v[212:215], a[4:7], a[68:71], v[212:215]
    ds_read_b64_tr_b16 a[30:31], v7 offset:43008
    v_mfma_f32_16x16x32_bf16 v[216:219], a[4:7], a[72:75], v[216:219]
    v_mfma_f32_16x16x32_bf16 v[220:223], a[4:7], a[76:79], v[220:223]
    s_waitcnt lgkmcnt(10)
    v_mfma_f32_16x16x32_bf16 v[224:227], a[8:11], a[64:67], v[224:227]
    ds_read_b64_tr_b16 a[0:1], v4 offset:36992
    v_mfma_f32_16x16x32_bf16 v[228:231], a[8:11], a[68:71], v[228:231]
    ds_read_b64_tr_b16 a[2:3], v4 offset:43136
    v_mfma_f32_16x16x32_bf16 v[232:235], a[8:11], a[72:75], v[232:235]
    v_mfma_f32_16x16x32_bf16 v[236:239], a[8:11], a[76:79], v[236:239]
    s_waitcnt lgkmcnt(10)
    v_mfma_f32_16x16x32_bf16 v[240:243], a[12:15], a[64:67], v[240:243]
    ds_read_b64_tr_b16 a[4:5], v5 offset:36992
    v_mfma_f32_16x16x32_bf16 v[244:247], a[12:15], a[68:71], v[244:247]
    ds_read_b64_tr_b16 a[6:7], v5 offset:43136
    v_mfma_f32_16x16x32_bf16 v[248:251], a[12:15], a[72:75], v[248:251]
    v_mfma_f32_16x16x32_bf16 v[252:255], a[12:15], a[76:79], v[252:255]
    s_barrier
    s_waitcnt vmcnt(14) lgkmcnt(10)
    v_mfma_f32_16x16x32_bf16 v[64:67], a[16:19], a[80:83], v[64:67]
    ds_read_b64_tr_b16 a[8:9], v6 offset:36992
    s_cmp_lg_u32 s48, 0
    s_cbranch_scc1 Lsw_29
    s_cmp_lg_u32 s74, 0
    s_cbranch_scc0 Lsw2_30
    v_mov_b32 v12, v15
    v_add_u32 v13, 40960, v15
    v_add_u32 v14, 81920, v15
    s_mov_b32 s60, s16
    s_mov_b32 s61, s17
    s_mov_b32 s62, s18
    s_mov_b32 s45, s57
    s_mov_b32 s46, 122880
    s_mov_b32 s47, 128
    s_mov_b32 s48, s74
    s_mov_b32 s74, 0
    s_branch Lsw_29
Lsw2_30:
    v_mov_b32 v12, v56
    v_mov_b32 v13, v57
    v_mov_b32 v14, v58
    s_mov_b32 s60, s12
    s_mov_b32 s61, s13
    s_mov_b32 s62, s14
    s_cmp_lt_u32 s73, 3
    s_cselect_b32 s45, s58, 0x7f000000
    s_mov_b32 s46, 393216
    s_mov_b32 s47, 786432
    s_mov_b32 s48, 10
Lsw_29:
    v_mfma_f32_16x16x32_bf16 v[68:71], a[16:19], a[84:87], v[68:71]
    ds_read_b64_tr_b16 a[10:11], v6 offset:43136
    s_add_u32 s53, s45, s46
    v_mfma_f32_16x16x32_bf16 v[72:75], a[16:19], a[88:91], v[72:75]
    s_mov_b32 m0, s52
    s_nop 0
    buffer_load_dwordx4 v12, s[60:63], s45 offen lds
    v_mfma_f32_16x16x32_bf16 v[76:79], a[16:19], a[92:95], v[76:79]
    s_add_u32 m0, m0, 4096
    s_waitcnt lgkmcnt(10)
    v_mfma_f32_16x16x32_bf16 v[80:83], a[20:23], a[80:83], v[80:83]
    ds_read_b64_tr_b16 a[12:13], v7 offset:36992
    buffer_load_dwordx4 v13, s[60:63], s45 offen lds
    v_mfma_f32_16x16x32_bf16 v[84:87], a[20:23], a[84:87], v[84:87]
    ds_read_b64_tr_b16 a[14:15], v7 offset:43136
    s_add_u32 m0, m0, 4096
    v_mfma_f32_16x16x32_bf16 v[88:91], a[20:23], a[88:91], v[88:91]
    buffer_load_dwordx4 v14, s[60:63], s45 offen lds
    s_add_u32 m0, m0, 4096
    v_mfma_f32_16x16x32_bf16 v[92:95], a[20:23], a[92:95], v[92:95]
    buffer_load_dwordx4 v12, s[60:63], s53 offen lds
    s_waitcnt lgkmcnt(10)
    v_mfma_f32_16x16x32_bf16 v[96:99], a[24:27], a[80:83], v[96:99]
    ds_read_b64_tr_b16 a[16:17], v4 offset:37120
    s_add_u32 m0, m0, 4096
    v_mfma_f32_16x16x32_bf16 v[100:103], a[24:27], a[84:87], v[100:103]
    ds_read_b64_tr_b16 a[18:19], v4 offset:43264
    buffer_load_dwordx4 v13, s[60:63], s53 offen lds
    v_mfma_f32_16x16x32_bf16 v[104:107], a[24:27], a[88:91], v[104:107]
    s_add_u32 m0, m0, 4096
    s_nop 0
    buffer_load_dwordx4 v14, s[60:63], s53 offen lds
    v_mfma_f32_16x16x32_bf16 v[108:111], a[24:27], a[92:95], v[108:111]
    s_add_u32 s45, s45, s47
    s_waitcnt lgkmcnt(10)
    v_mfma_f32_16x16x32_bf16 v[112:115], a[28:31], a[80:83], v[112:115]
    ds_read_b64_tr_b16 a[20:21], v5 offset:37120
    s_sub_u32 s48, s48, 1
    v_mfma_f32_16x16x32_bf16 v[116:119], a[28:31], a[84:87], v[116:119]
    ds_read_b64_tr_b16 a[22:23], v5 offset:43264
    s_add_u32 s52, s52, 24576
    v_mfma_f32_16x16x32_bf16 v[120:123], a[28:31], a[88:91], v[120:123]
    s_cmp_ge_u32 s52, 98304
    s_cselect_b32 s53, 98304, 0
    v_mfma_f32_16x16x32_bf16 v[124:127], a[28:31], a[92:95], v[124:127]
    s_sub_u32 s52, s52, s53
    s_waitcnt lgkmcnt(10)
    v_mfma_f32_16x16x32_bf16 v[128:131], a[0:3], a[80:83], v[128:131]
    ds_read_b64_tr_b16 a[24:25], v6 offset:37120
    buffer_load_dwordx4 a[64:67], v16, s[8:11], s49 offen sc1
    v_mfma_f32_16x16x32_bf16 v[132:135], a[0:3], a[84:87], v[132:135]
    ds_read_b64_tr_b16 a[26:27], v6 offset:43264
    buffer_load_dwordx4 a[68:71], v17, s[8:11], s49 offen sc1
    v_mfma_f32_16x16x32_bf16 v[136:139], a[0:3], a[88:91], v[136:139]
    buffer_load_dwordx4 a[72:75], v18, s[8:11], s49 offen sc1
    buffer_load_dwordx4 a[76:79], v19, s[8:11], s49 offen sc1
    v_mfma_f32_16x16x32_bf16 v[140:143], a[0:3], a[92:95], v[140:143]
    s_add_u32 s49, s49, 1024
    s_waitcnt lgkmcnt(10)
    v_mfma_f32_16x16x32_bf16 v[144:147], a[4:7], a[80:83], v[144:147]
    ds_read_b64_tr_b16 a[28:29], v7 offset:37120
    s_cmp_eq_u32 s49, s71
    v_mfma_f32_16x16x32_bf16 v[148:151], a[4:7], a[84:87], v[148:151]
    ds_read_b64_tr_b16 a[30:31], v7 offset:43264
    s_cselect_b32 s49, s72, s49
    v_mfma_f32_16x16x32_bf16 v[152:155], a[4:7], a[88:91], v[152:155]
    v_mfma_f32_16x16x32_bf16 v[156:159], a[4:7], a[92:95], v[156:159]
    s_waitcnt lgkmcnt(10)
    v_xor_b32 v4, 0xc000, v4
    v_xor_b32 v5, 0xc000, v5
    v_xor_b32 v6, 0xc000, v6
    v_xor_b32 v7, 0xc000, v7
    v_mfma_f32_16x16x32_bf16 v[160:163], a[8:11], a[80:83], v[160:163]
    ds_read_b64_tr_b16 a[0:1], v4 offset:0
    v_mfma_f32_16x16x32_bf16 v[164:167], a[8:11], a[84:87], v[164:167]
    ds_read_b64_tr_b16 a[2:3], v4 offset:6144
    v_mfma_f32_16x16x32_bf16 v[168:171], a[8:11], a[88:91], v[168:171]
    v_mfma_f32_16x16x32_bf16 v[172:175], a[8:11], a[92:95], v[172:175]
    s_waitcnt lgkmcnt(10)
    v_mfma_f32_16x16x32_bf16 v[176:179], a[12:15], a[80:83], v[176:179]
    ds_read_b64_tr_b16 a[4:5], v5 offset:0
    v_mfma_f32_16x16x32_bf16 v[180:183], a[12:15], a[84:87], v[180:183]
    ds_read_b64_tr_b16 a[6:7], v5 offset:6144
    v_mfma_f32_16x16x32_bf16 v[184:187], a[12:15], a[88:91], v[184:187]
    v_mfma_f32_16x16x32_bf16 v[188:191], a[12:15], a[92:95], v[188:191]
    s_waitcnt lgkmcnt(10)
    v_mfma_f32_16x16x32_bf16 v[192:195], a[16:19], a[80:83], v[192:195]
    ds_read_b64_tr_b16 a[8:9], v6 offset:0
    v_mfma_f32_16x16x32_bf16 v[196:199], a[16:19], a[84:87], v[196:199]
    ds_read_b64_tr_b16 a[10:11], v6 offset:6144
    v_mfma_f32_16x16x32_bf16 v[200:203], a[16:19], a[88:91], v[200:203]
    v_mfma_f32_16x16x32_bf16 v[204:207], a[16:19], a[92:95], v[204:207]
    s_waitcnt lgkmcnt(10)
    v_mfma_f32_16x16x32_bf16 v[208:211], a[20:23], a[80:83], v[208:211]
    ds_read_b64_tr_b16 a[12:13], v7 offset:0
    v_mfma_f32_16x16x32_bf16 v[212:215], a[20:23], a[84:87], v[212:215]
    ds_read_b64_tr_b16 a[14:15], v7 offset:6144
    v_mfma_f32_16x16x32_bf16 v[216:219], a[20:23], a[88:91], v[216:219]
    v_mfma_f32_16x16x32_bf16 v[220:223], a[20:23], a[92:95], v[220:223]
    s_waitcnt lgkmcnt(10)
    v_mfma_f32_16x16x32_bf16 v[224:227], a[24:27], a[80:83], v[224:227]
    ds_read_b64_tr_b16 a[16:17], v4 offset:128
    v_mfma_f32_16x16x32_bf16 v[228:231], a[24:27], a[84:87], v[228:231]
    ds_read_b64_tr_b16 a[18:19], v4 offset:6272
    v_mfma_f32_16x16x32_bf16 v[232:235], a[24:27], a[88:91], v[232:235]
    v_mfma_f32_16x16x32_bf16 v[236:239], a[24:27], a[92:95], v[236:239]
    s_waitcnt lgkmcnt(10)
    v_mfma_f32_16x16x32_bf16 v[240:243], a[28:31], a[80:83], v[240:243]
    ds_read_b64_tr_b16 a[20:21], v5 offset:128
    v_mfma_f32_16x16x32_bf16 v[244:247], a[28:31], a[84:87], v[244:247]
    ds_read_b64_tr_b16 a[22:23], v5 offset:6272
    v_mfma_f32_16x16x32_bf16 v[248:251], a[28:31], a[88:91], v[248:251]
    v_mfma_f32_16x16x32_bf16 v[252:255], a[28:31], a[92:95], v[252:255]
    s_sub_u32 s44, s44, 1
    s_cmp_lg_u32 s44, 0
    s_cbranch_scc1 g_s1_loop4
    s_waitcnt lgkmcnt(0)
    s_cmp_eq_u32 s40, 0
    s_nop 1
    s_cbranch_scc0 g_epi1
    v_and_b32 v8, 0x3fff, v8
    v_or_b32 v8, s70, v8
    v_and_b32 v9, 0x3fff, v9
    v_or_b32 v9, s70, v9
    v_and_b32 v10, 0x3fff, v10
    v_or_b32 v10, s70, v10
    v_and_b32 v11, 0x3fff, v11
    v_or_b32 v11, s70, v11
    ds_read_b64_tr_b16 a[0:1], v8 offset:0
    ds_read_b64_tr_b16 a[2:3], v8 offset:2048
    ds_read_b64_tr_b16 a[4:5], v8 offset:4096
    ds_read_b64_tr_b16 a[6:7], v8 offset:6144
    ds_read_b64_tr_b16 a[8:9], v8 offset:8192
    ds_read_b64_tr_b16 a[10:11], v8 offset:10240
    ds_read_b64_tr_b16 a[12:13], v8 offset:12288
    ds_read_b64_tr_b16 a[14:15], v8 offset:14336
    ds_read_b64_tr_b16 a[16:17], v8 offset:16384
    ds_read_b64_tr_b16 a[18:19], v8 offset:18432
    ds_read_b64_tr_b16 a[20:21], v8 offset:20480
    ds_read_b64_tr_b16 a[22:23], v8 offset:22528
    s_and_b32 s53, s56, 1
    s_mul_i32 s53, s53, 0xc000
    s_xor_b32 s70, s70, s53
    v_cvt_pk_bf16_f32 v64, v64, v65
    v_cvt_pk_bf16_f32 v65, v66, v67
    v_cvt_pk_bf16_f32 v66, v80, v81
    v_cvt_pk_bf16_f32 v67, v82, v83
    v_cvt_pk_bf16_f32 v68, v68, v69
    v_cvt_pk_bf16_f32 v69, v70, v71
    v_cvt_pk_bf16_f32 v70, v84, v85
    v_cvt_pk_bf16_f32 v71, v86, v87
    v_cvt_pk_bf16_f32 v72, v72, v73
    v_cvt_pk_bf16_f32 v73, v74, v75
    v_cvt_pk_bf16_f32 v74, v88, v89
    v_cvt_pk_bf16_f32 v75, v90, v91
    v_cvt_pk_bf16_f32 v76, v76, v77
    v_cvt_pk_bf16_f32 v77, v78, v79
    v_cvt_pk_bf16_f32 v78, v92, v93
    v_cvt_pk_bf16_f32 v79, v94, v95
    v_cvt_pk_bf16_f32 v96, v96, v97
    v_cvt_pk_bf16_f32 v97, v98, v99
    v_cvt_pk_bf16_f32 v98, v112, v113
    v_cvt_pk_bf16_f32 v99, v114, v115
    v_cvt_pk_bf16_f32 v100, v100, v101
    v_cvt_pk_bf16_f32 v101, v102, v103
    v_cvt_pk_bf16_f32 v102, v116, v117
    v_cvt_pk_bf16_f32 v103, v118, v119
    v_cvt_pk_bf16_f32 v104, v104, v105
    v_cvt_pk_bf16_f32 v105, v106, v107
    v_cvt_pk_bf16_f32 v106, v120, v121
    v_cvt_pk_bf16_f32 v107, v122, v123
    v_cvt_pk_bf16_f32 v108, v108, v109
    v_cvt_pk_bf16_f32 v109, v110, v111
    v_cvt_pk_bf16_f32 v110, v124, v125
    v_cvt_pk_bf16_f32 v111, v126, v127
    v_cvt_pk_bf16_f32 v128, v128, v129
    v_cvt_pk_bf16_f32 v129, v130, v131
    v_cvt_pk_bf16_f32 v130, v144, v145
    v_cvt_pk_bf16_f32 v131, v146, v147
    v_cvt_pk_bf16_f32 v132, v132, v133
    v_cvt_pk_bf16_f32 v133, v134, v135
    v_cvt_pk_bf16_f32 v134, v148, v149
    v_cvt_pk_bf16_f32 v135, v150, v151
    v_cvt_pk_bf16_f32 v136, v136, v137
    v_cvt_pk_bf16_f32 v137, v138, v139
    v_cvt_pk_bf16_f32 v138, v152, v153
    v_cvt_pk_bf16_f32 v139, v154, v155
    v_cvt_pk_bf16_f32 v140, v140, v141
    v_cvt_pk_bf16_f32 v141, v142, v143
    v_cvt_pk_bf16_f32 v142, v156, v157
    v_cvt_pk_bf16_f32 v143, v158, v159
    v_cvt_pk_bf16_f32 v160, v160, v161
    v_cvt_pk_bf16_f32 v161, v162, v163
    v_cvt_pk_bf16_f32 v162, v176, v177
    v_cvt_pk_bf16_f32 v163, v178, v179
    v_cvt_pk_bf16_f32 v164, v164, v165
    v_cvt_pk_bf16_f32 v165, v166, v167
    v_cvt_pk_bf16_f32 v166, v180, v181
    v_cvt_pk_bf16_f32 v167, v182, v183
    v_cvt_pk_bf16_f32 v168, v168, v169
    v_cvt_pk_bf16_f32 v169, v170, v171
    v_cvt_pk_bf16_f32 v170, v184, v185
    v_cvt_pk_bf16_f32 v171, v186, v187
    v_cvt_pk_bf16_f32 v172, v172, v173
    v_cvt_pk_bf16_f32 v173, v174, v175
    v_cvt_pk_bf16_f32 v174, v188, v189
    v_cvt_pk_bf16_f32 v175, v190, v191
    v_cvt_pk_bf16_f32 v192, v192, v193
    v_cvt_pk_bf16_f32 v193, v194, v195
    v_cvt_pk_bf16_f32 v194, v208, v209
    v_cvt_pk_bf16_f32 v195, v210, v211
    v_cvt_pk_bf16_f32 v196, v196, v197
    v_cvt_pk_bf16_f32 v197, v198, v199
    v_cvt_pk_bf16_f32 v198, v212, v213
    v_cvt_pk_bf16_f32 v199, v214, v215
    v_cvt_pk_bf16_f32 v200, v200, v201
    v_cvt_pk_bf16_f32 v201, v202, v203
    v_cvt_pk_bf16_f32 v202, v216, v217
    v_cvt_pk_bf16_f32 v203, v218, v219
    v_cvt_pk_bf16_f32 v204, v204, v205
    v_cvt_pk_bf16_f32 v205, v206, v207
    v_cvt_pk_bf16_f32 v206, v220, v221
    v_cvt_pk_bf16_f32 v207, v222, v223
    v_cvt_pk_bf16_f32 v224, v224, v225
    v_cvt_pk_bf16_f32 v225, v226, v227
    v_cvt_pk_bf16_f32 v226, v240, v241
    v_cvt_pk_bf16_f32 v227, v242, v243
    v_cvt_pk_bf16_f32 v228, v228, v229
    v_cvt_pk_bf16_f32 v229, v230, v231
    v_cvt_pk_bf16_f32 v230, v244, v245
    v_cvt_pk_bf16_f32 v231, v246, v247
    v_cvt_pk_bf16_f32 v232, v232, v233
    v_cvt_pk_bf16_f32 v233, v234, v235
    v_cvt_pk_bf16_f32 v234, v248, v249
    v_cvt_pk_bf16_f32 v235, v250, v251
    v_cvt_pk_bf16_f32 v236, v236, v237
    v_cvt_pk_bf16_f32 v237, v238, v239
    v_cvt_pk_bf16_f32 v238, v252, v253
    v_cvt_pk_bf16_f32 v239, v254, v255
    s_mov_b32 s44, s56
    s_nop 0
g_s2_loop4:
    s_waitcnt lgkmcnt(10)
    v_mfma_f32_16x16x32_bf16 v[80:83], v[64:67], a[0:3], 0
    ds_read_b64_tr_b16 a[24:25], v9 offset:0
    v_mfma_f32_16x16x32_bf16 v[84:87], v[68:71], a[0:3], 0
    ds_read_b64_tr_b16 a[26:27], v9 offset:2048
    v_mfma_f32_16x16x32_bf16 v[88:91], v[72:75], a[0:3], 0
    v_mfma_f32_16x16x32_bf16 v[92:95], v[76:79], a[0:3], 0
    s_waitcnt lgkmcnt(10)
    v_mfma_f32_16x16x32_bf16 v[80:83], v[96:99], a[4:7], v[80:83]
    ds_read_b64_tr_b16 a[28:29], v9 offset:4096
    v_cvt_pk_bf16_f32 v24, v176, v180
    v_mfma_f32_16x16x32_bf16 v[84:87], v[100:103], a[4:7], v[84:87]
    ds_read_b64_tr_b16 a[30:31], v9 offset:6144
    v_cvt_pk_bf16_f32 v25, v177, v181
    v_mfma_f32_16x16x32_bf16 v[88:91], v[104:107], a[4:7], v[88:91]
    v_cvt_pk_bf16_f32 v26, v178, v182
    v_cvt_pk_bf16_f32 v27, v179, v183
    v_mfma_f32_16x16x32_bf16 v[92:95], v[108:111], a[4:7], v[92:95]
    buffer_store_dwordx4 v[24:27], v20, s[8:11], s51 offen sc1
    s_waitcnt lgkmcnt(10)
    v_mfma_f32_16x16x32_bf16 v[80:83], v[128:131], a[8:11], v[80:83]
    ds_read_b64_tr_b16 a[0:1], v9 offset:8192
    v_cvt_pk_bf16_f32 v28, v184, v188
    v_mfma_f32_16x16x32_bf16 v[84:87], v[132:135], a[8:11], v[84:87]
    ds_read_b64_tr_b16 a[2:3], v9 offset:10240
    v_cvt_pk_bf16_f32 v29, v185, v189
    v_mfma_f32_16x16x32_bf16 v[88:91], v[136:139], a[8:11], v[88:91]
    v_cvt_pk_bf16_f32 v30, v186, v190
    v_cvt_pk_bf16_f32 v31, v187, v191
    v_mfma_f32_16x16x32_bf16 v[92:95], v[140:143], a[8:11], v[92:95]
    buffer_store_dwordx4 v[28:31], v21, s[8:11], s51 offen sc1
    s_waitcnt lgkmcnt(10)
    v_mfma_f32_16x16x32_bf16 v[80:83], v[160:163], a[12:15], v[80:83]
    ds_read_b64_tr_b16 a[4:5], v9 offset:12288
    s_mov_b32 s51, s50
    v_mfma_f32_16x16x32_bf16 v[84:87], v[164:167], a[12:15], v[84:87]
    ds_read_b64_tr_b16 a[6:7], v9 offset:14336
    s_add_u32 s50, s50, 1024
    v_mfma_f32_16x16x32_bf16 v[88:91], v[168:171], a[12:15], v[88:91]
    v_mfma_f32_16x16x32_bf16 v[92:95], v[172:175], a[12:15], v[92:95]
    s_waitcnt lgkmcnt(10)
    v_mfma_f32_16x16x32_bf16 v[80:83], v[192:195], a[16:19], v[80:83]
    ds_read_b64_tr_b16 a[8:9], v9 offset:16384
    v_mfma_f32_16x16x32_bf16 v[84:87], v[196:199], a[16:19], v[84:87]
    ds_read_b64_tr_b16 a[10:11], v9 offset:18432
    v_mfma_f32_16x16x32_bf16 v[88:91], v[200:203], a[16:19], v[88:91]
    v_mfma_f32_16x16x32_bf16 v[92:95], v[204:207], a[16:19], v[92:95]
    s_waitcnt lgkmcnt(10)
    v_mfma_f32_16x16x32_bf16 v[80:83], v[224:227], a[20:23], v[80:83]
    ds_read_b64_tr_b16 a[12:13], v9 offset:20480
    v_mfma_f32_16x16x32_bf16 v[84:87], v[228:231], a[20:23], v[84:87]
    ds_read_b64_tr_b16 a[14:15], v9 offset:22528
    v_mfma_f32_16x16x32_bf16 v[88:91], v[232:235], a[20:23], v[88:91]
    v_mfma_f32_16x16x32_bf16 v[92:95], v[236:239], a[20:23], v[92:95]
    s_waitcnt lgkmcnt(10)
    v_mfma_f32_16x16x32_bf16 v[112:115], v[64:67], a[24:27], 0
    ds_read_b64_tr_b16 a[16:17], v10 offset:0
    v_mfma_f32_16x16x32_bf16 v[116:119], v[68:71], a[24:27], 0
    ds_read_b64_tr_b16 a[18:19], v10 offset:2048
    v_mfma_f32_16x16x32_bf16 v[120:123], v[72:75], a[24:27], 0
    v_mfma_f32_16x16x32_bf16 v[124:127], v[76:79], a[24:27], 0
    s_waitcnt lgkmcnt(10)
    v_mfma_f32_16x16x32_bf16 v[112:115], v[96:99], a[28:31], v[112:115]
    ds_read_b64_tr_b16 a[20:21], v10 offset:4096
    v_cvt_pk_bf16_f32 v32, v80, v84
    v_mfma_f32_16x16x32_bf16 v[116:119], v[100:103], a[28:31], v[116:119]
    ds_read_b64_tr_b16 a[22:23], v10 offset:6144
    v_cvt_pk_bf16_f32 v33, v81, v85
    v_mfma_f32_16x16x32_bf16 v[120:123], v[104:107], a[28:31], v[120:123]
    v_cvt_pk_bf16_f32 v34, v82, v86
    v_cvt_pk_bf16_f32 v35, v83, v87
    v_mfma_f32_16x16x32_bf16 v[124:127], v[108:111], a[28:31], v[124:127]
    buffer_store_dwordx4 v[32:35], v20, s[8:11], s51 offen sc1
    s_waitcnt lgkmcnt(10)
    v_mfma_f32_16x16x32_bf16 v[112:115], v[128:131], a[0:3], v[112:115]
    ds_read_b64_tr_b16 a[24:25], v10 offset:8192
    v_cvt_pk_bf16_f32 v36, v88, v92
    v_mfma_f32_16x16x32_bf16 v[116:119], v[132:135], a[0:3], v[116:119]
    ds_read_b64_tr_b16 a[26:27], v10 offset:10240
    v_cvt_pk_bf16_f32 v37, v89, v93
    v_mfma_f32_16x16x32_bf16 v[120:123], v[136:139], a[0:3], v[120:123]
    v_cvt_pk_bf16_f32 v38, v90, v94
    v_cvt_pk_bf16_f32 v39, v91, v95
    v_mfma_f32_16x16x32_bf16 v[124:127], v[140:143], a[0:3], v[124:127]
    buffer_store_dwordx4 v[36:39], v21, s[8:11], s51 offen sc1
    s_waitcnt lgkmcnt(10)
    v_mfma_f32_16x16x32_bf16 v[112:115], v[160:163], a[4:7], v[112:115]
    ds_read_b64_tr_b16 a[28:29], v10 offset:12288
    s_mov_b32 s51, s50
    v_mfma_f32_16x16x32_bf16 v[116:119], v[164:167], a[4:7], v[116:119]
    ds_read_b64_tr_b16 a[30:31], v10 offset:14336
    s_add_u32 s50, s50, 1024
    v_mfma_f32_16x16x32_bf16 v[120:123], v[168:171], a[4:7], v[120:123]
    v_mfma_f32_16x16x32_bf16 v[124:127], v[172:175], a[4:7], v[124:127]
    s_waitcnt lgkmcnt(10)
    v_mfma_f32_16x16x32_bf16 v[112:115], v[192:195], a[8:11], v[112:115]
    ds_read_b64_tr_b16 a[0:1], v10 offset:16384
    v_mfma_f32_16x16x32_bf16 v[116:119], v[196:199], a[8:11], v[116:119]
    ds_read_b64_tr_b16 a[2:3], v10 offset:18432
    v_mfma_f32_16x16x32_bf16 v[120:123], v[200:203], a[8:11], v[120:123]
    v_mfma_f32_16x16x32_bf16 v[124:127], v[204:207], a[8:11], v[124:127]
    s_waitcnt lgkmcnt(10)
    v_mfma_f32_16x16x32_bf16 v[112:115], v[224:227], a[12:15], v[112:115]
    ds_read_b64_tr_b16 a[4:5], v10 offset:20480
    v_mfma_f32_16x16x32_bf16 v[116:119], v[228:231], a[12:15], v[116:119]
    ds_read_b64_tr_b16 a[6:7], v10 offset:22528
    v_mfma_f32_16x16x32_bf16 v[120:123], v[232:235], a[12:15], v[120:123]
    v_mfma_f32_16x16x32_bf16 v[124:127], v[236:239], a[12:15], v[124:127]
    s_waitcnt vmcnt(22)
    s_barrier
    s_waitcnt lgkmcnt(10)
    v_mfma_f32_16x16x32_bf16 v[144:147], v[64:67], a[16:19], 0
    ds_read_b64_tr_b16 a[8:9], v11 offset:0
    s_cmp_lg_u32 s48, 0
    s_cbranch_scc1 Lsw_31
    s_cmp_lg_u32 s74, 0
    s_cbranch_scc0 Lsw2_32
    v_mov_b32 v12, v15
    v_add_u32 v13, 40960, v15
    v_add_u32 v14, 81920, v15
    s_mov_b32 s60, s16
    s_mov_b32 s61, s17
    s_mov_b32 s62, s18
    s_mov_b32 s45, s57
    s_mov_b32 s46, 122880
    s_mov_b32 s47, 128
    s_mov_b32 s48, s74
    s_mov_b32 s74, 0
    s_branch Lsw_31
Lsw2_32:
    v_mov_b32 v12, v56
    v_mov_b32 v13, v57
    v_mov_b32 v14, v58
    s_mov_b32 s60, s12
    s_mov_b32 s61, s13
    s_mov_b32 s62, s14
    s_cmp_lt_u32 s73, 3
    s_cselect_b32 s45, s58, 0x7f000000
    s_mov_b32 s46, 393216
    s_mov_b32 s47, 786432
    s_mov_b32 s48, 10
Lsw_31:
    v_mfma_f32_16x16x32_bf16 v[148:151], v[68:71], a[16:19], 0
    ds_read_b64_tr_b16 a[10:11], v11 offset:2048
    s_add_u32 s53, s45, s46
    v_mfma_f32_16x16x32_bf16 v[152:155], v[72:75], a[16:19], 0
    s_mov_b32 m0, s52
    s_nop 0
    buffer_load_dwordx4 v12, s[60:63], s45 offen lds
    v_mfma_f32_16x16x32_bf16 v[156:159], v[76:79], a[16:19], 0
    s_add_u32 m0, m0, 4096
    s_waitcnt lgkmcnt(10)
    v_mfma_f32_16x16x32_bf16 v[144:147], v[96:99], a[20:23], v[144:147]
    ds_read_b64_tr_b16 a[12:13], v11 offset:4096
    buffer_load_dwordx4 v13, s[60:63], s45 offen lds
    v_mfma_f32_16x16x32_bf16 v[148:151], v[100:103], a[20:23], v[148:151]
    ds_read_b64_tr_b16 a[14:15], v11 offset:6144
    s_add_u32 m0, m0, 4096
    v_mfma_f32_16x16x32_bf16 v[152:155], v[104:107], a[20:23], v[152:155]
    buffer_load_dwordx4 v14, s[60:63], s45 offen lds
    s_add_u32 m0, m0, 4096
    v_mfma_f32_16x16x32_bf16 v[156:159], v[108:111], a[20:23], v[156:159]
    buffer_load_dwordx4 v12, s[60:63], s53 offen lds
    s_waitcnt lgkmcnt(10)
    v_mfma_f32_16x16x32_bf16 v[144:147], v[128:131], a[24:27], v[144:147]
    ds_read_b64_tr_b16 a[16:17], v11 offset:8192
    s_add_u32 m0, m0, 4096
    v_mfma_f32_16x16x32_bf16 v[148:151], v[132:135], a[24:27], v[148:151]
    ds_read_b64_tr_b16 a[18:19], v11 offset:10240
    buffer_load_dwordx4 v13, s[60:63], s53 offen lds
    v_mfma_f32_16x16x32_bf16 v[152:155], v[136:139], a[24:27], v[152:155]
    s_add_u32 m0, m0, 4096
    s_nop 0
    buffer_load_dwordx4 v14, s[60:63], s53 offen lds
    v_mfma_f32_16x16x32_bf16 v[156:159], v[140:143], a[24:27], v[156:159]
    s_add_u32 s45, s45, s47
    s_waitcnt lgkmcnt(10)
    v_mfma_f32_16x16x32_bf16 v[144:147], v[160:163], a[28:31], v[144:147]
    ds_read_b64_tr_b16 a[20:21], v11 offset:12288
    s_sub_u32 s48, s48, 1
    v_mfma_f32_16x16x32_bf16 v[148:151], v[164:167], a[28:31], v[148:151]
    ds_read_b64_tr_b16 a[22:23], v11 offset:14336
    s_add_u32 s52, s52, 24576
    v_mfma_f32_16x16x32_bf16 v[152:155], v[168:171], a[28:31], v[152:155]
    s_cmp_ge_u32 s52, 98304
    s_cselect_b32 s53, 98304, 0
    v_mfma_f32_16x16x32_bf16 v[156:159], v[172:175], a[28:31], v[156:159]
    s_sub_u32 s52, s52, s53
    s_waitcnt lgkmcnt(10)
    v_mfma_f32_16x16x32_bf16 v[144:147], v[192:195], a[0:3], v[144:147]
    ds_read_b64_tr_b16 a[24:25], v11 offset:16384
    v_cvt_pk_bf16_f32 v24, v112, v116
    v_mfma_f32_16x16x32_bf16 v[148:151], v[196:199], a[0:3], v[148:151]
    ds_read_b64_tr_b16 a[26:27], v11 offset:18432
    v_cvt_pk_bf16_f32 v25, v113, v117
    v_mfma_f32_16x16x32_bf16 v[152:155], v[200:203], a[0:3], v[152:155]
    v_cvt_pk_bf16_f32 v26, v114, v118
    v_cvt_pk_bf16_f32 v27, v115, v119
    v_mfma_f32_16x16x32_bf16 v[156:159], v[204:207], a[0:3], v[156:159]
    buffer_store_dwordx4 v[24:27], v20, s[8:11], s51 offen sc1
    s_waitcnt lgkmcnt(10)
    v_mfma_f32_16x16x32_bf16 v[144:147], v[224:227], a[4:7], v[144:147]
    ds_read_b64_tr_b16 a[28:29], v11 offset:20480
    v_cvt_pk_bf16_f32 v28, v120, v124
    v_mfma_f32_16x16x32_bf16 v[148:151], v[228:231], a[4:7], v[148:151]
    ds_read_b64_tr_b16 a[30:31], v11 offset:22528
    v_cvt_pk_bf16_f32 v29, v121, v125
    v_mfma_f32_16x16x32_bf16 v[152:155], v[232:235], a[4:7], v[152:155]
    v_cvt_pk_bf16_f32 v30, v122, v126
    v_cvt_pk_bf16_f32 v31, v123, v127
    v_mfma_f32_16x16x32_bf16 v[156:159], v[236:239], a[4:7], v[156:159]
    buffer_store_dwordx4 v[28:31], v21, s[8:11], s51 offen sc1
    s_mov_b32 s51, s50
    s_add_u32 s50, s50, 1024
    s_waitcnt lgkmcnt(10)
    v_mfma_f32_16x16x32_bf16 v[176:179], v[64:67], a[8:11], 0
    ds_read_b64_tr_b16 a[0:1], v8 offset:24576
    v_mfma_f32_16x16x32_bf16 v[180:183], v[68:71], a[8:11], 0
    ds_read_b64_tr_b16 a[2:3], v8 offset:26624
    v_mfma_f32_16x16x32_bf16 v[184:187], v[72:75], a[8:11], 0
    v_mfma_f32_16x16x32_bf16 v[188:191], v[76:79], a[8:11], 0
    s_waitcnt lgkmcnt(10)
    v_mfma_f32_16x16x32_bf16 v[176:179], v[96:99], a[12:15], v[176:179]
    ds_read_b64_tr_b16 a[4:5], v8 offset:28672
    v_cvt_pk_bf16_f32 v32, v144, v148
    v_mfma_f32_16x16x32_bf16 v[180:183], v[100:103], a[12:15], v[180:183]
    ds_read_b64_tr_b16 a[6:7], v8 offset:30720
    v_cvt_pk_bf16_f32 v33, v145, v149
    v_mfma_f32_16x16x32_bf16 v[184:187], v[104:107], a[12:15], v[184:187]
    v_cvt_pk_bf16_f32 v34, v146, v150
    v_cvt_pk_bf16_f32 v35, v147, v151
    v_mfma_f32_16x16x32_bf16 v[188:191], v[108:111], a[12:15], v[188:191]
    buffer_store_dwordx4 v[32:35], v20, s[8:11], s51 offen sc1
    s_waitcnt lgkmcnt(10)
    v_mfma_f32_16x16x32_bf16 v[176:179], v[128:131], a[16:19], v[176:179]
    ds_read_b64_tr_b16 a[8:9], v8 offset:32768
    v_cvt_pk_bf16_f32 v36, v152, v156
    v_mfma_f32_16x16x32_bf16 v[180:183], v[132:135], a[16:19], v[180:183]
    ds_read_b64_tr_b16 a[10:11], v8 offset:34816
    v_cvt_pk_bf16_f32 v37, v153, v157
    v_mfma_f32_16x16x32_bf16 v[184:187], v[136:139], a[16:19], v[184:187]
    v_cvt_pk_bf16_f32 v38, v154, v158
    v_cvt_pk_bf16_f32 v39, v155, v159
    v_mfma_f32_16x16x32_bf16 v[188:191], v[140:143], a[16:19], v[188:191]
    buffer_store_dwordx4 v[36:39], v21, s[8:11], s51 offen sc1
    s_waitcnt lgkmcnt(10)
    v_mfma_f32_16x16x32_bf16 v[176:179], v[160:163], a[20:23], v[176:179]
    ds_read_b64_tr_b16 a[12:13], v8 offset:36864
    s_mov_b32 s51, s50
    v_mfma_f32_16x16x32_bf16 v[180:183], v[164:167], a[20:23], v[180:183]
    ds_read_b64_tr_b16 a[14:15], v8 offset:38912
    s_add_u32 s50, s50, 1024
    v_mfma_f32_16x16x32_bf16 v[184:187], v[168:171], a[20:23], v[184:187]
    v_mfma_f32_16x16x32_bf16 v[188:191], v[172:175], a[20:23], v[188:191]
    s_waitcnt lgkmcnt(10)
    v_mfma_f32_16x16x32_bf16 v[176:179], v[192:195], a[24:27], v[176:179]
    ds_read_b64_tr_b16 a[16:17], v8 offset:40960
    v_mfma_f32_16x16x32_bf16 v[180:183], v[196:199], a[24:27], v[180:183]
    ds_read_b64_tr_b16 a[18:19], v8 offset:43008
    v_mfma_f32_16x16x32_bf16 v[184:187], v[200:203], a[24:27], v[184:187]
    v_mfma_f32_16x16x32_bf16 v[188:191], v[204:207], a[24:27], v[188:191]
    s_waitcnt lgkmcnt(10)
    v_mfma_f32_16x16x32_bf16 v[176:179], v[224:227], a[28:31], v[176:179]
    ds_read_b64_tr_b16 a[20:21], v8 offset:45056
    v_mfma_f32_16x16x32_bf16 v[180:183], v[228:231], a[28:31], v[180:183]
    ds_read_b64_tr_b16 a[22:23], v8 offset:47104
    v_mfma_f32_16x16x32_bf16 v[184:187], v[232:235], a[28:31], v[184:187]
    v_mfma_f32_16x16x32_bf16 v[188:191], v[236:239], a[28:31], v[188:191]
    s_waitcnt lgkmcnt(10)
    v_mfma_f32_16x16x32_bf16 v[80:83], v[64:67], a[0:3], 0
    ds_read_b64_tr_b16 a[24:25], v9 offset:24576
    v_mfma_f32_16x16x32_bf16 v[84:87], v[68:71], a[0:3], 0
    ds_read_b64_tr_b16 a[26:27], v9 offset:26624
    v_mfma_f32_16x16x32_bf16 v[88:91], v[72:75], a[0:3], 0
    v_mfma_f32_16x16x32_bf16 v[92:95], v[76:79], a[0:3], 0
    s_waitcnt lgkmcnt(10)
    v_mfma_f32_16x16x32_bf16 v[80:83], v[96:99], a[4:7], v[80:83]
    ds_read_b64_tr_b16 a[28:29], v9 offset:28672
    v_cvt_pk_bf16_f32 v24, v176, v180
    v_mfma_f32_16x16x32_bf16 v[84:87], v[100:103], a[4:7], v[84:87]
    ds_read_b64_tr_b16 a[30:31], v9 offset:30720
    v_cvt_pk_bf16_f32 v25, v177, v181
    v_mfma_f32_16x16x32_bf16 v[88:91], v[104:107], a[4:7], v[88:91]
    v_cvt_pk_bf16_f32 v26, v178, v182
    v_cvt_pk_bf16_f32 v27, v179, v183
    v_mfma_f32_16x16x32_bf16 v[92:95], v[108:111], a[4:7], v[92:95]
    buffer_store_dwordx4 v[24:27], v20, s[8:11], s51 offen sc1
    s_waitcnt lgkmcnt(10)
    v_mfma_f32_16x16x32_bf16 v[80:83], v[128:131], a[8:11], v[80:83]
    ds_read_b64_tr_b16 a[0:1], v9 offset:32768
    v_cvt_pk_bf16_f32 v28, v184, v188
    v_mfma_f32_16x16x32_bf16 v[84:87], v[132:135], a[8:11], v[84:87]
    ds_read_b64_tr_b16 a[2:3], v9 offset:34816
    v_cvt_pk_bf16_f32 v29, v185, v189
    v_mfma_f32_16x16x32_bf16 v[88:91], v[136:139], a[8:11], v[88:91]
    v_cvt_pk_bf16_f32 v30, v186, v190
    v_cvt_pk_bf16_f32 v31, v187, v191
    v_mfma_f32_16x16x32_bf16 v[92:95], v[140:143], a[8:11], v[92:95]
    buffer_store_dwordx4 v[28:31], v21, s[8:11], s51 offen sc1
    s_waitcnt lgkmcnt(10)
    v_mfma_f32_16x16x32_bf16 v[80:83], v[160:163], a[12:15], v[80:83]
    ds_read_b64_tr_b16 a[4:5], v9 offset:36864
    s_mov_b32 s51, s50
    v_mfma_f32_16x16x32_bf16 v[84:87], v[164:167], a[12:15], v[84:87]
    ds_read_b64_tr_b16 a[6:7], v9 offset:38912
    s_add_u32 s50, s50, 1024
    v_mfma_f32_16x16x32_bf16 v[88:91], v[168:171], a[12:15], v[88:91]
    v_mfma_f32_16x16x32_bf16 v[92:95], v[172:175], a[12:15], v[92:95]
    s_waitcnt lgkmcnt(10)
    v_mfma_f32_16x16x32_bf16 v[80:83], v[192:195], a[16:19], v[80:83]
    ds_read_b64_tr_b16 a[8:9], v9 offset:40960
    v_mfma_f32_16x16x32_bf16 v[84:87], v[196:199], a[16:19], v[84:87]
    ds_read_b64_tr_b16 a[10:11], v9 offset:43008
    v_mfma_f32_16x16x32_bf16 v[88:91], v[200:203], a[16:19], v[88:91]
    v_mfma_f32_16x16x32_bf16 v[92:95], v[204:207], a[16:19], v[92:95]
    s_waitcnt lgkmcnt(10)
    v_mfma_f32_16x16x32_bf16 v[80:83], v[224:227], a[20:23], v[80:83]
    ds_read_b64_tr_b16 a[12:13], v9 offset:45056
    v_mfma_f32_16x16x32_bf16 v[84:87], v[228:231], a[20:23], v[84:87]
    ds_read_b64_tr_b16 a[14:15], v9 offset:47104
    v_mfma_f32_16x16x32_bf16 v[88:91], v[232:235], a[20:23], v[88:91]
    v_mfma_f32_16x16x32_bf16 v[92:95], v[236:239], a[20:23], v[92:95]
    s_waitcnt lgkmcnt(10)
    v_mfma_f32_16x16x32_bf16 v[112:115], v[64:67], a[24:27], 0
    ds_read_b64_tr_b16 a[16:17], v10 offset:24576
    v_mfma_f32_16x16x32_bf16 v[116:119], v[68:71], a[24:27], 0
    ds_read_b64_tr_b16 a[18:19], v10 offset:26624
    v_mfma_f32_16x16x32_bf16 v[120:123], v[72:75], a[24:27], 0
    v_mfma_f32_16x16x32_bf16 v[124:127], v[76:79], a[24:27], 0
    s_waitcnt lgkmcnt(10)
    v_mfma_f32_16x16x32_bf16 v[112:115], v[96:99], a[28:31], v[112:115]
    ds_read_b64_tr_b16 a[20:21], v10 offset:28672
    v_cvt_pk_bf16_f32 v32, v80, v84
    v_mfma_f32_16x16x32_bf16 v[116:119], v[100:103], a[28:31], v[116:119]
    ds_read_b64_tr_b16 a[22:23], v10 offset:30720
    v_cvt_pk_bf16_f32 v33, v81, v85
    v_mfma_f32_16x16x32_bf16 v[120:123], v[104:107], a[28:31], v[120:123]
    v_cvt_pk_bf16_f32 v34, v82, v86
    v_cvt_pk_bf16_f32 v35, v83, v87
    v_mfma_f32_16x16x32_bf16 v[124:127], v[108:111], a[28:31], v[124:127]
    buffer_store_dwordx4 v[32:35], v20, s[8:11], s51 offen sc1
    s_waitcnt lgkmcnt(10)
    v_mfma_f32_16x16x32_bf16 v[112:115], v[128:131], a[0:3], v[112:115]
    ds_read_b64_tr_b16 a[24:25], v10 offset:32768
    v_cvt_pk_bf16_f32 v36, v88, v92
    v_mfma_f32_16x16x32_bf16 v[116:119], v[132:135], a[0:3], v[116:119]
    ds_read_b64_tr_b16 a[26:27], v10 offset:34816
    v_cvt_pk_bf16_f32 v37, v89, v93
    v_mfma_f32_16x16x32_bf16 v[120:123], v[136:139], a[0:3], v[120:123]
    v_cvt_pk_bf16_f32 v38, v90, v94
    v_cvt_pk_bf16_f32 v39, v91, v95
    v_mfma_f32_16x16x32_bf16 v[124:127], v[140:143], a[0:3], v[124:127]
    buffer_store_dwordx4 v[36:39], v21, s[8:11], s51 offen sc1
    s_waitcnt lgkmcnt(10)
    v_mfma_f32_16x16x32_bf16 v[112:115], v[160:163], a[4:7], v[112:115]
    ds_read_b64_tr_b16 a[28:29], v10 offset:36864
    s_mov_b32 s51, s50
    v_mfma_f32_16x16x32_bf16 v[116:119], v[164:167], a[4:7], v[116:119]
    ds_read_b64_tr_b16 a[30:31], v10 offset:38912
    s_add_u32 s50, s50, 1024
    v_mfma_f32_16x16x32_bf16 v[120:123], v[168:171], a[4:7], v[120:123]
    v_mfma_f32_16x16x32_bf16 v[124:127], v[172:175], a[4:7], v[124:127]
    s_waitcnt lgkmcnt(10)
    v_mfma_f32_16x16x32_bf16 v[112:115], v[192:195], a[8:11], v[112:115]
    ds_read_b64_tr_b16 a[0:1], v10 offset:40960
    v_mfma_f32_16x16x32_bf16 v[116:119], v[196:199], a[8:11], v[116:119]
    ds_read_b64_tr_b16 a[2:3], v10 offset:43008
    v_mfma_f32_16x16x32_bf16 v[120:123], v[200:203], a[8:11], v[120:123]
    v_mfma_f32_16x16x32_bf16 v[124:127], v[204:207], a[8:11], v[124:127]
    s_waitcnt lgkmcnt(10)
    v_mfma_f32_16x16x32_bf16 v[112:115], v[224:227], a[12:15], v[112:115]
    ds_read_b64_tr_b16 a[4:5], v10 offset:45056
    v_mfma_f32_16x16x32_bf16 v[116:119], v[228:231], a[12:15], v[116:119]
    ds_read_b64_tr_b16 a[6:7], v10 offset:47104
    v_mfma_f32_16x16x32_bf16 v[120:123], v[232:235], a[12:15], v[120:123]
    v_mfma_f32_16x16x32_bf16 v[124:127], v[236:239], a[12:15], v[124:127]
    s_waitcnt vmcnt(22)
    s_barrier
    s_waitcnt lgkmcnt(10)
    v_mfma_f32_16x16x32_bf16 v[144:147], v[64:67], a[16:19], 0
    ds_read_b64_tr_b16 a[8:9], v11 offset:24576
    s_cmp_lg_u32 s48, 0
    s_cbranch_scc1 Lsw_33
    s_cmp_lg_u32 s74, 0
    s_cbranch_scc0 Lsw2_34
    v_mov_b32 v12, v15
    v_add_u32 v13, 40960, v15
    v_add_u32 v14, 81920, v15
    s_mov_b32 s60, s16
    s_mov_b32 s61, s17
    s_mov_b32 s62, s18
    s_mov_b32 s45, s57
    s_mov_b32 s46, 122880
    s_mov_b32 s47, 128
    s_mov_b32 s48, s74
    s_mov_b32 s74, 0
    s_branch Lsw_33
Lsw2_34:
    v_mov_b32 v12, v56
    v_mov_b32 v13, v57
    v_mov_b32 v14, v58
    s_mov_b32 s60, s12
    s_mov_b32 s61, s13
    s_mov_b32 s62, s14
    s_cmp_lt_u32 s73, 3
    s_cselect_b32 s45, s58, 0x7f000000
    s_mov_b32 s46, 393216
    s_mov_b32 s47, 786432
    s_mov_b32 s48, 10
Lsw_33:
    v_mfma_f32_16x16x32_bf16 v[148:151], v[68:71], a[16:19], 0
    ds_read_b64_tr_b16 a[10:11], v11 offset:26624
    s_add_u32 s53, s45, s46
    v_mfma_f32_16x16x32_bf16 v[152:155], v[72:75], a[16:19], 0
    s_mov_b32 m0, s52
    s_nop 0
    buffer_load_dwordx4 v12, s[60:63], s45 offen lds
    v_mfma_f32_16x16x32_bf16 v[156:159], v[76:79], a[16:19], 0
    s_add_u32 m0, m0, 4096
    s_waitcnt lgkmcnt(10)
    v_mfma_f32_16x16x32_bf16 v[144:147], v[96:99], a[20:23], v[144:147]
    ds_read_b64_tr_b16 a[12:13], v11 offset:28672
    buffer_load_dwordx4 v13, s[60:63], s45 offen lds
    v_mfma_f32_16x16x32_bf16 v[148:151], v[100:103], a[20:23], v[148:151]
    ds_read_b64_tr_b16 a[14:15], v11 offset:30720
    s_add_u32 m0, m0, 4096
    v_mfma_f32_16x16x32_bf16 v[152:155], v[104:107], a[20:23], v[152:155]
    buffer_load_dwordx4 v14, s[60:63], s45 offen lds
    s_add_u32 m0, m0, 4096
    v_mfma_f32_16x16x32_bf16 v[156:159], v[108:111], a[20:23], v[156:159]
    buffer_load_dwordx4 v12, s[60:63], s53 offen lds
    s_waitcnt lgkmcnt(10)
    v_mfma_f32_16x16x32_bf16 v[144:147], v[128:131], a[24:27], v[144:147]
    ds_read_b64_tr_b16 a[16:17], v11 offset:32768
    s_add_u32 m0, m0, 4096
    v_mfma_f32_16x16x32_bf16 v[148:151], v[132:135], a[24:27], v[148:151]
    ds_read_b64_tr_b16 a[18:19], v11 offset:34816
    buffer_load_dwordx4 v13, s[60:63], s53 offen lds
    v_mfma_f32_16x16x32_bf16 v[152:155], v[136:139], a[24:27], v[152:155]
    s_add_u32 m0, m0, 4096
    s_nop 0
    buffer_load_dwordx4 v14, s[60:63], s53 offen lds
    v_mfma_f32_16x16x32_bf16 v[156:159], v[140:143], a[24:27], v[156:159]
    s_add_u32 s45, s45, s47
    s_waitcnt lgkmcnt(10)
    v_mfma_f32_16x16x32_bf16 v[144:147], v[160:163], a[28:31], v[144:147]
    ds_read_b64_tr_b16 a[20:21], v11 offset:36864
    s_sub_u32 s48, s48, 1
    v_mfma_f32_16x16x32_bf16 v[148:151], v[164:167], a[28:31], v[148:151]
    ds_read_b64_tr_b16 a[22:23], v11 offset:38912
    s_add_u32 s52, s52, 24576
    v_mfma_f32_16x16x32_bf16 v[152:155], v[168:171], a[28:31], v[152:155]
    s_cmp_ge_u32 s52, 98304
    s_cselect_b32 s53, 98304, 0
    v_mfma_f32_16x16x32_bf16 v[156:159], v[172:175], a[28:31], v[156:159]
    s_sub_u32 s52, s52, s53
    s_waitcnt lgkmcnt(10)
    v_mfma_f32_16x16x32_bf16 v[144:147], v[192:195], a[0:3], v[144:147]
    ds_read_b64_tr_b16 a[24:25], v11 offset:40960
    v_cvt_pk_bf16_f32 v24, v112, v116
    v_mfma_f32_16x16x32_bf16 v[148:151], v[196:199], a[0:3], v[148:151]
    ds_read_b64_tr_b16 a[26:27], v11 offset:43008
    v_cvt_pk_bf16_f32 v25, v113, v117
    v_mfma_f32_16x16x32_bf16 v[152:155], v[200:203], a[0:3], v[152:155]
    v_cvt_pk_bf16_f32 v26, v114, v118
    v_cvt_pk_bf16_f32 v27, v115, v119
    v_mfma_f32_16x16x32_bf16 v[156:159], v[204:207], a[0:3], v[156:159]
    buffer_store_dwordx4 v[24:27], v20, s[8:11], s51 offen sc1
    s_waitcnt lgkmcnt(10)
    v_mfma_f32_16x16x32_bf16 v[144:147], v[224:227], a[4:7], v[144:147]
    ds_read_b64_tr_b16 a[28:29], v11 offset:45056
    v_cvt_pk_bf16_f32 v28, v120, v124
    v_mfma_f32_16x16x32_bf16 v[148:151], v[228:231], a[4:7], v[148:151]
    ds_read_b64_tr_b16 a[30:31], v11 offset:47104
    v_cvt_pk_bf16_f32 v29, v121, v125
    v_mfma_f32_16x16x32_bf16 v[152:155], v[232:235], a[4:7], v[152:155]
    v_cvt_pk_bf16_f32 v30, v122, v126
    v_cvt_pk_bf16_f32 v31, v123, v127
    v_mfma_f32_16x16x32_bf16 v[156:159], v[236:239], a[4:7], v[156:159]
    buffer_store_dwordx4 v[28:31], v21, s[8:11], s51 offen sc1
    s_mov_b32 s51, s50
    s_add_u32 s50, s50, 1024
    s_waitcnt lgkmcnt(10)
    v_xor_b32 v8, 0xc000, v8
    v_xor_b32 v9, 0xc000, v9
    v_xor_b32 v10, 0xc000, v10
    v_xor_b32 v11, 0xc000, v11
    v_mfma_f32_16x16x32_bf16 v[176:179], v[64:67], a[8:11], 0
    ds_read_b64_tr_b16 a[0:1], v8 offset:0
    v_mfma_f32_16x16x32_bf16 v[180:183], v[68:71], a[8:11], 0
    ds_read_b64_tr_b16 a[2:3], v8 offset:2048
    v_mfma_f32_16x16x32_bf16 v[184:187], v[72:75], a[8:11], 0
    v_mfma_f32_16x16x32_bf16 v[188:191], v[76:79], a[8:11], 0
    s_waitcnt lgkmcnt(10)
    v_mfma_f32_16x16x32_bf16 v[176:179], v[96:99], a[12:15], v[176:179]
    ds_read_b64_tr_b16 a[4:5], v8 offset:4096
    v_cvt_pk_bf16_f32 v32, v144, v148
    v_mfma_f32_16x16x32_bf16 v[180:183], v[100:103], a[12:15], v[180:183]
    ds_read_b64_tr_b16 a[6:7], v8 offset:6144
    v_cvt_pk_bf16_f32 v33, v145, v149
    v_mfma_f32_16x16x32_bf16 v[184:187], v[104:107], a[12:15], v[184:187]
    v_cvt_pk_bf16_f32 v34, v146, v150
    v_cvt_pk_bf16_f32 v35, v147, v151
    v_mfma_f32_16x16x32_bf16 v[188:191], v[108:111], a[12:15], v[188:191]
    buffer_store_dwordx4 v[32:35], v20, s[8:11], s51 offen sc1
    s_waitcnt lgkmcnt(10)
    v_mfma_f32_16x16x32_bf16 v[176:179], v[128:131], a[16:19], v[176:179]
    ds_read_b64_tr_b16 a[8:9], v8 offset:8192
    v_cvt_pk_bf16_f32 v36, v152, v156
    v_mfma_f32_16x16x32_bf16 v[180:183], v[132:135], a[16:19], v[180:183]
    ds_read_b64_tr_b16 a[10:11], v8 offset:10240
    v_cvt_pk_bf16_f32 v37, v153, v157
    v_mfma_f32_16x16x32_bf16 v[184:187], v[136:139], a[16:19], v[184:187]
    v_cvt_pk_bf16_f32 v38, v154, v158
    v_cvt_pk_bf16_f32 v39, v155, v159
    v_mfma_f32_16x16x32_bf16 v[188:191], v[140:143], a[16:19], v[188:191]
    buffer_store_dwordx4 v[36:39], v21, s[8:11], s51 offen sc1
    s_waitcnt lgkmcnt(10)
    v_mfma_f32_16x16x32_bf16 v[176:179], v[160:163], a[20:23], v[176:179]
    ds_read_b64_tr_b16 a[12:13], v8 offset:12288
    s_mov_b32 s51, s50
    v_mfma_f32_16x16x32_bf16 v[180:183], v[164:167], a[20:23], v[180:183]
    ds_read_b64_tr_b16 a[14:15], v8 offset:14336
    s_add_u32 s50, s50, 1024
    v_mfma_f32_16x16x32_bf16 v[184:187], v[168:171], a[20:23], v[184:187]
    v_mfma_f32_16x16x32_bf16 v[188:191], v[172:175], a[20:23], v[188:191]
    s_waitcnt lgkmcnt(10)
    v_mfma_f32_16x16x32_bf16 v[176:179], v[192:195], a[24:27], v[176:179]
    ds_read_b64_tr_b16 a[16:17], v8 offset:16384
    v_mfma_f32_16x16x32_bf16 v[180:183], v[196:199], a[24:27], v[180:183]
    ds_read_b64_tr_b16 a[18:19], v8 offset:18432
    v_mfma_f32_16x16x32_bf16 v[184:187], v[200:203], a[24:27], v[184:187]
    v_mfma_f32_16x16x32_bf16 v[188:191], v[204:207], a[24:27], v[188:191]
    s_waitcnt lgkmcnt(10)
    v_mfma_f32_16x16x32_bf16 v[176:179], v[224:227], a[28:31], v[176:179]
    ds_read_b64_tr_b16 a[20:21], v8 offset:20480
    v_mfma_f32_16x16x32_bf16 v[180:183], v[228:231], a[28:31], v[180:183]
    ds_read_b64_tr_b16 a[22:23], v8 offset:22528
    v_mfma_f32_16x16x32_bf16 v[184:187], v[232:235], a[28:31], v[184:187]
    v_mfma_f32_16x16x32_bf16 v[188:191], v[236:239], a[28:31], v[188:191]
    s_sub_u32 s44, s44, 1
    s_cmp_lg_u32 s44, 0
    s_cbranch_scc1 g_s2_loop4
    s_nop 1
    v_cvt_pk_bf16_f32 v24, v176, v180
    v_cvt_pk_bf16_f32 v25, v177, v181
    v_cvt_pk_bf16_f32 v26, v178, v182
    v_cvt_pk_bf16_f32 v27, v179, v183
    buffer_store_dwordx4 v[24:27], v20, s[8:11], s51 offen sc1
    v_cvt_pk_bf16_f32 v28, v184, v188
    v_cvt_pk_bf16_f32 v29, v185, v189
    v_cvt_pk_bf16_f32 v30, v186, v190
    v_cvt_pk_bf16_f32 v31, v187, v191
    buffer_store_dwordx4 v[28:31], v21, s[8:11], s51 offen sc1
    s_nop 0
    s_branch g_fin
g_half:
    buffer_load_dwordx4 a[32:35], v16, s[8:11], s49 offen sc1
    buffer_load_dwordx4 a[36:39], v17, s[8:11], s49 offen sc1
    s_add_u32 s49, s49, 1024
    s_cmp_eq_u32 s49, s71
    s_cselect_b32 s49, s72, s49
    buffer_load_dwordx4 a[48:51], v16, s[8:11], s49 offen sc1
    buffer_load_dwordx4 a[52:55], v17, s[8:11], s49 offen sc1
    s_add_u32 s49, s49, 1024
    s_cmp_eq_u32 s49, s71
    s_cselect_b32 s49, s72, s49
    buffer_load_dwordx4 a[64:67], v16, s[8:11], s49 offen sc1
    buffer_load_dwordx4 a[68:71], v17, s[8:11], s49 offen sc1
    s_add_u32 s49, s49, 1024
    s_cmp_eq_u32 s49, s71
    s_cselect_b32 s49, s72, s49
    s_waitcnt vmcnt(0)
    s_barrier
    v_and_b32 v4, 0x3fff, v4
    v_or_b32 v4, s70, v4
    v_and_b32 v5, 0x3fff, v5
    v_or_b32 v5, s70, v5
    v_and_b32 v6, 0x3fff, v6
    v_or_b32 v6, s70, v6
    v_and_b32 v7, 0x3fff, v7
    v_or_b32 v7, s70, v7
    ds_read_b64_tr_b16 a[0:1], v4 offset:0
    ds_read_b64_tr_b16 a[2:3], v4 offset:6144
    ds_read_b64_tr_b16 a[4:5], v5 offset:0
    ds_read_b64_tr_b16 a[6:7], v5 offset:6144
    ds_read_b64_tr_b16 a[8:9], v6 offset:0
    ds_read_b64_tr_b16 a[10:11], v6 offset:6144
    ds_read_b64_tr_b16 a[12:13], v7 offset:0
    ds_read_b64_tr_b16 a[14:15], v7 offset:6144
    ds_read_b64_tr_b16 a[16:17], v4 offset:128
    ds_read_b64_tr_b16 a[18:19], v4 offset:6272
    ds_read_b64_tr_b16 a[20:21], v5 offset:128
    ds_read_b64_tr_b16 a[22:23], v5 offset:6272
    s_and_b32 s53, s44, 1
    s_mul_i32 s53, s53, 0xc000
    s_xor_b32 s70, s70, s53
g_s1_loop2:
    s_waitcnt vmcnt(10) lgkmcnt(10)
    v_mfma_f32_16x16x32_bf16 v[64:67], a[0:3], a[32:35], v[64:67]
    ds_read_b64_tr_b16 a[24:25], v6 offset:128
    buffer_load_dwordx4 a[80:83], v16, s[8:11], s49 offen sc1
    v_mfma_f32_16x16x32_bf16 v[68:71], a[0:3], a[36:39], v[68:71]
    ds_read_b64_tr_b16 a[26:27], v6 offset:6272
    buffer_load_dwordx4 a[84:87], v17, s[8:11], s49 offen sc1
    s_waitcnt lgkmcnt(10)
    v_mfma_f32_16x16x32_bf16 v[80:83], a[4:7], a[32:35], v[80:83]
    ds_read_b64_tr_b16 a[28:29], v7 offset:128
    s_add_u32 s49, s49, 1024
    v_mfma_f32_16x16x32_bf16 v[84:87], a[4:7], a[36:39], v[84:87]
    ds_read_b64_tr_b16 a[30:31], v7 offset:6272
    s_cmp_eq_u32 s49, s71
    s_waitcnt lgkmcnt(10)
    v_mfma_f32_16x16x32_bf16 v[96:99], a[8:11], a[32:35], v[96:99]
    ds_read_b64_tr_b16 a[0:1], v4 offset:256
    s_cselect_b32 s49, s72, s49
    v_mfma_f32_16x16x32_bf16 v[100:103], a[8:11], a[36:39], v[100:103]
    ds_read_b64_tr_b16 a[2:3], v4 offset:6400
    s_waitcnt lgkmcnt(10)
    v_mfma_f32_16x16x32_bf16 v[112:115], a[12:15], a[32:35], v[112:115]
    ds_read_b64_tr_b16 a[4:5], v5 offset:256
    v_mfma_f32_16x16x32_bf16 v[116:119], a[12:15], a[36:39], v[116:119]
    ds_read_b64_tr_b16 a[6:7], v5 offset:6400
    s_waitcnt lgkmcnt(10)
    v_mfma_f32_16x16x32_bf16 v[128:131], a[16:19], a[32:35], v[128:131]
    ds_read_b64_tr_b16 a[8:9], v6 offset:256
    v_mfma_f32_16x16x32_bf16 v[132:135], a[16:19], a[36:39], v[132:135]
    ds_read_b64_tr_b16 a[10:11], v6 offset:6400
    s_waitcnt lgkmcnt(10)
    v_mfma_f32_16x16x32_bf16 v[144:147], a[20:23], a[32:35], v[144:147]
    ds_read_b64_tr_b16 a[12:13], v7 offset:256
    v_mfma_f32_16x16x32_bf16 v[148:151], a[20:23], a[36:39], v[148:151]
    ds_read_b64_tr_b16 a[14:15], v7 offset:6400
    s_waitcnt lgkmcnt(10)
    v_mfma_f32_16x16x32_bf16 v[160:163], a[24:27], a[32:35], v[160:163]
    ds_read_b64_tr_b16 a[16:17], v4 offset:12288
    v_mfma_f32_16x16x32_bf16 v[164:167], a[24:27], a[36:39], v[164:167]
    ds_read_b64_tr_b16 a[18:19], v4 offset:18432
    s_waitcnt lgkmcnt(10)
    v_mfma_f32_16x16x32_bf16 v[176:179], a[28:31], a[32:35], v[176:179]
    ds_read_b64_tr_b16 a[20:21], v5 offset:12288
    v_mfma_f32_16x16x32_bf16 v[180:183], a[28:31], a[36:39], v[180:183]
    ds_read_b64_tr_b16 a[22:23], v5 offset:18432
    s_waitcnt lgkmcnt(10)
    v_mfma_f32_16x16x32_bf16 v[192:195], a[0:3], a[32:35], v[192:195]
    ds_read_b64_tr_b16 a[24:25], v6 offset:12288
    v_mfma_f32_16x16x32_bf16 v[196:199], a[0:3], a[36:39], v[196:199]
    ds_read_b64_tr_b16 a[26:27], v6 offset:18432
    s_waitcnt lgkmcnt(10)
    v_mfma_f32_16x16x32_bf16 v[208:211], a[4:7], a[32:35], v[208:211]
    ds_read_b64_tr_b16 a[28:29], v7 offset:12288
    v_mfma_f32_16x16x32_bf16 v[212:215], a[4:7], a[36:39], v[212:215]
    ds_read_b64_tr_b16 a[30:31], v7 offset:18432
    s_waitcnt lgkmcnt(10)
    v_mfma_f32_16x16x32_bf16 v[224:227], a[8:11], a[32:35], v[224:227]
    ds_read_b64_tr_b16 a[0:1], v4 offset:12416
    v_mfma_f32_16x16x32_bf16 v[228:231], a[8:11], a[36:39], v[228:231]
    ds_read_b64_tr_b16 a[2:3], v4 offset:18560
    s_waitcnt lgkmcnt(10)
    v_mfma_f32_16x16x32_bf16 v[240:243], a[12:15], a[32:35], v[240:243]
    ds_read_b64_tr_b16 a[4:5], v5 offset:12416
    v_mfma_f32_16x16x32_bf16 v[244:247], a[12:15], a[36:39], v[244:247]
    ds_read_b64_tr_b16 a[6:7], v5 offset:18560
    s_barrier
    s_waitcnt vmcnt(10) lgkmcnt(10)
    v_mfma_f32_16x16x32_bf16 v[64:67], a[16:19], a[48:51], v[64:67]
    ds_read_b64_tr_b16 a[8:9], v6 offset:12416
    s_cmp_lg_u32 s48, 0
    s_cbranch_scc1 Lsw_35
    s_cmp_lg_u32 s74, 0
    s_cbranch_scc0 Lsw2_36
    v_mov_b32 v12, v15
    v_add_u32 v13, 40960, v15
    v_add_u32 v14, 81920, v15
    s_mov_b32 s60, s16
    s_mov_b32 s61, s17
    s_mov_b32 s62, s18
    s_mov_b32 s45, s57
    s_mov_b32 s46, 122880
    s_mov_b32 s47, 128
    s_mov_b32 s48, s74
    s_mov_b32 s74, 0
    s_branch Lsw_35
Lsw2_36:
    v_mov_b32 v12, v56
    v_mov_b32 v13, v57
    v_mov_b32 v14, v58
    s_mov_b32 s60, s12
    s_mov_b32 s61, s13
    s_mov_b32 s62, s14
    s_cmp_lt_u32 s73, 3
    s_cselect_b32 s45, s58, 0x7f000000
    s_mov_b32 s46, 393216
    s_mov_b32 s47, 786432
    s_mov_b32 s48, 10
Lsw_35:
    v_mfma_f32_16x16x32_bf16 v[68:71], a[16:19], a[52:55], v[68:71]
    ds_read_b64_tr_b16 a[10:11], v6 offset:18560
    s_add_u32 s53, s45, s46
    s_waitcnt lgkmcnt(10)
    v_mfma_f32_16x16x32_bf16 v[80:83], a[20:23], a[48:51], v[80:83]
    ds_read_b64_tr_b16 a[12:13], v7 offset:12416
    s_mov_b32 m0, s52
    v_mfma_f32_16x16x32_bf16 v[84:87], a[20:23], a[52:55], v[84:87]
    ds_read_b64_tr_b16 a[14:15], v7 offset:18560
    buffer_load_dwordx4 v12, s[60:63], s45 offen lds
    s_waitcnt lgkmcnt(10)
    v_mfma_f32_16x16x32_bf16 v[96:99], a[24:27], a[48:51], v[96:99]
    ds_read_b64_tr_b16 a[16:17], v4 offset:12544
    s_add_u32 m0, m0, 4096
    v_mfma_f32_16x16x32_bf16 v[100:103], a[24:27], a[52:55], v[100:103]
    ds_read_b64_tr_b16 a[18:19], v4 offset:18688
    buffer_load_dwordx4 v13, s[60:63], s45 offen lds
    s_waitcnt lgkmcnt(10)
    v_mfma_f32_16x16x32_bf16 v[112:115], a[28:31], a[48:51], v[112:115]
    ds_read_b64_tr_b16 a[20:21], v5 offset:12544
    s_add_u32 m0, m0, 4096
    v_mfma_f32_16x16x32_bf16 v[116:119], a[28:31], a[52:55], v[116:119]
    ds_read_b64_tr_b16 a[22:23], v5 offset:18688
    buffer_load_dwordx4 v14, s[60:63], s45 offen lds
    s_waitcnt lgkmcnt(10)
    v_mfma_f32_16x16x32_bf16 v[128:131], a[0:3], a[48:51], v[128:131]
    ds_read_b64_tr_b16 a[24:25], v6 offset:12544
    s_add_u32 m0, m0, 4096
    v_mfma_f32_16x16x32_bf16 v[132:135], a[0:3], a[52:55], v[132:135]
    ds_read_b64_tr_b16 a[26:27], v6 offset:18688
    buffer_load_dwordx4 v12, s[60:63], s53 offen lds
    s_waitcnt lgkmcnt(10)
    v_mfma_f32_16x16x32_bf16 v[144:147], a[4:7], a[48:51], v[144:147]
    ds_read_b64_tr_b16 a[28:29], v7 offset:12544
    s_add_u32 m0, m0, 4096
    v_mfma_f32_16x16x32_bf16 v[148:151], a[4:7], a[52:55], v[148:151]
    ds_read_b64_tr_b16 a[30:31], v7 offset:18688
    buffer_load_dwordx4 v13, s[60:63], s53 offen lds
    s_waitcnt lgkmcnt(10)
    v_mfma_f32_16x16x32_bf16 v[160:163], a[8:11], a[48:51], v[160:163]
    ds_read_b64_tr_b16 a[0:1], v4 offset:24576
    s_add_u32 m0, m0, 4096
    v_mfma_f32_16x16x32_bf16 v[164:167], a[8:11], a[52:55], v[164:167]
    ds_read_b64_tr_b16 a[2:3], v4 offset:30720
    buffer_load_dwordx4 v14, s[60:63], s53 offen lds
    s_waitcnt lgkmcnt(10)
    v_mfma_f32_16x16x32_bf16 v[176:179], a[12:15], a[48:51], v[176:179]
    ds_read_b64_tr_b16 a[4:5], v5 offset:24576
    s_add_u32 s45, s45, s47
    v_mfma_f32_16x16x32_bf16 v[180:183], a[12:15], a[52:55], v[180:183]
    ds_read_b64_tr_b16 a[6:7], v5 offset:30720
    s_sub_u32 s48, s48, 1
    s_waitcnt lgkmcnt(10)
    v_mfma_f32_16x16x32_bf16 v[192:195], a[16:19], a[48:51], v[192:195]
    ds_read_b64_tr_b16 a[8:9], v6 offset:24576
    s_add_u32 s52, s52, 24576
    v_mfma_f32_16x16x32_bf16 v[196:199], a[16:19], a[52:55], v[196:199]
    ds_read_b64_tr_b16 a[10:11], v6 offset:30720
    s_cmp_ge_u32 s52, 98304
    s_waitcnt lgkmcnt(10)
    v_mfma_f32_16x16x32_bf16 v[208:211], a[20:23], a[48:51], v[208:211]
    ds_read_b64_tr_b16 a[12:13], v7 offset:24576
    s_cselect_b32 s53, 98304, 0
    v_mfma_f32_16x16x32_bf16 v[212:215], a[20:23], a[52:55], v[212:215]
    ds_read_b64_tr_b16 a[14:15], v7 offset:30720
    s_sub_u32 s52, s52, s53
    s_waitcnt lgkmcnt(10)
    v_mfma_f32_16x16x32_bf16 v[224:227], a[24:27], a[48:51], v[224:227]
    ds_read_b64_tr_b16 a[16:17], v4 offset:24704
    buffer_load_dwordx4 a[32:35], v16, s[8:11], s49 offen sc1
    v_mfma_f32_16x16x32_bf16 v[228:231], a[24:27], a[52:55], v[228:231]
    ds_read_b64_tr_b16 a[18:19], v4 offset:30848
    buffer_load_dwordx4 a[36:39], v17, s[8:11], s49 offen sc1
    s_waitcnt lgkmcnt(10)
    v_mfma_f32_16x16x32_bf16 v[240:243], a[28:31], a[48:51], v[240:243]
    ds_read_b64_tr_b16 a[20:21], v5 offset:24704
    s_add_u32 s49, s49, 1024
    v_mfma_f32_16x16x32_bf16 v[244:247], a[28:31], a[52:55], v[244:247]
    ds_read_b64_tr_b16 a[22:23], v5 offset:30848
    s_cmp_eq_u32 s49, s71
    s_cselect_b32 s49, s72, s49
    s_waitcnt vmcnt(10) lgkmcnt(10)
    v_mfma_f32_16x16x32_bf16 v[64:67], a[0:3], a[64:67], v[64:67]
    ds_read_b64_tr_b16 a[24:25], v6 offset:24704
    buffer_load_dwordx4 a[48:51], v16, s[8:11], s49 offen sc1
    v_mfma_f32_16x16x32_bf16 v[68:71], a[0:3], a[68:71], v[68:71]
    ds_read_b64_tr_b16 a[26:27], v6 offset:30848
    buffer_load_dwordx4 a[52:55], v17, s[8:11], s49 offen sc1
    s_waitcnt lgkmcnt(10)
    v_mfma_f32_16x16x32_bf16 v[80:83], a[4:7], a[64:67], v[80:83]
    ds_read_b64_tr_b16 a[28:29], v7 offset:24704
    s_add_u32 s49, s49, 1024
    v_mfma_f32_16x16x32_bf16 v[84:87], a[4:7], a[68:71], v[84:87]
    ds_read_b64_tr_b16 a[30:31], v7 offset:30848
    s_cmp_eq_u32 s49, s71
    s_waitcnt lgkmcnt(10)
    v_mfma_f32_16x16x32_bf16 v[96:99], a[8:11], a[64:67], v[96:99]
    ds_read_b64_tr_b16 a[0:1], v4 offset:24832
    s_cselect_b32 s49, s72, s49
    v_mfma_f32_16x16x32_bf16 v[100:103], a[8:11], a[68:71], v[100:103]
    ds_read_b64_tr_b16 a[2:3], v4 offset:30976
    s_waitcnt lgkmcnt(10)
    v_mfma_f32_16x16x32_bf16 v[112:115], a[12:15], a[64:67], v[112:115]
    ds_read_b64_tr_b16 a[4:5], v5 offset:24832
    v_mfma_f32_16x16x32_bf16 v[116:119], a[12:15], a[68:71], v[116:119]
    ds_read_b64_tr_b16 a[6:7], v5 offset:30976
    s_waitcnt lgkmcnt(10)
    v_mfma_f32_16x16x32_bf16 v[128:131], a[16:19], a[64:67], v[128:131]
    ds_read_b64_tr_b16 a[8:9], v6 offset:24832
    v_mfma_f32_16x16x32_bf16 v[132:135], a[16:19], a[68:71], v[132:135]
    ds_read_b64_tr_b16 a[10:11], v6 offset:30976
    s_waitcnt lgkmcnt(10)
    v_mfma_f32_16x16x32_bf16 v[144:147], a[20:23], a[64:67], v[144:147]
    ds_read_b64_tr_b16 a[12:13], v7 offset:24832
    v_mfma_f32_16x16x32_bf16 v[148:151], a[20:23], a[68:71], v[148:151]
    ds_read_b64_tr_b16 a[14:15], v7 offset:30976
    s_waitcnt lgkmcnt(10)
    v_mfma_f32_16x16x32_bf16 v[160:163], a[24:27], a[64:67], v[160:163]
    ds_read_b64_tr_b16 a[16:17], v4 offset:36864
    v_mfma_f32_16x16x32_bf16 v[164:167], a[24:27], a[68:71], v[164:167]
    ds_read_b64_tr_b16 a[18:19], v4 offset:43008
    s_waitcnt lgkmcnt(10)
    v_mfma_f32_16x16x32_bf16 v[176:179], a[28:31], a[64:67], v[176:179]
    ds_read_b64_tr_b16 a[20:21], v5 offset:36864
    v_mfma_f32_16x16x32_bf16 v[180:183], a[28:31], a[68:71], v[180:183]
    ds_read_b64_tr_b16 a[22:23], v5 offset:43008
    s_waitcnt lgkmcnt(10)
    v_mfma_f32_16x16x32_bf16 v[192:195], a[0:3], a[64:67], v[192:195]
    ds_read_b64_tr_b16 a[24:25], v6 offset:36864
    v_mfma_f32_16x16x32_bf16 v[196:199], a[0:3], a[68:71], v[196:199]
    ds_read_b64_tr_b16 a[26:27], v6 offset:43008
    s_waitcnt lgkmcnt(10)
    v_mfma_f32_16x16x32_bf16 v[208:211], a[4:7], a[64:67], v[208:211]
    ds_read_b64_tr_b16 a[28:29], v7 offset:36864
    v_mfma_f32_16x16x32_bf16 v[212:215], a[4:7], a[68:71], v[212:215]
    ds_read_b64_tr_b16 a[30:31], v7 offset:43008
    s_waitcnt lgkmcnt(10)
    v_mfma_f32_16x16x32_bf16 v[224:227], a[8:11], a[64:67], v[224:227]
    ds_read_b64_tr_b16 a[0:1], v4 offset:36992
    v_mfma_f32_16x16x32_bf16 v[228:231], a[8:11], a[68:71], v[228:231]
    ds_read_b64_tr_b16 a[2:3], v4 offset:43136
    s_waitcnt lgkmcnt(10)
    v_mfma_f32_16x16x32_bf16 v[240:243], a[12:15], a[64:67], v[240:243]
    ds_read_b64_tr_b16 a[4:5], v5 offset:36992
    v_mfma_f32_16x16x32_bf16 v[244:247], a[12:15], a[68:71], v[244:247]
    ds_read_b64_tr_b16 a[6:7], v5 offset:43136
    s_barrier
    s_waitcnt vmcnt(10) lgkmcnt(10)
    v_mfma_f32_16x16x32_bf16 v[64:67], a[16:19], a[80:83], v[64:67]
    ds_read_b64_tr_b16 a[8:9], v6 offset:36992
    s_cmp_lg_u32 s48, 0
    s_cbranch_scc1 Lsw_37
    s_cmp_lg_u32 s74, 0
    s_cbranch_scc0 Lsw2_38
    v_mov_b32 v12, v15
    v_add_u32 v13, 40960, v15
    v_add_u32 v14, 81920, v15
    s_mov_b32 s60, s16
    s_mov_b32 s61, s17
    s_mov_b32 s62, s18
    s_mov_b32 s45, s57
    s_mov_b32 s46, 122880
    s_mov_b32 s47, 128
    s_mov_b32 s48, s74
    s_mov_b32 s74, 0
    s_branch Lsw_37
Lsw2_38:
    v_mov_b32 v12, v56
    v_mov_b32 v13, v57
    v_mov_b32 v14, v58
    s_mov_b32 s60, s12
    s_mov_b32 s61, s13
    s_mov_b32 s62, s14
    s_cmp_lt_u32 s73, 3
    s_cselect_b32 s45, s58, 0x7f000000
    s_mov_b32 s46, 393216
    s_mov_b32 s47, 786432
    s_mov_b32 s48, 10
Lsw_37:
    v_mfma_f32_16x16x32_bf16 v[68:71], a[16:19], a[84:87], v[68:71]
    ds_read_b64_tr_b16 a[10:11], v6 offset:43136
    s_add_u32 s53, s45, s46
    s_waitcnt lgkmcnt(10)
    v_mfma_f32_16x16x32_bf16 v[80:83], a[20:23], a[80:83], v[80:83]
    ds_read_b64_tr_b16 a[12:13], v7 offset:36992
    s_mov_b32 m0, s52
    v_mfma_f32_16x16x32_bf16 v[84:87], a[20:23], a[84:87], v[84:87]
    ds_read_b64_tr_b16 a[14:15], v7 offset:43136
    buffer_load_dwordx4 v12, s[60:63], s45 offen lds
    s_waitcnt lgkmcnt(10)
    v_mfma_f32_16x16x32_bf16 v[96:99], a[24:27], a[80:83], v[96:99]
    ds_read_b64_tr_b16 a[16:17], v4 offset:37120
    s_add_u32 m0, m0, 4096
    v_mfma_f32_16x16x32_bf16 v[100:103], a[24:27], a[84:87], v[100:103]
    ds_read_b64_tr_b16 a[18:19], v4 offset:43264
    buffer_load_dwordx4 v13, s[60:63], s45 offen lds
    s_waitcnt lgkmcnt(10)
    v_mfma_f32_16x16x32_bf16 v[112:115], a[28:31], a[80:83], v[112:115]
    ds_read_b64_tr_b16 a[20:21], v5 offset:37120
    s_add_u32 m0, m0, 4096
    v_mfma_f32_16x16x32_bf16 v[116:119], a[28:31], a[84:87], v[116:119]
    ds_read_b64_tr_b16 a[22:23], v5 offset:43264
    buffer_load_dwordx4 v14, s[60:63], s45 offen lds
    s_waitcnt lgkmcnt(10)
    v_mfma_f32_16x16x32_bf16 v[128:131], a[0:3], a[80:83], v[128:131]
    ds_read_b64_tr_b16 a[24:25], v6 offset:37120
    s_add_u32 m0, m0, 4096
    v_mfma_f32_16x16x32_bf16 v[132:135], a[0:3], a[84:87], v[132:135]
    ds_read_b64_tr_b16 a[26:27], v6 offset:43264
    buffer_load_dwordx4 v12, s[60:63], s53 offen lds
    s_waitcnt lgkmcnt(10)
    v_mfma_f32_16x16x32_bf16 v[144:147], a[4:7], a[80:83], v[144:147]
    ds_read_b64_tr_b16 a[28:29], v7 offset:37120
    s_add_u32 m0, m0, 4096
    v_mfma_f32_16x16x32_bf16 v[148:151], a[4:7], a[84:87], v[148:151]
    ds_read_b64_tr_b16 a[30:31], v7 offset:43264
    buffer_load_dwordx4 v13, s[60:63], s53 offen lds
    s_waitcnt lgkmcnt(10)
    v_xor_b32 v4, 0xc000, v4
    v_xor_b32 v5, 0xc000, v5
    v_xor_b32 v6, 0xc000, v6
    v_xor_b32 v7, 0xc000, v7
    v_mfma_f32_16x16x32_bf16 v[160:163], a[8:11], a[80:83], v[160:163]
    ds_read_b64_tr_b16 a[0:1], v4 offset:0
    s_add_u32 m0, m0, 4096
    v_mfma_f32_16x16x32_bf16 v[164:167], a[8:11], a[84:87], v[164:167]
    ds_read_b64_tr_b16 a[2:3], v4 offset:6144
    buffer_load_dwordx4 v14, s[60:63], s53 offen lds
    s_waitcnt lgkmcnt(10)
    v_mfma_f32_16x16x32_bf16 v[176:179], a[12:15], a[80:83], v[176:179]
    ds_read_b64_tr_b16 a[4:5], v5 offset:0
    s_add_u32 s45, s45, s47
    v_mfma_f32_16x16x32_bf16 v[180:183], a[12:15], a[84:87], v[180:183]
    ds_read_b64_tr_b16 a[6:7], v5 offset:6144
    s_sub_u32 s48, s48, 1
    s_waitcnt lgkmcnt(10)
    v_mfma_f32_16x16x32_bf16 v[192:195], a[16:19], a[80:83], v[192:195]
    ds_read_b64_tr_b16 a[8:9], v6 offset:0
    s_add_u32 s52, s52, 24576
    v_mfma_f32_16x16x32_bf16 v[196:199], a[16:19], a[84:87], v[196:199]
    ds_read_b64_tr_b16 a[10:11], v6 offset:6144
    s_cmp_ge_u32 s52, 98304
    s_waitcnt lgkmcnt(10)
    v_mfma_f32_16x16x32_bf16 v[208:211], a[20:23], a[80:83], v[208:211]
    ds_read_b64_tr_b16 a[12:13], v7 offset:0
    s_cselect_b32 s53, 98304, 0
    v_mfma_f32_16x16x32_bf16 v[212:215], a[20:23], a[84:87], v[212:215]
    ds_read_b64_tr_b16 a[14:15], v7 offset:6144
    s_sub_u32 s52, s52, s53
    s_waitcnt lgkmcnt(10)
    v_mfma_f32_16x16x32_bf16 v[224:227], a[24:27], a[80:83], v[224:227]
    ds_read_b64_tr_b16 a[16:17], v4 offset:128
    buffer_load_dwordx4 a[64:67], v16, s[8:11], s49 offen sc1
    v_mfma_f32_16x16x32_bf16 v[228:231], a[24:27], a[84:87], v[228:231]
    ds_read_b64_tr_b16 a[18:19], v4 offset:6272
    buffer_load_dwordx4 a[68:71], v17, s[8:11], s49 offen sc1
    s_waitcnt lgkmcnt(10)
    v_mfma_f32_16x16x32_bf16 v[240:243], a[28:31], a[80:83], v[240:243]
    ds_read_b64_tr_b16 a[20:21], v5 offset:128
    s_add_u32 s49, s49, 1024
    v_mfma_f32_16x16x32_bf16 v[244:247], a[28:31], a[84:87], v[244:247]
    ds_read_b64_tr_b16 a[22:23], v5 offset:6272
    s_cmp_eq_u32 s49, s71
    s_cselect_b32 s49, s72, s49
    s_sub_u32 s44, s44, 1
    s_cmp_lg_u32 s44, 0
    s_cbranch_scc1 g_s1_loop2
    s_waitcnt lgkmcnt(0)
    s_cmp_eq_u32 s40, 0
    s_cbranch_scc0 g_epi1
    v_and_b32 v8, 0x3fff, v8
    v_or_b32 v8, s70, v8
    v_and_b32 v9, 0x3fff, v9
    v_or_b32 v9, s70, v9
    v_and_b32 v10, 0x3fff, v10
    v_or_b32 v10, s70, v10
    v_and_b32 v11, 0x3fff, v11
    v_or_b32 v11, s70, v11
    ds_read_b64_tr_b16 a[0:1], v8 offset:0
    ds_read_b64_tr_b16 a[2:3], v8 offset:2048
    ds_read_b64_tr_b16 a[4:5], v8 offset:4096
    ds_read_b64_tr_b16 a[6:7], v8 offset:6144
    ds_read_b64_tr_b16 a[8:9], v8 offset:8192
    ds_read_b64_tr_b16 a[10:11], v8 offset:10240
    ds_read_b64_tr_b16 a[12:13], v8 offset:12288
    ds_read_b64_tr_b16 a[14:15], v8 offset:14336
    ds_read_b64_tr_b16 a[16:17], v8 offset:16384
    ds_read_b64_tr_b16 a[18:19], v8 offset:18432
    ds_read_b64_tr_b16 a[20:21], v8 offset:20480
    ds_read_b64_tr_b16 a[22:23], v8 offset:22528
    s_and_b32 s53, s56, 1
    s_mul_i32 s53, s53, 0xc000
    s_xor_b32 s70, s70, s53
    v_cvt_pk_bf16_f32 v64, v64, v65
    v_cvt_pk_bf16_f32 v65, v66, v67
    v_cvt_pk_bf16_f32 v66, v80, v81
    v_cvt_pk_bf16_f32 v67, v82, v83
    v_cvt_pk_bf16_f32 v68, v68, v69
    v_cvt_pk_bf16_f32 v69, v70, v71
    v_cvt_pk_bf16_f32 v70, v84, v85
    v_cvt_pk_bf16_f32 v71, v86, v87
    v_cvt_pk_bf16_f32 v96, v96, v97
    v_cvt_pk_bf16_f32 v97, v98, v99
    v_cvt_pk_bf16_f32 v98, v112, v113
    v_cvt_pk_bf16_f32 v99, v114, v115
    v_cvt_pk_bf16_f32 v100, v100, v101
    v_cvt_pk_bf16_f32 v101, v102, v103
    v_cvt_pk_bf16_f32 v102, v116, v117
    v_cvt_pk_bf16_f32 v103, v118, v119
    v_cvt_pk_bf16_f32 v128, v128, v129
    v_cvt_pk_bf16_f32 v129, v130, v131
    v_cvt_pk_bf16_f32 v130, v144, v145
    v_cvt_pk_bf16_f32 v131, v146, v147
    v_cvt_pk_bf16_f32 v132, v132, v133
    v_cvt_pk_bf16_f32 v133, v134, v135
    v_cvt_pk_bf16_f32 v134, v148, v149
    v_cvt_pk_bf16_f32 v135, v150, v151
    v_cvt_pk_bf16_f32 v160, v160, v161
    v_cvt_pk_bf16_f32 v161, v162, v163
    v_cvt_pk_bf16_f32 v162, v176, v177
    v_cvt_pk_bf16_f32 v163, v178, v179
    v_cvt_pk_bf16_f32 v164, v164, v165
    v_cvt_pk_bf16_f32 v165, v166, v167
    v_cvt_pk_bf16_f32 v166, v180, v181
    v_cvt_pk_bf16_f32 v167, v182, v183
    v_cvt_pk_bf16_f32 v192, v192, v193
    v_cvt_pk_bf16_f32 v193, v194, v195
    v_cvt_pk_bf16_f32 v194, v208, v209
    v_cvt_pk_bf16_f32 v195, v210, v211
    v_cvt_pk_bf16_f32 v196, v196, v197
    v_cvt_pk_bf16_f32 v197, v198, v199
    v_cvt_pk_bf16_f32 v198, v212, v213
    v_cvt_pk_bf16_f32 v199, v214, v215
    v_cvt_pk_bf16_f32 v224, v224, v225
    v_cvt_pk_bf16_f32 v225, v226, v227
    v_cvt_pk_bf16_f32 v226, v240, v241
    v_cvt_pk_bf16_f32 v227, v242, v243
    v_cvt_pk_bf16_f32 v228, v228, v229
    v_cvt_pk_bf16_f32 v229, v230, v231
    v_cvt_pk_bf16_f32 v230, v244, v245
    v_cvt_pk_bf16_f32 v231, v246, v247
    s_mov_b32 s44, s56
    s_nop 0
g_s2_loop2:
    s_waitcnt lgkmcnt(10)
    v_mfma_f32_16x16x32_bf16 v[80:83], v[64:67], a[0:3], 0
    ds_read_b64_tr_b16 a[24:25], v9 offset:0
    v_mfma_f32_16x16x32_bf16 v[84:87], v[68:71], a[0:3], 0
    ds_read_b64_tr_b16 a[26:27], v9 offset:2048
    s_waitcnt lgkmcnt(10)
    v_mfma_f32_16x16x32_bf16 v[80:83], v[96:99], a[4:7], v[80:83]
    ds_read_b64_tr_b16 a[28:29], v9 offset:4096
    v_mfma_f32_16x16x32_bf16 v[84:87], v[100:103], a[4:7], v[84:87]
    ds_read_b64_tr_b16 a[30:31], v9 offset:6144
    s_waitcnt lgkmcnt(10)
    v_mfma_f32_16x16x32_bf16 v[80:83], v[128:131], a[8:11], v[80:83]
    ds_read_b64_tr_b16 a[0:1], v9 offset:8192
    v_cvt_pk_bf16_f32 v24, v176, v180
    v_mfma_f32_16x16x32_bf16 v[84:87], v[132:135], a[8:11], v[84:87]
    ds_read_b64_tr_b16 a[2:3], v9 offset:10240
    v_cvt_pk_bf16_f32 v25, v177, v181
    s_waitcnt lgkmcnt(10)
    v_mfma_f32_16x16x32_bf16 v[80:83], v[160:163], a[12:15], v[80:83]
    ds_read_b64_tr_b16 a[4:5], v9 offset:12288
    v_cvt_pk_bf16_f32 v26, v178, v182
    v_mfma_f32_16x16x32_bf16 v[84:87], v[164:167], a[12:15], v[84:87]
    ds_read_b64_tr_b16 a[6:7], v9 offset:14336
    v_cvt_pk_bf16_f32 v27, v179, v183
    s_waitcnt lgkmcnt(10)
    v_mfma_f32_16x16x32_bf16 v[80:83], v[192:195], a[16:19], v[80:83]
    ds_read_b64_tr_b16 a[8:9], v9 offset:16384
    buffer_store_dwordx4 v[24:27], v20, s[8:11], s51 offen sc1
    v_mfma_f32_16x16x32_bf16 v[84:87], v[196:199], a[16:19], v[84:87]
    ds_read_b64_tr_b16 a[10:11], v9 offset:18432
    s_mov_b32 s51, s50
    s_waitcnt lgkmcnt(10)
    v_mfma_f32_16x16x32_bf16 v[80:83], v[224:227], a[20:23], v[80:83]
    ds_read_b64_tr_b16 a[12:13], v9 offset:20480
    s_add_u32 s50, s50, 1024
    v_mfma_f32_16x16x32_bf16 v[84:87], v[228:231], a[20:23], v[84:87]
    ds_read_b64_tr_b16 a[14:15], v9 offset:22528
    s_waitcnt lgkmcnt(10)
    v_mfma_f32_16x16x32_bf16 v[112:115], v[64:67], a[24:27], 0
    ds_read_b64_tr_b16 a[16:17], v10 offset:0
    v_mfma_f32_16x16x32_bf16 v[116:119], v[68:71], a[24:27], 0
    ds_read_b64_tr_b16 a[18:19], v10 offset:2048
    s_waitcnt lgkmcnt(10)
    v_mfma_f32_16x16x32_bf16 v[112:115], v[96:99], a[28:31], v[112:115]
    ds_read_b64_tr_b16 a[20:21], v10 offset:4096
    v_mfma_f32_16x16x32_bf16 v[116:119], v[100:103], a[28:31], v[116:119]
    ds_read_b64_tr_b16 a[22:23], v10 offset:6144
    s_waitcnt lgkmcnt(10)
    v_mfma_f32_16x16x32_bf16 v[112:115], v[128:131], a[0:3], v[112:115]
    ds_read_b64_tr_b16 a[24:25], v10 offset:8192
    v_cvt_pk_bf16_f32 v32, v80, v84
    v_mfma_f32_16x16x32_bf16 v[116:119], v[132:135], a[0:3], v[116:119]
    ds_read_b64_tr_b16 a[26:27], v10 offset:10240
    v_cvt_pk_bf16_f32 v33, v81, v85
    s_waitcnt lgkmcnt(10)
    v_mfma_f32_16x16x32_bf16 v[112:115], v[160:163], a[4:7], v[112:115]
    ds_read_b64_tr_b16 a[28:29], v10 offset:12288
    v_cvt_pk_bf16_f32 v34, v82, v86
    v_mfma_f32_16x16x32_bf16 v[116:119], v[164:167], a[4:7], v[116:119]
    ds_read_b64_tr_b16 a[30:31], v10 offset:14336
    v_cvt_pk_bf16_f32 v35, v83, v87
    s_waitcnt lgkmcnt(10)
    v_mfma_f32_16x16x32_bf16 v[112:115], v[192:195], a[8:11], v[112:115]
    ds_read_b64_tr_b16 a[0:1], v10 offset:16384
    buffer_store_dwordx4 v[32:35], v20, s[8:11], s51 offen sc1
    v_mfma_f32_16x16x32_bf16 v[116:119], v[196:199], a[8:11], v[116:119]
    ds_read_b64_tr_b16 a[2:3], v10 offset:18432
    s_mov_b32 s51, s50
    s_waitcnt lgkmcnt(10)
    v_mfma_f32_16x16x32_bf16 v[112:115], v[224:227], a[12:15], v[112:115]
    ds_read_b64_tr_b16 a[4:5], v10 offset:20480
    s_add_u32 s50, s50, 1024
    v_mfma_f32_16x16x32_bf16 v[116:119], v[228:231], a[12:15], v[116:119]
    ds_read_b64_tr_b16 a[6:7], v10 offset:22528
    s_waitcnt vmcnt(14)
    s_barrier
    s_waitcnt lgkmcnt(10)
    v_mfma_f32_16x16x32_bf16 v[144:147], v[64:67], a[16:19], 0
    ds_read_b64_tr_b16 a[8:9], v11 offset:0
    s_cmp_lg_u32 s48, 0
    s_cbranch_scc1 Lsw_39
    s_cmp_lg_u32 s74, 0
    s_cbranch_scc0 Lsw2_40
    v_mov_b32 v12, v15
    v_add_u32 v13, 40960, v15
    v_add_u32 v14, 81920, v15
    s_mov_b32 s60, s16
    s_mov_b32 s61, s17
    s_mov_b32 s62, s18
    s_mov_b32 s45, s57
    s_mov_b32 s46, 122880
    s_mov_b32 s47, 128
    s_mov_b32 s48, s74
    s_mov_b32 s74, 0
    s_branch Lsw_39
Lsw2_40:
    v_mov_b32 v12, v56
    v_mov_b32 v13, v57
    v_mov_b32 v14, v58
    s_mov_b32 s60, s12
    s_mov_b32 s61, s13
    s_mov_b32 s62, s14
    s_cmp_lt_u32 s73, 3
    s_cselect_b32 s45, s58, 0x7f000000
    s_mov_b32 s46, 393216
    s_mov_b32 s47, 786432
    s_mov_b32 s48, 10
Lsw_39:
    v_mfma_f32_16x16x32_bf16 v[148:151], v[68:71], a[16:19], 0
    ds_read_b64_tr_b16 a[10:11], v11 offset:2048
    s_add_u32 s53, s45, s46
    s_waitcnt lgkmcnt(10)
    v_mfma_f32_16x16x32_bf16 v[144:147], v[96:99], a[20:23], v[144:147]
    ds_read_b64_tr_b16 a[12:13], v11 offset:4096
    s_mov_b32 m0, s52
    v_mfma_f32_16x16x32_bf16 v[148:151], v[100:103], a[20:23], v[148:151]
    ds_read_b64_tr_b16 a[14:15], v11 offset:6144
    buffer_load_dwordx4 v12, s[60:63], s45 offen lds
    s_waitcnt lgkmcnt(10)
    v_mfma_f32_16x16x32_bf16 v[144:147], v[128:131], a[24:27], v[144:147]
    ds_read_b64_tr_b16 a[16:17], v11 offset:8192
    s_add_u32 m0, m0, 4096
    v_mfma_f32_16x16x32_bf16 v[148:151], v[132:135], a[24:27], v[148:151]
    ds_read_b64_tr_b16 a[18:19], v11 offset:10240
    buffer_load_dwordx4 v13, s[60:63], s45 offen lds
    s_waitcnt lgkmcnt(10)
    v_mfma_f32_16x16x32_bf16 v[144:147], v[160:163], a[28:31], v[144:147]
    ds_read_b64_tr_b16 a[20:21], v11 offset:12288
    s_add_u32 m0, m0, 4096
    v_mfma_f32_16x16x32_bf16 v[148:151], v[164:167], a[28:31], v[148:151]
    ds_read_b64_tr_b16 a[22:23], v11 offset:14336
    buffer_load_dwordx4 v14, s[60:63], s45 offen lds
    s_waitcnt lgkmcnt(10)
    v_mfma_f32_16x16x32_bf16 v[144:147], v[192:195], a[0:3], v[144:147]
    ds_read_b64_tr_b16 a[24:25], v11 offset:16384
    s_add_u32 m0, m0, 4096
    v_mfma_f32_16x16x32_bf16 v[148:151], v[196:199], a[0:3], v[148:151]
    ds_read_b64_tr_b16 a[26:27], v11 offset:18432
    buffer_load_dwordx4 v12, s[60:63], s53 offen lds
    s_waitcnt lgkmcnt(10)
    v_mfma_f32_16x16x32_bf16 v[144:147], v[224:227], a[4:7], v[144:147]
    ds_read_b64_tr_b16 a[28:29], v11 offset:20480
    s_add_u32 m0, m0, 4096
    v_mfma_f32_16x16x32_bf16 v[148:151], v[228:231], a[4:7], v[148:151]
    ds_read_b64_tr_b16 a[30:31], v11 offset:22528
    buffer_load_dwordx4 v13, s[60:63], s53 offen lds
    s_add_u32 m0, m0, 4096
    s_nop 0
    buffer_load_dwordx4 v14, s[60:63], s53 offen lds
    s_add_u32 s45, s45, s47
    s_sub_u32 s48, s48, 1
    s_add_u32 s52, s52, 24576
    s_cmp_ge_u32 s52, 98304
    s_cselect_b32 s53, 98304, 0
    s_sub_u32 s52, s52, s53
    v_cvt_pk_bf16_f32 v24, v112, v116
    v_cvt_pk_bf16_f32 v25, v113, v117
    v_cvt_pk_bf16_f32 v26, v114, v118
    v_cvt_pk_bf16_f32 v27, v115, v119
    buffer_store_dwordx4 v[24:27], v20, s[8:11], s51 offen sc1
    s_mov_b32 s51, s50
    s_add_u32 s50, s50, 1024
    s_waitcnt lgkmcnt(10)
    v_mfma_f32_16x16x32_bf16 v[176:179], v[64:67], a[8:11], 0
    ds_read_b64_tr_b16 a[0:1], v8 offset:24576
    v_mfma_f32_16x16x32_bf16 v[180:183], v[68:71], a[8:11], 0
    ds_read_b64_tr_b16 a[2:3], v8 offset:26624
    s_waitcnt lgkmcnt(10)
    v_mfma_f32_16x16x32_bf16 v[176:179], v[96:99], a[12:15], v[176:179]
    ds_read_b64_tr_b16 a[4:5], v8 offset:28672
    v_mfma_f32_16x16x32_bf16 v[180:183], v[100:103], a[12:15], v[180:183]
    ds_read_b64_tr_b16 a[6:7], v8 offset:30720
    s_waitcnt lgkmcnt(10)
    v_mfma_f32_16x16x32_bf16 v[176:179], v[128:131], a[16:19], v[176:179]
    ds_read_b64_tr_b16 a[8:9], v8 offset:32768
    v_cvt_pk_bf16_f32 v32, v144, v148
    v_mfma_f32_16x16x32_bf16 v[180:183], v[132:135], a[16:19], v[180:183]
    ds_read_b64_tr_b16 a[10:11], v8 offset:34816
    v_cvt_pk_bf16_f32 v33, v145, v149
    s_waitcnt lgkmcnt(10)
    v_mfma_f32_16x16x32_bf16 v[176:179], v[160:163], a[20:23], v[176:179]
    ds_read_b64_tr_b16 a[12:13], v8 offset:36864
    v_cvt_pk_bf16_f32 v34, v146, v150
    v_mfma_f32_16x16x32_bf16 v[180:183], v[164:167], a[20:23], v[180:183]
    ds_read_b64_tr_b16 a[14:15], v8 offset:38912
    v_cvt_pk_bf16_f32 v35, v147, v151
    s_waitcnt lgkmcnt(10)
    v_mfma_f32_16x16x32_bf16 v[176:179], v[192:195], a[24:27], v[176:179]
    ds_read_b64_tr_b16 a[16:17], v8 offset:40960
    buffer_store_dwordx4 v[32:35], v20, s[8:11], s51 offen sc1
    v_mfma_f32_16x16x32_bf16 v[180:183], v[196:199], a[24:27], v[180:183]
    ds_read_b64_tr_b16 a[18:19], v8 offset:43008
    s_mov_b32 s51, s50
    s_waitcnt lgkmcnt(10)
    v_mfma_f32_16x16x32_bf16 v[176:179], v[224:227], a[28:31], v[176:179]
    ds_read_b64_tr_b16 a[20:21], v8 offset:45056
    s_add_u32 s50, s50, 1024
    v_mfma_f32_16x16x32_bf16 v[180:183], v[228:231], a[28:31], v[180:183]
    ds_read_b64_tr_b16 a[22:23], v8 offset:47104
    s_waitcnt lgkmcnt(10)
    v_mfma_f32_16x16x32_bf16 v[80:83], v[64:67], a[0:3], 0
    ds_read_b64_tr_b16 a[24:25], v9 offset:24576
    v_mfma_f32_16x16x32_bf16 v[84:87], v[68:71], a[0:3], 0
    ds_read_b64_tr_b16 a[26:27], v9 offset:26624
    s_waitcnt lgkmcnt(10)
    v_mfma_f32_16x16x32_bf16 v[80:83], v[96:99], a[4:7], v[80:83]
    ds_read_b64_tr_b16 a[28:29], v9 offset:28672
    v_mfma_f32_16x16x32_bf16 v[84:87], v[100:103], a[4:7], v[84:87]
    ds_read_b64_tr_b16 a[30:31], v9 offset:30720
    s_waitcnt lgkmcnt(10)
    v_mfma_f32_16x16x32_bf16 v[80:83], v[128:131], a[8:11], v[80:83]
    ds_read_b64_tr_b16 a[0:1], v9 offset:32768
    v_cvt_pk_bf16_f32 v24, v176, v180
    v_mfma_f32_16x16x32_bf16 v[84:87], v[132:135], a[8:11], v[84:87]
    ds_read_b64_tr_b16 a[2:3], v9 offset:34816
    v_cvt_pk_bf16_f32 v25, v177, v181
    s_waitcnt lgkmcnt(10)
    v_mfma_f32_16x16x32_bf16 v[80:83], v[160:163], a[12:15], v[80:83]
    ds_read_b64_tr_b16 a[4:5], v9 offset:36864
    v_cvt_pk_bf16_f32 v26, v178, v182
    v_mfma_f32_16x16x32_bf16 v[84:87], v[164:167], a[12:15], v[84:87]
    ds_read_b64_tr_b16 a[6:7], v9 offset:38912
    v_cvt_pk_bf16_f32 v27, v179, v183
    s_waitcnt lgkmcnt(10)
    v_mfma_f32_16x16x32_bf16 v[80:83], v[192:195], a[16:19], v[80:83]
    ds_read_b64_tr_b16 a[8:9], v9 offset:40960
    buffer_store_dwordx4 v[24:27], v20, s[8:11], s51 offen sc1
    v_mfma_f32_16x16x32_bf16 v[84:87], v[196:199], a[16:19], v[84:87]
    ds_read_b64_tr_b16 a[10:11], v9 offset:43008
    s_mov_b32 s51, s50
    s_waitcnt lgkmcnt(10)
    v_mfma_f32_16x16x32_bf16 v[80:83], v[224:227], a[20:23], v[80:83]
    ds_read_b64_tr_b16 a[12:13], v9 offset:45056
    s_add_u32 s50, s50, 1024
    v_mfma_f32_16x16x32_bf16 v[84:87], v[228:231], a[20:23], v[84:87]
    ds_read_b64_tr_b16 a[14:15], v9 offset:47104
    s_waitcnt lgkmcnt(10)
    v_mfma_f32_16x16x32_bf16 v[112:115], v[64:67], a[24:27], 0
    ds_read_b64_tr_b16 a[16:17], v10 offset:24576
    v_mfma_f32_16x16x32_bf16 v[116:119], v[68:71], a[24:27], 0
    ds_read_b64_tr_b16 a[18:19], v10 offset:26624
    s_waitcnt lgkmcnt(10)
    v_mfma_f32_16x16x32_bf16 v[112:115], v[96:99], a[28:31], v[112:115]
    ds_read_b64_tr_b16 a[20:21], v10 offset:28672
    v_mfma_f32_16x16x32_bf16 v[116:119], v[100:103], a[28:31], v[116:119]
    ds_read_b64_tr_b16 a[22:23], v10 offset:30720
    s_waitcnt lgkmcnt(10)
    v_mfma_f32_16x16x32_bf16 v[112:115], v[128:131], a[0:3], v[112:115]
    ds_read_b64_tr_b16 a[24:25], v10 offset:32768
    v_cvt_pk_bf16_f32 v32, v80, v84
    v_mfma_f32_16x16x32_bf16 v[116:119], v[132:135], a[0:3], v[116:119]
    ds_read_b64_tr_b16 a[26:27], v10 offset:34816
    v_cvt_pk_bf16_f32 v33, v81, v85
    s_waitcnt lgkmcnt(10)
    v_mfma_f32_16x16x32_bf16 v[112:115], v[160:163], a[4:7], v[112:115]
    ds_read_b64_tr_b16 a[28:29], v10 offset:36864
    v_cvt_pk_bf16_f32 v34, v82, v86
    v_mfma_f32_16x16x32_bf16 v[116:119], v[164:167], a[4:7], v[116:119]
    ds_read_b64_tr_b16 a[30:31], v10 offset:38912
    v_cvt_pk_bf16_f32 v35, v83, v87
    s_waitcnt lgkmcnt(10)
    v_mfma_f32_16x16x32_bf16 v[112:115], v[192:195], a[8:11], v[112:115]
    ds_read_b64_tr_b16 a[0:1], v10 offset:40960
    buffer_store_dwordx4 v[32:35], v20, s[8:11], s51 offen sc1
    v_mfma_f32_16x16x32_bf16 v[116:119], v[196:199], a[8:11], v[116:119]
    ds_read_b64_tr_b16 a[2:3], v10 offset:43008
    s_mov_b32 s51, s50
    s_waitcnt lgkmcnt(10)
    v_mfma_f32_16x16x32_bf16 v[112:115], v[224:227], a[12:15], v[112:115]
    ds_read_b64_tr_b16 a[4:5], v10 offset:45056
    s_add_u32 s50, s50, 1024
    v_mfma_f32_16x16x32_bf16 v[116:119], v[228:231], a[12:15], v[116:119]
    ds_read_b64_tr_b16 a[6:7], v10 offset:47104
    s_waitcnt vmcnt(14)
    s_barrier
    s_waitcnt lgkmcnt(10)
    v_mfma_f32_16x16x32_bf16 v[144:147], v[64:67], a[16:19], 0
    ds_read_b64_tr_b16 a[8:9], v11 offset:24576
    s_cmp_lg_u32 s48, 0
    s_cbranch_scc1 Lsw_41
    s_cmp_lg_u32 s74, 0
    s_cbranch_scc0 Lsw2_42
    v_mov_b32 v12, v15
    v_add_u32 v13, 40960, v15
    v_add_u32 v14, 81920, v15
    s_mov_b32 s60, s16
    s_mov_b32 s61, s17
    s_mov_b32 s62, s18
    s_mov_b32 s45, s57
    s_mov_b32 s46, 122880
    s_mov_b32 s47, 128
    s_mov_b32 s48, s74
    s_mov_b32 s74, 0
    s_branch Lsw_41
Lsw2_42:
    v_mov_b32 v12, v56
    v_mov_b32 v13, v57
    v_mov_b32 v14, v58
    s_mov_b32 s60, s12
    s_mov_b32 s61, s13
    s_mov_b32 s62, s14
    s_cmp_lt_u32 s73, 3
    s_cselect_b32 s45, s58, 0x7f000000
    s_mov_b32 s46, 393216
    s_mov_b32 s47, 786432
    s_mov_b32 s48, 10
Lsw_41:
    v_mfma_f32_16x16x32_bf16 v[148:151], v[68:71], a[16:19], 0
    ds_read_b64_tr_b16 a[10:11], v11 offset:26624
    s_add_u32 s53, s45, s46
    s_waitcnt lgkmcnt(10)
    v_mfma_f32_16x16x32_bf16 v[144:147], v[96:99], a[20:23], v[144:147]
    ds_read_b64_tr_b16 a[12:13], v11 offset:28672
    s_mov_b32 m0, s52
    v_mfma_f32_16x16x32_bf16 v[148:151], v[100:103], a[20:23], v[148:151]
    ds_read_b64_tr_b16 a[14:15], v11 offset:30720
    buffer_load_dwordx4 v12, s[60:63], s45 offen lds
    s_waitcnt lgkmcnt(10)
    v_mfma_f32_16x16x32_bf16 v[144:147], v[128:131], a[24:27], v[144:147]
    ds_read_b64_tr_b16 a[16:17], v11 offset:32768
    s_add_u32 m0, m0, 4096
    v_mfma_f32_16x16x32_bf16 v[148:151], v[132:135], a[24:27], v[148:151]
    ds_read_b64_tr_b16 a[18:19], v11 offset:34816
    buffer_load_dwordx4 v13, s[60:63], s45 offen lds
    s_waitcnt lgkmcnt(10)
    v_mfma_f32_16x16x32_bf16 v[144:147], v[160:163], a[28:31], v[144:147]
    ds_read_b64_tr_b16 a[20:21], v11 offset:36864
    s_add_u32 m0, m0, 4096
    v_mfma_f32_16x16x32_bf16 v[148:151], v[164:167], a[28:31], v[148:151]
    ds_read_b64_tr_b16 a[22:23], v11 offset:38912
    buffer_load_dwordx4 v14, s[60:63], s45 offen lds
    s_waitcnt lgkmcnt(10)
    v_mfma_f32_16x16x32_bf16 v[144:147], v[192:195], a[0:3], v[144:147]
    ds_read_b64_tr_b16 a[24:25], v11 offset:40960
    s_add_u32 m0, m0, 4096
    v_mfma_f32_16x16x32_bf16 v[148:151], v[196:199], a[0:3], v[148:151]
    ds_read_b64_tr_b16 a[26:27], v11 offset:43008
    buffer_load_dwordx4 v12, s[60:63], s53 offen lds
    s_waitcnt lgkmcnt(10)
    v_mfma_f32_16x16x32_bf16 v[144:147], v[224:227], a[4:7], v[144:147]
    ds_read_b64_tr_b16 a[28:29], v11 offset:45056
    s_add_u32 m0, m0, 4096
    v_mfma_f32_16x16x32_bf16 v[148:151], v[228:231], a[4:7], v[148:151]
    ds_read_b64_tr_b16 a[30:31], v11 offset:47104
    buffer_load_dwordx4 v13, s[60:63], s53 offen lds
    s_add_u32 m0, m0, 4096
    s_nop 0
    buffer_load_dwordx4 v14, s[60:63], s53 offen lds
    s_add_u32 s45, s45, s47
    s_sub_u32 s48, s48, 1
    s_add_u32 s52, s52, 24576
    s_cmp_ge_u32 s52, 98304
    s_cselect_b32 s53, 98304, 0
    s_sub_u32 s52, s52, s53
    v_cvt_pk_bf16_f32 v24, v112, v116
    v_cvt_pk_bf16_f32 v25, v113, v117
    v_cvt_pk_bf16_f32 v26, v114, v118
    v_cvt_pk_bf16_f32 v27, v115, v119
    buffer_store_dwordx4 v[24:27], v20, s[8:11], s51 offen sc1
    s_mov_b32 s51, s50
    s_add_u32 s50, s50, 1024
    s_waitcnt lgkmcnt(10)
    v_xor_b32 v8, 0xc000, v8
    v_xor_b32 v9, 0xc000, v9
    v_xor_b32 v10, 0xc000, v10
    v_xor_b32 v11, 0xc000, v11
    v_mfma_f32_16x16x32_bf16 v[176:179], v[64:67], a[8:11], 0
    ds_read_b64_tr_b16 a[0:1], v8 offset:0
    v_mfma_f32_16x16x32_bf16 v[180:183], v[68:71], a[8:11], 0
    ds_read_b64_tr_b16 a[2:3], v8 offset:2048
    s_waitcnt lgkmcnt(10)
    v_mfma_f32_16x16x32_bf16 v[176:179], v[96:99], a[12:15], v[176:179]
    ds_read_b64_tr_b16 a[4:5], v8 offset:4096
    v_mfma_f32_16x16x32_bf16 v[180:183], v[100:103], a[12:15], v[180:183]
    ds_read_b64_tr_b16 a[6:7], v8 offset:6144
    s_waitcnt lgkmcnt(10)
    v_mfma_f32_16x16x32_bf16 v[176:179], v[128:131], a[16:19], v[176:179]
    ds_read_b64_tr_b16 a[8:9], v8 offset:8192
    v_cvt_pk_bf16_f32 v32, v144, v148
    v_mfma_f32_16x16x32_bf16 v[180:183], v[132:135], a[16:19], v[180:183]
    ds_read_b64_tr_b16 a[10:11], v8 offset:10240
    v_cvt_pk_bf16_f32 v33, v145, v149
    s_waitcnt lgkmcnt(10)
    v_mfma_f32_16x16x32_bf16 v[176:179], v[160:163], a[20:23], v[176:179]
    ds_read_b64_tr_b16 a[12:13], v8 offset:12288
    v_cvt_pk_bf16_f32 v34, v146, v150
    v_mfma_f32_16x16x32_bf16 v[180:183], v[164:167], a[20:23], v[180:183]
    ds_read_b64_tr_b16 a[14:15], v8 offset:14336
    v_cvt_pk_bf16_f32 v35, v147, v151
    s_waitcnt lgkmcnt(10)
    v_mfma_f32_16x16x32_bf16 v[176:179], v[192:195], a[24:27], v[176:179]
    ds_read_b64_tr_b16 a[16:17], v8 offset:16384
    buffer_store_dwordx4 v[32:35], v20, s[8:11], s51 offen sc1
    v_mfma_f32_16x16x32_bf16 v[180:183], v[196:199], a[24:27], v[180:183]
    ds_read_b64_tr_b16 a[18:19], v8 offset:18432
    s_mov_b32 s51, s50
    s_waitcnt lgkmcnt(10)
    v_mfma_f32_16x16x32_bf16 v[176:179], v[224:227], a[28:31], v[176:179]
    ds_read_b64_tr_b16 a[20:21], v8 offset:20480
    s_add_u32 s50, s50, 1024
    v_mfma_f32_16x16x32_bf16 v[180:183], v[228:231], a[28:31], v[180:183]
    ds_read_b64_tr_b16 a[22:23], v8 offset:22528
    s_sub_u32 s44, s44, 1
    s_cmp_lg_u32 s44, 0
    s_cbranch_scc1 g_s2_loop2
    s_nop 3
    v_cvt_pk_bf16_f32 v24, v176, v180
    v_cvt_pk_bf16_f32 v25, v177, v181
    v_cvt_pk_bf16_f32 v26, v178, v182
    v_cvt_pk_bf16_f32 v27, v179, v183
    buffer_store_dwordx4 v[24:27], v20, s[8:11], s51 offen sc1
    s_nop 0
    s_branch g_fin
g_epi1:
    s_mov_b32 s53, s69
    s_cmp_ge_u32 s40, 3
    s_cbranch_scc1 g_epi_mlp
    s_lshl_b32 s53, s53, 5
    s_add_u32 s53, s53, s41
    s_mul_i32 s53, s53, 6144
    s_cmp_eq_u32 s40, 1
    s_mov_b32 s54, 0x1000000
    s_cbranch_scc0 Lskip_43
    s_mov_b32 s54, 0x2800000
Lskip_43:
    s_add_u32 s53, s53, s54
    s_add_u32 s54, s53, 3072
    v_cvt_pk_bf16_f32 v64, v64, v65
    v_cvt_pk_bf16_f32 v65, v66, v67
    v_cvt_pk_bf16_f32 v66, v80, v81
    v_cvt_pk_bf16_f32 v67, v82, v83
    buffer_store_dwordx4 v[64:67], v3, s[8:11], s53 offen offset:0 sc1
    v_cvt_pk_bf16_f32 v96, v96, v97
    v_cvt_pk_bf16_f32 v97, v98, v99
    v_cvt_pk_bf16_f32 v98, v112, v113
    v_cvt_pk_bf16_f32 v99, v114, v115
    buffer_store_dwordx4 v[96:99], v3, s[8:11], s53 offen offset:1024 sc1
    v_cvt_pk_bf16_f32 v128, v128, v129
    v_cvt_pk_bf16_f32 v129, v130, v131
    v_cvt_pk_bf16_f32 v130, v144, v145
    v_cvt_pk_bf16_f32 v131, v146, v147
    buffer_store_dwordx4 v[128:131], v3, s[8:11], s53 offen offset:2048 sc1
    v_cvt_pk_bf16_f32 v160, v160, v161
    v_cvt_pk_bf16_f32 v161, v162, v163
    v_cvt_pk_bf16_f32 v162, v176, v177
    v_cvt_pk_bf16_f32 v163, v178, v179
    buffer_store_dwordx4 v[160:163], v3, s[8:11], s54 offen offset:0 sc1
    v_cvt_pk_bf16_f32 v192, v192, v193
    v_cvt_pk_bf16_f32 v193, v194, v195
    v_cvt_pk_bf16_f32 v194, v208, v209
    v_cvt_pk_bf16_f32 v195, v210, v211
    buffer_store_dwordx4 v[192:195], v3, s[8:11], s54 offen offset:1024 sc1
    v_cvt_pk_bf16_f32 v224, v224, v225
    v_cvt_pk_bf16_f32 v225, v226, v227
    v_cvt_pk_bf16_f32 v226, v240, v241
    v_cvt_pk_bf16_f32 v227, v242, v243
    buffer_store_dwordx4 v[224:227], v3, s[8:11], s54 offen offset:2048 sc1
    s_add_u32 s53, s53, 196608
    s_add_u32 s54, s53, 3072
    v_cvt_pk_bf16_f32 v68, v68, v69
    v_cvt_pk_bf16_f32 v69, v70, v71
    v_cvt_pk_bf16_f32 v70, v84, v85
    v_cvt_pk_bf16_f32 v71, v86, v87
    buffer_store_dwordx4 v[68:71], v3, s[8:11], s53 offen offset:0 sc1
    v_cvt_pk_bf16_f32 v100, v100, v101
    v_cvt_pk_bf16_f32 v101, v102, v103
    v_cvt_pk_bf16_f32 v102, v116, v117
    v_cvt_pk_bf16_f32 v103, v118, v119
    buffer_store_dwordx4 v[100:103], v3, s[8:11], s53 offen offset:1024 sc1
    v_cvt_pk_bf16_f32 v132, v132, v133
    v_cvt_pk_bf16_f32 v133, v134, v135
    v_cvt_pk_bf16_f32 v134, v148, v149
    v_cvt_pk_bf16_f32 v135, v150, v151
    buffer_store_dwordx4 v[132:135], v3, s[8:11], s53 offen offset:2048 sc1
    v_cvt_pk_bf16_f32 v164, v164, v165
    v_cvt_pk_bf16_f32 v165, v166, v167
    v_cvt_pk_bf16_f32 v166, v180, v181
    v_cvt_pk_bf16_f32 v167, v182, v183
    buffer_store_dwordx4 v[164:167], v3, s[8:11], s54 offen offset:0 sc1
    v_cvt_pk_bf16_f32 v196, v196, v197
    v_cvt_pk_bf16_f32 v197, v198, v199
    v_cvt_pk_bf16_f32 v198, v212, v213
    v_cvt_pk_bf16_f32 v199, v214, v215
    buffer_store_dwordx4 v[196:199], v3, s[8:11], s54 offen offset:1024 sc1
    v_cvt_pk_bf16_f32 v228, v228, v229
    v_cvt_pk_bf16_f32 v229, v230, v231
    v_cvt_pk_bf16_f32 v230, v244, v245
    v_cvt_pk_bf16_f32 v231, v246, v247
    buffer_store_dwordx4 v[228:231], v3, s[8:11], s54 offen offset:2048 sc1
    s_add_u32 s53, s53, 196608
    s_cmp_lg_u32 s85, 0
    s_cbranch_scc1 g_fin
    s_add_u32 s54, s53, 3072
    v_cvt_pk_bf16_f32 v72, v72, v73
    v_cvt_pk_bf16_f32 v73, v74, v75
    v_cvt_pk_bf16_f32 v74, v88, v89
    v_cvt_pk_bf16_f32 v75, v90, v91
    buffer_store_dwordx4 v[72:75], v3, s[8:11], s53 offen offset:0 sc1
    v_cvt_pk_bf16_f32 v104, v104, v105
    v_cvt_pk_bf16_f32 v105, v106, v107
    v_cvt_pk_bf16_f32 v106, v120, v121
    v_cvt_pk_bf16_f32 v107, v122, v123
    buffer_store_dwordx4 v[104:107], v3, s[8:11], s53 offen offset:1024 sc1
    v_cvt_pk_bf16_f32 v136, v136, v137
    v_cvt_pk_bf16_f32 v137, v138, v139
    v_cvt_pk_bf16_f32 v138, v152, v153
    v_cvt_pk_bf16_f32 v139, v154, v155
    buffer_store_dwordx4 v[136:139], v3, s[8:11], s53 offen offset:2048 sc1
    v_cvt_pk_bf16_f32 v168, v168, v169
    v_cvt_pk_bf16_f32 v169, v170, v171
    v_cvt_pk_bf16_f32 v170, v184, v185
    v_cvt_pk_bf16_f32 v171, v186, v187
    buffer_store_dwordx4 v[168:171], v3, s[8:11], s54 offen offset:0 sc1
    v_cvt_pk_bf16_f32 v200, v200, v201
    v_cvt_pk_bf16_f32 v201, v202, v203
    v_cvt_pk_bf16_f32 v202, v216, v217
    v_cvt_pk_bf16_f32 v203, v218, v219
    buffer_store_dwordx4 v[200:203], v3, s[8:11], s54 offen offset:1024 sc1
    v_cvt_pk_bf16_f32 v232, v232, v233
    v_cvt_pk_bf16_f32 v233, v234, v235
    v_cvt_pk_bf16_f32 v234, v248, v249
    v_cvt_pk_bf16_f32 v235, v250, v251
    buffer_store_dwordx4 v[232:235], v3, s[8:11], s54 offen offset:2048 sc1
    s_add_u32 s53, s53, 196608
    s_add_u32 s54, s53, 3072
    v_cvt_pk_bf16_f32 v76, v76, v77
    v_cvt_pk_bf16_f32 v77, v78, v79
    v_cvt_pk_bf16_f32 v78, v92, v93
    v_cvt_pk_bf16_f32 v79, v94, v95
    buffer_store_dwordx4 v[76:79], v3, s[8:11], s53 offen offset:0 sc1
    v_cvt_pk_bf16_f32 v108, v108, v109
    v_cvt_pk_bf16_f32 v109, v110, v111
    v_cvt_pk_bf16_f32 v110, v124, v125
    v_cvt_pk_bf16_f32 v111, v126, v127
    buffer_store_dwordx4 v[108:111], v3, s[8:11], s53 offen offset:1024 sc1
    v_cvt_pk_bf16_f32 v140, v140, v141
    v_cvt_pk_bf16_f32 v141, v142, v143
    v_cvt_pk_bf16_f32 v142, v156, v157
    v_cvt_pk_bf16_f32 v143, v158, v159
    buffer_store_dwordx4 v[140:143], v3, s[8:11], s53 offen offset:2048 sc1
    v_cvt_pk_bf16_f32 v172, v172, v173
    v_cvt_pk_bf16_f32 v173, v174, v175
    v_cvt_pk_bf16_f32 v174, v188, v189
    v_cvt_pk_bf16_f32 v175, v190, v191
    buffer_store_dwordx4 v[172:175], v3, s[8:11], s54 offen offset:0 sc1
    v_cvt_pk_bf16_f32 v204, v204, v205
    v_cvt_pk_bf16_f32 v205, v206, v207
    v_cvt_pk_bf16_f32 v206, v220, v221
    v_cvt_pk_bf16_f32 v207, v222, v223
    buffer_store_dwordx4 v[204:207], v3, s[8:11], s54 offen offset:1024 sc1
    v_cvt_pk_bf16_f32 v236, v236, v237
    v_cvt_pk_bf16_f32 v237, v238, v239
    v_cvt_pk_bf16_f32 v238, v252, v253
    v_cvt_pk_bf16_f32 v239, v254, v255
    buffer_store_dwordx4 v[236:239], v3, s[8:11], s54 offen offset:2048 sc1
    s_add_u32 s53, s53, 196608
    s_branch g_fin
g_epi_mlp:
    v_lshrrev_b32 v24, 4, v1
    v_lshlrev_b32 v24, 3, v24
    buffer_load_dwordx2 v[32:33], v24, s[20:23], s58 offen offset:0
    buffer_load_dwordx2 v[34:35], v24, s[20:23], s58 offen offset:32
    buffer_load_dwordx2 v[36:37], v24, s[20:23], s58 offen offset:64
    buffer_load_dwordx2 v[38:39], v24, s[20:23], s58 offen offset:96
    buffer_load_dwordx2 v[40:41], v24, s[20:23], s58 offen offset:128
    buffer_load_dwordx2 v[42:43], v24, s[20:23], s58 offen offset:160
    buffer_load_dwordx2 v[44:45], v24, s[20:23], s58 offen offset:192
    buffer_load_dwordx2 v[46:47], v24, s[20:23], s58 offen offset:224
    buffer_load_dwordx2 v[48:49], v24, s[20:23], s58 offen offset:256
    buffer_load_dwordx2 v[50:51], v24, s[20:23], s58 offen offset:288
    buffer_load_dwordx2 v[52:53], v24, s[20:23], s58 offen offset:320
    buffer_load_dwordx2 v[54:55], v24, s[20:23], s58 offen offset:352
    s_waitcnt vmcnt(0)
    s_cmp_eq_u32 s40, 5
    s_cbranch_scc1 g_epi_mb
    s_mov_b32 s45, 0xc0135761
    s_mov_b32 s46, 0xbdd2d3e8
    v_mov_b32 v31, s45
    v_lshlrev_b32 v24, 16, v32
    v_and_b32 v25, 0xffff0000, v32
    v_lshlrev_b32 v26, 16, v33
    v_and_b32 v27, 0xffff0000, v33
    v_add_f32 v64, v64, v24
    v_add_f32 v65, v65, v25
    v_add_f32 v66, v66, v26
    v_add_f32 v67, v67, v27
    v_add_f32 v68, v68, v24
    v_add_f32 v69, v69, v25
    v_add_f32 v70, v70, v26
    v_add_f32 v71, v71, v27
    v_add_f32 v72, v72, v24
    v_add_f32 v73, v73, v25
    v_add_f32 v74, v74, v26
    v_add_f32 v75, v75, v27
    v_add_f32 v76, v76, v24
    v_add_f32 v77, v77, v25
    v_add_f32 v78, v78, v26
    v_add_f32 v79, v79, v27
    v_mul_f32 v56, v64, v64
    v_mul_f32 v57, v65, v65
    v_mul_f32 v58, v66, v66
    v_mul_f32 v59, v67, v67
    v_fma_f32 v56, v56, s46, v31
    v_fma_f32 v57, v57, s46, v31
    v_fma_f32 v58, v58, s46, v31
    v_fma_f32 v59, v59, s46, v31
    v_mul_f32 v56, v56, v64
    v_mul_f32 v57, v57, v65
    v_mul_f32 v58, v58, v66
    v_mul_f32 v59, v59, v67
    v_exp_f32 v56, v56
    v_exp_f32 v57, v57
    v_exp_f32 v58, v58
    v_exp_f32 v59, v59
    v_add_f32 v56, 1.0, v56
    v_add_f32 v57, 1.0, v57
    v_add_f32 v58, 1.0, v58
    v_add_f32 v59, 1.0, v59
    v_rcp_f32 v56, v56
    v_rcp_f32 v57, v57
    v_rcp_f32 v58, v58
    v_rcp_f32 v59, v59
    v_mul_f32 v64, v64, v56
    v_mul_f32 v65, v65, v57
    v_mul_f32 v66, v66, v58
    v_mul_f32 v67, v67, v59
    v_mul_f32 v56, v68, v68
    v_mul_f32 v57, v69, v69
    v_mul_f32 v58, v70, v70
    v_mul_f32 v59, v71, v71
    v_fma_f32 v56, v56, s46, v31
    v_fma_f32 v57, v57, s46, v31
    v_fma_f32 v58, v58, s46, v31
    v_fma_f32 v59, v59, s46, v31
    v_mul_f32 v56, v56, v68
    v_mul_f32 v57, v57, v69
    v_mul_f32 v58, v58, v70
    v_mul_f32 v59, v59, v71
    v_exp_f32 v56, v56
    v_exp_f32 v57, v57
    v_exp_f32 v58, v58
    v_exp_f32 v59, v59
    v_add_f32 v56, 1.0, v56
    v_add_f32 v57, 1.0, v57
    v_add_f32 v58, 1.0, v58
    v_add_f32 v59, 1.0, v59
    v_rcp_f32 v56, v56
    v_rcp_f32 v57, v57
    v_rcp_f32 v58, v58
    v_rcp_f32 v59, v59
    v_mul_f32 v68, v68, v56
    v_mul_f32 v69, v69, v57
    v_mul_f32 v70, v70, v58
    v_mul_f32 v71, v71, v59
    v_mul_f32 v56, v72, v72
    v_mul_f32 v57, v73, v73
    v_mul_f32 v58, v74, v74
    v_mul_f32 v59, v75, v75
    v_fma_f32 v56, v56, s46, v31
    v_fma_f32 v57, v57, s46, v31
    v_fma_f32 v58, v58, s46, v31
    v_fma_f32 v59, v59, s46, v31
    v_mul_f32 v56, v56, v72
    v_mul_f32 v57, v57, v73
    v_mul_f32 v58, v58, v74
    v_mul_f32 v59, v59, v75
    v_exp_f32 v56, v56
    v_exp_f32 v57, v57
    v_exp_f32 v58, v58
    v_exp_f32 v59, v59
    v_add_f32 v56, 1.0, v56
    v_add_f32 v57, 1.0, v57
    v_add_f32 v58, 1.0, v58
    v_add_f32 v59, 1.0, v59
    v_rcp_f32 v56, v56
    v_rcp_f32 v57, v57
    v_rcp_f32 v58, v58
    v_rcp_f32 v59, v59
    v_mul_f32 v72, v72, v56
    v_mul_f32 v73, v73, v57
    v_mul_f32 v74, v74, v58
    v_mul_f32 v75, v75, v59
    v_mul_f32 v56, v76, v76
    v_mul_f32 v57, v77, v77
    v_mul_f32 v58, v78, v78
    v_mul_f32 v59, v79, v79
    v_fma_f32 v56, v56, s46, v31
    v_fma_f32 v57, v57, s46, v31
    v_fma_f32 v58, v58, s46, v31
    v_fma_f32 v59, v59, s46, v31
    v_mul_f32 v56, v56, v76
    v_mul_f32 v57, v57, v77
    v_mul_f32 v58, v58, v78
    v_mul_f32 v59, v59, v79
    v_exp_f32 v56, v56
    v_exp_f32 v57, v57
    v_exp_f32 v58, v58
    v_exp_f32 v59, v59
    v_add_f32 v56, 1.0, v56
    v_add_f32 v57, 1.0, v57
    v_add_f32 v58, 1.0, v58
    v_add_f32 v59, 1.0, v59
    v_rcp_f32 v56, v56
    v_rcp_f32 v57, v57
    v_rcp_f32 v58, v58
    v_rcp_f32 v59, v59
    v_mul_f32 v76, v76, v56
    v_mul_f32 v77, v77, v57
    v_mul_f32 v78, v78, v58
    v_mul_f32 v79, v79, v59
    v_lshlrev_b32 v24, 16, v34
    v_and_b32 v25, 0xffff0000, v34
    v_lshlrev_b32 v26, 16, v35
    v_and_b32 v27, 0xffff0000, v35
    v_add_f32 v80, v80, v24
    v_add_f32 v81, v81, v25
    v_add_f32 v82, v82, v26
    v_add_f32 v83, v83, v27
    v_add_f32 v84, v84, v24
    v_add_f32 v85, v85, v25
    v_add_f32 v86, v86, v26
    v_add_f32 v87, v87, v27
    v_add_f32 v88, v88, v24
    v_add_f32 v89, v89, v25
    v_add_f32 v90, v90, v26
    v_add_f32 v91, v91, v27
    v_add_f32 v92, v92, v24
    v_add_f32 v93, v93, v25
    v_add_f32 v94, v94, v26
    v_add_f32 v95, v95, v27
    v_mul_f32 v56, v80, v80
    v_mul_f32 v57, v81, v81
    v_mul_f32 v58, v82, v82
    v_mul_f32 v59, v83, v83
    v_fma_f32 v56, v56, s46, v31
    v_fma_f32 v57, v57, s46, v31
    v_fma_f32 v58, v58, s46, v31
    v_fma_f32 v59, v59, s46, v31
    v_mul_f32 v56, v56, v80
    v_mul_f32 v57, v57, v81
    v_mul_f32 v58, v58, v82
    v_mul_f32 v59, v59, v83
    v_exp_f32 v56, v56
    v_exp_f32 v57, v57
    v_exp_f32 v58, v58
    v_exp_f32 v59, v59
    v_add_f32 v56, 1.0, v56
    v_add_f32 v57, 1.0, v57
    v_add_f32 v58, 1.0, v58
    v_add_f32 v59, 1.0, v59
    v_rcp_f32 v56, v56
    v_rcp_f32 v57, v57
    v_rcp_f32 v58, v58
    v_rcp_f32 v59, v59
    v_mul_f32 v80, v80, v56
    v_mul_f32 v81, v81, v57
    v_mul_f32 v82, v82, v58
    v_mul_f32 v83, v83, v59
    v_mul_f32 v56, v84, v84
    v_mul_f32 v57, v85, v85
    v_mul_f32 v58, v86, v86
    v_mul_f32 v59, v87, v87
    v_fma_f32 v56, v56, s46, v31
    v_fma_f32 v57, v57, s46, v31
    v_fma_f32 v58, v58, s46, v31
    v_fma_f32 v59, v59, s46, v31
    v_mul_f32 v56, v56, v84
    v_mul_f32 v57, v57, v85
    v_mul_f32 v58, v58, v86
    v_mul_f32 v59, v59, v87
    v_exp_f32 v56, v56
    v_exp_f32 v57, v57
    v_exp_f32 v58, v58
    v_exp_f32 v59, v59
    v_add_f32 v56, 1.0, v56
    v_add_f32 v57, 1.0, v57
    v_add_f32 v58, 1.0, v58
    v_add_f32 v59, 1.0, v59
    v_rcp_f32 v56, v56
    v_rcp_f32 v57, v57
    v_rcp_f32 v58, v58
    v_rcp_f32 v59, v59
    v_mul_f32 v84, v84, v56
    v_mul_f32 v85, v85, v57
    v_mul_f32 v86, v86, v58
    v_mul_f32 v87, v87, v59
    v_mul_f32 v56, v88, v88
    v_mul_f32 v57, v89, v89
    v_mul_f32 v58, v90, v90
    v_mul_f32 v59, v91, v91
    v_fma_f32 v56, v56, s46, v31
    v_fma_f32 v57, v57, s46, v31
    v_fma_f32 v58, v58, s46, v31
    v_fma_f32 v59, v59, s46, v31
    v_mul_f32 v56, v56, v88
    v_mul_f32 v57, v57, v89
    v_mul_f32 v58, v58, v90
    v_mul_f32 v59, v59, v91
    v_exp_f32 v56, v56
    v_exp_f32 v57, v57
    v_exp_f32 v58, v58
    v_exp_f32 v59, v59
    v_add_f32 v56, 1.0, v56
    v_add_f32 v57, 1.0, v57
    v_add_f32 v58, 1.0, v58
    v_add_f32 v59, 1.0, v59
    v_rcp_f32 v56, v56
    v_rcp_f32 v57, v57
    v_rcp_f32 v58, v58
    v_rcp_f32 v59, v59
    v_mul_f32 v88, v88, v56
    v_mul_f32 v89, v89, v57
    v_mul_f32 v90, v90, v58
    v_mul_f32 v91, v91, v59
    v_mul_f32 v56, v92, v92
    v_mul_f32 v57, v93, v93
    v_mul_f32 v58, v94, v94
    v_mul_f32 v59, v95, v95
    v_fma_f32 v56, v56, s46, v31
    v_fma_f32 v57, v57, s46, v31
    v_fma_f32 v58, v58, s46, v31
    v_fma_f32 v59, v59, s46, v31
    v_mul_f32 v56, v56, v92
    v_mul_f32 v57, v57, v93
    v_mul_f32 v58, v58, v94
    v_mul_f32 v59, v59, v95
    v_exp_f32 v56, v56
    v_exp_f32 v57, v57
    v_exp_f32 v58, v58
    v_exp_f32 v59, v59
    v_add_f32 v56, 1.0, v56
    v_add_f32 v57, 1.0, v57
    v_add_f32 v58, 1.0, v58
    v_add_f32 v59, 1.0, v59
    v_rcp_f32 v56, v56
    v_rcp_f32 v57, v57
    v_rcp_f32 v58, v58
    v_rcp_f32 v59, v59
    v_mul_f32 v92, v92, v56
    v_mul_f32 v93, v93, v57
    v_mul_f32 v94, v94, v58
    v_mul_f32 v95, v95, v59
    v_lshlrev_b32 v24, 16, v36
    v_and_b32 v25, 0xffff0000, v36
    v_lshlrev_b32 v26, 16, v37
    v_and_b32 v27, 0xffff0000, v37
    v_add_f32 v96, v96, v24
    v_add_f32 v97, v97, v25
    v_add_f32 v98, v98, v26
    v_add_f32 v99, v99, v27
    v_add_f32 v100, v100, v24
    v_add_f32 v101, v101, v25
    v_add_f32 v102, v102, v26
    v_add_f32 v103, v103, v27
    v_add_f32 v104, v104, v24
    v_add_f32 v105, v105, v25
    v_add_f32 v106, v106, v26
    v_add_f32 v107, v107, v27
    v_add_f32 v108, v108, v24
    v_add_f32 v109, v109, v25
    v_add_f32 v110, v110, v26
    v_add_f32 v111, v111, v27
    v_mul_f32 v56, v96, v96
    v_mul_f32 v57, v97, v97
    v_mul_f32 v58, v98, v98
    v_mul_f32 v59, v99, v99
    v_fma_f32 v56, v56, s46, v31
    v_fma_f32 v57, v57, s46, v31
    v_fma_f32 v58, v58, s46, v31
    v_fma_f32 v59, v59, s46, v31
    v_mul_f32 v56, v56, v96
    v_mul_f32 v57, v57, v97
    v_mul_f32 v58, v58, v98
    v_mul_f32 v59, v59, v99
    v_exp_f32 v56, v56
    v_exp_f32 v57, v57
    v_exp_f32 v58, v58
    v_exp_f32 v59, v59
    v_add_f32 v56, 1.0, v56
    v_add_f32 v57, 1.0, v57
    v_add_f32 v58, 1.0, v58
    v_add_f32 v59, 1.0, v59
    v_rcp_f32 v56, v56
    v_rcp_f32 v57, v57
    v_rcp_f32 v58, v58
    v_rcp_f32 v59, v59
    v_mul_f32 v96, v96, v56
    v_mul_f32 v97, v97, v57
    v_mul_f32 v98, v98, v58
    v_mul_f32 v99, v99, v59
    v_mul_f32 v56, v100, v100
    v_mul_f32 v57, v101, v101
    v_mul_f32 v58, v102, v102
    v_mul_f32 v59, v103, v103
    v_fma_f32 v56, v56, s46, v31
    v_fma_f32 v57, v57, s46, v31
    v_fma_f32 v58, v58, s46, v31
    v_fma_f32 v59, v59, s46, v31
    v_mul_f32 v56, v56, v100
    v_mul_f32 v57, v57, v101
    v_mul_f32 v58, v58, v102
    v_mul_f32 v59, v59, v103
    v_exp_f32 v56, v56
    v_exp_f32 v57, v57
    v_exp_f32 v58, v58
    v_exp_f32 v59, v59
    v_add_f32 v56, 1.0, v56
    v_add_f32 v57, 1.0, v57
    v_add_f32 v58, 1.0, v58
    v_add_f32 v59, 1.0, v59
    v_rcp_f32 v56, v56
    v_rcp_f32 v57, v57
    v_rcp_f32 v58, v58
    v_rcp_f32 v59, v59
    v_mul_f32 v100, v100, v56
    v_mul_f32 v101, v101, v57
    v_mul_f32 v102, v102, v58
    v_mul_f32 v103, v103, v59
    v_mul_f32 v56, v104, v104
    v_mul_f32 v57, v105, v105
    v_mul_f32 v58, v106, v106
    v_mul_f32 v59, v107, v107
    v_fma_f32 v56, v56, s46, v31
    v_fma_f32 v57, v57, s46, v31
    v_fma_f32 v58, v58, s46, v31
    v_fma_f32 v59, v59, s46, v31
    v_mul_f32 v56, v56, v104
    v_mul_f32 v57, v57, v105
    v_mul_f32 v58, v58, v106
    v_mul_f32 v59, v59, v107
    v_exp_f32 v56, v56
    v_exp_f32 v57, v57
    v_exp_f32 v58, v58
    v_exp_f32 v59, v59
    v_add_f32 v56, 1.0, v56
    v_add_f32 v57, 1.0, v57
    v_add_f32 v58, 1.0, v58
    v_add_f32 v59, 1.0, v59
    v_rcp_f32 v56, v56
    v_rcp_f32 v57, v57
    v_rcp_f32 v58, v58
    v_rcp_f32 v59, v59
    v_mul_f32 v104, v104, v56
    v_mul_f32 v105, v105, v57
    v_mul_f32 v106, v106, v58
    v_mul_f32 v107, v107, v59
    v_mul_f32 v56, v108, v108
    v_mul_f32 v57, v109, v109
    v_mul_f32 v58, v110, v110
    v_mul_f32 v59, v111, v111
    v_fma_f32 v56, v56, s46, v31
    v_fma_f32 v57, v57, s46, v31
    v_fma_f32 v58, v58, s46, v31
    v_fma_f32 v59, v59, s46, v31
    v_mul_f32 v56, v56, v108
    v_mul_f32 v57, v57, v109
    v_mul_f32 v58, v58, v110
    v_mul_f32 v59, v59, v111
    v_exp_f32 v56, v56
    v_exp_f32 v57, v57
    v_exp_f32 v58, v58
    v_exp_f32 v59, v59
    v_add_f32 v56, 1.0, v56
    v_add_f32 v57, 1.0, v57
    v_add_f32 v58, 1.0, v58
    v_add_f32 v59, 1.0, v59
    v_rcp_f32 v56, v56
    v_rcp_f32 v57, v57
    v_rcp_f32 v58, v58
    v_rcp_f32 v59, v59
    v_mul_f32 v108, v108, v56
    v_mul_f32 v109, v109, v57
    v_mul_f32 v110, v110, v58
    v_mul_f32 v111, v111, v59
    v_lshlrev_b32 v24, 16, v38
    v_and_b32 v25, 0xffff0000, v38
    v_lshlrev_b32 v26, 16, v39
    v_and_b32 v27, 0xffff0000, v39
    v_add_f32 v112, v112, v24
    v_add_f32 v113, v113, v25
    v_add_f32 v114, v114, v26
    v_add_f32 v115, v115, v27
    v_add_f32 v116, v116, v24
    v_add_f32 v117, v117, v25
    v_add_f32 v118, v118, v26
    v_add_f32 v119, v119, v27
    v_add_f32 v120, v120, v24
    v_add_f32 v121, v121, v25
    v_add_f32 v122, v122, v26
    v_add_f32 v123, v123, v27
    v_add_f32 v124, v124, v24
    v_add_f32 v125, v125, v25
    v_add_f32 v126, v126, v26
    v_add_f32 v127, v127, v27
    v_mul_f32 v56, v112, v112
    v_mul_f32 v57, v113, v113
    v_mul_f32 v58, v114, v114
    v_mul_f32 v59, v115, v115
    v_fma_f32 v56, v56, s46, v31
    v_fma_f32 v57, v57, s46, v31
    v_fma_f32 v58, v58, s46, v31
    v_fma_f32 v59, v59, s46, v31
    v_mul_f32 v56, v56, v112
    v_mul_f32 v57, v57, v113
    v_mul_f32 v58, v58, v114
    v_mul_f32 v59, v59, v115
    v_exp_f32 v56, v56
    v_exp_f32 v57, v57
    v_exp_f32 v58, v58
    v_exp_f32 v59, v59
    v_add_f32 v56, 1.0, v56
    v_add_f32 v57, 1.0, v57
    v_add_f32 v58, 1.0, v58
    v_add_f32 v59, 1.0, v59
    v_rcp_f32 v56, v56
    v_rcp_f32 v57, v57
    v_rcp_f32 v58, v58
    v_rcp_f32 v59, v59
    v_mul_f32 v112, v112, v56
    v_mul_f32 v113, v113, v57
    v_mul_f32 v114, v114, v58
    v_mul_f32 v115, v115, v59
    v_mul_f32 v56, v116, v116
    v_mul_f32 v57, v117, v117
    v_mul_f32 v58, v118, v118
    v_mul_f32 v59, v119, v119
    v_fma_f32 v56, v56, s46, v31
    v_fma_f32 v57, v57, s46, v31
    v_fma_f32 v58, v58, s46, v31
    v_fma_f32 v59, v59, s46, v31
    v_mul_f32 v56, v56, v116
    v_mul_f32 v57, v57, v117
    v_mul_f32 v58, v58, v118
    v_mul_f32 v59, v59, v119
    v_exp_f32 v56, v56
    v_exp_f32 v57, v57
    v_exp_f32 v58, v58
    v_exp_f32 v59, v59
    v_add_f32 v56, 1.0, v56
    v_add_f32 v57, 1.0, v57
    v_add_f32 v58, 1.0, v58
    v_add_f32 v59, 1.0, v59
    v_rcp_f32 v56, v56
    v_rcp_f32 v57, v57
    v_rcp_f32 v58, v58
    v_rcp_f32 v59, v59
    v_mul_f32 v116, v116, v56
    v_mul_f32 v117, v117, v57
    v_mul_f32 v118, v118, v58
    v_mul_f32 v119, v119, v59
    v_mul_f32 v56, v120, v120
    v_mul_f32 v57, v121, v121
    v_mul_f32 v58, v122, v122
    v_mul_f32 v59, v123, v123
    v_fma_f32 v56, v56, s46, v31
    v_fma_f32 v57, v57, s46, v31
    v_fma_f32 v58, v58, s46, v31
    v_fma_f32 v59, v59, s46, v31
    v_mul_f32 v56, v56, v120
    v_mul_f32 v57, v57, v121
    v_mul_f32 v58, v58, v122
    v_mul_f32 v59, v59, v123
    v_exp_f32 v56, v56
    v_exp_f32 v57, v57
    v_exp_f32 v58, v58
    v_exp_f32 v59, v59
    v_add_f32 v56, 1.0, v56
    v_add_f32 v57, 1.0, v57
    v_add_f32 v58, 1.0, v58
    v_add_f32 v59, 1.0, v59
    v_rcp_f32 v56, v56
    v_rcp_f32 v57, v57
    v_rcp_f32 v58, v58
    v_rcp_f32 v59, v59
    v_mul_f32 v120, v120, v56
    v_mul_f32 v121, v121, v57
    v_mul_f32 v122, v122, v58
    v_mul_f32 v123, v123, v59
    v_mul_f32 v56, v124, v124
    v_mul_f32 v57, v125, v125
    v_mul_f32 v58, v126, v126
    v_mul_f32 v59, v127, v127
    v_fma_f32 v56, v56, s46, v31
    v_fma_f32 v57, v57, s46, v31
    v_fma_f32 v58, v58, s46, v31
    v_fma_f32 v59, v59, s46, v31
    v_mul_f32 v56, v56, v124
    v_mul_f32 v57, v57, v125
    v_mul_f32 v58, v58, v126
    v_mul_f32 v59, v59, v127
    v_exp_f32 v56, v56
    v_exp_f32 v57, v57
    v_exp_f32 v58, v58
    v_exp_f32 v59, v59
    v_add_f32 v56, 1.0, v56
    v_add_f32 v57, 1.0, v57
    v_add_f32 v58, 1.0, v58
    v_add_f32 v59, 1.0, v59
    v_rcp_f32 v56, v56
    v_rcp_f32 v57, v57
    v_rcp_f32 v58, v58
    v_rcp_f32 v59, v59
    v_mul_f32 v124, v124, v56
    v_mul_f32 v125, v125, v57
    v_mul_f32 v126, v126, v58
    v_mul_f32 v127, v127, v59
    v_lshlrev_b32 v24, 16, v40
    v_and_b32 v25, 0xffff0000, v40
    v_lshlrev_b32 v26, 16, v41
    v_and_b32 v27, 0xffff0000, v41
    v_add_f32 v128, v128, v24
    v_add_f32 v129, v129, v25
    v_add_f32 v130, v130, v26
    v_add_f32 v131, v131, v27
    v_add_f32 v132, v132, v24
    v_add_f32 v133, v133, v25
    v_add_f32 v134, v134, v26
    v_add_f32 v135, v135, v27
    v_add_f32 v136, v136, v24
    v_add_f32 v137, v137, v25
    v_add_f32 v138, v138, v26
    v_add_f32 v139, v139, v27
    v_add_f32 v140, v140, v24
    v_add_f32 v141, v141, v25
    v_add_f32 v142, v142, v26
    v_add_f32 v143, v143, v27
    v_mul_f32 v56, v128, v128
    v_mul_f32 v57, v129, v129
    v_mul_f32 v58, v130, v130
    v_mul_f32 v59, v131, v131
    v_fma_f32 v56, v56, s46, v31
    v_fma_f32 v57, v57, s46, v31
    v_fma_f32 v58, v58, s46, v31
    v_fma_f32 v59, v59, s46, v31
    v_mul_f32 v56, v56, v128
    v_mul_f32 v57, v57, v129
    v_mul_f32 v58, v58, v130
    v_mul_f32 v59, v59, v131
    v_exp_f32 v56, v56
    v_exp_f32 v57, v57
    v_exp_f32 v58, v58
    v_exp_f32 v59, v59
    v_add_f32 v56, 1.0, v56
    v_add_f32 v57, 1.0, v57
    v_add_f32 v58, 1.0, v58
    v_add_f32 v59, 1.0, v59
    v_rcp_f32 v56, v56
    v_rcp_f32 v57, v57
    v_rcp_f32 v58, v58
    v_rcp_f32 v59, v59
    v_mul_f32 v128, v128, v56
    v_mul_f32 v129, v129, v57
    v_mul_f32 v130, v130, v58
    v_mul_f32 v131, v131, v59
    v_mul_f32 v56, v132, v132
    v_mul_f32 v57, v133, v133
    v_mul_f32 v58, v134, v134
    v_mul_f32 v59, v135, v135
    v_fma_f32 v56, v56, s46, v31
    v_fma_f32 v57, v57, s46, v31
    v_fma_f32 v58, v58, s46, v31
    v_fma_f32 v59, v59, s46, v31
    v_mul_f32 v56, v56, v132
    v_mul_f32 v57, v57, v133
    v_mul_f32 v58, v58, v134
    v_mul_f32 v59, v59, v135
    v_exp_f32 v56, v56
    v_exp_f32 v57, v57
    v_exp_f32 v58, v58
    v_exp_f32 v59, v59
    v_add_f32 v56, 1.0, v56
    v_add_f32 v57, 1.0, v57
    v_add_f32 v58, 1.0, v58
    v_add_f32 v59, 1.0, v59
    v_rcp_f32 v56, v56
    v_rcp_f32 v57, v57
    v_rcp_f32 v58, v58
    v_rcp_f32 v59, v59
    v_mul_f32 v132, v132, v56
    v_mul_f32 v133, v133, v57
    v_mul_f32 v134, v134, v58
    v_mul_f32 v135, v135, v59
    v_mul_f32 v56, v136, v136
    v_mul_f32 v57, v137, v137
    v_mul_f32 v58, v138, v138
    v_mul_f32 v59, v139, v139
    v_fma_f32 v56, v56, s46, v31
    v_fma_f32 v57, v57, s46, v31
    v_fma_f32 v58, v58, s46, v31
    v_fma_f32 v59, v59, s46, v31
    v_mul_f32 v56, v56, v136
    v_mul_f32 v57, v57, v137
    v_mul_f32 v58, v58, v138
    v_mul_f32 v59, v59, v139
    v_exp_f32 v56, v56
    v_exp_f32 v57, v57
    v_exp_f32 v58, v58
    v_exp_f32 v59, v59
    v_add_f32 v56, 1.0, v56
    v_add_f32 v57, 1.0, v57
    v_add_f32 v58, 1.0, v58
    v_add_f32 v59, 1.0, v59
    v_rcp_f32 v56, v56
    v_rcp_f32 v57, v57
    v_rcp_f32 v58, v58
    v_rcp_f32 v59, v59
    v_mul_f32 v136, v136, v56
    v_mul_f32 v137, v137, v57
    v_mul_f32 v138, v138, v58
    v_mul_f32 v139, v139, v59
    v_mul_f32 v56, v140, v140
    v_mul_f32 v57, v141, v141
    v_mul_f32 v58, v142, v142
    v_mul_f32 v59, v143, v143
    v_fma_f32 v56, v56, s46, v31
    v_fma_f32 v57, v57, s46, v31
    v_fma_f32 v58, v58, s46, v31
    v_fma_f32 v59, v59, s46, v31
    v_mul_f32 v56, v56, v140
    v_mul_f32 v57, v57, v141
    v_mul_f32 v58, v58, v142
    v_mul_f32 v59, v59, v143
    v_exp_f32 v56, v56
    v_exp_f32 v57, v57
    v_exp_f32 v58, v58
    v_exp_f32 v59, v59
    v_add_f32 v56, 1.0, v56
    v_add_f32 v57, 1.0, v57
    v_add_f32 v58, 1.0, v58
    v_add_f32 v59, 1.0, v59
    v_rcp_f32 v56, v56
    v_rcp_f32 v57, v57
    v_rcp_f32 v58, v58
    v_rcp_f32 v59, v59
    v_mul_f32 v140, v140, v56
    v_mul_f32 v141, v141, v57
    v_mul_f32 v142, v142, v58
    v_mul_f32 v143, v143, v59
    v_lshlrev_b32 v24, 16, v42
    v_and_b32 v25, 0xffff0000, v42
    v_lshlrev_b32 v26, 16, v43
    v_and_b32 v27, 0xffff0000, v43
    v_add_f32 v144, v144, v24
    v_add_f32 v145, v145, v25
    v_add_f32 v146, v146, v26
    v_add_f32 v147, v147, v27
    v_add_f32 v148, v148, v24
    v_add_f32 v149, v149, v25
    v_add_f32 v150, v150, v26
    v_add_f32 v151, v151, v27
    v_add_f32 v152, v152, v24
    v_add_f32 v153, v153, v25
    v_add_f32 v154, v154, v26
    v_add_f32 v155, v155, v27
    v_add_f32 v156, v156, v24
    v_add_f32 v157, v157, v25
    v_add_f32 v158, v158, v26
    v_add_f32 v159, v159, v27
    v_mul_f32 v56, v144, v144
    v_mul_f32 v57, v145, v145
    v_mul_f32 v58, v146, v146
    v_mul_f32 v59, v147, v147
    v_fma_f32 v56, v56, s46, v31
    v_fma_f32 v57, v57, s46, v31
    v_fma_f32 v58, v58, s46, v31
    v_fma_f32 v59, v59, s46, v31
    v_mul_f32 v56, v56, v144
    v_mul_f32 v57, v57, v145
    v_mul_f32 v58, v58, v146
    v_mul_f32 v59, v59, v147
    v_exp_f32 v56, v56
    v_exp_f32 v57, v57
    v_exp_f32 v58, v58
    v_exp_f32 v59, v59
    v_add_f32 v56, 1.0, v56
    v_add_f32 v57, 1.0, v57
    v_add_f32 v58, 1.0, v58
    v_add_f32 v59, 1.0, v59
    v_rcp_f32 v56, v56
    v_rcp_f32 v57, v57
    v_rcp_f32 v58, v58
    v_rcp_f32 v59, v59
    v_mul_f32 v144, v144, v56
    v_mul_f32 v145, v145, v57
    v_mul_f32 v146, v146, v58
    v_mul_f32 v147, v147, v59
    v_mul_f32 v56, v148, v148
    v_mul_f32 v57, v149, v149
    v_mul_f32 v58, v150, v150
    v_mul_f32 v59, v151, v151
    v_fma_f32 v56, v56, s46, v31
    v_fma_f32 v57, v57, s46, v31
    v_fma_f32 v58, v58, s46, v31
    v_fma_f32 v59, v59, s46, v31
    v_mul_f32 v56, v56, v148
    v_mul_f32 v57, v57, v149
    v_mul_f32 v58, v58, v150
    v_mul_f32 v59, v59, v151
    v_exp_f32 v56, v56
    v_exp_f32 v57, v57
    v_exp_f32 v58, v58
    v_exp_f32 v59, v59
    v_add_f32 v56, 1.0, v56
    v_add_f32 v57, 1.0, v57
    v_add_f32 v58, 1.0, v58
    v_add_f32 v59, 1.0, v59
    v_rcp_f32 v56, v56
    v_rcp_f32 v57, v57
    v_rcp_f32 v58, v58
    v_rcp_f32 v59, v59
    v_mul_f32 v148, v148, v56
    v_mul_f32 v149, v149, v57
    v_mul_f32 v150, v150, v58
    v_mul_f32 v151, v151, v59
    v_mul_f32 v56, v152, v152
    v_mul_f32 v57, v153, v153
    v_mul_f32 v58, v154, v154
    v_mul_f32 v59, v155, v155
    v_fma_f32 v56, v56, s46, v31
    v_fma_f32 v57, v57, s46, v31
    v_fma_f32 v58, v58, s46, v31
    v_fma_f32 v59, v59, s46, v31
    v_mul_f32 v56, v56, v152
    v_mul_f32 v57, v57, v153
    v_mul_f32 v58, v58, v154
    v_mul_f32 v59, v59, v155
    v_exp_f32 v56, v56
    v_exp_f32 v57, v57
    v_exp_f32 v58, v58
    v_exp_f32 v59, v59
    v_add_f32 v56, 1.0, v56
    v_add_f32 v57, 1.0, v57
    v_add_f32 v58, 1.0, v58
    v_add_f32 v59, 1.0, v59
    v_rcp_f32 v56, v56
    v_rcp_f32 v57, v57
    v_rcp_f32 v58, v58
    v_rcp_f32 v59, v59
    v_mul_f32 v152, v152, v56
    v_mul_f32 v153, v153, v57
    v_mul_f32 v154, v154, v58
    v_mul_f32 v155, v155, v59
    v_mul_f32 v56, v156, v156
    v_mul_f32 v57, v157, v157
    v_mul_f32 v58, v158, v158
    v_mul_f32 v59, v159, v159
    v_fma_f32 v56, v56, s46, v31
    v_fma_f32 v57, v57, s46, v31
    v_fma_f32 v58, v58, s46, v31
    v_fma_f32 v59, v59, s46, v31
    v_mul_f32 v56, v56, v156
    v_mul_f32 v57, v57, v157
    v_mul_f32 v58, v58, v158
    v_mul_f32 v59, v59, v159
    v_exp_f32 v56, v56
    v_exp_f32 v57, v57
    v_exp_f32 v58, v58
    v_exp_f32 v59, v59
    v_add_f32 v56, 1.0, v56
    v_add_f32 v57, 1.0, v57
    v_add_f32 v58, 1.0, v58
    v_add_f32 v59, 1.0, v59
    v_rcp_f32 v56, v56
    v_rcp_f32 v57, v57
    v_rcp_f32 v58, v58
    v_rcp_f32 v59, v59
    v_mul_f32 v156, v156, v56
    v_mul_f32 v157, v157, v57
    v_mul_f32 v158, v158, v58
    v_mul_f32 v159, v159, v59
    v_lshlrev_b32 v24, 16, v44
    v_and_b32 v25, 0xffff0000, v44
    v_lshlrev_b32 v26, 16, v45
    v_and_b32 v27, 0xffff0000, v45
    v_add_f32 v160, v160, v24
    v_add_f32 v161, v161, v25
    v_add_f32 v162, v162, v26
    v_add_f32 v163, v163, v27
    v_add_f32 v164, v164, v24
    v_add_f32 v165, v165, v25
    v_add_f32 v166, v166, v26
    v_add_f32 v167, v167, v27
    v_add_f32 v168, v168, v24
    v_add_f32 v169, v169, v25
    v_add_f32 v170, v170, v26
    v_add_f32 v171, v171, v27
    v_add_f32 v172, v172, v24
    v_add_f32 v173, v173, v25
    v_add_f32 v174, v174, v26
    v_add_f32 v175, v175, v27
    v_mul_f32 v56, v160, v160
    v_mul_f32 v57, v161, v161
    v_mul_f32 v58, v162, v162
    v_mul_f32 v59, v163, v163
    v_fma_f32 v56, v56, s46, v31
    v_fma_f32 v57, v57, s46, v31
    v_fma_f32 v58, v58, s46, v31
    v_fma_f32 v59, v59, s46, v31
    v_mul_f32 v56, v56, v160
    v_mul_f32 v57, v57, v161
    v_mul_f32 v58, v58, v162
    v_mul_f32 v59, v59, v163
    v_exp_f32 v56, v56
    v_exp_f32 v57, v57
    v_exp_f32 v58, v58
    v_exp_f32 v59, v59
    v_add_f32 v56, 1.0, v56
    v_add_f32 v57, 1.0, v57
    v_add_f32 v58, 1.0, v58
    v_add_f32 v59, 1.0, v59
    v_rcp_f32 v56, v56
    v_rcp_f32 v57, v57
    v_rcp_f32 v58, v58
    v_rcp_f32 v59, v59
    v_mul_f32 v160, v160, v56
    v_mul_f32 v161, v161, v57
    v_mul_f32 v162, v162, v58
    v_mul_f32 v163, v163, v59
    v_mul_f32 v56, v164, v164
    v_mul_f32 v57, v165, v165
    v_mul_f32 v58, v166, v166
    v_mul_f32 v59, v167, v167
    v_fma_f32 v56, v56, s46, v31
    v_fma_f32 v57, v57, s46, v31
    v_fma_f32 v58, v58, s46, v31
    v_fma_f32 v59, v59, s46, v31
    v_mul_f32 v56, v56, v164
    v_mul_f32 v57, v57, v165
    v_mul_f32 v58, v58, v166
    v_mul_f32 v59, v59, v167
    v_exp_f32 v56, v56
    v_exp_f32 v57, v57
    v_exp_f32 v58, v58
    v_exp_f32 v59, v59
    v_add_f32 v56, 1.0, v56
    v_add_f32 v57, 1.0, v57
    v_add_f32 v58, 1.0, v58
    v_add_f32 v59, 1.0, v59
    v_rcp_f32 v56, v56
    v_rcp_f32 v57, v57
    v_rcp_f32 v58, v58
    v_rcp_f32 v59, v59
    v_mul_f32 v164, v164, v56
    v_mul_f32 v165, v165, v57
    v_mul_f32 v166, v166, v58
    v_mul_f32 v167, v167, v59
    v_mul_f32 v56, v168, v168
    v_mul_f32 v57, v169, v169
    v_mul_f32 v58, v170, v170
    v_mul_f32 v59, v171, v171
    v_fma_f32 v56, v56, s46, v31
    v_fma_f32 v57, v57, s46, v31
    v_fma_f32 v58, v58, s46, v31
    v_fma_f32 v59, v59, s46, v31
    v_mul_f32 v56, v56, v168
    v_mul_f32 v57, v57, v169
    v_mul_f32 v58, v58, v170
    v_mul_f32 v59, v59, v171
    v_exp_f32 v56, v56
    v_exp_f32 v57, v57
    v_exp_f32 v58, v58
    v_exp_f32 v59, v59
    v_add_f32 v56, 1.0, v56
    v_add_f32 v57, 1.0, v57
    v_add_f32 v58, 1.0, v58
    v_add_f32 v59, 1.0, v59
    v_rcp_f32 v56, v56
    v_rcp_f32 v57, v57
    v_rcp_f32 v58, v58
    v_rcp_f32 v59, v59
    v_mul_f32 v168, v168, v56
    v_mul_f32 v169, v169, v57
    v_mul_f32 v170, v170, v58
    v_mul_f32 v171, v171, v59
    v_mul_f32 v56, v172, v172
    v_mul_f32 v57, v173, v173
    v_mul_f32 v58, v174, v174
    v_mul_f32 v59, v175, v175
    v_fma_f32 v56, v56, s46, v31
    v_fma_f32 v57, v57, s46, v31
    v_fma_f32 v58, v58, s46, v31
    v_fma_f32 v59, v59, s46, v31
    v_mul_f32 v56, v56, v172
    v_mul_f32 v57, v57, v173
    v_mul_f32 v58, v58, v174
    v_mul_f32 v59, v59, v175
    v_exp_f32 v56, v56
    v_exp_f32 v57, v57
    v_exp_f32 v58, v58
    v_exp_f32 v59, v59
    v_add_f32 v56, 1.0, v56
    v_add_f32 v57, 1.0, v57
    v_add_f32 v58, 1.0, v58
    v_add_f32 v59, 1.0, v59
    v_rcp_f32 v56, v56
    v_rcp_f32 v57, v57
    v_rcp_f32 v58, v58
    v_rcp_f32 v59, v59
    v_mul_f32 v172, v172, v56
    v_mul_f32 v173, v173, v57
    v_mul_f32 v174, v174, v58
    v_mul_f32 v175, v175, v59
    v_lshlrev_b32 v24, 16, v46
    v_and_b32 v25, 0xffff0000, v46
    v_lshlrev_b32 v26, 16, v47
    v_and_b32 v27, 0xffff0000, v47
    v_add_f32 v176, v176, v24
    v_add_f32 v177, v177, v25
    v_add_f32 v178, v178, v26
    v_add_f32 v179, v179, v27
    v_add_f32 v180, v180, v24
    v_add_f32 v181, v181, v25
    v_add_f32 v182, v182, v26
    v_add_f32 v183, v183, v27
    v_add_f32 v184, v184, v24
    v_add_f32 v185, v185, v25
    v_add_f32 v186, v186, v26
    v_add_f32 v187, v187, v27
    v_add_f32 v188, v188, v24
    v_add_f32 v189, v189, v25
    v_add_f32 v190, v190, v26
    v_add_f32 v191, v191, v27
    v_mul_f32 v56, v176, v176
    v_mul_f32 v57, v177, v177
    v_mul_f32 v58, v178, v178
    v_mul_f32 v59, v179, v179
    v_fma_f32 v56, v56, s46, v31
    v_fma_f32 v57, v57, s46, v31
    v_fma_f32 v58, v58, s46, v31
    v_fma_f32 v59, v59, s46, v31
    v_mul_f32 v56, v56, v176
    v_mul_f32 v57, v57, v177
    v_mul_f32 v58, v58, v178
    v_mul_f32 v59, v59, v179
    v_exp_f32 v56, v56
    v_exp_f32 v57, v57
    v_exp_f32 v58, v58
    v_exp_f32 v59, v59
    v_add_f32 v56, 1.0, v56
    v_add_f32 v57, 1.0, v57
    v_add_f32 v58, 1.0, v58
    v_add_f32 v59, 1.0, v59
    v_rcp_f32 v56, v56
    v_rcp_f32 v57, v57
    v_rcp_f32 v58, v58
    v_rcp_f32 v59, v59
    v_mul_f32 v176, v176, v56
    v_mul_f32 v177, v177, v57
    v_mul_f32 v178, v178, v58
    v_mul_f32 v179, v179, v59
    v_mul_f32 v56, v180, v180
    v_mul_f32 v57, v181, v181
    v_mul_f32 v58, v182, v182
    v_mul_f32 v59, v183, v183
    v_fma_f32 v56, v56, s46, v31
    v_fma_f32 v57, v57, s46, v31
    v_fma_f32 v58, v58, s46, v31
    v_fma_f32 v59, v59, s46, v31
    v_mul_f32 v56, v56, v180
    v_mul_f32 v57, v57, v181
    v_mul_f32 v58, v58, v182
    v_mul_f32 v59, v59, v183
    v_exp_f32 v56, v56
    v_exp_f32 v57, v57
    v_exp_f32 v58, v58
    v_exp_f32 v59, v59
    v_add_f32 v56, 1.0, v56
    v_add_f32 v57, 1.0, v57
    v_add_f32 v58, 1.0, v58
    v_add_f32 v59, 1.0, v59
    v_rcp_f32 v56, v56
    v_rcp_f32 v57, v57
    v_rcp_f32 v58, v58
    v_rcp_f32 v59, v59
    v_mul_f32 v180, v180, v56
    v_mul_f32 v181, v181, v57
    v_mul_f32 v182, v182, v58
    v_mul_f32 v183, v183, v59
    v_mul_f32 v56, v184, v184
    v_mul_f32 v57, v185, v185
    v_mul_f32 v58, v186, v186
    v_mul_f32 v59, v187, v187
    v_fma_f32 v56, v56, s46, v31
    v_fma_f32 v57, v57, s46, v31
    v_fma_f32 v58, v58, s46, v31
    v_fma_f32 v59, v59, s46, v31
    v_mul_f32 v56, v56, v184
    v_mul_f32 v57, v57, v185
    v_mul_f32 v58, v58, v186
    v_mul_f32 v59, v59, v187
    v_exp_f32 v56, v56
    v_exp_f32 v57, v57
    v_exp_f32 v58, v58
    v_exp_f32 v59, v59
    v_add_f32 v56, 1.0, v56
    v_add_f32 v57, 1.0, v57
    v_add_f32 v58, 1.0, v58
    v_add_f32 v59, 1.0, v59
    v_rcp_f32 v56, v56
    v_rcp_f32 v57, v57
    v_rcp_f32 v58, v58
    v_rcp_f32 v59, v59
    v_mul_f32 v184, v184, v56
    v_mul_f32 v185, v185, v57
    v_mul_f32 v186, v186, v58
    v_mul_f32 v187, v187, v59
    v_mul_f32 v56, v188, v188
    v_mul_f32 v57, v189, v189
    v_mul_f32 v58, v190, v190
    v_mul_f32 v59, v191, v191
    v_fma_f32 v56, v56, s46, v31
    v_fma_f32 v57, v57, s46, v31
    v_fma_f32 v58, v58, s46, v31
    v_fma_f32 v59, v59, s46, v31
    v_mul_f32 v56, v56, v188
    v_mul_f32 v57, v57, v189
    v_mul_f32 v58, v58, v190
    v_mul_f32 v59, v59, v191
    v_exp_f32 v56, v56
    v_exp_f32 v57, v57
    v_exp_f32 v58, v58
    v_exp_f32 v59, v59
    v_add_f32 v56, 1.0, v56
    v_add_f32 v57, 1.0, v57
    v_add_f32 v58, 1.0, v58
    v_add_f32 v59, 1.0, v59
    v_rcp_f32 v56, v56
    v_rcp_f32 v57, v57
    v_rcp_f32 v58, v58
    v_rcp_f32 v59, v59
    v_mul_f32 v188, v188, v56
    v_mul_f32 v189, v189, v57
    v_mul_f32 v190, v190, v58
    v_mul_f32 v191, v191, v59
    v_lshlrev_b32 v24, 16, v48
    v_and_b32 v25, 0xffff0000, v48
    v_lshlrev_b32 v26, 16, v49
    v_and_b32 v27, 0xffff0000, v49
    v_add_f32 v192, v192, v24
    v_add_f32 v193, v193, v25
    v_add_f32 v194, v194, v26
    v_add_f32 v195, v195, v27
    v_add_f32 v196, v196, v24
    v_add_f32 v197, v197, v25
    v_add_f32 v198, v198, v26
    v_add_f32 v199, v199, v27
    v_add_f32 v200, v200, v24
    v_add_f32 v201, v201, v25
    v_add_f32 v202, v202, v26
    v_add_f32 v203, v203, v27
    v_add_f32 v204, v204, v24
    v_add_f32 v205, v205, v25
    v_add_f32 v206, v206, v26
    v_add_f32 v207, v207, v27
    v_mul_f32 v56, v192, v192
    v_mul_f32 v57, v193, v193
    v_mul_f32 v58, v194, v194
    v_mul_f32 v59, v195, v195
    v_fma_f32 v56, v56, s46, v31
    v_fma_f32 v57, v57, s46, v31
    v_fma_f32 v58, v58, s46, v31
    v_fma_f32 v59, v59, s46, v31
    v_mul_f32 v56, v56, v192
    v_mul_f32 v57, v57, v193
    v_mul_f32 v58, v58, v194
    v_mul_f32 v59, v59, v195
    v_exp_f32 v56, v56
    v_exp_f32 v57, v57
    v_exp_f32 v58, v58
    v_exp_f32 v59, v59
    v_add_f32 v56, 1.0, v56
    v_add_f32 v57, 1.0, v57
    v_add_f32 v58, 1.0, v58
    v_add_f32 v59, 1.0, v59
    v_rcp_f32 v56, v56
    v_rcp_f32 v57, v57
    v_rcp_f32 v58, v58
    v_rcp_f32 v59, v59
    v_mul_f32 v192, v192, v56
    v_mul_f32 v193, v193, v57
    v_mul_f32 v194, v194, v58
    v_mul_f32 v195, v195, v59
    v_mul_f32 v56, v196, v196
    v_mul_f32 v57, v197, v197
    v_mul_f32 v58, v198, v198
    v_mul_f32 v59, v199, v199
    v_fma_f32 v56, v56, s46, v31
    v_fma_f32 v57, v57, s46, v31
    v_fma_f32 v58, v58, s46, v31
    v_fma_f32 v59, v59, s46, v31
    v_mul_f32 v56, v56, v196
    v_mul_f32 v57, v57, v197
    v_mul_f32 v58, v58, v198
    v_mul_f32 v59, v59, v199
    v_exp_f32 v56, v56
    v_exp_f32 v57, v57
    v_exp_f32 v58, v58
    v_exp_f32 v59, v59
    v_add_f32 v56, 1.0, v56
    v_add_f32 v57, 1.0, v57
    v_add_f32 v58, 1.0, v58
    v_add_f32 v59, 1.0, v59
    v_rcp_f32 v56, v56
    v_rcp_f32 v57, v57
    v_rcp_f32 v58, v58
    v_rcp_f32 v59, v59
    v_mul_f32 v196, v196, v56
    v_mul_f32 v197, v197, v57
    v_mul_f32 v198, v198, v58
    v_mul_f32 v199, v199, v59
    v_mul_f32 v56, v200, v200
    v_mul_f32 v57, v201, v201
    v_mul_f32 v58, v202, v202
    v_mul_f32 v59, v203, v203
    v_fma_f32 v56, v56, s46, v31
    v_fma_f32 v57, v57, s46, v31
    v_fma_f32 v58, v58, s46, v31
    v_fma_f32 v59, v59, s46, v31
    v_mul_f32 v56, v56, v200
    v_mul_f32 v57, v57, v201
    v_mul_f32 v58, v58, v202
    v_mul_f32 v59, v59, v203
    v_exp_f32 v56, v56
    v_exp_f32 v57, v57
    v_exp_f32 v58, v58
    v_exp_f32 v59, v59
    v_add_f32 v56, 1.0, v56
    v_add_f32 v57, 1.0, v57
    v_add_f32 v58, 1.0, v58
    v_add_f32 v59, 1.0, v59
    v_rcp_f32 v56, v56
    v_rcp_f32 v57, v57
    v_rcp_f32 v58, v58
    v_rcp_f32 v59, v59
    v_mul_f32 v200, v200, v56
    v_mul_f32 v201, v201, v57
    v_mul_f32 v202, v202, v58
    v_mul_f32 v203, v203, v59
    v_mul_f32 v56, v204, v204
    v_mul_f32 v57, v205, v205
    v_mul_f32 v58, v206, v206
    v_mul_f32 v59, v207, v207
    v_fma_f32 v56, v56, s46, v31
    v_fma_f32 v57, v57, s46, v31
    v_fma_f32 v58, v58, s46, v31
    v_fma_f32 v59, v59, s46, v31
    v_mul_f32 v56, v56, v204
    v_mul_f32 v57, v57, v205
    v_mul_f32 v58, v58, v206
    v_mul_f32 v59, v59, v207
    v_exp_f32 v56, v56
    v_exp_f32 v57, v57
    v_exp_f32 v58, v58
    v_exp_f32 v59, v59
    v_add_f32 v56, 1.0, v56
    v_add_f32 v57, 1.0, v57
    v_add_f32 v58, 1.0, v58
    v_add_f32 v59, 1.0, v59
    v_rcp_f32 v56, v56
    v_rcp_f32 v57, v57
    v_rcp_f32 v58, v58
    v_rcp_f32 v59, v59
    v_mul_f32 v204, v204, v56
    v_mul_f32 v205, v205, v57
    v_mul_f32 v206, v206, v58
    v_mul_f32 v207, v207, v59
    v_lshlrev_b32 v24, 16, v50
    v_and_b32 v25, 0xffff0000, v50
    v_lshlrev_b32 v26, 16, v51
    v_and_b32 v27, 0xffff0000, v51
    v_add_f32 v208, v208, v24
    v_add_f32 v209, v209, v25
    v_add_f32 v210, v210, v26
    v_add_f32 v211, v211, v27
    v_add_f32 v212, v212, v24
    v_add_f32 v213, v213, v25
    v_add_f32 v214, v214, v26
    v_add_f32 v215, v215, v27
    v_add_f32 v216, v216, v24
    v_add_f32 v217, v217, v25
    v_add_f32 v218, v218, v26
    v_add_f32 v219, v219, v27
    v_add_f32 v220, v220, v24
    v_add_f32 v221, v221, v25
    v_add_f32 v222, v222, v26
    v_add_f32 v223, v223, v27
    v_mul_f32 v56, v208, v208
    v_mul_f32 v57, v209, v209
    v_mul_f32 v58, v210, v210
    v_mul_f32 v59, v211, v211
    v_fma_f32 v56, v56, s46, v31
    v_fma_f32 v57, v57, s46, v31
    v_fma_f32 v58, v58, s46, v31
    v_fma_f32 v59, v59, s46, v31
    v_mul_f32 v56, v56, v208
    v_mul_f32 v57, v57, v209
    v_mul_f32 v58, v58, v210
    v_mul_f32 v59, v59, v211
    v_exp_f32 v56, v56
    v_exp_f32 v57, v57
    v_exp_f32 v58, v58
    v_exp_f32 v59, v59
    v_add_f32 v56, 1.0, v56
    v_add_f32 v57, 1.0, v57
    v_add_f32 v58, 1.0, v58
    v_add_f32 v59, 1.0, v59
    v_rcp_f32 v56, v56
    v_rcp_f32 v57, v57
    v_rcp_f32 v58, v58
    v_rcp_f32 v59, v59
    v_mul_f32 v208, v208, v56
    v_mul_f32 v209, v209, v57
    v_mul_f32 v210, v210, v58
    v_mul_f32 v211, v211, v59
    v_mul_f32 v56, v212, v212
    v_mul_f32 v57, v213, v213
    v_mul_f32 v58, v214, v214
    v_mul_f32 v59, v215, v215
    v_fma_f32 v56, v56, s46, v31
    v_fma_f32 v57, v57, s46, v31
    v_fma_f32 v58, v58, s46, v31
    v_fma_f32 v59, v59, s46, v31
    v_mul_f32 v56, v56, v212
    v_mul_f32 v57, v57, v213
    v_mul_f32 v58, v58, v214
    v_mul_f32 v59, v59, v215
    v_exp_f32 v56, v56
    v_exp_f32 v57, v57
    v_exp_f32 v58, v58
    v_exp_f32 v59, v59
    v_add_f32 v56, 1.0, v56
    v_add_f32 v57, 1.0, v57
    v_add_f32 v58, 1.0, v58
    v_add_f32 v59, 1.0, v59
    v_rcp_f32 v56, v56
    v_rcp_f32 v57, v57
    v_rcp_f32 v58, v58
    v_rcp_f32 v59, v59
    v_mul_f32 v212, v212, v56
    v_mul_f32 v213, v213, v57
    v_mul_f32 v214, v214, v58
    v_mul_f32 v215, v215, v59
    v_mul_f32 v56, v216, v216
    v_mul_f32 v57, v217, v217
    v_mul_f32 v58, v218, v218
    v_mul_f32 v59, v219, v219
    v_fma_f32 v56, v56, s46, v31
    v_fma_f32 v57, v57, s46, v31
    v_fma_f32 v58, v58, s46, v31
    v_fma_f32 v59, v59, s46, v31
    v_mul_f32 v56, v56, v216
    v_mul_f32 v57, v57, v217
    v_mul_f32 v58, v58, v218
    v_mul_f32 v59, v59, v219
    v_exp_f32 v56, v56
    v_exp_f32 v57, v57
    v_exp_f32 v58, v58
    v_exp_f32 v59, v59
    v_add_f32 v56, 1.0, v56
    v_add_f32 v57, 1.0, v57
    v_add_f32 v58, 1.0, v58
    v_add_f32 v59, 1.0, v59
    v_rcp_f32 v56, v56
    v_rcp_f32 v57, v57
    v_rcp_f32 v58, v58
    v_rcp_f32 v59, v59
    v_mul_f32 v216, v216, v56
    v_mul_f32 v217, v217, v57
    v_mul_f32 v218, v218, v58
    v_mul_f32 v219, v219, v59
    v_mul_f32 v56, v220, v220
    v_mul_f32 v57, v221, v221
    v_mul_f32 v58, v222, v222
    v_mul_f32 v59, v223, v223
    v_fma_f32 v56, v56, s46, v31
    v_fma_f32 v57, v57, s46, v31
    v_fma_f32 v58, v58, s46, v31
    v_fma_f32 v59, v59, s46, v31
    v_mul_f32 v56, v56, v220
    v_mul_f32 v57, v57, v221
    v_mul_f32 v58, v58, v222
    v_mul_f32 v59, v59, v223
    v_exp_f32 v56, v56
    v_exp_f32 v57, v57
    v_exp_f32 v58, v58
    v_exp_f32 v59, v59
    v_add_f32 v56, 1.0, v56
    v_add_f32 v57, 1.0, v57
    v_add_f32 v58, 1.0, v58
    v_add_f32 v59, 1.0, v59
    v_rcp_f32 v56, v56
    v_rcp_f32 v57, v57
    v_rcp_f32 v58, v58
    v_rcp_f32 v59, v59
    v_mul_f32 v220, v220, v56
    v_mul_f32 v221, v221, v57
    v_mul_f32 v222, v222, v58
    v_mul_f32 v223, v223, v59
    v_lshlrev_b32 v24, 16, v52
    v_and_b32 v25, 0xffff0000, v52
    v_lshlrev_b32 v26, 16, v53
    v_and_b32 v27, 0xffff0000, v53
    v_add_f32 v224, v224, v24
    v_add_f32 v225, v225, v25
    v_add_f32 v226, v226, v26
    v_add_f32 v227, v227, v27
    v_add_f32 v228, v228, v24
    v_add_f32 v229, v229, v25
    v_add_f32 v230, v230, v26
    v_add_f32 v231, v231, v27
    v_add_f32 v232, v232, v24
    v_add_f32 v233, v233, v25
    v_add_f32 v234, v234, v26
    v_add_f32 v235, v235, v27
    v_add_f32 v236, v236, v24
    v_add_f32 v237, v237, v25
    v_add_f32 v238, v238, v26
    v_add_f32 v239, v239, v27
    v_mul_f32 v56, v224, v224
    v_mul_f32 v57, v225, v225
    v_mul_f32 v58, v226, v226
    v_mul_f32 v59, v227, v227
    v_fma_f32 v56, v56, s46, v31
    v_fma_f32 v57, v57, s46, v31
    v_fma_f32 v58, v58, s46, v31
    v_fma_f32 v59, v59, s46, v31
    v_mul_f32 v56, v56, v224
    v_mul_f32 v57, v57, v225
    v_mul_f32 v58, v58, v226
    v_mul_f32 v59, v59, v227
    v_exp_f32 v56, v56
    v_exp_f32 v57, v57
    v_exp_f32 v58, v58
    v_exp_f32 v59, v59
    v_add_f32 v56, 1.0, v56
    v_add_f32 v57, 1.0, v57
    v_add_f32 v58, 1.0, v58
    v_add_f32 v59, 1.0, v59
    v_rcp_f32 v56, v56
    v_rcp_f32 v57, v57
    v_rcp_f32 v58, v58
    v_rcp_f32 v59, v59
    v_mul_f32 v224, v224, v56
    v_mul_f32 v225, v225, v57
    v_mul_f32 v226, v226, v58
    v_mul_f32 v227, v227, v59
    v_mul_f32 v56, v228, v228
    v_mul_f32 v57, v229, v229
    v_mul_f32 v58, v230, v230
    v_mul_f32 v59, v231, v231
    v_fma_f32 v56, v56, s46, v31
    v_fma_f32 v57, v57, s46, v31
    v_fma_f32 v58, v58, s46, v31
    v_fma_f32 v59, v59, s46, v31
    v_mul_f32 v56, v56, v228
    v_mul_f32 v57, v57, v229
    v_mul_f32 v58, v58, v230
    v_mul_f32 v59, v59, v231
    v_exp_f32 v56, v56
    v_exp_f32 v57, v57
    v_exp_f32 v58, v58
    v_exp_f32 v59, v59
    v_add_f32 v56, 1.0, v56
    v_add_f32 v57, 1.0, v57
    v_add_f32 v58, 1.0, v58
    v_add_f32 v59, 1.0, v59
    v_rcp_f32 v56, v56
    v_rcp_f32 v57, v57
    v_rcp_f32 v58, v58
    v_rcp_f32 v59, v59
    v_mul_f32 v228, v228, v56
    v_mul_f32 v229, v229, v57
    v_mul_f32 v230, v230, v58
    v_mul_f32 v231, v231, v59
    v_mul_f32 v56, v232, v232
    v_mul_f32 v57, v233, v233
    v_mul_f32 v58, v234, v234
    v_mul_f32 v59, v235, v235
    v_fma_f32 v56, v56, s46, v31
    v_fma_f32 v57, v57, s46, v31
    v_fma_f32 v58, v58, s46, v31
    v_fma_f32 v59, v59, s46, v31
    v_mul_f32 v56, v56, v232
    v_mul_f32 v57, v57, v233
    v_mul_f32 v58, v58, v234
    v_mul_f32 v59, v59, v235
    v_exp_f32 v56, v56
    v_exp_f32 v57, v57
    v_exp_f32 v58, v58
    v_exp_f32 v59, v59
    v_add_f32 v56, 1.0, v56
    v_add_f32 v57, 1.0, v57
    v_add_f32 v58, 1.0, v58
    v_add_f32 v59, 1.0, v59
    v_rcp_f32 v56, v56
    v_rcp_f32 v57, v57
    v_rcp_f32 v58, v58
    v_rcp_f32 v59, v59
    v_mul_f32 v232, v232, v56
    v_mul_f32 v233, v233, v57
    v_mul_f32 v234, v234, v58
    v_mul_f32 v235, v235, v59
    v_mul_f32 v56, v236, v236
    v_mul_f32 v57, v237, v237
    v_mul_f32 v58, v238, v238
    v_mul_f32 v59, v239, v239
    v_fma_f32 v56, v56, s46, v31
    v_fma_f32 v57, v57, s46, v31
    v_fma_f32 v58, v58, s46, v31
    v_fma_f32 v59, v59, s46, v31
    v_mul_f32 v56, v56, v236
    v_mul_f32 v57, v57, v237
    v_mul_f32 v58, v58, v238
    v_mul_f32 v59, v59, v239
    v_exp_f32 v56, v56
    v_exp_f32 v57, v57
    v_exp_f32 v58, v58
    v_exp_f32 v59, v59
    v_add_f32 v56, 1.0, v56
    v_add_f32 v57, 1.0, v57
    v_add_f32 v58, 1.0, v58
    v_add_f32 v59, 1.0, v59
    v_rcp_f32 v56, v56
    v_rcp_f32 v57, v57
    v_rcp_f32 v58, v58
    v_rcp_f32 v59, v59
    v_mul_f32 v236, v236, v56
    v_mul_f32 v237, v237, v57
    v_mul_f32 v238, v238, v58
    v_mul_f32 v239, v239, v59
    v_lshlrev_b32 v24, 16, v54
    v_and_b32 v25, 0xffff0000, v54
    v_lshlrev_b32 v26, 16, v55
    v_and_b32 v27, 0xffff0000, v55
    v_add_f32 v240, v240, v24
    v_add_f32 v241, v241, v25
    v_add_f32 v242, v242, v26
    v_add_f32 v243, v243, v27
    v_add_f32 v244, v244, v24
    v_add_f32 v245, v245, v25
    v_add_f32 v246, v246, v26
    v_add_f32 v247, v247, v27
    v_add_f32 v248, v248, v24
    v_add_f32 v249, v249, v25
    v_add_f32 v250, v250, v26
    v_add_f32 v251, v251, v27
    v_add_f32 v252, v252, v24
    v_add_f32 v253, v253, v25
    v_add_f32 v254, v254, v26
    v_add_f32 v255, v255, v27
    v_mul_f32 v56, v240, v240
    v_mul_f32 v57, v241, v241
    v_mul_f32 v58, v242, v242
    v_mul_f32 v59, v243, v243
    v_fma_f32 v56, v56, s46, v31
    v_fma_f32 v57, v57, s46, v31
    v_fma_f32 v58, v58, s46, v31
    v_fma_f32 v59, v59, s46, v31
    v_mul_f32 v56, v56, v240
    v_mul_f32 v57, v57, v241
    v_mul_f32 v58, v58, v242
    v_mul_f32 v59, v59, v243
    v_exp_f32 v56, v56
    v_exp_f32 v57, v57
    v_exp_f32 v58, v58
    v_exp_f32 v59, v59
    v_add_f32 v56, 1.0, v56
    v_add_f32 v57, 1.0, v57
    v_add_f32 v58, 1.0, v58
    v_add_f32 v59, 1.0, v59
    v_rcp_f32 v56, v56
    v_rcp_f32 v57, v57
    v_rcp_f32 v58, v58
    v_rcp_f32 v59, v59
    v_mul_f32 v240, v240, v56
    v_mul_f32 v241, v241, v57
    v_mul_f32 v242, v242, v58
    v_mul_f32 v243, v243, v59
    v_mul_f32 v56, v244, v244
    v_mul_f32 v57, v245, v245
    v_mul_f32 v58, v246, v246
    v_mul_f32 v59, v247, v247
    v_fma_f32 v56, v56, s46, v31
    v_fma_f32 v57, v57, s46, v31
    v_fma_f32 v58, v58, s46, v31
    v_fma_f32 v59, v59, s46, v31
    v_mul_f32 v56, v56, v244
    v_mul_f32 v57, v57, v245
    v_mul_f32 v58, v58, v246
    v_mul_f32 v59, v59, v247
    v_exp_f32 v56, v56
    v_exp_f32 v57, v57
    v_exp_f32 v58, v58
    v_exp_f32 v59, v59
    v_add_f32 v56, 1.0, v56
    v_add_f32 v57, 1.0, v57
    v_add_f32 v58, 1.0, v58
    v_add_f32 v59, 1.0, v59
    v_rcp_f32 v56, v56
    v_rcp_f32 v57, v57
    v_rcp_f32 v58, v58
    v_rcp_f32 v59, v59
    v_mul_f32 v244, v244, v56
    v_mul_f32 v245, v245, v57
    v_mul_f32 v246, v246, v58
    v_mul_f32 v247, v247, v59
    v_mul_f32 v56, v248, v248
    v_mul_f32 v57, v249, v249
    v_mul_f32 v58, v250, v250
    v_mul_f32 v59, v251, v251
    v_fma_f32 v56, v56, s46, v31
    v_fma_f32 v57, v57, s46, v31
    v_fma_f32 v58, v58, s46, v31
    v_fma_f32 v59, v59, s46, v31
    v_mul_f32 v56, v56, v248
    v_mul_f32 v57, v57, v249
    v_mul_f32 v58, v58, v250
    v_mul_f32 v59, v59, v251
    v_exp_f32 v56, v56
    v_exp_f32 v57, v57
    v_exp_f32 v58, v58
    v_exp_f32 v59, v59
    v_add_f32 v56, 1.0, v56
    v_add_f32 v57, 1.0, v57
    v_add_f32 v58, 1.0, v58
    v_add_f32 v59, 1.0, v59
    v_rcp_f32 v56, v56
    v_rcp_f32 v57, v57
    v_rcp_f32 v58, v58
    v_rcp_f32 v59, v59
    v_mul_f32 v248, v248, v56
    v_mul_f32 v249, v249, v57
    v_mul_f32 v250, v250, v58
    v_mul_f32 v251, v251, v59
    v_mul_f32 v56, v252, v252
    v_mul_f32 v57, v253, v253
    v_mul_f32 v58, v254, v254
    v_mul_f32 v59, v255, v255
    v_fma_f32 v56, v56, s46, v31
    v_fma_f32 v57, v57, s46, v31
    v_fma_f32 v58, v58, s46, v31
    v_fma_f32 v59, v59, s46, v31
    v_mul_f32 v56, v56, v252
    v_mul_f32 v57, v57, v253
    v_mul_f32 v58, v58, v254
    v_mul_f32 v59, v59, v255
    v_exp_f32 v56, v56
    v_exp_f32 v57, v57
    v_exp_f32 v58, v58
    v_exp_f32 v59, v59
    v_add_f32 v56, 1.0, v56
    v_add_f32 v57, 1.0, v57
    v_add_f32 v58, 1.0, v58
    v_add_f32 v59, 1.0, v59
    v_rcp_f32 v56, v56
    v_rcp_f32 v57, v57
    v_rcp_f32 v58, v58
    v_rcp_f32 v59, v59
    v_mul_f32 v252, v252, v56
    v_mul_f32 v253, v253, v57
    v_mul_f32 v254, v254, v58
    v_mul_f32 v255, v255, v59
    s_mul_i32 s53, s53, 48
    s_mul_i32 s54, s41, 6
    s_add_u32 s53, s53, s54
    s_lshl_b32 s53, s53, 10
    s_add_u32 s53, s53, 0x800000
    s_add_u32 s54, s53, 3072
    v_cvt_pk_bf16_f32 v64, v64, v65
    v_cvt_pk_bf16_f32 v65, v66, v67
    v_cvt_pk_bf16_f32 v66, v80, v81
    v_cvt_pk_bf16_f32 v67, v82, v83
    buffer_store_dwordx4 v[64:67], v3, s[8:11], s53 offen offset:0 sc1
    v_cvt_pk_bf16_f32 v96, v96, v97
    v_cvt_pk_bf16_f32 v97, v98, v99
    v_cvt_pk_bf16_f32 v98, v112, v113
    v_cvt_pk_bf16_f32 v99, v114, v115
    buffer_store_dwordx4 v[96:99], v3, s[8:11], s53 offen offset:1024 sc1
    v_cvt_pk_bf16_f32 v128, v128, v129
    v_cvt_pk_bf16_f32 v129, v130, v131
    v_cvt_pk_bf16_f32 v130, v144, v145
    v_cvt_pk_bf16_f32 v131, v146, v147
    buffer_store_dwordx4 v[128:131], v3, s[8:11], s53 offen offset:2048 sc1
    v_cvt_pk_bf16_f32 v160, v160, v161
    v_cvt_pk_bf16_f32 v161, v162, v163
    v_cvt_pk_bf16_f32 v162, v176, v177
    v_cvt_pk_bf16_f32 v163, v178, v179
    buffer_store_dwordx4 v[160:163], v3, s[8:11], s54 offen offset:0 sc1
    v_cvt_pk_bf16_f32 v192, v192, v193
    v_cvt_pk_bf16_f32 v193, v194, v195
    v_cvt_pk_bf16_f32 v194, v208, v209
    v_cvt_pk_bf16_f32 v195, v210, v211
    buffer_store_dwordx4 v[192:195], v3, s[8:11], s54 offen offset:1024 sc1
    v_cvt_pk_bf16_f32 v224, v224, v225
    v_cvt_pk_bf16_f32 v225, v226, v227
    v_cvt_pk_bf16_f32 v226, v240, v241
    v_cvt_pk_bf16_f32 v227, v242, v243
    buffer_store_dwordx4 v[224:227], v3, s[8:11], s54 offen offset:2048 sc1
    s_add_u32 s53, s53, 49152
    s_add_u32 s54, s53, 3072
    v_cvt_pk_bf16_f32 v68, v68, v69
    v_cvt_pk_bf16_f32 v69, v70, v71
    v_cvt_pk_bf16_f32 v70, v84, v85
    v_cvt_pk_bf16_f32 v71, v86, v87
    buffer_store_dwordx4 v[68:71], v3, s[8:11], s53 offen offset:0 sc1
    v_cvt_pk_bf16_f32 v100, v100, v101
    v_cvt_pk_bf16_f32 v101, v102, v103
    v_cvt_pk_bf16_f32 v102, v116, v117
    v_cvt_pk_bf16_f32 v103, v118, v119
    buffer_store_dwordx4 v[100:103], v3, s[8:11], s53 offen offset:1024 sc1
    v_cvt_pk_bf16_f32 v132, v132, v133
    v_cvt_pk_bf16_f32 v133, v134, v135
    v_cvt_pk_bf16_f32 v134, v148, v149
    v_cvt_pk_bf16_f32 v135, v150, v151
    buffer_store_dwordx4 v[132:135], v3, s[8:11], s53 offen offset:2048 sc1
    v_cvt_pk_bf16_f32 v164, v164, v165
    v_cvt_pk_bf16_f32 v165, v166, v167
    v_cvt_pk_bf16_f32 v166, v180, v181
    v_cvt_pk_bf16_f32 v167, v182, v183
    buffer_store_dwordx4 v[164:167], v3, s[8:11], s54 offen offset:0 sc1
    v_cvt_pk_bf16_f32 v196, v196, v197
    v_cvt_pk_bf16_f32 v197, v198, v199
    v_cvt_pk_bf16_f32 v198, v212, v213
    v_cvt_pk_bf16_f32 v199, v214, v215
    buffer_store_dwordx4 v[196:199], v3, s[8:11], s54 offen offset:1024 sc1
    v_cvt_pk_bf16_f32 v228, v228, v229
    v_cvt_pk_bf16_f32 v229, v230, v231
    v_cvt_pk_bf16_f32 v230, v244, v245
    v_cvt_pk_bf16_f32 v231, v246, v247
    buffer_store_dwordx4 v[228:231], v3, s[8:11], s54 offen offset:2048 sc1
    s_add_u32 s53, s53, 49152
    s_add_u32 s54, s53, 3072
    v_cvt_pk_bf16_f32 v72, v72, v73
    v_cvt_pk_bf16_f32 v73, v74, v75
    v_cvt_pk_bf16_f32 v74, v88, v89
    v_cvt_pk_bf16_f32 v75, v90, v91
    buffer_store_dwordx4 v[72:75], v3, s[8:11], s53 offen offset:0 sc1
    v_cvt_pk_bf16_f32 v104, v104, v105
    v_cvt_pk_bf16_f32 v105, v106, v107
    v_cvt_pk_bf16_f32 v106, v120, v121
    v_cvt_pk_bf16_f32 v107, v122, v123
    buffer_store_dwordx4 v[104:107], v3, s[8:11], s53 offen offset:1024 sc1
    v_cvt_pk_bf16_f32 v136, v136, v137
    v_cvt_pk_bf16_f32 v137, v138, v139
    v_cvt_pk_bf16_f32 v138, v152, v153
    v_cvt_pk_bf16_f32 v139, v154, v155
    buffer_store_dwordx4 v[136:139], v3, s[8:11], s53 offen offset:2048 sc1
    v_cvt_pk_bf16_f32 v168, v168, v169
    v_cvt_pk_bf16_f32 v169, v170, v171
    v_cvt_pk_bf16_f32 v170, v184, v185
    v_cvt_pk_bf16_f32 v171, v186, v187
    buffer_store_dwordx4 v[168:171], v3, s[8:11], s54 offen offset:0 sc1
    v_cvt_pk_bf16_f32 v200, v200, v201
    v_cvt_pk_bf16_f32 v201, v202, v203
    v_cvt_pk_bf16_f32 v202, v216, v217
    v_cvt_pk_bf16_f32 v203, v218, v219
    buffer_store_dwordx4 v[200:203], v3, s[8:11], s54 offen offset:1024 sc1
    v_cvt_pk_bf16_f32 v232, v232, v233
    v_cvt_pk_bf16_f32 v233, v234, v235
    v_cvt_pk_bf16_f32 v234, v248, v249
    v_cvt_pk_bf16_f32 v235, v250, v251
    buffer_store_dwordx4 v[232:235], v3, s[8:11], s54 offen offset:2048 sc1
    s_add_u32 s53, s53, 49152
    s_add_u32 s54, s53, 3072
    v_cvt_pk_bf16_f32 v76, v76, v77
    v_cvt_pk_bf16_f32 v77, v78, v79
    v_cvt_pk_bf16_f32 v78, v92, v93
    v_cvt_pk_bf16_f32 v79, v94, v95
    buffer_store_dwordx4 v[76:79], v3, s[8:11], s53 offen offset:0 sc1
    v_cvt_pk_bf16_f32 v108, v108, v109
    v_cvt_pk_bf16_f32 v109, v110, v111
    v_cvt_pk_bf16_f32 v110, v124, v125
    v_cvt_pk_bf16_f32 v111, v126, v127
    buffer_store_dwordx4 v[108:111], v3, s[8:11], s53 offen offset:1024 sc1
    v_cvt_pk_bf16_f32 v140, v140, v141
    v_cvt_pk_bf16_f32 v141, v142, v143
    v_cvt_pk_bf16_f32 v142, v156, v157
    v_cvt_pk_bf16_f32 v143, v158, v159
    buffer_store_dwordx4 v[140:143], v3, s[8:11], s53 offen offset:2048 sc1
    v_cvt_pk_bf16_f32 v172, v172, v173
    v_cvt_pk_bf16_f32 v173, v174, v175
    v_cvt_pk_bf16_f32 v174, v188, v189
    v_cvt_pk_bf16_f32 v175, v190, v191
    buffer_store_dwordx4 v[172:175], v3, s[8:11], s54 offen offset:0 sc1
    v_cvt_pk_bf16_f32 v204, v204, v205
    v_cvt_pk_bf16_f32 v205, v206, v207
    v_cvt_pk_bf16_f32 v206, v220, v221
    v_cvt_pk_bf16_f32 v207, v222, v223
    buffer_store_dwordx4 v[204:207], v3, s[8:11], s54 offen offset:1024 sc1
    v_cvt_pk_bf16_f32 v236, v236, v237
    v_cvt_pk_bf16_f32 v237, v238, v239
    v_cvt_pk_bf16_f32 v238, v252, v253
    v_cvt_pk_bf16_f32 v239, v254, v255
    buffer_store_dwordx4 v[236:239], v3, s[8:11], s54 offen offset:2048 sc1
    s_add_u32 s53, s53, 49152
    s_branch g_fin
g_epi_mb:
    s_mul_i32 s53, s53, 40
    s_lshr_b32 s54, s58, 5
    s_add_u32 s53, s53, s54
    s_lshl_b32 s53, s53, 9
    s_add_u32 s53, s53, 0x500000
    v_lshlrev_b32 v30, 3, v1
    s_mov_b32 s45, 0xbfb8aa3b
    v_lshlrev_b32 v24, 16, v32
    v_and_b32 v25, 0xffff0000, v32
    v_lshlrev_b32 v26, 16, v33
    v_and_b32 v27, 0xffff0000, v33
    v_add_f32 v64, v64, v24
    v_add_f32 v65, v65, v25
    v_add_f32 v66, v66, v26
    v_add_f32 v67, v67, v27
    v_add_f32 v68, v68, v24
    v_add_f32 v69, v69, v25
    v_add_f32 v70, v70, v26
    v_add_f32 v71, v71, v27
    v_add_f32 v72, v72, v24
    v_add_f32 v73, v73, v25
    v_add_f32 v74, v74, v26
    v_add_f32 v75, v75, v27
    v_add_f32 v76, v76, v24
    v_add_f32 v77, v77, v25
    v_add_f32 v78, v78, v26
    v_add_f32 v79, v79, v27
    v_cvt_pk_bf16_f32 v60, v64, v65
    v_cvt_pk_bf16_f32 v61, v66, v67
    v_lshlrev_b32 v64, 16, v60
    v_and_b32 v65, 0xffff0000, v60
    v_lshlrev_b32 v66, 16, v61
    v_and_b32 v67, 0xffff0000, v61
    v_mul_f32 v56, s45, v64
    v_mul_f32 v57, s45, v65
    v_mul_f32 v58, s45, v66
    v_mul_f32 v59, s45, v67
    v_exp_f32 v56, v56
    v_exp_f32 v57, v57
    v_exp_f32 v58, v58
    v_exp_f32 v59, v59
    v_add_f32 v56, 1.0, v56
    v_add_f32 v57, 1.0, v57
    v_add_f32 v58, 1.0, v58
    v_add_f32 v59, 1.0, v59
    v_rcp_f32 v56, v56
    v_rcp_f32 v57, v57
    v_rcp_f32 v58, v58
    v_rcp_f32 v59, v59
    v_mul_f32 v64, v64, v56
    v_mul_f32 v65, v65, v57
    v_mul_f32 v66, v66, v58
    v_mul_f32 v67, v67, v59
    v_cvt_pk_bf16_f32 v64, v64, v65
    v_cvt_pk_bf16_f32 v65, v66, v67
    s_add_u32 s54, s53, 0
    buffer_store_dwordx2 v[64:65], v30, s[8:11], s54 offen offset:0 sc1
    v_cvt_pk_bf16_f32 v60, v68, v69
    v_cvt_pk_bf16_f32 v61, v70, v71
    v_lshlrev_b32 v68, 16, v60
    v_and_b32 v69, 0xffff0000, v60
    v_lshlrev_b32 v70, 16, v61
    v_and_b32 v71, 0xffff0000, v61
    v_mul_f32 v56, s45, v68
    v_mul_f32 v57, s45, v69
    v_mul_f32 v58, s45, v70
    v_mul_f32 v59, s45, v71
    v_exp_f32 v56, v56
    v_exp_f32 v57, v57
    v_exp_f32 v58, v58
    v_exp_f32 v59, v59
    v_add_f32 v56, 1.0, v56
    v_add_f32 v57, 1.0, v57
    v_add_f32 v58, 1.0, v58
    v_add_f32 v59, 1.0, v59
    v_rcp_f32 v56, v56
    v_rcp_f32 v57, v57
    v_rcp_f32 v58, v58
    v_rcp_f32 v59, v59
    v_mul_f32 v68, v68, v56
    v_mul_f32 v69, v69, v57
    v_mul_f32 v70, v70, v58
    v_mul_f32 v71, v71, v59
    v_cvt_pk_bf16_f32 v68, v68, v69
    v_cvt_pk_bf16_f32 v69, v70, v71
    s_add_u32 s54, s53, 20480
    buffer_store_dwordx2 v[68:69], v30, s[8:11], s54 offen offset:0 sc1
    v_cvt_pk_bf16_f32 v60, v72, v73
    v_cvt_pk_bf16_f32 v61, v74, v75
    v_lshlrev_b32 v72, 16, v60
    v_and_b32 v73, 0xffff0000, v60
    v_lshlrev_b32 v74, 16, v61
    v_and_b32 v75, 0xffff0000, v61
    v_mul_f32 v56, s45, v72
    v_mul_f32 v57, s45, v73
    v_mul_f32 v58, s45, v74
    v_mul_f32 v59, s45, v75
    v_exp_f32 v56, v56
    v_exp_f32 v57, v57
    v_exp_f32 v58, v58
    v_exp_f32 v59, v59
    v_add_f32 v56, 1.0, v56
    v_add_f32 v57, 1.0, v57
    v_add_f32 v58, 1.0, v58
    v_add_f32 v59, 1.0, v59
    v_rcp_f32 v56, v56
    v_rcp_f32 v57, v57
    v_rcp_f32 v58, v58
    v_rcp_f32 v59, v59
    v_mul_f32 v72, v72, v56
    v_mul_f32 v73, v73, v57
    v_mul_f32 v74, v74, v58
    v_mul_f32 v75, v75, v59
    v_cvt_pk_bf16_f32 v72, v72, v73
    v_cvt_pk_bf16_f32 v73, v74, v75
    s_add_u32 s54, s53, 40960
    buffer_store_dwordx2 v[72:73], v30, s[8:11], s54 offen offset:0 sc1
    v_cvt_pk_bf16_f32 v60, v76, v77
    v_cvt_pk_bf16_f32 v61, v78, v79
    v_lshlrev_b32 v76, 16, v60
    v_and_b32 v77, 0xffff0000, v60
    v_lshlrev_b32 v78, 16, v61
    v_and_b32 v79, 0xffff0000, v61
    v_mul_f32 v56, s45, v76
    v_mul_f32 v57, s45, v77
    v_mul_f32 v58, s45, v78
    v_mul_f32 v59, s45, v79
    v_exp_f32 v56, v56
    v_exp_f32 v57, v57
    v_exp_f32 v58, v58
    v_exp_f32 v59, v59
    v_add_f32 v56, 1.0, v56
    v_add_f32 v57, 1.0, v57
    v_add_f32 v58, 1.0, v58
    v_add_f32 v59, 1.0, v59
    v_rcp_f32 v56, v56
    v_rcp_f32 v57, v57
    v_rcp_f32 v58, v58
    v_rcp_f32 v59, v59
    v_mul_f32 v76, v76, v56
    v_mul_f32 v77, v77, v57
    v_mul_f32 v78, v78, v58
    v_mul_f32 v79, v79, v59
    v_cvt_pk_bf16_f32 v76, v76, v77
    v_cvt_pk_bf16_f32 v77, v78, v79
    s_add_u32 s54, s53, 61440
    buffer_store_dwordx2 v[76:77], v30, s[8:11], s54 offen offset:0 sc1
    v_lshlrev_b32 v24, 16, v34
    v_and_b32 v25, 0xffff0000, v34
    v_lshlrev_b32 v26, 16, v35
    v_and_b32 v27, 0xffff0000, v35
    v_add_f32 v80, v80, v24
    v_add_f32 v81, v81, v25
    v_add_f32 v82, v82, v26
    v_add_f32 v83, v83, v27
    v_add_f32 v84, v84, v24
    v_add_f32 v85, v85, v25
    v_add_f32 v86, v86, v26
    v_add_f32 v87, v87, v27
    v_add_f32 v88, v88, v24
    v_add_f32 v89, v89, v25
    v_add_f32 v90, v90, v26
    v_add_f32 v91, v91, v27
    v_add_f32 v92, v92, v24
    v_add_f32 v93, v93, v25
    v_add_f32 v94, v94, v26
    v_add_f32 v95, v95, v27
    v_cvt_pk_bf16_f32 v60, v80, v81
    v_cvt_pk_bf16_f32 v61, v82, v83
    v_lshlrev_b32 v80, 16, v60
    v_and_b32 v81, 0xffff0000, v60
    v_lshlrev_b32 v82, 16, v61
    v_and_b32 v83, 0xffff0000, v61
    v_mul_f32 v56, s45, v80
    v_mul_f32 v57, s45, v81
    v_mul_f32 v58, s45, v82
    v_mul_f32 v59, s45, v83
    v_exp_f32 v56, v56
    v_exp_f32 v57, v57
    v_exp_f32 v58, v58
    v_exp_f32 v59, v59
    v_add_f32 v56, 1.0, v56
    v_add_f32 v57, 1.0, v57
    v_add_f32 v58, 1.0, v58
    v_add_f32 v59, 1.0, v59
    v_rcp_f32 v56, v56
    v_rcp_f32 v57, v57
    v_rcp_f32 v58, v58
    v_rcp_f32 v59, v59
    v_mul_f32 v80, v80, v56
    v_mul_f32 v81, v81, v57
    v_mul_f32 v82, v82, v58
    v_mul_f32 v83, v83, v59
    v_cvt_pk_bf16_f32 v80, v80, v81
    v_cvt_pk_bf16_f32 v81, v82, v83
    s_add_u32 s54, s53, 0
    buffer_store_dwordx2 v[80:81], v30, s[8:11], s54 offen offset:512 sc1
    v_cvt_pk_bf16_f32 v60, v84, v85
    v_cvt_pk_bf16_f32 v61, v86, v87
    v_lshlrev_b32 v84, 16, v60
    v_and_b32 v85, 0xffff0000, v60
    v_lshlrev_b32 v86, 16, v61
    v_and_b32 v87, 0xffff0000, v61
    v_mul_f32 v56, s45, v84
    v_mul_f32 v57, s45, v85
    v_mul_f32 v58, s45, v86
    v_mul_f32 v59, s45, v87
    v_exp_f32 v56, v56
    v_exp_f32 v57, v57
    v_exp_f32 v58, v58
    v_exp_f32 v59, v59
    v_add_f32 v56, 1.0, v56
    v_add_f32 v57, 1.0, v57
    v_add_f32 v58, 1.0, v58
    v_add_f32 v59, 1.0, v59
    v_rcp_f32 v56, v56
    v_rcp_f32 v57, v57
    v_rcp_f32 v58, v58
    v_rcp_f32 v59, v59
    v_mul_f32 v84, v84, v56
    v_mul_f32 v85, v85, v57
    v_mul_f32 v86, v86, v58
    v_mul_f32 v87, v87, v59
    v_cvt_pk_bf16_f32 v84, v84, v85
    v_cvt_pk_bf16_f32 v85, v86, v87
    s_add_u32 s54, s53, 20480
    buffer_store_dwordx2 v[84:85], v30, s[8:11], s54 offen offset:512 sc1
    v_cvt_pk_bf16_f32 v60, v88, v89
    v_cvt_pk_bf16_f32 v61, v90, v91
    v_lshlrev_b32 v88, 16, v60
    v_and_b32 v89, 0xffff0000, v60
    v_lshlrev_b32 v90, 16, v61
    v_and_b32 v91, 0xffff0000, v61
    v_mul_f32 v56, s45, v88
    v_mul_f32 v57, s45, v89
    v_mul_f32 v58, s45, v90
    v_mul_f32 v59, s45, v91
    v_exp_f32 v56, v56
    v_exp_f32 v57, v57
    v_exp_f32 v58, v58
    v_exp_f32 v59, v59
    v_add_f32 v56, 1.0, v56
    v_add_f32 v57, 1.0, v57
    v_add_f32 v58, 1.0, v58
    v_add_f32 v59, 1.0, v59
    v_rcp_f32 v56, v56
    v_rcp_f32 v57, v57
    v_rcp_f32 v58, v58
    v_rcp_f32 v59, v59
    v_mul_f32 v88, v88, v56
    v_mul_f32 v89, v89, v57
    v_mul_f32 v90, v90, v58
    v_mul_f32 v91, v91, v59
    v_cvt_pk_bf16_f32 v88, v88, v89
    v_cvt_pk_bf16_f32 v89, v90, v91
    s_add_u32 s54, s53, 40960
    buffer_store_dwordx2 v[88:89], v30, s[8:11], s54 offen offset:512 sc1
    v_cvt_pk_bf16_f32 v60, v92, v93
    v_cvt_pk_bf16_f32 v61, v94, v95
    v_lshlrev_b32 v92, 16, v60
    v_and_b32 v93, 0xffff0000, v60
    v_lshlrev_b32 v94, 16, v61
    v_and_b32 v95, 0xffff0000, v61
    v_mul_f32 v56, s45, v92
    v_mul_f32 v57, s45, v93
    v_mul_f32 v58, s45, v94
    v_mul_f32 v59, s45, v95
    v_exp_f32 v56, v56
    v_exp_f32 v57, v57
    v_exp_f32 v58, v58
    v_exp_f32 v59, v59
    v_add_f32 v56, 1.0, v56
    v_add_f32 v57, 1.0, v57
    v_add_f32 v58, 1.0, v58
    v_add_f32 v59, 1.0, v59
    v_rcp_f32 v56, v56
    v_rcp_f32 v57, v57
    v_rcp_f32 v58, v58
    v_rcp_f32 v59, v59
    v_mul_f32 v92, v92, v56
    v_mul_f32 v93, v93, v57
    v_mul_f32 v94, v94, v58
    v_mul_f32 v95, v95, v59
    v_cvt_pk_bf16_f32 v92, v92, v93
    v_cvt_pk_bf16_f32 v93, v94, v95
    s_add_u32 s54, s53, 61440
    buffer_store_dwordx2 v[92:93], v30, s[8:11], s54 offen offset:512 sc1
    v_lshlrev_b32 v24, 16, v36
    v_and_b32 v25, 0xffff0000, v36
    v_lshlrev_b32 v26, 16, v37
    v_and_b32 v27, 0xffff0000, v37
    v_add_f32 v96, v96, v24
    v_add_f32 v97, v97, v25
    v_add_f32 v98, v98, v26
    v_add_f32 v99, v99, v27
    v_add_f32 v100, v100, v24
    v_add_f32 v101, v101, v25
    v_add_f32 v102, v102, v26
    v_add_f32 v103, v103, v27
    v_add_f32 v104, v104, v24
    v_add_f32 v105, v105, v25
    v_add_f32 v106, v106, v26
    v_add_f32 v107, v107, v27
    v_add_f32 v108, v108, v24
    v_add_f32 v109, v109, v25
    v_add_f32 v110, v110, v26
    v_add_f32 v111, v111, v27
    v_cvt_pk_bf16_f32 v60, v96, v97
    v_cvt_pk_bf16_f32 v61, v98, v99
    v_lshlrev_b32 v96, 16, v60
    v_and_b32 v97, 0xffff0000, v60
    v_lshlrev_b32 v98, 16, v61
    v_and_b32 v99, 0xffff0000, v61
    v_mul_f32 v56, s45, v96
    v_mul_f32 v57, s45, v97
    v_mul_f32 v58, s45, v98
    v_mul_f32 v59, s45, v99
    v_exp_f32 v56, v56
    v_exp_f32 v57, v57
    v_exp_f32 v58, v58
    v_exp_f32 v59, v59
    v_add_f32 v56, 1.0, v56
    v_add_f32 v57, 1.0, v57
    v_add_f32 v58, 1.0, v58
    v_add_f32 v59, 1.0, v59
    v_rcp_f32 v56, v56
    v_rcp_f32 v57, v57
    v_rcp_f32 v58, v58
    v_rcp_f32 v59, v59
    v_mul_f32 v96, v96, v56
    v_mul_f32 v97, v97, v57
    v_mul_f32 v98, v98, v58
    v_mul_f32 v99, v99, v59
    v_cvt_pk_bf16_f32 v96, v96, v97
    v_cvt_pk_bf16_f32 v97, v98, v99
    s_add_u32 s54, s53, 0
    buffer_store_dwordx2 v[96:97], v30, s[8:11], s54 offen offset:1024 sc1
    v_cvt_pk_bf16_f32 v60, v100, v101
    v_cvt_pk_bf16_f32 v61, v102, v103
    v_lshlrev_b32 v100, 16, v60
    v_and_b32 v101, 0xffff0000, v60
    v_lshlrev_b32 v102, 16, v61
    v_and_b32 v103, 0xffff0000, v61
    v_mul_f32 v56, s45, v100
    v_mul_f32 v57, s45, v101
    v_mul_f32 v58, s45, v102
    v_mul_f32 v59, s45, v103
    v_exp_f32 v56, v56
    v_exp_f32 v57, v57
    v_exp_f32 v58, v58
    v_exp_f32 v59, v59
    v_add_f32 v56, 1.0, v56
    v_add_f32 v57, 1.0, v57
    v_add_f32 v58, 1.0, v58
    v_add_f32 v59, 1.0, v59
    v_rcp_f32 v56, v56
    v_rcp_f32 v57, v57
    v_rcp_f32 v58, v58
    v_rcp_f32 v59, v59
    v_mul_f32 v100, v100, v56
    v_mul_f32 v101, v101, v57
    v_mul_f32 v102, v102, v58
    v_mul_f32 v103, v103, v59
    v_cvt_pk_bf16_f32 v100, v100, v101
    v_cvt_pk_bf16_f32 v101, v102, v103
    s_add_u32 s54, s53, 20480
    buffer_store_dwordx2 v[100:101], v30, s[8:11], s54 offen offset:1024 sc1
    v_cvt_pk_bf16_f32 v60, v104, v105
    v_cvt_pk_bf16_f32 v61, v106, v107
    v_lshlrev_b32 v104, 16, v60
    v_and_b32 v105, 0xffff0000, v60
    v_lshlrev_b32 v106, 16, v61
    v_and_b32 v107, 0xffff0000, v61
    v_mul_f32 v56, s45, v104
    v_mul_f32 v57, s45, v105
    v_mul_f32 v58, s45, v106
    v_mul_f32 v59, s45, v107
    v_exp_f32 v56, v56
    v_exp_f32 v57, v57
    v_exp_f32 v58, v58
    v_exp_f32 v59, v59
    v_add_f32 v56, 1.0, v56
    v_add_f32 v57, 1.0, v57
    v_add_f32 v58, 1.0, v58
    v_add_f32 v59, 1.0, v59
    v_rcp_f32 v56, v56
    v_rcp_f32 v57, v57
    v_rcp_f32 v58, v58
    v_rcp_f32 v59, v59
    v_mul_f32 v104, v104, v56
    v_mul_f32 v105, v105, v57
    v_mul_f32 v106, v106, v58
    v_mul_f32 v107, v107, v59
    v_cvt_pk_bf16_f32 v104, v104, v105
    v_cvt_pk_bf16_f32 v105, v106, v107
    s_add_u32 s54, s53, 40960
    buffer_store_dwordx2 v[104:105], v30, s[8:11], s54 offen offset:1024 sc1
    v_cvt_pk_bf16_f32 v60, v108, v109
    v_cvt_pk_bf16_f32 v61, v110, v111
    v_lshlrev_b32 v108, 16, v60
    v_and_b32 v109, 0xffff0000, v60
    v_lshlrev_b32 v110, 16, v61
    v_and_b32 v111, 0xffff0000, v61
    v_mul_f32 v56, s45, v108
    v_mul_f32 v57, s45, v109
    v_mul_f32 v58, s45, v110
    v_mul_f32 v59, s45, v111
    v_exp_f32 v56, v56
    v_exp_f32 v57, v57
    v_exp_f32 v58, v58
    v_exp_f32 v59, v59
    v_add_f32 v56, 1.0, v56
    v_add_f32 v57, 1.0, v57
    v_add_f32 v58, 1.0, v58
    v_add_f32 v59, 1.0, v59
    v_rcp_f32 v56, v56
    v_rcp_f32 v57, v57
    v_rcp_f32 v58, v58
    v_rcp_f32 v59, v59
    v_mul_f32 v108, v108, v56
    v_mul_f32 v109, v109, v57
    v_mul_f32 v110, v110, v58
    v_mul_f32 v111, v111, v59
    v_cvt_pk_bf16_f32 v108, v108, v109
    v_cvt_pk_bf16_f32 v109, v110, v111
    s_add_u32 s54, s53, 61440
    buffer_store_dwordx2 v[108:109], v30, s[8:11], s54 offen offset:1024 sc1
    v_lshlrev_b32 v24, 16, v38
    v_and_b32 v25, 0xffff0000, v38
    v_lshlrev_b32 v26, 16, v39
    v_and_b32 v27, 0xffff0000, v39
    v_add_f32 v112, v112, v24
    v_add_f32 v113, v113, v25
    v_add_f32 v114, v114, v26
    v_add_f32 v115, v115, v27
    v_add_f32 v116, v116, v24
    v_add_f32 v117, v117, v25
    v_add_f32 v118, v118, v26
    v_add_f32 v119, v119, v27
    v_add_f32 v120, v120, v24
    v_add_f32 v121, v121, v25
    v_add_f32 v122, v122, v26
    v_add_f32 v123, v123, v27
    v_add_f32 v124, v124, v24
    v_add_f32 v125, v125, v25
    v_add_f32 v126, v126, v26
    v_add_f32 v127, v127, v27
    v_cvt_pk_bf16_f32 v60, v112, v113
    v_cvt_pk_bf16_f32 v61, v114, v115
    v_lshlrev_b32 v112, 16, v60
    v_and_b32 v113, 0xffff0000, v60
    v_lshlrev_b32 v114, 16, v61
    v_and_b32 v115, 0xffff0000, v61
    v_mul_f32 v56, s45, v112
    v_mul_f32 v57, s45, v113
    v_mul_f32 v58, s45, v114
    v_mul_f32 v59, s45, v115
    v_exp_f32 v56, v56
    v_exp_f32 v57, v57
    v_exp_f32 v58, v58
    v_exp_f32 v59, v59
    v_add_f32 v56, 1.0, v56
    v_add_f32 v57, 1.0, v57
    v_add_f32 v58, 1.0, v58
    v_add_f32 v59, 1.0, v59
    v_rcp_f32 v56, v56
    v_rcp_f32 v57, v57
    v_rcp_f32 v58, v58
    v_rcp_f32 v59, v59
    v_mul_f32 v112, v112, v56
    v_mul_f32 v113, v113, v57
    v_mul_f32 v114, v114, v58
    v_mul_f32 v115, v115, v59
    v_cvt_pk_bf16_f32 v112, v112, v113
    v_cvt_pk_bf16_f32 v113, v114, v115
    s_add_u32 s54, s53, 0
    buffer_store_dwordx2 v[112:113], v30, s[8:11], s54 offen offset:1536 sc1
    v_cvt_pk_bf16_f32 v60, v116, v117
    v_cvt_pk_bf16_f32 v61, v118, v119
    v_lshlrev_b32 v116, 16, v60
    v_and_b32 v117, 0xffff0000, v60
    v_lshlrev_b32 v118, 16, v61
    v_and_b32 v119, 0xffff0000, v61
    v_mul_f32 v56, s45, v116
    v_mul_f32 v57, s45, v117
    v_mul_f32 v58, s45, v118
    v_mul_f32 v59, s45, v119
    v_exp_f32 v56, v56
    v_exp_f32 v57, v57
    v_exp_f32 v58, v58
    v_exp_f32 v59, v59
    v_add_f32 v56, 1.0, v56
    v_add_f32 v57, 1.0, v57
    v_add_f32 v58, 1.0, v58
    v_add_f32 v59, 1.0, v59
    v_rcp_f32 v56, v56
    v_rcp_f32 v57, v57
    v_rcp_f32 v58, v58
    v_rcp_f32 v59, v59
    v_mul_f32 v116, v116, v56
    v_mul_f32 v117, v117, v57
    v_mul_f32 v118, v118, v58
    v_mul_f32 v119, v119, v59
    v_cvt_pk_bf16_f32 v116, v116, v117
    v_cvt_pk_bf16_f32 v117, v118, v119
    s_add_u32 s54, s53, 20480
    buffer_store_dwordx2 v[116:117], v30, s[8:11], s54 offen offset:1536 sc1
    v_cvt_pk_bf16_f32 v60, v120, v121
    v_cvt_pk_bf16_f32 v61, v122, v123
    v_lshlrev_b32 v120, 16, v60
    v_and_b32 v121, 0xffff0000, v60
    v_lshlrev_b32 v122, 16, v61
    v_and_b32 v123, 0xffff0000, v61
    v_mul_f32 v56, s45, v120
    v_mul_f32 v57, s45, v121
    v_mul_f32 v58, s45, v122
    v_mul_f32 v59, s45, v123
    v_exp_f32 v56, v56
    v_exp_f32 v57, v57
    v_exp_f32 v58, v58
    v_exp_f32 v59, v59
    v_add_f32 v56, 1.0, v56
    v_add_f32 v57, 1.0, v57
    v_add_f32 v58, 1.0, v58
    v_add_f32 v59, 1.0, v59
    v_rcp_f32 v56, v56
    v_rcp_f32 v57, v57
    v_rcp_f32 v58, v58
    v_rcp_f32 v59, v59
    v_mul_f32 v120, v120, v56
    v_mul_f32 v121, v121, v57
    v_mul_f32 v122, v122, v58
    v_mul_f32 v123, v123, v59
    v_cvt_pk_bf16_f32 v120, v120, v121
    v_cvt_pk_bf16_f32 v121, v122, v123
    s_add_u32 s54, s53, 40960
    buffer_store_dwordx2 v[120:121], v30, s[8:11], s54 offen offset:1536 sc1
    v_cvt_pk_bf16_f32 v60, v124, v125
    v_cvt_pk_bf16_f32 v61, v126, v127
    v_lshlrev_b32 v124, 16, v60
    v_and_b32 v125, 0xffff0000, v60
    v_lshlrev_b32 v126, 16, v61
    v_and_b32 v127, 0xffff0000, v61
    v_mul_f32 v56, s45, v124
    v_mul_f32 v57, s45, v125
    v_mul_f32 v58, s45, v126
    v_mul_f32 v59, s45, v127
    v_exp_f32 v56, v56
    v_exp_f32 v57, v57
    v_exp_f32 v58, v58
    v_exp_f32 v59, v59
    v_add_f32 v56, 1.0, v56
    v_add_f32 v57, 1.0, v57
    v_add_f32 v58, 1.0, v58
    v_add_f32 v59, 1.0, v59
    v_rcp_f32 v56, v56
    v_rcp_f32 v57, v57
    v_rcp_f32 v58, v58
    v_rcp_f32 v59, v59
    v_mul_f32 v124, v124, v56
    v_mul_f32 v125, v125, v57
    v_mul_f32 v126, v126, v58
    v_mul_f32 v127, v127, v59
    v_cvt_pk_bf16_f32 v124, v124, v125
    v_cvt_pk_bf16_f32 v125, v126, v127
    s_add_u32 s54, s53, 61440
    buffer_store_dwordx2 v[124:125], v30, s[8:11], s54 offen offset:1536 sc1
    v_lshlrev_b32 v24, 16, v40
    v_and_b32 v25, 0xffff0000, v40
    v_lshlrev_b32 v26, 16, v41
    v_and_b32 v27, 0xffff0000, v41
    v_add_f32 v128, v128, v24
    v_add_f32 v129, v129, v25
    v_add_f32 v130, v130, v26
    v_add_f32 v131, v131, v27
    v_add_f32 v132, v132, v24
    v_add_f32 v133, v133, v25
    v_add_f32 v134, v134, v26
    v_add_f32 v135, v135, v27
    v_add_f32 v136, v136, v24
    v_add_f32 v137, v137, v25
    v_add_f32 v138, v138, v26
    v_add_f32 v139, v139, v27
    v_add_f32 v140, v140, v24
    v_add_f32 v141, v141, v25
    v_add_f32 v142, v142, v26
    v_add_f32 v143, v143, v27
    v_cvt_pk_bf16_f32 v60, v128, v129
    v_cvt_pk_bf16_f32 v61, v130, v131
    v_lshlrev_b32 v128, 16, v60
    v_and_b32 v129, 0xffff0000, v60
    v_lshlrev_b32 v130, 16, v61
    v_and_b32 v131, 0xffff0000, v61
    v_mul_f32 v56, s45, v128
    v_mul_f32 v57, s45, v129
    v_mul_f32 v58, s45, v130
    v_mul_f32 v59, s45, v131
    v_exp_f32 v56, v56
    v_exp_f32 v57, v57
    v_exp_f32 v58, v58
    v_exp_f32 v59, v59
    v_add_f32 v56, 1.0, v56
    v_add_f32 v57, 1.0, v57
    v_add_f32 v58, 1.0, v58
    v_add_f32 v59, 1.0, v59
    v_rcp_f32 v56, v56
    v_rcp_f32 v57, v57
    v_rcp_f32 v58, v58
    v_rcp_f32 v59, v59
    v_mul_f32 v128, v128, v56
    v_mul_f32 v129, v129, v57
    v_mul_f32 v130, v130, v58
    v_mul_f32 v131, v131, v59
    v_cvt_pk_bf16_f32 v128, v128, v129
    v_cvt_pk_bf16_f32 v129, v130, v131
    s_add_u32 s54, s53, 0
    buffer_store_dwordx2 v[128:129], v30, s[8:11], s54 offen offset:2048 sc1
    v_cvt_pk_bf16_f32 v60, v132, v133
    v_cvt_pk_bf16_f32 v61, v134, v135
    v_lshlrev_b32 v132, 16, v60
    v_and_b32 v133, 0xffff0000, v60
    v_lshlrev_b32 v134, 16, v61
    v_and_b32 v135, 0xffff0000, v61
    v_mul_f32 v56, s45, v132
    v_mul_f32 v57, s45, v133
    v_mul_f32 v58, s45, v134
    v_mul_f32 v59, s45, v135
    v_exp_f32 v56, v56
    v_exp_f32 v57, v57
    v_exp_f32 v58, v58
    v_exp_f32 v59, v59
    v_add_f32 v56, 1.0, v56
    v_add_f32 v57, 1.0, v57
    v_add_f32 v58, 1.0, v58
    v_add_f32 v59, 1.0, v59
    v_rcp_f32 v56, v56
    v_rcp_f32 v57, v57
    v_rcp_f32 v58, v58
    v_rcp_f32 v59, v59
    v_mul_f32 v132, v132, v56
    v_mul_f32 v133, v133, v57
    v_mul_f32 v134, v134, v58
    v_mul_f32 v135, v135, v59
    v_cvt_pk_bf16_f32 v132, v132, v133
    v_cvt_pk_bf16_f32 v133, v134, v135
    s_add_u32 s54, s53, 20480
    buffer_store_dwordx2 v[132:133], v30, s[8:11], s54 offen offset:2048 sc1
    v_cvt_pk_bf16_f32 v60, v136, v137
    v_cvt_pk_bf16_f32 v61, v138, v139
    v_lshlrev_b32 v136, 16, v60
    v_and_b32 v137, 0xffff0000, v60
    v_lshlrev_b32 v138, 16, v61
    v_and_b32 v139, 0xffff0000, v61
    v_mul_f32 v56, s45, v136
    v_mul_f32 v57, s45, v137
    v_mul_f32 v58, s45, v138
    v_mul_f32 v59, s45, v139
    v_exp_f32 v56, v56
    v_exp_f32 v57, v57
    v_exp_f32 v58, v58
    v_exp_f32 v59, v59
    v_add_f32 v56, 1.0, v56
    v_add_f32 v57, 1.0, v57
    v_add_f32 v58, 1.0, v58
    v_add_f32 v59, 1.0, v59
    v_rcp_f32 v56, v56
    v_rcp_f32 v57, v57
    v_rcp_f32 v58, v58
    v_rcp_f32 v59, v59
    v_mul_f32 v136, v136, v56
    v_mul_f32 v137, v137, v57
    v_mul_f32 v138, v138, v58
    v_mul_f32 v139, v139, v59
    v_cvt_pk_bf16_f32 v136, v136, v137
    v_cvt_pk_bf16_f32 v137, v138, v139
    s_add_u32 s54, s53, 40960
    buffer_store_dwordx2 v[136:137], v30, s[8:11], s54 offen offset:2048 sc1
    v_cvt_pk_bf16_f32 v60, v140, v141
    v_cvt_pk_bf16_f32 v61, v142, v143
    v_lshlrev_b32 v140, 16, v60
    v_and_b32 v141, 0xffff0000, v60
    v_lshlrev_b32 v142, 16, v61
    v_and_b32 v143, 0xffff0000, v61
    v_mul_f32 v56, s45, v140
    v_mul_f32 v57, s45, v141
    v_mul_f32 v58, s45, v142
    v_mul_f32 v59, s45, v143
    v_exp_f32 v56, v56
    v_exp_f32 v57, v57
    v_exp_f32 v58, v58
    v_exp_f32 v59, v59
    v_add_f32 v56, 1.0, v56
    v_add_f32 v57, 1.0, v57
    v_add_f32 v58, 1.0, v58
    v_add_f32 v59, 1.0, v59
    v_rcp_f32 v56, v56
    v_rcp_f32 v57, v57
    v_rcp_f32 v58, v58
    v_rcp_f32 v59, v59
    v_mul_f32 v140, v140, v56
    v_mul_f32 v141, v141, v57
    v_mul_f32 v142, v142, v58
    v_mul_f32 v143, v143, v59
    v_cvt_pk_bf16_f32 v140, v140, v141
    v_cvt_pk_bf16_f32 v141, v142, v143
    s_add_u32 s54, s53, 61440
    buffer_store_dwordx2 v[140:141], v30, s[8:11], s54 offen offset:2048 sc1
    v_lshlrev_b32 v24, 16, v42
    v_and_b32 v25, 0xffff0000, v42
    v_lshlrev_b32 v26, 16, v43
    v_and_b32 v27, 0xffff0000, v43
    v_add_f32 v144, v144, v24
    v_add_f32 v145, v145, v25
    v_add_f32 v146, v146, v26
    v_add_f32 v147, v147, v27
    v_add_f32 v148, v148, v24
    v_add_f32 v149, v149, v25
    v_add_f32 v150, v150, v26
    v_add_f32 v151, v151, v27
    v_add_f32 v152, v152, v24
    v_add_f32 v153, v153, v25
    v_add_f32 v154, v154, v26
    v_add_f32 v155, v155, v27
    v_add_f32 v156, v156, v24
    v_add_f32 v157, v157, v25
    v_add_f32 v158, v158, v26
    v_add_f32 v159, v159, v27
    v_cvt_pk_bf16_f32 v60, v144, v145
    v_cvt_pk_bf16_f32 v61, v146, v147
    v_lshlrev_b32 v144, 16, v60
    v_and_b32 v145, 0xffff0000, v60
    v_lshlrev_b32 v146, 16, v61
    v_and_b32 v147, 0xffff0000, v61
    v_mul_f32 v56, s45, v144
    v_mul_f32 v57, s45, v145
    v_mul_f32 v58, s45, v146
    v_mul_f32 v59, s45, v147
    v_exp_f32 v56, v56
    v_exp_f32 v57, v57
    v_exp_f32 v58, v58
    v_exp_f32 v59, v59
    v_add_f32 v56, 1.0, v56
    v_add_f32 v57, 1.0, v57
    v_add_f32 v58, 1.0, v58
    v_add_f32 v59, 1.0, v59
    v_rcp_f32 v56, v56
    v_rcp_f32 v57, v57
    v_rcp_f32 v58, v58
    v_rcp_f32 v59, v59
    v_mul_f32 v144, v144, v56
    v_mul_f32 v145, v145, v57
    v_mul_f32 v146, v146, v58
    v_mul_f32 v147, v147, v59
    v_cvt_pk_bf16_f32 v144, v144, v145
    v_cvt_pk_bf16_f32 v145, v146, v147
    s_add_u32 s54, s53, 0
    buffer_store_dwordx2 v[144:145], v30, s[8:11], s54 offen offset:2560 sc1
    v_cvt_pk_bf16_f32 v60, v148, v149
    v_cvt_pk_bf16_f32 v61, v150, v151
    v_lshlrev_b32 v148, 16, v60
    v_and_b32 v149, 0xffff0000, v60
    v_lshlrev_b32 v150, 16, v61
    v_and_b32 v151, 0xffff0000, v61
    v_mul_f32 v56, s45, v148
    v_mul_f32 v57, s45, v149
    v_mul_f32 v58, s45, v150
    v_mul_f32 v59, s45, v151
    v_exp_f32 v56, v56
    v_exp_f32 v57, v57
    v_exp_f32 v58, v58
    v_exp_f32 v59, v59
    v_add_f32 v56, 1.0, v56
    v_add_f32 v57, 1.0, v57
    v_add_f32 v58, 1.0, v58
    v_add_f32 v59, 1.0, v59
    v_rcp_f32 v56, v56
    v_rcp_f32 v57, v57
    v_rcp_f32 v58, v58
    v_rcp_f32 v59, v59
    v_mul_f32 v148, v148, v56
    v_mul_f32 v149, v149, v57
    v_mul_f32 v150, v150, v58
    v_mul_f32 v151, v151, v59
    v_cvt_pk_bf16_f32 v148, v148, v149
    v_cvt_pk_bf16_f32 v149, v150, v151
    s_add_u32 s54, s53, 20480
    buffer_store_dwordx2 v[148:149], v30, s[8:11], s54 offen offset:2560 sc1
    v_cvt_pk_bf16_f32 v60, v152, v153
    v_cvt_pk_bf16_f32 v61, v154, v155
    v_lshlrev_b32 v152, 16, v60
    v_and_b32 v153, 0xffff0000, v60
    v_lshlrev_b32 v154, 16, v61
    v_and_b32 v155, 0xffff0000, v61
    v_mul_f32 v56, s45, v152
    v_mul_f32 v57, s45, v153
    v_mul_f32 v58, s45, v154
    v_mul_f32 v59, s45, v155
    v_exp_f32 v56, v56
    v_exp_f32 v57, v57
    v_exp_f32 v58, v58
    v_exp_f32 v59, v59
    v_add_f32 v56, 1.0, v56
    v_add_f32 v57, 1.0, v57
    v_add_f32 v58, 1.0, v58
    v_add_f32 v59, 1.0, v59
    v_rcp_f32 v56, v56
    v_rcp_f32 v57, v57
    v_rcp_f32 v58, v58
    v_rcp_f32 v59, v59
    v_mul_f32 v152, v152, v56
    v_mul_f32 v153, v153, v57
    v_mul_f32 v154, v154, v58
    v_mul_f32 v155, v155, v59
    v_cvt_pk_bf16_f32 v152, v152, v153
    v_cvt_pk_bf16_f32 v153, v154, v155
    s_add_u32 s54, s53, 40960
    buffer_store_dwordx2 v[152:153], v30, s[8:11], s54 offen offset:2560 sc1
    v_cvt_pk_bf16_f32 v60, v156, v157
    v_cvt_pk_bf16_f32 v61, v158, v159
    v_lshlrev_b32 v156, 16, v60
    v_and_b32 v157, 0xffff0000, v60
    v_lshlrev_b32 v158, 16, v61
    v_and_b32 v159, 0xffff0000, v61
    v_mul_f32 v56, s45, v156
    v_mul_f32 v57, s45, v157
    v_mul_f32 v58, s45, v158
    v_mul_f32 v59, s45, v159
    v_exp_f32 v56, v56
    v_exp_f32 v57, v57
    v_exp_f32 v58, v58
    v_exp_f32 v59, v59
    v_add_f32 v56, 1.0, v56
    v_add_f32 v57, 1.0, v57
    v_add_f32 v58, 1.0, v58
    v_add_f32 v59, 1.0, v59
    v_rcp_f32 v56, v56
    v_rcp_f32 v57, v57
    v_rcp_f32 v58, v58
    v_rcp_f32 v59, v59
    v_mul_f32 v156, v156, v56
    v_mul_f32 v157, v157, v57
    v_mul_f32 v158, v158, v58
    v_mul_f32 v159, v159, v59
    v_cvt_pk_bf16_f32 v156, v156, v157
    v_cvt_pk_bf16_f32 v157, v158, v159
    s_add_u32 s54, s53, 61440
    buffer_store_dwordx2 v[156:157], v30, s[8:11], s54 offen offset:2560 sc1
    v_lshlrev_b32 v24, 16, v44
    v_and_b32 v25, 0xffff0000, v44
    v_lshlrev_b32 v26, 16, v45
    v_and_b32 v27, 0xffff0000, v45
    v_add_f32 v160, v160, v24
    v_add_f32 v161, v161, v25
    v_add_f32 v162, v162, v26
    v_add_f32 v163, v163, v27
    v_add_f32 v164, v164, v24
    v_add_f32 v165, v165, v25
    v_add_f32 v166, v166, v26
    v_add_f32 v167, v167, v27
    v_add_f32 v168, v168, v24
    v_add_f32 v169, v169, v25
    v_add_f32 v170, v170, v26
    v_add_f32 v171, v171, v27
    v_add_f32 v172, v172, v24
    v_add_f32 v173, v173, v25
    v_add_f32 v174, v174, v26
    v_add_f32 v175, v175, v27
    v_cvt_pk_bf16_f32 v60, v160, v161
    v_cvt_pk_bf16_f32 v61, v162, v163
    v_lshlrev_b32 v160, 16, v60
    v_and_b32 v161, 0xffff0000, v60
    v_lshlrev_b32 v162, 16, v61
    v_and_b32 v163, 0xffff0000, v61
    v_mul_f32 v56, s45, v160
    v_mul_f32 v57, s45, v161
    v_mul_f32 v58, s45, v162
    v_mul_f32 v59, s45, v163
    v_exp_f32 v56, v56
    v_exp_f32 v57, v57
    v_exp_f32 v58, v58
    v_exp_f32 v59, v59
    v_add_f32 v56, 1.0, v56
    v_add_f32 v57, 1.0, v57
    v_add_f32 v58, 1.0, v58
    v_add_f32 v59, 1.0, v59
    v_rcp_f32 v56, v56
    v_rcp_f32 v57, v57
    v_rcp_f32 v58, v58
    v_rcp_f32 v59, v59
    v_mul_f32 v160, v160, v56
    v_mul_f32 v161, v161, v57
    v_mul_f32 v162, v162, v58
    v_mul_f32 v163, v163, v59
    v_cvt_pk_bf16_f32 v160, v160, v161
    v_cvt_pk_bf16_f32 v161, v162, v163
    s_add_u32 s54, s53, 0
    buffer_store_dwordx2 v[160:161], v30, s[8:11], s54 offen offset:3072 sc1
    v_cvt_pk_bf16_f32 v60, v164, v165
    v_cvt_pk_bf16_f32 v61, v166, v167
    v_lshlrev_b32 v164, 16, v60
    v_and_b32 v165, 0xffff0000, v60
    v_lshlrev_b32 v166, 16, v61
    v_and_b32 v167, 0xffff0000, v61
    v_mul_f32 v56, s45, v164
    v_mul_f32 v57, s45, v165
    v_mul_f32 v58, s45, v166
    v_mul_f32 v59, s45, v167
    v_exp_f32 v56, v56
    v_exp_f32 v57, v57
    v_exp_f32 v58, v58
    v_exp_f32 v59, v59
    v_add_f32 v56, 1.0, v56
    v_add_f32 v57, 1.0, v57
    v_add_f32 v58, 1.0, v58
    v_add_f32 v59, 1.0, v59
    v_rcp_f32 v56, v56
    v_rcp_f32 v57, v57
    v_rcp_f32 v58, v58
    v_rcp_f32 v59, v59
    v_mul_f32 v164, v164, v56
    v_mul_f32 v165, v165, v57
    v_mul_f32 v166, v166, v58
    v_mul_f32 v167, v167, v59
    v_cvt_pk_bf16_f32 v164, v164, v165
    v_cvt_pk_bf16_f32 v165, v166, v167
    s_add_u32 s54, s53, 20480
    buffer_store_dwordx2 v[164:165], v30, s[8:11], s54 offen offset:3072 sc1
    v_cvt_pk_bf16_f32 v60, v168, v169
    v_cvt_pk_bf16_f32 v61, v170, v171
    v_lshlrev_b32 v168, 16, v60
    v_and_b32 v169, 0xffff0000, v60
    v_lshlrev_b32 v170, 16, v61
    v_and_b32 v171, 0xffff0000, v61
    v_mul_f32 v56, s45, v168
    v_mul_f32 v57, s45, v169
    v_mul_f32 v58, s45, v170
    v_mul_f32 v59, s45, v171
    v_exp_f32 v56, v56
    v_exp_f32 v57, v57
    v_exp_f32 v58, v58
    v_exp_f32 v59, v59
    v_add_f32 v56, 1.0, v56
    v_add_f32 v57, 1.0, v57
    v_add_f32 v58, 1.0, v58
    v_add_f32 v59, 1.0, v59
    v_rcp_f32 v56, v56
    v_rcp_f32 v57, v57
    v_rcp_f32 v58, v58
    v_rcp_f32 v59, v59
    v_mul_f32 v168, v168, v56
    v_mul_f32 v169, v169, v57
    v_mul_f32 v170, v170, v58
    v_mul_f32 v171, v171, v59
    v_cvt_pk_bf16_f32 v168, v168, v169
    v_cvt_pk_bf16_f32 v169, v170, v171
    s_add_u32 s54, s53, 40960
    buffer_store_dwordx2 v[168:169], v30, s[8:11], s54 offen offset:3072 sc1
    v_cvt_pk_bf16_f32 v60, v172, v173
    v_cvt_pk_bf16_f32 v61, v174, v175
    v_lshlrev_b32 v172, 16, v60
    v_and_b32 v173, 0xffff0000, v60
    v_lshlrev_b32 v174, 16, v61
    v_and_b32 v175, 0xffff0000, v61
    v_mul_f32 v56, s45, v172
    v_mul_f32 v57, s45, v173
    v_mul_f32 v58, s45, v174
    v_mul_f32 v59, s45, v175
    v_exp_f32 v56, v56
    v_exp_f32 v57, v57
    v_exp_f32 v58, v58
    v_exp_f32 v59, v59
    v_add_f32 v56, 1.0, v56
    v_add_f32 v57, 1.0, v57
    v_add_f32 v58, 1.0, v58
    v_add_f32 v59, 1.0, v59
    v_rcp_f32 v56, v56
    v_rcp_f32 v57, v57
    v_rcp_f32 v58, v58
    v_rcp_f32 v59, v59
    v_mul_f32 v172, v172, v56
    v_mul_f32 v173, v173, v57
    v_mul_f32 v174, v174, v58
    v_mul_f32 v175, v175, v59
    v_cvt_pk_bf16_f32 v172, v172, v173
    v_cvt_pk_bf16_f32 v173, v174, v175
    s_add_u32 s54, s53, 61440
    buffer_store_dwordx2 v[172:173], v30, s[8:11], s54 offen offset:3072 sc1
    v_lshlrev_b32 v24, 16, v46
    v_and_b32 v25, 0xffff0000, v46
    v_lshlrev_b32 v26, 16, v47
    v_and_b32 v27, 0xffff0000, v47
    v_add_f32 v176, v176, v24
    v_add_f32 v177, v177, v25
    v_add_f32 v178, v178, v26
    v_add_f32 v179, v179, v27
    v_add_f32 v180, v180, v24
    v_add_f32 v181, v181, v25
    v_add_f32 v182, v182, v26
    v_add_f32 v183, v183, v27
    v_add_f32 v184, v184, v24
    v_add_f32 v185, v185, v25
    v_add_f32 v186, v186, v26
    v_add_f32 v187, v187, v27
    v_add_f32 v188, v188, v24
    v_add_f32 v189, v189, v25
    v_add_f32 v190, v190, v26
    v_add_f32 v191, v191, v27
    v_cvt_pk_bf16_f32 v60, v176, v177
    v_cvt_pk_bf16_f32 v61, v178, v179
    v_lshlrev_b32 v176, 16, v60
    v_and_b32 v177, 0xffff0000, v60
    v_lshlrev_b32 v178, 16, v61
    v_and_b32 v179, 0xffff0000, v61
    v_mul_f32 v56, s45, v176
    v_mul_f32 v57, s45, v177
    v_mul_f32 v58, s45, v178
    v_mul_f32 v59, s45, v179
    v_exp_f32 v56, v56
    v_exp_f32 v57, v57
    v_exp_f32 v58, v58
    v_exp_f32 v59, v59
    v_add_f32 v56, 1.0, v56
    v_add_f32 v57, 1.0, v57
    v_add_f32 v58, 1.0, v58
    v_add_f32 v59, 1.0, v59
    v_rcp_f32 v56, v56
    v_rcp_f32 v57, v57
    v_rcp_f32 v58, v58
    v_rcp_f32 v59, v59
    v_mul_f32 v176, v176, v56
    v_mul_f32 v177, v177, v57
    v_mul_f32 v178, v178, v58
    v_mul_f32 v179, v179, v59
    v_cvt_pk_bf16_f32 v176, v176, v177
    v_cvt_pk_bf16_f32 v177, v178, v179
    s_add_u32 s54, s53, 0
    buffer_store_dwordx2 v[176:177], v30, s[8:11], s54 offen offset:3584 sc1
    v_cvt_pk_bf16_f32 v60, v180, v181
    v_cvt_pk_bf16_f32 v61, v182, v183
    v_lshlrev_b32 v180, 16, v60
    v_and_b32 v181, 0xffff0000, v60
    v_lshlrev_b32 v182, 16, v61
    v_and_b32 v183, 0xffff0000, v61
    v_mul_f32 v56, s45, v180
    v_mul_f32 v57, s45, v181
    v_mul_f32 v58, s45, v182
    v_mul_f32 v59, s45, v183
    v_exp_f32 v56, v56
    v_exp_f32 v57, v57
    v_exp_f32 v58, v58
    v_exp_f32 v59, v59
    v_add_f32 v56, 1.0, v56
    v_add_f32 v57, 1.0, v57
    v_add_f32 v58, 1.0, v58
    v_add_f32 v59, 1.0, v59
    v_rcp_f32 v56, v56
    v_rcp_f32 v57, v57
    v_rcp_f32 v58, v58
    v_rcp_f32 v59, v59
    v_mul_f32 v180, v180, v56
    v_mul_f32 v181, v181, v57
    v_mul_f32 v182, v182, v58
    v_mul_f32 v183, v183, v59
    v_cvt_pk_bf16_f32 v180, v180, v181
    v_cvt_pk_bf16_f32 v181, v182, v183
    s_add_u32 s54, s53, 20480
    buffer_store_dwordx2 v[180:181], v30, s[8:11], s54 offen offset:3584 sc1
    v_cvt_pk_bf16_f32 v60, v184, v185
    v_cvt_pk_bf16_f32 v61, v186, v187
    v_lshlrev_b32 v184, 16, v60
    v_and_b32 v185, 0xffff0000, v60
    v_lshlrev_b32 v186, 16, v61
    v_and_b32 v187, 0xffff0000, v61
    v_mul_f32 v56, s45, v184
    v_mul_f32 v57, s45, v185
    v_mul_f32 v58, s45, v186
    v_mul_f32 v59, s45, v187
    v_exp_f32 v56, v56
    v_exp_f32 v57, v57
    v_exp_f32 v58, v58
    v_exp_f32 v59, v59
    v_add_f32 v56, 1.0, v56
    v_add_f32 v57, 1.0, v57
    v_add_f32 v58, 1.0, v58
    v_add_f32 v59, 1.0, v59
    v_rcp_f32 v56, v56
    v_rcp_f32 v57, v57
    v_rcp_f32 v58, v58
    v_rcp_f32 v59, v59
    v_mul_f32 v184, v184, v56
    v_mul_f32 v185, v185, v57
    v_mul_f32 v186, v186, v58
    v_mul_f32 v187, v187, v59
    v_cvt_pk_bf16_f32 v184, v184, v185
    v_cvt_pk_bf16_f32 v185, v186, v187
    s_add_u32 s54, s53, 40960
    buffer_store_dwordx2 v[184:185], v30, s[8:11], s54 offen offset:3584 sc1
    v_cvt_pk_bf16_f32 v60, v188, v189
    v_cvt_pk_bf16_f32 v61, v190, v191
    v_lshlrev_b32 v188, 16, v60
    v_and_b32 v189, 0xffff0000, v60
    v_lshlrev_b32 v190, 16, v61
    v_and_b32 v191, 0xffff0000, v61
    v_mul_f32 v56, s45, v188
    v_mul_f32 v57, s45, v189
    v_mul_f32 v58, s45, v190
    v_mul_f32 v59, s45, v191
    v_exp_f32 v56, v56
    v_exp_f32 v57, v57
    v_exp_f32 v58, v58
    v_exp_f32 v59, v59
    v_add_f32 v56, 1.0, v56
    v_add_f32 v57, 1.0, v57
    v_add_f32 v58, 1.0, v58
    v_add_f32 v59, 1.0, v59
    v_rcp_f32 v56, v56
    v_rcp_f32 v57, v57
    v_rcp_f32 v58, v58
    v_rcp_f32 v59, v59
    v_mul_f32 v188, v188, v56
    v_mul_f32 v189, v189, v57
    v_mul_f32 v190, v190, v58
    v_mul_f32 v191, v191, v59
    v_cvt_pk_bf16_f32 v188, v188, v189
    v_cvt_pk_bf16_f32 v189, v190, v191
    s_add_u32 s54, s53, 61440
    buffer_store_dwordx2 v[188:189], v30, s[8:11], s54 offen offset:3584 sc1
    v_lshlrev_b32 v24, 16, v48
    v_and_b32 v25, 0xffff0000, v48
    v_lshlrev_b32 v26, 16, v49
    v_and_b32 v27, 0xffff0000, v49
    v_add_f32 v192, v192, v24
    v_add_f32 v193, v193, v25
    v_add_f32 v194, v194, v26
    v_add_f32 v195, v195, v27
    v_add_f32 v196, v196, v24
    v_add_f32 v197, v197, v25
    v_add_f32 v198, v198, v26
    v_add_f32 v199, v199, v27
    v_add_f32 v200, v200, v24
    v_add_f32 v201, v201, v25
    v_add_f32 v202, v202, v26
    v_add_f32 v203, v203, v27
    v_add_f32 v204, v204, v24
    v_add_f32 v205, v205, v25
    v_add_f32 v206, v206, v26
    v_add_f32 v207, v207, v27
    v_cvt_pk_bf16_f32 v60, v192, v193
    v_cvt_pk_bf16_f32 v61, v194, v195
    v_lshlrev_b32 v192, 16, v60
    v_and_b32 v193, 0xffff0000, v60
    v_lshlrev_b32 v194, 16, v61
    v_and_b32 v195, 0xffff0000, v61
    v_mul_f32 v56, s45, v192
    v_mul_f32 v57, s45, v193
    v_mul_f32 v58, s45, v194
    v_mul_f32 v59, s45, v195
    v_exp_f32 v56, v56
    v_exp_f32 v57, v57
    v_exp_f32 v58, v58
    v_exp_f32 v59, v59
    v_add_f32 v56, 1.0, v56
    v_add_f32 v57, 1.0, v57
    v_add_f32 v58, 1.0, v58
    v_add_f32 v59, 1.0, v59
    v_rcp_f32 v56, v56
    v_rcp_f32 v57, v57
    v_rcp_f32 v58, v58
    v_rcp_f32 v59, v59
    v_mul_f32 v192, v192, v56
    v_mul_f32 v193, v193, v57
    v_mul_f32 v194, v194, v58
    v_mul_f32 v195, v195, v59
    v_cvt_pk_bf16_f32 v192, v192, v193
    v_cvt_pk_bf16_f32 v193, v194, v195
    s_add_u32 s54, s53, 4096
    buffer_store_dwordx2 v[192:193], v30, s[8:11], s54 offen offset:0 sc1
    v_cvt_pk_bf16_f32 v60, v196, v197
    v_cvt_pk_bf16_f32 v61, v198, v199
    v_lshlrev_b32 v196, 16, v60
    v_and_b32 v197, 0xffff0000, v60
    v_lshlrev_b32 v198, 16, v61
    v_and_b32 v199, 0xffff0000, v61
    v_mul_f32 v56, s45, v196
    v_mul_f32 v57, s45, v197
    v_mul_f32 v58, s45, v198
    v_mul_f32 v59, s45, v199
    v_exp_f32 v56, v56
    v_exp_f32 v57, v57
    v_exp_f32 v58, v58
    v_exp_f32 v59, v59
    v_add_f32 v56, 1.0, v56
    v_add_f32 v57, 1.0, v57
    v_add_f32 v58, 1.0, v58
    v_add_f32 v59, 1.0, v59
    v_rcp_f32 v56, v56
    v_rcp_f32 v57, v57
    v_rcp_f32 v58, v58
    v_rcp_f32 v59, v59
    v_mul_f32 v196, v196, v56
    v_mul_f32 v197, v197, v57
    v_mul_f32 v198, v198, v58
    v_mul_f32 v199, v199, v59
    v_cvt_pk_bf16_f32 v196, v196, v197
    v_cvt_pk_bf16_f32 v197, v198, v199
    s_add_u32 s54, s53, 24576
    buffer_store_dwordx2 v[196:197], v30, s[8:11], s54 offen offset:0 sc1
    v_cvt_pk_bf16_f32 v60, v200, v201
    v_cvt_pk_bf16_f32 v61, v202, v203
    v_lshlrev_b32 v200, 16, v60
    v_and_b32 v201, 0xffff0000, v60
    v_lshlrev_b32 v202, 16, v61
    v_and_b32 v203, 0xffff0000, v61
    v_mul_f32 v56, s45, v200
    v_mul_f32 v57, s45, v201
    v_mul_f32 v58, s45, v202
    v_mul_f32 v59, s45, v203
    v_exp_f32 v56, v56
    v_exp_f32 v57, v57
    v_exp_f32 v58, v58
    v_exp_f32 v59, v59
    v_add_f32 v56, 1.0, v56
    v_add_f32 v57, 1.0, v57
    v_add_f32 v58, 1.0, v58
    v_add_f32 v59, 1.0, v59
    v_rcp_f32 v56, v56
    v_rcp_f32 v57, v57
    v_rcp_f32 v58, v58
    v_rcp_f32 v59, v59
    v_mul_f32 v200, v200, v56
    v_mul_f32 v201, v201, v57
    v_mul_f32 v202, v202, v58
    v_mul_f32 v203, v203, v59
    v_cvt_pk_bf16_f32 v200, v200, v201
    v_cvt_pk_bf16_f32 v201, v202, v203
    s_add_u32 s54, s53, 45056
    buffer_store_dwordx2 v[200:201], v30, s[8:11], s54 offen offset:0 sc1
    v_cvt_pk_bf16_f32 v60, v204, v205
    v_cvt_pk_bf16_f32 v61, v206, v207
    v_lshlrev_b32 v204, 16, v60
    v_and_b32 v205, 0xffff0000, v60
    v_lshlrev_b32 v206, 16, v61
    v_and_b32 v207, 0xffff0000, v61
    v_mul_f32 v56, s45, v204
    v_mul_f32 v57, s45, v205
    v_mul_f32 v58, s45, v206
    v_mul_f32 v59, s45, v207
    v_exp_f32 v56, v56
    v_exp_f32 v57, v57
    v_exp_f32 v58, v58
    v_exp_f32 v59, v59
    v_add_f32 v56, 1.0, v56
    v_add_f32 v57, 1.0, v57
    v_add_f32 v58, 1.0, v58
    v_add_f32 v59, 1.0, v59
    v_rcp_f32 v56, v56
    v_rcp_f32 v57, v57
    v_rcp_f32 v58, v58
    v_rcp_f32 v59, v59
    v_mul_f32 v204, v204, v56
    v_mul_f32 v205, v205, v57
    v_mul_f32 v206, v206, v58
    v_mul_f32 v207, v207, v59
    v_cvt_pk_bf16_f32 v204, v204, v205
    v_cvt_pk_bf16_f32 v205, v206, v207
    s_add_u32 s54, s53, 65536
    buffer_store_dwordx2 v[204:205], v30, s[8:11], s54 offen offset:0 sc1
    v_lshlrev_b32 v24, 16, v50
    v_and_b32 v25, 0xffff0000, v50
    v_lshlrev_b32 v26, 16, v51
    v_and_b32 v27, 0xffff0000, v51
    v_add_f32 v208, v208, v24
    v_add_f32 v209, v209, v25
    v_add_f32 v210, v210, v26
    v_add_f32 v211, v211, v27
    v_add_f32 v212, v212, v24
    v_add_f32 v213, v213, v25
    v_add_f32 v214, v214, v26
    v_add_f32 v215, v215, v27
    v_add_f32 v216, v216, v24
    v_add_f32 v217, v217, v25
    v_add_f32 v218, v218, v26
    v_add_f32 v219, v219, v27
    v_add_f32 v220, v220, v24
    v_add_f32 v221, v221, v25
    v_add_f32 v222, v222, v26
    v_add_f32 v223, v223, v27
    v_cvt_pk_bf16_f32 v60, v208, v209
    v_cvt_pk_bf16_f32 v61, v210, v211
    v_lshlrev_b32 v208, 16, v60
    v_and_b32 v209, 0xffff0000, v60
    v_lshlrev_b32 v210, 16, v61
    v_and_b32 v211, 0xffff0000, v61
    v_mul_f32 v56, s45, v208
    v_mul_f32 v57, s45, v209
    v_mul_f32 v58, s45, v210
    v_mul_f32 v59, s45, v211
    v_exp_f32 v56, v56
    v_exp_f32 v57, v57
    v_exp_f32 v58, v58
    v_exp_f32 v59, v59
    v_add_f32 v56, 1.0, v56
    v_add_f32 v57, 1.0, v57
    v_add_f32 v58, 1.0, v58
    v_add_f32 v59, 1.0, v59
    v_rcp_f32 v56, v56
    v_rcp_f32 v57, v57
    v_rcp_f32 v58, v58
    v_rcp_f32 v59, v59
    v_mul_f32 v208, v208, v56
    v_mul_f32 v209, v209, v57
    v_mul_f32 v210, v210, v58
    v_mul_f32 v211, v211, v59
    v_cvt_pk_bf16_f32 v208, v208, v209
    v_cvt_pk_bf16_f32 v209, v210, v211
    s_add_u32 s54, s53, 4096
    buffer_store_dwordx2 v[208:209], v30, s[8:11], s54 offen offset:512 sc1
    v_cvt_pk_bf16_f32 v60, v212, v213
    v_cvt_pk_bf16_f32 v61, v214, v215
    v_lshlrev_b32 v212, 16, v60
    v_and_b32 v213, 0xffff0000, v60
    v_lshlrev_b32 v214, 16, v61
    v_and_b32 v215, 0xffff0000, v61
    v_mul_f32 v56, s45, v212
    v_mul_f32 v57, s45, v213
    v_mul_f32 v58, s45, v214
    v_mul_f32 v59, s45, v215
    v_exp_f32 v56, v56
    v_exp_f32 v57, v57
    v_exp_f32 v58, v58
    v_exp_f32 v59, v59
    v_add_f32 v56, 1.0, v56
    v_add_f32 v57, 1.0, v57
    v_add_f32 v58, 1.0, v58
    v_add_f32 v59, 1.0, v59
    v_rcp_f32 v56, v56
    v_rcp_f32 v57, v57
    v_rcp_f32 v58, v58
    v_rcp_f32 v59, v59
    v_mul_f32 v212, v212, v56
    v_mul_f32 v213, v213, v57
    v_mul_f32 v214, v214, v58
    v_mul_f32 v215, v215, v59
    v_cvt_pk_bf16_f32 v212, v212, v213
    v_cvt_pk_bf16_f32 v213, v214, v215
    s_add_u32 s54, s53, 24576
    buffer_store_dwordx2 v[212:213], v30, s[8:11], s54 offen offset:512 sc1
    v_cvt_pk_bf16_f32 v60, v216, v217
    v_cvt_pk_bf16_f32 v61, v218, v219
    v_lshlrev_b32 v216, 16, v60
    v_and_b32 v217, 0xffff0000, v60
    v_lshlrev_b32 v218, 16, v61
    v_and_b32 v219, 0xffff0000, v61
    v_mul_f32 v56, s45, v216
    v_mul_f32 v57, s45, v217
    v_mul_f32 v58, s45, v218
    v_mul_f32 v59, s45, v219
    v_exp_f32 v56, v56
    v_exp_f32 v57, v57
    v_exp_f32 v58, v58
    v_exp_f32 v59, v59
    v_add_f32 v56, 1.0, v56
    v_add_f32 v57, 1.0, v57
    v_add_f32 v58, 1.0, v58
    v_add_f32 v59, 1.0, v59
    v_rcp_f32 v56, v56
    v_rcp_f32 v57, v57
    v_rcp_f32 v58, v58
    v_rcp_f32 v59, v59
    v_mul_f32 v216, v216, v56
    v_mul_f32 v217, v217, v57
    v_mul_f32 v218, v218, v58
    v_mul_f32 v219, v219, v59
    v_cvt_pk_bf16_f32 v216, v216, v217
    v_cvt_pk_bf16_f32 v217, v218, v219
    s_add_u32 s54, s53, 45056
    buffer_store_dwordx2 v[216:217], v30, s[8:11], s54 offen offset:512 sc1
    v_cvt_pk_bf16_f32 v60, v220, v221
    v_cvt_pk_bf16_f32 v61, v222, v223
    v_lshlrev_b32 v220, 16, v60
    v_and_b32 v221, 0xffff0000, v60
    v_lshlrev_b32 v222, 16, v61
    v_and_b32 v223, 0xffff0000, v61
    v_mul_f32 v56, s45, v220
    v_mul_f32 v57, s45, v221
    v_mul_f32 v58, s45, v222
    v_mul_f32 v59, s45, v223
    v_exp_f32 v56, v56
    v_exp_f32 v57, v57
    v_exp_f32 v58, v58
    v_exp_f32 v59, v59
    v_add_f32 v56, 1.0, v56
    v_add_f32 v57, 1.0, v57
    v_add_f32 v58, 1.0, v58
    v_add_f32 v59, 1.0, v59
    v_rcp_f32 v56, v56
    v_rcp_f32 v57, v57
    v_rcp_f32 v58, v58
    v_rcp_f32 v59, v59
    v_mul_f32 v220, v220, v56
    v_mul_f32 v221, v221, v57
    v_mul_f32 v222, v222, v58
    v_mul_f32 v223, v223, v59
    v_cvt_pk_bf16_f32 v220, v220, v221
    v_cvt_pk_bf16_f32 v221, v222, v223
    s_add_u32 s54, s53, 65536
    buffer_store_dwordx2 v[220:221], v30, s[8:11], s54 offen offset:512 sc1
    v_lshlrev_b32 v24, 16, v52
    v_and_b32 v25, 0xffff0000, v52
    v_lshlrev_b32 v26, 16, v53
    v_and_b32 v27, 0xffff0000, v53
    v_add_f32 v224, v224, v24
    v_add_f32 v225, v225, v25
    v_add_f32 v226, v226, v26
    v_add_f32 v227, v227, v27
    v_add_f32 v228, v228, v24
    v_add_f32 v229, v229, v25
    v_add_f32 v230, v230, v26
    v_add_f32 v231, v231, v27
    v_add_f32 v232, v232, v24
    v_add_f32 v233, v233, v25
    v_add_f32 v234, v234, v26
    v_add_f32 v235, v235, v27
    v_add_f32 v236, v236, v24
    v_add_f32 v237, v237, v25
    v_add_f32 v238, v238, v26
    v_add_f32 v239, v239, v27
    v_cvt_pk_bf16_f32 v60, v224, v225
    v_cvt_pk_bf16_f32 v61, v226, v227
    v_lshlrev_b32 v224, 16, v60
    v_and_b32 v225, 0xffff0000, v60
    v_lshlrev_b32 v226, 16, v61
    v_and_b32 v227, 0xffff0000, v61
    v_mul_f32 v56, s45, v224
    v_mul_f32 v57, s45, v225
    v_mul_f32 v58, s45, v226
    v_mul_f32 v59, s45, v227
    v_exp_f32 v56, v56
    v_exp_f32 v57, v57
    v_exp_f32 v58, v58
    v_exp_f32 v59, v59
    v_add_f32 v56, 1.0, v56
    v_add_f32 v57, 1.0, v57
    v_add_f32 v58, 1.0, v58
    v_add_f32 v59, 1.0, v59
    v_rcp_f32 v56, v56
    v_rcp_f32 v57, v57
    v_rcp_f32 v58, v58
    v_rcp_f32 v59, v59
    v_mul_f32 v224, v224, v56
    v_mul_f32 v225, v225, v57
    v_mul_f32 v226, v226, v58
    v_mul_f32 v227, v227, v59
    v_cvt_pk_bf16_f32 v224, v224, v225
    v_cvt_pk_bf16_f32 v225, v226, v227
    s_add_u32 s54, s53, 4096
    buffer_store_dwordx2 v[224:225], v30, s[8:11], s54 offen offset:1024 sc1
    v_cvt_pk_bf16_f32 v60, v228, v229
    v_cvt_pk_bf16_f32 v61, v230, v231
    v_lshlrev_b32 v228, 16, v60
    v_and_b32 v229, 0xffff0000, v60
    v_lshlrev_b32 v230, 16, v61
    v_and_b32 v231, 0xffff0000, v61
    v_mul_f32 v56, s45, v228
    v_mul_f32 v57, s45, v229
    v_mul_f32 v58, s45, v230
    v_mul_f32 v59, s45, v231
    v_exp_f32 v56, v56
    v_exp_f32 v57, v57
    v_exp_f32 v58, v58
    v_exp_f32 v59, v59
    v_add_f32 v56, 1.0, v56
    v_add_f32 v57, 1.0, v57
    v_add_f32 v58, 1.0, v58
    v_add_f32 v59, 1.0, v59
    v_rcp_f32 v56, v56
    v_rcp_f32 v57, v57
    v_rcp_f32 v58, v58
    v_rcp_f32 v59, v59
    v_mul_f32 v228, v228, v56
    v_mul_f32 v229, v229, v57
    v_mul_f32 v230, v230, v58
    v_mul_f32 v231, v231, v59
    v_cvt_pk_bf16_f32 v228, v228, v229
    v_cvt_pk_bf16_f32 v229, v230, v231
    s_add_u32 s54, s53, 24576
    buffer_store_dwordx2 v[228:229], v30, s[8:11], s54 offen offset:1024 sc1
    v_cvt_pk_bf16_f32 v60, v232, v233
    v_cvt_pk_bf16_f32 v61, v234, v235
    v_lshlrev_b32 v232, 16, v60
    v_and_b32 v233, 0xffff0000, v60
    v_lshlrev_b32 v234, 16, v61
    v_and_b32 v235, 0xffff0000, v61
    v_mul_f32 v56, s45, v232
    v_mul_f32 v57, s45, v233
    v_mul_f32 v58, s45, v234
    v_mul_f32 v59, s45, v235
    v_exp_f32 v56, v56
    v_exp_f32 v57, v57
    v_exp_f32 v58, v58
    v_exp_f32 v59, v59
    v_add_f32 v56, 1.0, v56
    v_add_f32 v57, 1.0, v57
    v_add_f32 v58, 1.0, v58
    v_add_f32 v59, 1.0, v59
    v_rcp_f32 v56, v56
    v_rcp_f32 v57, v57
    v_rcp_f32 v58, v58
    v_rcp_f32 v59, v59
    v_mul_f32 v232, v232, v56
    v_mul_f32 v233, v233, v57
    v_mul_f32 v234, v234, v58
    v_mul_f32 v235, v235, v59
    v_cvt_pk_bf16_f32 v232, v232, v233
    v_cvt_pk_bf16_f32 v233, v234, v235
    s_add_u32 s54, s53, 45056
    buffer_store_dwordx2 v[232:233], v30, s[8:11], s54 offen offset:1024 sc1
    v_cvt_pk_bf16_f32 v60, v236, v237
    v_cvt_pk_bf16_f32 v61, v238, v239
    v_lshlrev_b32 v236, 16, v60
    v_and_b32 v237, 0xffff0000, v60
    v_lshlrev_b32 v238, 16, v61
    v_and_b32 v239, 0xffff0000, v61
    v_mul_f32 v56, s45, v236
    v_mul_f32 v57, s45, v237
    v_mul_f32 v58, s45, v238
    v_mul_f32 v59, s45, v239
    v_exp_f32 v56, v56
    v_exp_f32 v57, v57
    v_exp_f32 v58, v58
    v_exp_f32 v59, v59
    v_add_f32 v56, 1.0, v56
    v_add_f32 v57, 1.0, v57
    v_add_f32 v58, 1.0, v58
    v_add_f32 v59, 1.0, v59
    v_rcp_f32 v56, v56
    v_rcp_f32 v57, v57
    v_rcp_f32 v58, v58
    v_rcp_f32 v59, v59
    v_mul_f32 v236, v236, v56
    v_mul_f32 v237, v237, v57
    v_mul_f32 v238, v238, v58
    v_mul_f32 v239, v239, v59
    v_cvt_pk_bf16_f32 v236, v236, v237
    v_cvt_pk_bf16_f32 v237, v238, v239
    s_add_u32 s54, s53, 65536
    buffer_store_dwordx2 v[236:237], v30, s[8:11], s54 offen offset:1024 sc1
    v_lshlrev_b32 v24, 16, v54
    v_and_b32 v25, 0xffff0000, v54
    v_lshlrev_b32 v26, 16, v55
    v_and_b32 v27, 0xffff0000, v55
    v_add_f32 v240, v240, v24
    v_add_f32 v241, v241, v25
    v_add_f32 v242, v242, v26
    v_add_f32 v243, v243, v27
    v_add_f32 v244, v244, v24
    v_add_f32 v245, v245, v25
    v_add_f32 v246, v246, v26
    v_add_f32 v247, v247, v27
    v_add_f32 v248, v248, v24
    v_add_f32 v249, v249, v25
    v_add_f32 v250, v250, v26
    v_add_f32 v251, v251, v27
    v_add_f32 v252, v252, v24
    v_add_f32 v253, v253, v25
    v_add_f32 v254, v254, v26
    v_add_f32 v255, v255, v27
    v_cvt_pk_bf16_f32 v60, v240, v241
    v_cvt_pk_bf16_f32 v61, v242, v243
    v_lshlrev_b32 v240, 16, v60
    v_and_b32 v241, 0xffff0000, v60
    v_lshlrev_b32 v242, 16, v61
    v_and_b32 v243, 0xffff0000, v61
    v_mul_f32 v56, s45, v240
    v_mul_f32 v57, s45, v241
    v_mul_f32 v58, s45, v242
    v_mul_f32 v59, s45, v243
    v_exp_f32 v56, v56
    v_exp_f32 v57, v57
    v_exp_f32 v58, v58
    v_exp_f32 v59, v59
    v_add_f32 v56, 1.0, v56
    v_add_f32 v57, 1.0, v57
    v_add_f32 v58, 1.0, v58
    v_add_f32 v59, 1.0, v59
    v_rcp_f32 v56, v56
    v_rcp_f32 v57, v57
    v_rcp_f32 v58, v58
    v_rcp_f32 v59, v59
    v_mul_f32 v240, v240, v56
    v_mul_f32 v241, v241, v57
    v_mul_f32 v242, v242, v58
    v_mul_f32 v243, v243, v59
    v_cvt_pk_bf16_f32 v240, v240, v241
    v_cvt_pk_bf16_f32 v241, v242, v243
    s_add_u32 s54, s53, 4096
    buffer_store_dwordx2 v[240:241], v30, s[8:11], s54 offen offset:1536 sc1
    v_cvt_pk_bf16_f32 v60, v244, v245
    v_cvt_pk_bf16_f32 v61, v246, v247
    v_lshlrev_b32 v244, 16, v60
    v_and_b32 v245, 0xffff0000, v60
    v_lshlrev_b32 v246, 16, v61
    v_and_b32 v247, 0xffff0000, v61
    v_mul_f32 v56, s45, v244
    v_mul_f32 v57, s45, v245
    v_mul_f32 v58, s45, v246
    v_mul_f32 v59, s45, v247
    v_exp_f32 v56, v56
    v_exp_f32 v57, v57
    v_exp_f32 v58, v58
    v_exp_f32 v59, v59
    v_add_f32 v56, 1.0, v56
    v_add_f32 v57, 1.0, v57
    v_add_f32 v58, 1.0, v58
    v_add_f32 v59, 1.0, v59
    v_rcp_f32 v56, v56
    v_rcp_f32 v57, v57
    v_rcp_f32 v58, v58
    v_rcp_f32 v59, v59
    v_mul_f32 v244, v244, v56
    v_mul_f32 v245, v245, v57
    v_mul_f32 v246, v246, v58
    v_mul_f32 v247, v247, v59
    v_cvt_pk_bf16_f32 v244, v244, v245
    v_cvt_pk_bf16_f32 v245, v246, v247
    s_add_u32 s54, s53, 24576
    buffer_store_dwordx2 v[244:245], v30, s[8:11], s54 offen offset:1536 sc1
    v_cvt_pk_bf16_f32 v60, v248, v249
    v_cvt_pk_bf16_f32 v61, v250, v251
    v_lshlrev_b32 v248, 16, v60
    v_and_b32 v249, 0xffff0000, v60
    v_lshlrev_b32 v250, 16, v61
    v_and_b32 v251, 0xffff0000, v61
    v_mul_f32 v56, s45, v248
    v_mul_f32 v57, s45, v249
    v_mul_f32 v58, s45, v250
    v_mul_f32 v59, s45, v251
    v_exp_f32 v56, v56
    v_exp_f32 v57, v57
    v_exp_f32 v58, v58
    v_exp_f32 v59, v59
    v_add_f32 v56, 1.0, v56
    v_add_f32 v57, 1.0, v57
    v_add_f32 v58, 1.0, v58
    v_add_f32 v59, 1.0, v59
    v_rcp_f32 v56, v56
    v_rcp_f32 v57, v57
    v_rcp_f32 v58, v58
    v_rcp_f32 v59, v59
    v_mul_f32 v248, v248, v56
    v_mul_f32 v249, v249, v57
    v_mul_f32 v250, v250, v58
    v_mul_f32 v251, v251, v59
    v_cvt_pk_bf16_f32 v248, v248, v249
    v_cvt_pk_bf16_f32 v249, v250, v251
    s_add_u32 s54, s53, 45056
    buffer_store_dwordx2 v[248:249], v30, s[8:11], s54 offen offset:1536 sc1
    v_cvt_pk_bf16_f32 v60, v252, v253
    v_cvt_pk_bf16_f32 v61, v254, v255
    v_lshlrev_b32 v252, 16, v60
    v_and_b32 v253, 0xffff0000, v60
    v_lshlrev_b32 v254, 16, v61
    v_and_b32 v255, 0xffff0000, v61
    v_mul_f32 v56, s45, v252
    v_mul_f32 v57, s45, v253
    v_mul_f32 v58, s45, v254
    v_mul_f32 v59, s45, v255
    v_exp_f32 v56, v56
    v_exp_f32 v57, v57
    v_exp_f32 v58, v58
    v_exp_f32 v59, v59
    v_add_f32 v56, 1.0, v56
    v_add_f32 v57, 1.0, v57
    v_add_f32 v58, 1.0, v58
    v_add_f32 v59, 1.0, v59
    v_rcp_f32 v56, v56
    v_rcp_f32 v57, v57
    v_rcp_f32 v58, v58
    v_rcp_f32 v59, v59
    v_mul_f32 v252, v252, v56
    v_mul_f32 v253, v253, v57
    v_mul_f32 v254, v254, v58
    v_mul_f32 v255, v255, v59
    v_cvt_pk_bf16_f32 v252, v252, v253
    v_cvt_pk_bf16_f32 v253, v254, v255
    s_add_u32 s54, s53, 65536
    buffer_store_dwordx2 v[252:253], v30, s[8:11], s54 offen offset:1536 sc1
g_fin:
    s_lshl_b32 s53, s40, 11
    s_cmp_lt_u32 s40, 2
    s_cselect_b32 s54, 1, 0
    s_lshl_b32 s54, s42, s54
    s_lshr_b32 s74, s85, 1
    s_add_u32 s54, s54, s74
    s_mov_b32 s74, 0
    s_lshl_b32 s54, s54, 7
    s_add_u32 s53, s53, s54
    s_lshl_b32 s54, s41, 2
    s_add_u32 s53, s53, s54
    s_add_u32 s53, s53, 0xe280000
    s_waitcnt vmcnt(0) lgkmcnt(0)
    s_barrier
    s_cmp_lg_u32 s86, 0
    s_cbranch_scc1 g_fin2
    v_mov_b32 v24, 0
    s_mov_b32 s54, 0
    s_nop 0
wc_44:
    buffer_load_dword v25, v24, s[64:67], 0 offen offset:4 sc1
    s_add_u32 s54, s54, 1
    s_cmp_gt_u32 s54, 2097152
    s_cbranch_scc1 rec_fail
    s_waitcnt vmcnt(0)
    v_cmp_gt_u32 vcc, 16, v25
    s_cbranch_vccz wcd_45
    s_sleep 4
    s_branch wc_44
    s_nop 1
wcd_45:
    s_mov_b32 s86, 1
g_fin2:
    s_mov_b32 s50, 0x7f000000
    s_cmp_eq_u32 s87, 2
    s_cselect_b32 s51, s50, 0
    s_movk_i32 s57, 0x2000
    s_cmp_eq_u32 s87, 1
    s_cselect_b32 s57, s50, s57
    s_cmp_lg_u32 s40, 0
    s_cselect_b32 s57, s50, s57
    v_mov_b32 v24, s51
    v_mov_b32 v25, s57
    v_and_b32 v26, 1, v0
    v_cmp_eq_u32 vcc, 1, v26
    s_nop 1
    v_cndmask_b32 v24, v24, v25, vcc
    v_lshrrev_b32 v26, 1, v0
    v_lshl_add_u32 v24, v26, 7, v24
    s_cmp_lt_u32 s40, 2
    s_cselect_b32 s51, 4, 2
    s_cmp_lg_u32 s85, 0
    s_cselect_b32 s51, 2, s51
    v_mov_b32 v25, s50
    v_cmp_gt_u32 vcc, s51, v0
    s_nop 1
    v_cndmask_b32 v24, v25, v24, vcc
    v_mov_b32 v25, 1
    buffer_store_dword v25, v24, s[8:11], s53 offen sc1
    s_cmp_lt_u32 s73, 3
    s_cselect_b32 s80, 1, 0
    s_branch w_next
g_warm:
    s_mov_b32 s80, 0
    s_bfe_u32 s42, s2, 0x30005
    s_lshr_b32 s40, s2, 8
    s_cmp_eq_u32 s85, 0
    s_cselect_b32 s68, 2, 1
    s_lshl_b32 s69, s42, 4
    s_cmp_eq_u32 s85, 2
    s_cselect_b32 s53, 8, 0
    s_add_u32 s69, s69, s53
    s_lshl_b32 s54, s55, s68
    s_add_u32 s69, s69, s54
    s_lshl_b32 s53, s59, 10
    s_add_u32 s71, s72, s53
    s_lshl_b32 s50, s69, 4
    s_add_u32 s50, s50, s41
    s_mul_i32 s50, s50, 40960
    s_add_u32 s50, s50, 0x4000000
    s_mov_b32 s51, 0x7f000000
    s_mul_i32 s57, s41, 245760
    s_mov_b32 s56, 5
    s_cmp_eq_u32 s87, 1
    s_cselect_b32 s56, 3, s56
    s_cmp_eq_u32 s87, 2
    s_cbranch_scc0 Lskip_46
    s_mov_b32 s56, 2
    s_add_u32 s57, s57, 768
    s_add_u32 s50, s50, 24576
Lskip_46:
    s_lshl_b32 s74, s56, 1
    s_cmp_eq_u32 s40, 0
    s_cselect_b32 s74, s74, 0
    s_lshr_b32 s44, s59, 2
    s_and_b32 s73, s81, 7
    s_cmp_gt_u32 s40, 2
    s_cselect_b32 s73, 7, s73
    s_cmp_lg_u32 s85, 0
    s_cselect_b32 s73, 7, s73
    s_bfe_u32 s53, s81, 0x30003
    s_lshl_b32 s53, s53, 4
    s_lshl_b32 s54, s55, 2
    s_add_u32 s53, s53, s54
    s_mul_i32 s72, s53, 20480
    s_nop 0
    s_cmp_lt_u32 s73, 3
    s_cbranch_scc0 Lnx_47
    s_mov_b64 s[12:13], s[28:29]
    s_cmp_eq_u32 s73, 1
    s_cselect_b64 s[12:13], s[26:27], s[12:13]
    s_cmp_eq_u32 s73, 2
    s_cselect_b64 s[12:13], s[24:25], s[12:13]
    s_and_b32 s13, s13, 0xffff
Lnx_47:
    v_mov_b32 v64, 0
    v_mov_b32 v65, 0
    v_mov_b32 v66, 0
    v_mov_b32 v67, 0
    v_mov_b32 v68, 0
    v_mov_b32 v69, 0
    v_mov_b32 v70, 0
    v_mov_b32 v71, 0
    v_mov_b32 v72, 0
    v_mov_b32 v73, 0
    v_mov_b32 v74, 0
    v_mov_b32 v75, 0
    v_mov_b32 v76, 0
    v_mov_b32 v77, 0
    v_mov_b32 v78, 0
    v_mov_b32 v79, 0
    v_mov_b32 v80, 0
    v_mov_b32 v81, 0
    v_mov_b32 v82, 0
    v_mov_b32 v83, 0
    v_mov_b32 v84, 0
    v_mov_b32 v85, 0
    v_mov_b32 v86, 0
    v_mov_b32 v87, 0
    v_mov_b32 v88, 0
    v_mov_b32 v89, 0
    v_mov_b32 v90, 0
    v_mov_b32 v91, 0
    v_mov_b32 v92, 0
    v_mov_b32 v93, 0
    v_mov_b32 v94, 0
    v_mov_b32 v95, 0
    v_mov_b32 v96, 0
    v_mov_b32 v97, 0
    v_mov_b32 v98, 0
    v_mov_b32 v99, 0
    v_mov_b32 v100, 0
    v_mov_b32 v101, 0
    v_mov_b32 v102, 0
    v_mov_b32 v103, 0
    v_mov_b32 v104, 0
    v_mov_b32 v105, 0
    v_mov_b32 v106, 0
    v_mov_b32 v107, 0
    v_mov_b32 v108, 0
    v_mov_b32 v109, 0
    v_mov_b32 v110, 0
    v_mov_b32 v111, 0
    v_mov_b32 v112, 0
    v_mov_b32 v113, 0
    v_mov_b32 v114, 0
    v_mov_b32 v115, 0
    v_mov_b32 v116, 0
    v_mov_b32 v117, 0
    v_mov_b32 v118, 0
    v_mov_b32 v119, 0
    v_mov_b32 v120, 0
    v_mov_b32 v121, 0
    v_mov_b32 v122, 0
    v_mov_b32 v123, 0
    v_mov_b32 v124, 0
    v_mov_b32 v125, 0
    v_mov_b32 v126, 0
    v_mov_b32 v127, 0
    v_mov_b32 v128, 0
    v_mov_b32 v129, 0
    v_mov_b32 v130, 0
    v_mov_b32 v131, 0
    v_mov_b32 v132, 0
    v_mov_b32 v133, 0
    v_mov_b32 v134, 0
    v_mov_b32 v135, 0
    v_mov_b32 v136, 0
    v_mov_b32 v137, 0
    v_mov_b32 v138, 0
    v_mov_b32 v139, 0
    v_mov_b32 v140, 0
    v_mov_b32 v141, 0
    v_mov_b32 v142, 0
    v_mov_b32 v143, 0
    v_mov_b32 v144, 0
    v_mov_b32 v145, 0
    v_mov_b32 v146, 0
    v_mov_b32 v147, 0
    v_mov_b32 v148, 0
    v_mov_b32 v149, 0
    v_mov_b32 v150, 0
    v_mov_b32 v151, 0
    v_mov_b32 v152, 0
    v_mov_b32 v153, 0
    v_mov_b32 v154, 0
    v_mov_b32 v155, 0
    v_mov_b32 v156, 0
    v_mov_b32 v157, 0
    v_mov_b32 v158, 0
    v_mov_b32 v159, 0
    v_mov_b32 v160, 0
    v_mov_b32 v161, 0
    v_mov_b32 v162, 0
    v_mov_b32 v163, 0
    v_mov_b32 v164, 0
    v_mov_b32 v165, 0
    v_mov_b32 v166, 0
    v_mov_b32 v167, 0
    v_mov_b32 v168, 0
    v_mov_b32 v169, 0
    v_mov_b32 v170, 0
    v_mov_b32 v171, 0
    v_mov_b32 v172, 0
    v_mov_b32 v173, 0
    v_mov_b32 v174, 0
    v_mov_b32 v175, 0
    v_mov_b32 v176, 0
    v_mov_b32 v177, 0
    v_mov_b32 v178, 0
    v_mov_b32 v179, 0
    v_mov_b32 v180, 0
    v_mov_b32 v181, 0
    v_mov_b32 v182, 0
    v_mov_b32 v183, 0
    v_mov_b32 v184, 0
    v_mov_b32 v185, 0
    v_mov_b32 v186, 0
    v_mov_b32 v187, 0
    v_mov_b32 v188, 0
    v_mov_b32 v189, 0
    v_mov_b32 v190, 0
    v_mov_b32 v191, 0
    v_mov_b32 v192, 0
    v_mov_b32 v193, 0
    v_mov_b32 v194, 0
    v_mov_b32 v195, 0
    v_mov_b32 v196, 0
    v_mov_b32 v197, 0
    v_mov_b32 v198, 0
    v_mov_b32 v199, 0
    v_mov_b32 v200, 0
    v_mov_b32 v201, 0
    v_mov_b32 v202, 0
    v_mov_b32 v203, 0
    v_mov_b32 v204, 0
    v_mov_b32 v205, 0
    v_mov_b32 v206, 0
    v_mov_b32 v207, 0
    v_mov_b32 v208, 0
    v_mov_b32 v209, 0
    v_mov_b32 v210, 0
    v_mov_b32 v211, 0
    v_mov_b32 v212, 0
    v_mov_b32 v213, 0
    v_mov_b32 v214, 0
    v_mov_b32 v215, 0
    v_mov_b32 v216, 0
    v_mov_b32 v217, 0
    v_mov_b32 v218, 0
    v_mov_b32 v219, 0
    v_mov_b32 v220, 0
    v_mov_b32 v221, 0
    v_mov_b32 v222, 0
    v_mov_b32 v223, 0
    v_mov_b32 v224, 0
    v_mov_b32 v225, 0
    v_mov_b32 v226, 0
    v_mov_b32 v227, 0
    v_mov_b32 v228, 0
    v_mov_b32 v229, 0
    v_mov_b32 v230, 0
    v_mov_b32 v231, 0
    v_mov_b32 v232, 0
    v_mov_b32 v233, 0
    v_mov_b32 v234, 0
    v_mov_b32 v235, 0
    v_mov_b32 v236, 0
    v_mov_b32 v237, 0
    v_mov_b32 v238, 0
    v_mov_b32 v239, 0
    v_mov_b32 v240, 0
    v_mov_b32 v241, 0
    v_mov_b32 v242, 0
    v_mov_b32 v243, 0
    v_mov_b32 v244, 0
    v_mov_b32 v245, 0
    v_mov_b32 v246, 0
    v_mov_b32 v247, 0
    v_mov_b32 v248, 0
    v_mov_b32 v249, 0
    v_mov_b32 v250, 0
    v_mov_b32 v251, 0
    v_mov_b32 v252, 0
    v_mov_b32 v253, 0
    v_mov_b32 v254, 0
    v_mov_b32 v255, 0
    s_nop 0
    s_branch g_go4
ln_entry:
    s_mov_b32 s80, 0
    s_load_dwordx2 s[12:13], s[0:1], 0
    s_load_dwordx2 s[16:17], s[0:1], 104
    s_load_dwordx2 s[20:21], s[0:1], 112
    s_load_dwordx2 s[24:25], s[0:1], 32
    s_load_dwordx2 s[28:29], s[0:1], 24
    s_load_dwordx2 s[32:33], s[0:1], 40
    s_waitcnt lgkmcnt(0)
    s_and_b32 s13, s13, 0xffff
    s_mov_b32 s14, 0x280000
    s_mov_b32 s15, 0x00020000
    s_and_b32 s17, s17, 0xffff
    s_mov_b32 s18, 0x100
    s_mov_b32 s19, 0x00020000
    s_and_b32 s21, s21, 0xffff
    s_mov_b32 s22, 0x10000000
    s_mov_b32 s23, 0x00020000
    s_and_b32 s25, s25, 0xffff
    s_mov_b32 s26, 0x780000
    s_mov_b32 s27, 0x00020000
    s_and_b32 s29, s29, 0xffff
    s_mov_b32 s30, 0x780000
    s_mov_b32 s31, 0x00020000
    s_and_b32 s33, s33, 0xffff
    s_mov_b32 s34, 0x780000
    s_mov_b32 s35, 0x00020000
    s_cmp_lt_u32 s2, 16
    s_cbranch_scc0 ln_go
    v_lshlrev_b32 v1, 4, v0
    s_lshl_b32 s5, s2, 12
    s_add_u32 s5, s5, 0xe280000
    v_mov_b32 v8, 0
    v_mov_b32 v9, 0
    v_mov_b32 v10, 0
    v_mov_b32 v11, 0
    buffer_store_dwordx4 v[8:11], v1, s[20:23], s5 offen sc1
    s_waitcnt vmcnt(0) lgkmcnt(0)
    s_barrier
    v_mov_b32 v1, 0x7f000000
    v_cmp_eq_u32 vcc, 0, v0
    s_nop 1
    v_cndmask_b32 v1, v1, v0, vcc
    v_mov_b32 v2, 1
    buffer_atomic_add v2, v1, s[16:19], 0 offen offset:4
    s_nop 0
ln_go:
    v_and_b32 v1, 63, v0
    v_lshrrev_b32 v2, 6, v0
    v_and_b32 v3, 15, v1
    v_lshrrev_b32 v4, 4, v1
    s_lshl_b32 s3, s2, 4
    v_add_u32 v5, s3, v3
    v_mul_u32_u24 v5, 1280, v5
    v_mul_u32_u24 v6, 320, v2
    v_add_u32 v5, v5, v6
    v_lshl_add_u32 v5, v4, 3, v5
    buffer_load_dwordx2 v[8:9], v5, s[12:15], 0 offen offset:0
    buffer_load_dwordx2 v[10:11], v5, s[12:15], 0 offen offset:32
    buffer_load_dwordx2 v[12:13], v5, s[12:15], 0 offen offset:64
    buffer_load_dwordx2 v[14:15], v5, s[12:15], 0 offen offset:96
    buffer_load_dwordx2 v[16:17], v5, s[12:15], 0 offen offset:128
    buffer_load_dwordx2 v[18:19], v5, s[12:15], 0 offen offset:160
    buffer_load_dwordx2 v[20:21], v5, s[12:15], 0 offen offset:192
    buffer_load_dwordx2 v[22:23], v5, s[12:15], 0 offen offset:224
    buffer_load_dwordx2 v[24:25], v5, s[12:15], 0 offen offset:256
    buffer_load_dwordx2 v[26:27], v5, s[12:15], 0 offen offset:288
    v_lshlrev_b32 v7, 6, v3
    v_lshl_add_u32 v6, v2, 2, v4
    v_lshl_add_u32 v6, v6, 2, v7
    s_mul_i32 s3, s2, 20480
    v_mul_u32_u24 v28, 5120, v2
    v_lshl_add_u32 v28, v1, 4, v28
    v_add_u32 v28, s3, v28
    v_lshlrev_b32 v29, 4, v0
    s_mul_i32 s6, s2, 61440
    s_waitcnt vmcnt(0)
    v_lshlrev_b32 v32, 16, v8
    v_and_b32 v33, 0xffff0000, v8
    v_lshlrev_b32 v34, 16, v9
    v_and_b32 v35, 0xffff0000, v9
    v_lshlrev_b32 v36, 16, v10
    v_and_b32 v37, 0xffff0000, v10
    v_lshlrev_b32 v38, 16, v11
    v_and_b32 v39, 0xffff0000, v11
    v_lshlrev_b32 v40, 16, v12
    v_and_b32 v41, 0xffff0000, v12
    v_lshlrev_b32 v42, 16, v13
    v_and_b32 v43, 0xffff0000, v13
    v_lshlrev_b32 v44, 16, v14
    v_and_b32 v45, 0xffff0000, v14
    v_lshlrev_b32 v46, 16, v15
    v_and_b32 v47, 0xffff0000, v15
    v_lshlrev_b32 v48, 16, v16
    v_and_b32 v49, 0xffff0000, v16
    v_lshlrev_b32 v50, 16, v17
    v_and_b32 v51, 0xffff0000, v17
    v_lshlrev_b32 v52, 16, v18
    v_and_b32 v53, 0xffff0000, v18
    v_lshlrev_b32 v54, 16, v19
    v_and_b32 v55, 0xffff0000, v19
    v_lshlrev_b32 v56, 16, v20
    v_and_b32 v57, 0xffff0000, v20
    v_lshlrev_b32 v58, 16, v21
    v_and_b32 v59, 0xffff0000, v21
    v_lshlrev_b32 v60, 16, v22
    v_and_b32 v61, 0xffff0000, v22
    v_lshlrev_b32 v62, 16, v23
    v_and_b32 v63, 0xffff0000, v23
    v_lshlrev_b32 v64, 16, v24
    v_and_b32 v65, 0xffff0000, v24
    v_lshlrev_b32 v66, 16, v25
    v_and_b32 v67, 0xffff0000, v25
    v_lshlrev_b32 v68, 16, v26
    v_and_b32 v69, 0xffff0000, v26
    v_lshlrev_b32 v70, 16, v27
    v_and_b32 v71, 0xffff0000, v27
    v_add_f32 v72, v32, v36
    v_add_f32 v73, v33, v37
    v_add_f32 v74, v34, v38
    v_add_f32 v75, v35, v39
    v_add_f32 v72, v72, v40
    v_add_f32 v73, v73, v41
    v_add_f32 v74, v74, v42
    v_add_f32 v75, v75, v43
    v_add_f32 v72, v72, v44
    v_add_f32 v73, v73, v45
    v_add_f32 v74, v74, v46
    v_add_f32 v75, v75, v47
    v_add_f32 v72, v72, v48
    v_add_f32 v73, v73, v49
    v_add_f32 v74, v74, v50
    v_add_f32 v75, v75, v51
    v_add_f32 v72, v72, v52
    v_add_f32 v73, v73, v53
    v_add_f32 v74, v74, v54
    v_add_f32 v75, v75, v55
    v_add_f32 v72, v72, v56
    v_add_f32 v73, v73, v57
    v_add_f32 v74, v74, v58
    v_add_f32 v75, v75, v59
    v_add_f32 v72, v72, v60
    v_add_f32 v73, v73, v61
    v_add_f32 v74, v74, v62
    v_add_f32 v75, v75, v63
    v_add_f32 v72, v72, v64
    v_add_f32 v73, v73, v65
    v_add_f32 v74, v74, v66
    v_add_f32 v75, v75, v67
    v_add_f32 v72, v72, v68
    v_add_f32 v73, v73, v69
    v_add_f32 v74, v74, v70
    v_add_f32 v75, v75, v71
    v_add_f32 v72, v72, v73
    v_add_f32 v74, v74, v75
    v_add_f32 v72, v72, v74
    ds_write_b32 v6, v72 offset:0
    s_waitcnt lgkmcnt(0)
    s_barrier
    ds_read_b128 v[76:79], v7 offset:0
    ds_read_b128 v[80:83], v7 offset:16
    ds_read_b128 v[84:87], v7 offset:32
    ds_read_b128 v[88:91], v7 offset:48
    s_waitcnt lgkmcnt(0)
    v_add_f32 v76, v76, v84
    v_add_f32 v77, v77, v85
    v_add_f32 v78, v78, v86
    v_add_f32 v79, v79, v87
    v_add_f32 v80, v80, v88
    v_add_f32 v81, v81, v89
    v_add_f32 v82, v82, v90
    v_add_f32 v83, v83, v91
    v_add_f32 v76, v76, v80
    v_add_f32 v77, v77, v81
    v_add_f32 v78, v78, v82
    v_add_f32 v79, v79, v83
    v_add_f32 v76, v76, v78
    v_add_f32 v77, v77, v79
    v_add_f32 v76, v76, v77
    v_mul_f32 v72, 0x3acccccd, v76
    v_mov_b32 v29, v72
    v_mov_b32 v72, 0
    v_mov_b32 v73, 0
    v_mov_b32 v74, 0
    v_mov_b32 v75, 0
    v_sub_f32 v30, v32, v29
    v_fmac_f32 v72, v30, v30
    v_sub_f32 v30, v33, v29
    v_fmac_f32 v73, v30, v30
    v_sub_f32 v30, v34, v29
    v_fmac_f32 v74, v30, v30
    v_sub_f32 v30, v35, v29
    v_fmac_f32 v75, v30, v30
    v_sub_f32 v30, v36, v29
    v_fmac_f32 v72, v30, v30
    v_sub_f32 v30, v37, v29
    v_fmac_f32 v73, v30, v30
    v_sub_f32 v30, v38, v29
    v_fmac_f32 v74, v30, v30
    v_sub_f32 v30, v39, v29
    v_fmac_f32 v75, v30, v30
    v_sub_f32 v30, v40, v29
    v_fmac_f32 v72, v30, v30
    v_sub_f32 v30, v41, v29
    v_fmac_f32 v73, v30, v30
    v_sub_f32 v30, v42, v29
    v_fmac_f32 v74, v30, v30
    v_sub_f32 v30, v43, v29
    v_fmac_f32 v75, v30, v30
    v_sub_f32 v30, v44, v29
    v_fmac_f32 v72, v30, v30
    v_sub_f32 v30, v45, v29
    v_fmac_f32 v73, v30, v30
    v_sub_f32 v30, v46, v29
    v_fmac_f32 v74, v30, v30
    v_sub_f32 v30, v47, v29
    v_fmac_f32 v75, v30, v30
    v_sub_f32 v30, v48, v29
    v_fmac_f32 v72, v30, v30
    v_sub_f32 v30, v49, v29
    v_fmac_f32 v73, v30, v30
    v_sub_f32 v30, v50, v29
    v_fmac_f32 v74, v30, v30
    v_sub_f32 v30, v51, v29
    v_fmac_f32 v75, v30, v30
    v_sub_f32 v30, v52, v29
    v_fmac_f32 v72, v30, v30
    v_sub_f32 v30, v53, v29
    v_fmac_f32 v73, v30, v30
    v_sub_f32 v30, v54, v29
    v_fmac_f32 v74, v30, v30
    v_sub_f32 v30, v55, v29
    v_fmac_f32 v75, v30, v30
    v_sub_f32 v30, v56, v29
    v_fmac_f32 v72, v30, v30
    v_sub_f32 v30, v57, v29
    v_fmac_f32 v73, v30, v30
    v_sub_f32 v30, v58, v29
    v_fmac_f32 v74, v30, v30
    v_sub_f32 v30, v59, v29
    v_fmac_f32 v75, v30, v30
    v_sub_f32 v30, v60, v29
    v_fmac_f32 v72, v30, v30
    v_sub_f32 v30, v61, v29
    v_fmac_f32 v73, v30, v30
    v_sub_f32 v30, v62, v29
    v_fmac_f32 v74, v30, v30
    v_sub_f32 v30, v63, v29
    v_fmac_f32 v75, v30, v30
    v_sub_f32 v30, v64, v29
    v_fmac_f32 v72, v30, v30
    v_sub_f32 v30, v65, v29
    v_fmac_f32 v73, v30, v30
    v_sub_f32 v30, v66, v29
    v_fmac_f32 v74, v30, v30
    v_sub_f32 v30, v67, v29
    v_fmac_f32 v75, v30, v30
    v_sub_f32 v30, v68, v29
    v_fmac_f32 v72, v30, v30
    v_sub_f32 v30, v69, v29
    v_fmac_f32 v73, v30, v30
    v_sub_f32 v30, v70, v29
    v_fmac_f32 v74, v30, v30
    v_sub_f32 v30, v71, v29
    v_fmac_f32 v75, v30, v30
    v_add_f32 v72, v72, v73
    v_add_f32 v74, v74, v75
    v_add_f32 v72, v72, v74
    ds_write_b32 v6, v72 offset:1024
    s_waitcnt lgkmcnt(0)
    s_barrier
    ds_read_b128 v[76:79], v7 offset:1024
    ds_read_b128 v[80:83], v7 offset:1040
    ds_read_b128 v[84:87], v7 offset:1056
    ds_read_b128 v[88:91], v7 offset:1072
    s_waitcnt lgkmcnt(0)
    v_add_f32 v76, v76, v84
    v_add_f32 v77, v77, v85
    v_add_f32 v78, v78, v86
    v_add_f32 v79, v79, v87
    v_add_f32 v80, v80, v88
    v_add_f32 v81, v81, v89
    v_add_f32 v82, v82, v90
    v_add_f32 v83, v83, v91
    v_add_f32 v76, v76, v80
    v_add_f32 v77, v77, v81
    v_add_f32 v78, v78, v82
    v_add_f32 v79, v79, v83
    v_add_f32 v76, v76, v78
    v_add_f32 v77, v77, v79
    v_add_f32 v76, v76, v77
    v_mul_f32 v72, 0x3acccccd, v76
    v_cvt_pk_bf16_f32 v30, v29, v72
    v_lshlrev_b32 v29, 16, v30
    v_and_b32 v30, 0xffff0000, v30
    v_add_f32 v30, 0x3727c5ac, v30
    v_cvt_pk_bf16_f32 v30, v30, v30
    v_and_b32 v30, 0xffff0000, v30
    v_sqrt_f32 v30, v30
    s_nop 0
    v_cvt_pk_bf16_f32 v30, v30, v30
    v_and_b32 v30, 0xffff0000, v30
    v_rcp_f32 v31, v30
    s_nop 0
    v_fma_f32 v30, -v30, v31, 2.0
    v_mul_f32 v31, v31, v30
    v_sub_f32 v32, v32, v29
    v_sub_f32 v33, v33, v29
    v_cvt_pk_bf16_f32 v30, v32, v33
    v_lshlrev_b32 v32, 16, v30
    v_and_b32 v33, 0xffff0000, v30
    v_mul_f32 v32, v32, v31
    v_mul_f32 v33, v33, v31
    v_cvt_pk_bf16_f32 v8, v32, v33
    v_sub_f32 v34, v34, v29
    v_sub_f32 v35, v35, v29
    v_cvt_pk_bf16_f32 v30, v34, v35
    v_lshlrev_b32 v34, 16, v30
    v_and_b32 v35, 0xffff0000, v30
    v_mul_f32 v34, v34, v31
    v_mul_f32 v35, v35, v31
    v_cvt_pk_bf16_f32 v9, v34, v35
    v_sub_f32 v36, v36, v29
    v_sub_f32 v37, v37, v29
    v_cvt_pk_bf16_f32 v30, v36, v37
    v_lshlrev_b32 v36, 16, v30
    v_and_b32 v37, 0xffff0000, v30
    v_mul_f32 v36, v36, v31
    v_mul_f32 v37, v37, v31
    v_cvt_pk_bf16_f32 v10, v36, v37
    v_sub_f32 v38, v38, v29
    v_sub_f32 v39, v39, v29
    v_cvt_pk_bf16_f32 v30, v38, v39
    v_lshlrev_b32 v38, 16, v30
    v_and_b32 v39, 0xffff0000, v30
    v_mul_f32 v38, v38, v31
    v_mul_f32 v39, v39, v31
    v_cvt_pk_bf16_f32 v11, v38, v39
    v_sub_f32 v40, v40, v29
    v_sub_f32 v41, v41, v29
    v_cvt_pk_bf16_f32 v30, v40, v41
    v_lshlrev_b32 v40, 16, v30
    v_and_b32 v41, 0xffff0000, v30
    v_mul_f32 v40, v40, v31
    v_mul_f32 v41, v41, v31
    v_cvt_pk_bf16_f32 v12, v40, v41
    v_sub_f32 v42, v42, v29
    v_sub_f32 v43, v43, v29
    v_cvt_pk_bf16_f32 v30, v42, v43
    v_lshlrev_b32 v42, 16, v30
    v_and_b32 v43, 0xffff0000, v30
    v_mul_f32 v42, v42, v31
    v_mul_f32 v43, v43, v31
    v_cvt_pk_bf16_f32 v13, v42, v43
    v_sub_f32 v44, v44, v29
    v_sub_f32 v45, v45, v29
    v_cvt_pk_bf16_f32 v30, v44, v45
    v_lshlrev_b32 v44, 16, v30
    v_and_b32 v45, 0xffff0000, v30
    v_mul_f32 v44, v44, v31
    v_mul_f32 v45, v45, v31
    v_cvt_pk_bf16_f32 v14, v44, v45
    v_sub_f32 v46, v46, v29
    v_sub_f32 v47, v47, v29
    v_cvt_pk_bf16_f32 v30, v46, v47
    v_lshlrev_b32 v46, 16, v30
    v_and_b32 v47, 0xffff0000, v30
    v_mul_f32 v46, v46, v31
    v_mul_f32 v47, v47, v31
    v_cvt_pk_bf16_f32 v15, v46, v47
    v_sub_f32 v48, v48, v29
    v_sub_f32 v49, v49, v29
    v_cvt_pk_bf16_f32 v30, v48, v49
    v_lshlrev_b32 v48, 16, v30
    v_and_b32 v49, 0xffff0000, v30
    v_mul_f32 v48, v48, v31
    v_mul_f32 v49, v49, v31
    v_cvt_pk_bf16_f32 v16, v48, v49
    v_sub_f32 v50, v50, v29
    v_sub_f32 v51, v51, v29
    v_cvt_pk_bf16_f32 v30, v50, v51
    v_lshlrev_b32 v50, 16, v30
    v_and_b32 v51, 0xffff0000, v30
    v_mul_f32 v50, v50, v31
    v_mul_f32 v51, v51, v31
    v_cvt_pk_bf16_f32 v17, v50, v51
    v_sub_f32 v52, v52, v29
    v_sub_f32 v53, v53, v29
    v_cvt_pk_bf16_f32 v30, v52, v53
    v_lshlrev_b32 v52, 16, v30
    v_and_b32 v53, 0xffff0000, v30
    v_mul_f32 v52, v52, v31
    v_mul_f32 v53, v53, v31
    v_cvt_pk_bf16_f32 v18, v52, v53
    v_sub_f32 v54, v54, v29
    v_sub_f32 v55, v55, v29
    v_cvt_pk_bf16_f32 v30, v54, v55
    v_lshlrev_b32 v54, 16, v30
    v_and_b32 v55, 0xffff0000, v30
    v_mul_f32 v54, v54, v31
    v_mul_f32 v55, v55, v31
    v_cvt_pk_bf16_f32 v19, v54, v55
    v_sub_f32 v56, v56, v29
    v_sub_f32 v57, v57, v29
    v_cvt_pk_bf16_f32 v30, v56, v57
    v_lshlrev_b32 v56, 16, v30
    v_and_b32 v57, 0xffff0000, v30
    v_mul_f32 v56, v56, v31
    v_mul_f32 v57, v57, v31
    v_cvt_pk_bf16_f32 v20, v56, v57
    v_sub_f32 v58, v58, v29
    v_sub_f32 v59, v59, v29
    v_cvt_pk_bf16_f32 v30, v58, v59
    v_lshlrev_b32 v58, 16, v30
    v_and_b32 v59, 0xffff0000, v30
    v_mul_f32 v58, v58, v31
    v_mul_f32 v59, v59, v31
    v_cvt_pk_bf16_f32 v21, v58, v59
    v_sub_f32 v60, v60, v29
    v_sub_f32 v61, v61, v29
    v_cvt_pk_bf16_f32 v30, v60, v61
    v_lshlrev_b32 v60, 16, v30
    v_and_b32 v61, 0xffff0000, v30
    v_mul_f32 v60, v60, v31
    v_mul_f32 v61, v61, v31
    v_cvt_pk_bf16_f32 v22, v60, v61
    v_sub_f32 v62, v62, v29
    v_sub_f32 v63, v63, v29
    v_cvt_pk_bf16_f32 v30, v62, v63
    v_lshlrev_b32 v62, 16, v30
    v_and_b32 v63, 0xffff0000, v30
    v_mul_f32 v62, v62, v31
    v_mul_f32 v63, v63, v31
    v_cvt_pk_bf16_f32 v23, v62, v63
    v_sub_f32 v64, v64, v29
    v_sub_f32 v65, v65, v29
    v_cvt_pk_bf16_f32 v30, v64, v65
    v_lshlrev_b32 v64, 16, v30
    v_and_b32 v65, 0xffff0000, v30
    v_mul_f32 v64, v64, v31
    v_mul_f32 v65, v65, v31
    v_cvt_pk_bf16_f32 v24, v64, v65
    v_sub_f32 v66, v66, v29
    v_sub_f32 v67, v67, v29
    v_cvt_pk_bf16_f32 v30, v66, v67
    v_lshlrev_b32 v66, 16, v30
    v_and_b32 v67, 0xffff0000, v30
    v_mul_f32 v66, v66, v31
    v_mul_f32 v67, v67, v31
    v_cvt_pk_bf16_f32 v25, v66, v67
    v_sub_f32 v68, v68, v29
    v_sub_f32 v69, v69, v29
    v_cvt_pk_bf16_f32 v30, v68, v69
    v_lshlrev_b32 v68, 16, v30
    v_and_b32 v69, 0xffff0000, v30
    v_mul_f32 v68, v68, v31
    v_mul_f32 v69, v69, v31
    v_cvt_pk_bf16_f32 v26, v68, v69
    v_sub_f32 v70, v70, v29
    v_sub_f32 v71, v71, v29
    v_cvt_pk_bf16_f32 v30, v70, v71
    v_lshlrev_b32 v70, 16, v30
    v_and_b32 v71, 0xffff0000, v30
    v_mul_f32 v70, v70, v31
    v_mul_f32 v71, v71, v31
    v_cvt_pk_bf16_f32 v27, v70, v71
    s_mov_b32 s3, 0x0
    buffer_store_dwordx4 v[8:11], v28, s[20:23], s3 offen offset:0 sc1
    buffer_store_dwordx4 v[12:15], v28, s[20:23], s3 offen offset:1024 sc1
    buffer_store_dwordx4 v[16:19], v28, s[20:23], s3 offen offset:2048 sc1
    buffer_store_dwordx4 v[20:23], v28, s[20:23], s3 offen offset:3072 sc1
    s_mov_b32 s4, 0x1000
    buffer_store_dwordx4 v[24:27], v28, s[20:23], s4 offen sc1
    v_lshlrev_b32 v32, 16, v8
    v_and_b32 v33, 0xffff0000, v8
    v_lshlrev_b32 v34, 16, v9
    v_and_b32 v35, 0xffff0000, v9
    v_lshlrev_b32 v36, 16, v10
    v_and_b32 v37, 0xffff0000, v10
    v_lshlrev_b32 v38, 16, v11
    v_and_b32 v39, 0xffff0000, v11
    v_lshlrev_b32 v40, 16, v12
    v_and_b32 v41, 0xffff0000, v12
    v_lshlrev_b32 v42, 16, v13
    v_and_b32 v43, 0xffff0000, v13
    v_lshlrev_b32 v44, 16, v14
    v_and_b32 v45, 0xffff0000, v14
    v_lshlrev_b32 v46, 16, v15
    v_and_b32 v47, 0xffff0000, v15
    v_lshlrev_b32 v48, 16, v16
    v_and_b32 v49, 0xffff0000, v16
    v_lshlrev_b32 v50, 16, v17
    v_and_b32 v51, 0xffff0000, v17
    v_lshlrev_b32 v52, 16, v18
    v_and_b32 v53, 0xffff0000, v18
    v_lshlrev_b32 v54, 16, v19
    v_and_b32 v55, 0xffff0000, v19
    v_lshlrev_b32 v56, 16, v20
    v_and_b32 v57, 0xffff0000, v20
    v_lshlrev_b32 v58, 16, v21
    v_and_b32 v59, 0xffff0000, v21
    v_lshlrev_b32 v60, 16, v22
    v_and_b32 v61, 0xffff0000, v22
    v_lshlrev_b32 v62, 16, v23
    v_and_b32 v63, 0xffff0000, v23
    v_lshlrev_b32 v64, 16, v24
    v_and_b32 v65, 0xffff0000, v24
    v_lshlrev_b32 v66, 16, v25
    v_and_b32 v67, 0xffff0000, v25
    v_lshlrev_b32 v68, 16, v26
    v_and_b32 v69, 0xffff0000, v26
    v_lshlrev_b32 v70, 16, v27
    v_and_b32 v71, 0xffff0000, v27
    s_lshr_b32 s5, s2, 4
    s_lshl_b32 s5, s5, 7
    s_and_b32 s6, s2, 15
    s_lshl_b32 s6, s6, 2
    s_add_u32 s5, s5, s6
    s_add_u32 s5, s5, 0xe28f000
    v_mov_b32 v96, 0
    s_mov_b32 s6, 0
    s_nop 0
wc_48:
    buffer_load_dword v97, v96, s[16:19], 0 offen offset:4 sc1
    s_add_u32 s6, s6, 1
    s_cmp_gt_u32 s6, 2097152
    s_cbranch_scc1 rec_fail
    s_waitcnt vmcnt(0)
    v_cmp_gt_u32 vcc, 16, v97
    s_cbranch_vccz wcd_49
    s_sleep 4
    s_branch wc_48
    s_nop 1
wcd_49:
    s_mov_b32 s86, 1
    s_waitcnt vmcnt(0) lgkmcnt(0)
    s_barrier
    v_mov_b32 v96, 0x7f000000
    v_cmp_eq_u32 vcc, 0, v0
    s_nop 1
    v_cndmask_b32 v96, v96, v0, vcc
    v_mov_b32 v97, 1
    buffer_store_dword v97, v96, s[20:23], s5 offen sc1
    v_add_f32 v72, v32, v36
    v_add_f32 v73, v33, v37
    v_add_f32 v74, v34, v38
    v_add_f32 v75, v35, v39
    v_add_f32 v72, v72, v40
    v_add_f32 v73, v73, v41
    v_add_f32 v74, v74, v42
    v_add_f32 v75, v75, v43
    v_add_f32 v72, v72, v44
    v_add_f32 v73, v73, v45
    v_add_f32 v74, v74, v46
    v_add_f32 v75, v75, v47
    v_add_f32 v72, v72, v48
    v_add_f32 v73, v73, v49
    v_add_f32 v74, v74, v50
    v_add_f32 v75, v75, v51
    v_add_f32 v72, v72, v52
    v_add_f32 v73, v73, v53
    v_add_f32 v74, v74, v54
    v_add_f32 v75, v75, v55
    v_add_f32 v72, v72, v56
    v_add_f32 v73, v73, v57
    v_add_f32 v74, v74, v58
    v_add_f32 v75, v75, v59
    v_add_f32 v72, v72, v60
    v_add_f32 v73, v73, v61
    v_add_f32 v74, v74, v62
    v_add_f32 v75, v75, v63
    v_add_f32 v72, v72, v64
    v_add_f32 v73, v73, v65
    v_add_f32 v74, v74, v66
    v_add_f32 v75, v75, v67
    v_add_f32 v72, v72, v68
    v_add_f32 v73, v73, v69
    v_add_f32 v74, v74, v70
    v_add_f32 v75, v75, v71
    v_add_f32 v72, v72, v73
    v_add_f32 v74, v74, v75
    v_add_f32 v72, v72, v74
    ds_write_b32 v6, v72 offset:2048
    s_waitcnt lgkmcnt(0)
    s_barrier
    ds_read_b128 v[76:79], v7 offset:2048
    ds_read_b128 v[80:83], v7 offset:2064
    ds_read_b128 v[84:87], v7 offset:2080
    ds_read_b128 v[88:91], v7 offset:2096
    s_waitcnt lgkmcnt(0)
    v_add_f32 v76, v76, v84
    v_add_f32 v77, v77, v85
    v_add_f32 v78, v78, v86
    v_add_f32 v79, v79, v87
    v_add_f32 v80, v80, v88
    v_add_f32 v81, v81, v89
    v_add_f32 v82, v82, v90
    v_add_f32 v83, v83, v91
    v_add_f32 v76, v76, v80
    v_add_f32 v77, v77, v81
    v_add_f32 v78, v78, v82
    v_add_f32 v79, v79, v83
    v_add_f32 v76, v76, v78
    v_add_f32 v77, v77, v79
    v_add_f32 v76, v76, v77
    v_mul_f32 v72, 0x3acccccd, v76
    v_mov_b32 v29, v72
    v_mov_b32 v72, 0
    v_mov_b32 v73, 0
    v_mov_b32 v74, 0
    v_mov_b32 v75, 0
    v_sub_f32 v30, v32, v29
    v_fmac_f32 v72, v30, v30
    v_sub_f32 v30, v33, v29
    v_fmac_f32 v73, v30, v30
    v_sub_f32 v30, v34, v29
    v_fmac_f32 v74, v30, v30
    v_sub_f32 v30, v35, v29
    v_fmac_f32 v75, v30, v30
    v_sub_f32 v30, v36, v29
    v_fmac_f32 v72, v30, v30
    v_sub_f32 v30, v37, v29
    v_fmac_f32 v73, v30, v30
    v_sub_f32 v30, v38, v29
    v_fmac_f32 v74, v30, v30
    v_sub_f32 v30, v39, v29
    v_fmac_f32 v75, v30, v30
    v_sub_f32 v30, v40, v29
    v_fmac_f32 v72, v30, v30
    v_sub_f32 v30, v41, v29
    v_fmac_f32 v73, v30, v30
    v_sub_f32 v30, v42, v29
    v_fmac_f32 v74, v30, v30
    v_sub_f32 v30, v43, v29
    v_fmac_f32 v75, v30, v30
    v_sub_f32 v30, v44, v29
    v_fmac_f32 v72, v30, v30
    v_sub_f32 v30, v45, v29
    v_fmac_f32 v73, v30, v30
    v_sub_f32 v30, v46, v29
    v_fmac_f32 v74, v30, v30
    v_sub_f32 v30, v47, v29
    v_fmac_f32 v75, v30, v30
    v_sub_f32 v30, v48, v29
    v_fmac_f32 v72, v30, v30
    v_sub_f32 v30, v49, v29
    v_fmac_f32 v73, v30, v30
    v_sub_f32 v30, v50, v29
    v_fmac_f32 v74, v30, v30
    v_sub_f32 v30, v51, v29
    v_fmac_f32 v75, v30, v30
    v_sub_f32 v30, v52, v29
    v_fmac_f32 v72, v30, v30
    v_sub_f32 v30, v53, v29
    v_fmac_f32 v73, v30, v30
    v_sub_f32 v30, v54, v29
    v_fmac_f32 v74, v30, v30
    v_sub_f32 v30, v55, v29
    v_fmac_f32 v75, v30, v30
    v_sub_f32 v30, v56, v29
    v_fmac_f32 v72, v30, v30
    v_sub_f32 v30, v57, v29
    v_fmac_f32 v73, v30, v30
    v_sub_f32 v30, v58, v29
    v_fmac_f32 v74, v30, v30
    v_sub_f32 v30, v59, v29
    v_fmac_f32 v75, v30, v30
    v_sub_f32 v30, v60, v29
    v_fmac_f32 v72, v30, v30
    v_sub_f32 v30, v61, v29
    v_fmac_f32 v73, v30, v30
    v_sub_f32 v30, v62, v29
    v_fmac_f32 v74, v30, v30
    v_sub_f32 v30, v63, v29
    v_fmac_f32 v75, v30, v30
    v_sub_f32 v30, v64, v29
    v_fmac_f32 v72, v30, v30
    v_sub_f32 v30, v65, v29
    v_fmac_f32 v73, v30, v30
    v_sub_f32 v30, v66, v29
    v_fmac_f32 v74, v30, v30
    v_sub_f32 v30, v67, v29
    v_fmac_f32 v75, v30, v30
    v_sub_f32 v30, v68, v29
    v_fmac_f32 v72, v30, v30
    v_sub_f32 v30, v69, v29
    v_fmac_f32 v73, v30, v30
    v_sub_f32 v30, v70, v29
    v_fmac_f32 v74, v30, v30
    v_sub_f32 v30, v71, v29
    v_fmac_f32 v75, v30, v30
    v_add_f32 v72, v72, v73
    v_add_f32 v74, v74, v75
    v_add_f32 v72, v72, v74
    ds_write_b32 v6, v72 offset:3072
    s_waitcnt lgkmcnt(0)
    s_barrier
    ds_read_b128 v[76:79], v7 offset:3072
    ds_read_b128 v[80:83], v7 offset:3088
    ds_read_b128 v[84:87], v7 offset:3104
    ds_read_b128 v[88:91], v7 offset:3120
    s_waitcnt lgkmcnt(0)
    v_add_f32 v76, v76, v84
    v_add_f32 v77, v77, v85
    v_add_f32 v78, v78, v86
    v_add_f32 v79, v79, v87
    v_add_f32 v80, v80, v88
    v_add_f32 v81, v81, v89
    v_add_f32 v82, v82, v90
    v_add_f32 v83, v83, v91
    v_add_f32 v76, v76, v80
    v_add_f32 v77, v77, v81
    v_add_f32 v78, v78, v82
    v_add_f32 v79, v79, v83
    v_add_f32 v76, v76, v78
    v_add_f32 v77, v77, v79
    v_add_f32 v76, v76, v77
    v_mul_f32 v72, 0x3acccccd, v76
    v_cvt_pk_bf16_f32 v30, v29, v72
    v_lshlrev_b32 v29, 16, v30
    v_and_b32 v30, 0xffff0000, v30
    v_add_f32 v30, 0x3727c5ac, v30
    v_cvt_pk_bf16_f32 v30, v30, v30
    v_and_b32 v30, 0xffff0000, v30
    v_sqrt_f32 v30, v30
    s_nop 0
    v_cvt_pk_bf16_f32 v30, v30, v30
    v_and_b32 v30, 0xffff0000, v30
    v_rcp_f32 v31, v30
    s_nop 0
    v_fma_f32 v30, -v30, v31, 2.0
    v_mul_f32 v31, v31, v30
    v_sub_f32 v32, v32, v29
    v_sub_f32 v33, v33, v29
    v_cvt_pk_bf16_f32 v30, v32, v33
    v_lshlrev_b32 v32, 16, v30
    v_and_b32 v33, 0xffff0000, v30
    v_mul_f32 v32, v32, v31
    v_mul_f32 v33, v33, v31
    v_cvt_pk_bf16_f32 v8, v32, v33
    v_sub_f32 v34, v34, v29
    v_sub_f32 v35, v35, v29
    v_cvt_pk_bf16_f32 v30, v34, v35
    v_lshlrev_b32 v34, 16, v30
    v_and_b32 v35, 0xffff0000, v30
    v_mul_f32 v34, v34, v31
    v_mul_f32 v35, v35, v31
    v_cvt_pk_bf16_f32 v9, v34, v35
    v_sub_f32 v36, v36, v29
    v_sub_f32 v37, v37, v29
    v_cvt_pk_bf16_f32 v30, v36, v37
    v_lshlrev_b32 v36, 16, v30
    v_and_b32 v37, 0xffff0000, v30
    v_mul_f32 v36, v36, v31
    v_mul_f32 v37, v37, v31
    v_cvt_pk_bf16_f32 v10, v36, v37
    v_sub_f32 v38, v38, v29
    v_sub_f32 v39, v39, v29
    v_cvt_pk_bf16_f32 v30, v38, v39
    v_lshlrev_b32 v38, 16, v30
    v_and_b32 v39, 0xffff0000, v30
    v_mul_f32 v38, v38, v31
    v_mul_f32 v39, v39, v31
    v_cvt_pk_bf16_f32 v11, v38, v39
    v_sub_f32 v40, v40, v29
    v_sub_f32 v41, v41, v29
    v_cvt_pk_bf16_f32 v30, v40, v41
    v_lshlrev_b32 v40, 16, v30
    v_and_b32 v41, 0xffff0000, v30
    v_mul_f32 v40, v40, v31
    v_mul_f32 v41, v41, v31
    v_cvt_pk_bf16_f32 v12, v40, v41
    v_sub_f32 v42, v42, v29
    v_sub_f32 v43, v43, v29
    v_cvt_pk_bf16_f32 v30, v42, v43
    v_lshlrev_b32 v42, 16, v30
    v_and_b32 v43, 0xffff0000, v30
    v_mul_f32 v42, v42, v31
    v_mul_f32 v43, v43, v31
    v_cvt_pk_bf16_f32 v13, v42, v43
    v_sub_f32 v44, v44, v29
    v_sub_f32 v45, v45, v29
    v_cvt_pk_bf16_f32 v30, v44, v45
    v_lshlrev_b32 v44, 16, v30
    v_and_b32 v45, 0xffff0000, v30
    v_mul_f32 v44, v44, v31
    v_mul_f32 v45, v45, v31
    v_cvt_pk_bf16_f32 v14, v44, v45
    v_sub_f32 v46, v46, v29
    v_sub_f32 v47, v47, v29
    v_cvt_pk_bf16_f32 v30, v46, v47
    v_lshlrev_b32 v46, 16, v30
    v_and_b32 v47, 0xffff0000, v30
    v_mul_f32 v46, v46, v31
    v_mul_f32 v47, v47, v31
    v_cvt_pk_bf16_f32 v15, v46, v47
    v_sub_f32 v48, v48, v29
    v_sub_f32 v49, v49, v29
    v_cvt_pk_bf16_f32 v30, v48, v49
    v_lshlrev_b32 v48, 16, v30
    v_and_b32 v49, 0xffff0000, v30
    v_mul_f32 v48, v48, v31
    v_mul_f32 v49, v49, v31
    v_cvt_pk_bf16_f32 v16, v48, v49
    v_sub_f32 v50, v50, v29
    v_sub_f32 v51, v51, v29
    v_cvt_pk_bf16_f32 v30, v50, v51
    v_lshlrev_b32 v50, 16, v30
    v_and_b32 v51, 0xffff0000, v30
    v_mul_f32 v50, v50, v31
    v_mul_f32 v51, v51, v31
    v_cvt_pk_bf16_f32 v17, v50, v51
    v_sub_f32 v52, v52, v29
    v_sub_f32 v53, v53, v29
    v_cvt_pk_bf16_f32 v30, v52, v53
    v_lshlrev_b32 v52, 16, v30
    v_and_b32 v53, 0xffff0000, v30
    v_mul_f32 v52, v52, v31
    v_mul_f32 v53, v53, v31
    v_cvt_pk_bf16_f32 v18, v52, v53
    v_sub_f32 v54, v54, v29
    v_sub_f32 v55, v55, v29
    v_cvt_pk_bf16_f32 v30, v54, v55
    v_lshlrev_b32 v54, 16, v30
    v_and_b32 v55, 0xffff0000, v30
    v_mul_f32 v54, v54, v31
    v_mul_f32 v55, v55, v31
    v_cvt_pk_bf16_f32 v19, v54, v55
    v_sub_f32 v56, v56, v29
    v_sub_f32 v57, v57, v29
    v_cvt_pk_bf16_f32 v30, v56, v57
    v_lshlrev_b32 v56, 16, v30
    v_and_b32 v57, 0xffff0000, v30
    v_mul_f32 v56, v56, v31
    v_mul_f32 v57, v57, v31
    v_cvt_pk_bf16_f32 v20, v56, v57
    v_sub_f32 v58, v58, v29
    v_sub_f32 v59, v59, v29
    v_cvt_pk_bf16_f32 v30, v58, v59
    v_lshlrev_b32 v58, 16, v30
    v_and_b32 v59, 0xffff0000, v30
    v_mul_f32 v58, v58, v31
    v_mul_f32 v59, v59, v31
    v_cvt_pk_bf16_f32 v21, v58, v59
    v_sub_f32 v60, v60, v29
    v_sub_f32 v61, v61, v29
    v_cvt_pk_bf16_f32 v30, v60, v61
    v_lshlrev_b32 v60, 16, v30
    v_and_b32 v61, 0xffff0000, v30
    v_mul_f32 v60, v60, v31
    v_mul_f32 v61, v61, v31
    v_cvt_pk_bf16_f32 v22, v60, v61
    v_sub_f32 v62, v62, v29
    v_sub_f32 v63, v63, v29
    v_cvt_pk_bf16_f32 v30, v62, v63
    v_lshlrev_b32 v62, 16, v30
    v_and_b32 v63, 0xffff0000, v30
    v_mul_f32 v62, v62, v31
    v_mul_f32 v63, v63, v31
    v_cvt_pk_bf16_f32 v23, v62, v63
    v_sub_f32 v64, v64, v29
    v_sub_f32 v65, v65, v29
    v_cvt_pk_bf16_f32 v30, v64, v65
    v_lshlrev_b32 v64, 16, v30
    v_and_b32 v65, 0xffff0000, v30
    v_mul_f32 v64, v64, v31
    v_mul_f32 v65, v65, v31
    v_cvt_pk_bf16_f32 v24, v64, v65
    v_sub_f32 v66, v66, v29
    v_sub_f32 v67, v67, v29
    v_cvt_pk_bf16_f32 v30, v66, v67
    v_lshlrev_b32 v66, 16, v30
    v_and_b32 v67, 0xffff0000, v30
    v_mul_f32 v66, v66, v31
    v_mul_f32 v67, v67, v31
    v_cvt_pk_bf16_f32 v25, v66, v67
    v_sub_f32 v68, v68, v29
    v_sub_f32 v69, v69, v29
    v_cvt_pk_bf16_f32 v30, v68, v69
    v_lshlrev_b32 v68, 16, v30
    v_and_b32 v69, 0xffff0000, v30
    v_mul_f32 v68, v68, v31
    v_mul_f32 v69, v69, v31
    v_cvt_pk_bf16_f32 v26, v68, v69
    v_sub_f32 v70, v70, v29
    v_sub_f32 v71, v71, v29
    v_cvt_pk_bf16_f32 v30, v70, v71
    v_lshlrev_b32 v70, 16, v30
    v_and_b32 v71, 0xffff0000, v30
    v_mul_f32 v70, v70, v31
    v_mul_f32 v71, v71, v31
    v_cvt_pk_bf16_f32 v27, v70, v71
    s_mov_b32 s3, 0x280000
    s_mov_b32 s4, 0x281000
    buffer_store_dwordx4 v[8:11], v28, s[20:23], s3 offen offset:0 sc1
    buffer_store_dwordx4 v[12:15], v28, s[20:23], s3 offen offset:1024 sc1
    buffer_store_dwordx4 v[16:19], v28, s[20:23], s3 offen offset:2048 sc1
    buffer_store_dwordx4 v[20:23], v28, s[20:23], s3 offen offset:3072 sc1
    buffer_store_dwordx4 v[24:27], v28, s[20:23], s4 offen sc1
    s_add_u32 s5, s5, 0x400
    s_waitcnt vmcnt(0) lgkmcnt(0)
    s_barrier
    v_mov_b32 v96, 0x7f000000
    v_cmp_eq_u32 vcc, 0, v0
    s_nop 1
    v_cndmask_b32 v96, v96, v0, vcc
    v_mov_b32 v97, 1
    buffer_store_dword v97, v96, s[20:23], s5 offen sc1
    s_branch w_next
pa_entry:
    s_mov_b32 s80, 0
    s_load_dwordx2 s[8:9], s[0:1], 112
    s_waitcnt lgkmcnt(0)
    s_and_b32 s9, s9, 0xffff
    s_mov_b32 s10, 0x10000000
    s_mov_b32 s11, 0x00020000
    v_and_b32 v1, 63, v0
    v_lshrrev_b32 v2, 6, v0
    s_nop 0
    v_readfirstlane_b32 s12, v2
    v_lshlrev_b32 v3, 4, v1
    v_and_b32 v4, 15, v1
    v_lshrrev_b32 v5, 4, v1
    s_lshr_b32 s13, s2, 3
    s_and_b32 s14, s2, 7
    s_lshl_b32 s14, s14, 2
    s_add_u32 s14, s14, s12
    s_lshr_b32 s15, s13, 3
    s_lshl_b32 s15, s15, 7
    s_lshl_b32 s16, s13, 7
    s_add_u32 s16, s16, 0x3000
    s_add_u32 s17, s15, 0x1000
    s_lshr_b32 s15, s13, 2
    s_lshl_b32 s15, s15, 7
    s_add_u32 s15, s15, 0x800
    v_mov_b32 v10, s16
    v_and_b32 v7, 1, v1
    v_mov_b32 v6, s17
    v_mov_b32 v8, s15
    v_cmp_eq_u32 vcc, 1, v7
    s_nop 1
    v_cndmask_b32 v6, v6, v8, vcc
    s_lshl_b32 s31, s14, 2
    s_add_u32 s31, s31, 0xe280000
    s_mov_b32 s16, 0
wf2_50:
    buffer_load_dword v7, v6, s[8:11], s31 offen sc1
    buffer_load_dword v8, v10, s[8:11], s31 offen sc1
    s_add_u32 s16, s16, 1
    s_cmp_gt_u32 s16, 2097152
    s_cbranch_scc1 rec_fail
    s_waitcnt vmcnt(0)
    v_cmp_eq_u32 vcc, 0, v7
    s_cbranch_vccz wf2d_51
    s_sleep 8
    s_branch wf2_50
    s_nop 1
wf2d_51:
    v_cmp_eq_u32 vcc, 0, v8
    s_mov_b32 s32, 1
    s_cbranch_vccz Lskip_52
    s_mov_b32 s32, 0
Lskip_52:
    s_lshl_b32 s15, s13, 6
    s_add_u32 s15, s15, s14
    s_mul_i32 s15, s15, 6144
    s_lshl_b32 s16, s13, 5
    s_add_u32 s16, s16, s14
    s_mul_i32 s16, s16, 3072
    s_add_u32 s16, s16, 0xaa00000
    v_and_b32 v6, 7, v4
    v_lshlrev_b32 v6, 4, v6
    v_lshl_add_u32 v6, v5, 7, v6
    s_waitcnt vmcnt(6)
    s_add_u32 s17, s15, 0x1000000
    buffer_load_dwordx4 v[16:19], v3, s[8:11], s17 offen offset:0 sc1
    s_add_u32 s17, s15, 0x2800000
    buffer_load_dwordx4 v[64:67], v3, s[8:11], s17 offen offset:0 sc1
    s_add_u32 s17, s15, 0x1030000
    buffer_load_dwordx4 v[40:43], v3, s[8:11], s17 offen offset:0 sc1
    s_add_u32 s17, s15, 0x2830000
    buffer_load_dwordx4 v[88:91], v3, s[8:11], s17 offen offset:0 sc1
    s_waitcnt vmcnt(6)
    s_add_u32 s17, s15, 0x1000000
    buffer_load_dwordx4 v[20:23], v3, s[8:11], s17 offen offset:1024 sc1
    s_add_u32 s17, s15, 0x2800000
    buffer_load_dwordx4 v[68:71], v3, s[8:11], s17 offen offset:1024 sc1
    s_add_u32 s17, s15, 0x1030000
    buffer_load_dwordx4 v[44:47], v3, s[8:11], s17 offen offset:1024 sc1
    s_add_u32 s17, s15, 0x2830000
    buffer_load_dwordx4 v[92:95], v3, s[8:11], s17 offen offset:1024 sc1
    s_waitcnt vmcnt(6)
    s_add_u32 s17, s15, 0x1000000
    buffer_load_dwordx4 v[24:27], v3, s[8:11], s17 offen offset:2048 sc1
    s_add_u32 s17, s15, 0x2800000
    buffer_load_dwordx4 v[72:75], v3, s[8:11], s17 offen offset:2048 sc1
    s_add_u32 s17, s15, 0x1030000
    buffer_load_dwordx4 v[48:51], v3, s[8:11], s17 offen offset:2048 sc1
    s_add_u32 s17, s15, 0x2830000
    buffer_load_dwordx4 v[96:99], v3, s[8:11], s17 offen offset:2048 sc1
    s_waitcnt vmcnt(6)
    s_add_u32 s17, s15, 0x1000c00
    buffer_load_dwordx4 v[28:31], v3, s[8:11], s17 offen offset:0 sc1
    s_add_u32 s17, s15, 0x2800c00
    buffer_load_dwordx4 v[76:79], v3, s[8:11], s17 offen offset:0 sc1
    s_add_u32 s17, s15, 0x1030c00
    buffer_load_dwordx4 v[52:55], v3, s[8:11], s17 offen offset:0 sc1
    s_add_u32 s17, s15, 0x2830c00
    buffer_load_dwordx4 v[100:103], v3, s[8:11], s17 offen offset:0 sc1
    s_waitcnt vmcnt(6)
    s_add_u32 s17, s15, 0x1000c00
    buffer_load_dwordx4 v[32:35], v3, s[8:11], s17 offen offset:1024 sc1
    s_add_u32 s17, s15, 0x2800c00
    buffer_load_dwordx4 v[80:83], v3, s[8:11], s17 offen offset:1024 sc1
    s_add_u32 s17, s15, 0x1030c00
    buffer_load_dwordx4 v[56:59], v3, s[8:11], s17 offen offset:1024 sc1
    s_add_u32 s17, s15, 0x2830c00
    buffer_load_dwordx4 v[104:107], v3, s[8:11], s17 offen offset:1024 sc1
    s_waitcnt vmcnt(6)
    s_add_u32 s17, s15, 0x1000c00
    buffer_load_dwordx4 v[36:39], v3, s[8:11], s17 offen offset:2048 sc1
    s_add_u32 s17, s15, 0x2800c00
    buffer_load_dwordx4 v[84:87], v3, s[8:11], s17 offen offset:2048 sc1
    s_add_u32 s17, s15, 0x1030c00
    buffer_load_dwordx4 v[60:63], v3, s[8:11], s17 offen offset:2048 sc1
    s_add_u32 s17, s15, 0x2830c00
    buffer_load_dwordx4 v[108:111], v3, s[8:11], s17 offen offset:2048 sc1
    s_cmp_eq_u32 s32, 1
    s_cbranch_scc1 pa_km
    s_mov_b32 s17, 0
wf_53:
    buffer_load_dword v7, v10, s[8:11], s31 offen sc1
    s_add_u32 s17, s17, 1
    s_cmp_gt_u32 s17, 2097152
    s_cbranch_scc1 rec_fail
    s_waitcnt vmcnt(0)
    v_cmp_eq_u32 vcc, 0, v7
    s_cbranch_vccz wfd_54
    s_sleep 3
    s_branch wf_53
    s_nop 1
wfd_54:
pa_km:
    buffer_load_dwordx4 v[112:115], v6, s[8:11], s16 offen offset:0 sc1
    buffer_load_dwordx4 v[116:119], v6, s[8:11], s16 offen offset:512 sc1
    buffer_load_dwordx4 v[120:123], v6, s[8:11], s16 offen offset:1024 sc1
    buffer_load_dwordx4 v[124:127], v6, s[8:11], s16 offen offset:1536 sc1
    buffer_load_dwordx4 v[128:131], v6, s[8:11], s16 offen offset:2048 sc1
    buffer_load_dwordx4 v[132:135], v6, s[8:11], s16 offen offset:2560 sc1
    v_lshl_add_u32 v7, v5, 2, 0
    v_cmp_gt_u32 s[20:21], v7, v4
    v_lshl_add_u32 v7, v5, 2, 1
    v_cmp_gt_u32 s[22:23], v7, v4
    v_lshl_add_u32 v7, v5, 2, 2
    v_cmp_gt_u32 s[24:25], v7, v4
    v_lshl_add_u32 v7, v5, 2, 3
    v_cmp_gt_u32 s[26:27], v7, v4
    v_mov_b32 v8, 0xff800000
    s_mov_b32 s18, 0x3dd53b95
    s_waitcnt vmcnt(26)
    v_mfma_f32_16x16x32_bf16 v[136:139], v[64:67], v[16:19], 0
    v_mfma_f32_16x16x32_bf16 v[144:147], v[64:67], v[40:43], 0
    v_mfma_f32_16x16x32_bf16 v[148:151], v[88:91], v[40:43], 0
    s_waitcnt vmcnt(22)
    v_mfma_f32_16x16x32_bf16 v[136:139], v[68:71], v[20:23], v[136:139]
    v_mfma_f32_16x16x32_bf16 v[144:147], v[68:71], v[44:47], v[144:147]
    v_mfma_f32_16x16x32_bf16 v[148:151], v[92:95], v[44:47], v[148:151]
    s_waitcnt vmcnt(18)
    v_mfma_f32_16x16x32_bf16 v[136:139], v[72:75], v[24:27], v[136:139]
    v_mfma_f32_16x16x32_bf16 v[144:147], v[72:75], v[48:51], v[144:147]
    v_mfma_f32_16x16x32_bf16 v[148:151], v[96:99], v[48:51], v[148:151]
    s_waitcnt vmcnt(14)
    v_mfma_f32_16x16x32_bf16 v[136:139], v[76:79], v[28:31], v[136:139]
    v_mfma_f32_16x16x32_bf16 v[144:147], v[76:79], v[52:55], v[144:147]
    v_mfma_f32_16x16x32_bf16 v[148:151], v[100:103], v[52:55], v[148:151]
    s_waitcnt vmcnt(10)
    v_mfma_f32_16x16x32_bf16 v[136:139], v[80:83], v[32:35], v[136:139]
    v_mfma_f32_16x16x32_bf16 v[144:147], v[80:83], v[56:59], v[144:147]
    v_mfma_f32_16x16x32_bf16 v[148:151], v[104:107], v[56:59], v[148:151]
    s_waitcnt vmcnt(6)
    v_mfma_f32_16x16x32_bf16 v[136:139], v[84:87], v[36:39], v[136:139]
    v_mfma_f32_16x16x32_bf16 v[144:147], v[84:87], v[60:63], v[144:147]
    v_mfma_f32_16x16x32_bf16 v[148:151], v[108:111], v[60:63], v[148:151]
    s_waitcnt vmcnt(5)
    v_mfma_f32_16x16x32_bf16 v[140:143], v[112:115], v[16:19], 0
    v_mfma_f32_16x16x32_bf16 v[152:155], v[112:115], v[40:43], 0
    s_waitcnt vmcnt(4)
    v_mfma_f32_16x16x32_bf16 v[140:143], v[116:119], v[20:23], v[140:143]
    v_mfma_f32_16x16x32_bf16 v[152:155], v[116:119], v[44:47], v[152:155]
    s_waitcnt vmcnt(3)
    v_mfma_f32_16x16x32_bf16 v[140:143], v[120:123], v[24:27], v[140:143]
    v_mfma_f32_16x16x32_bf16 v[152:155], v[120:123], v[48:51], v[152:155]
    s_waitcnt vmcnt(2)
    v_mfma_f32_16x16x32_bf16 v[140:143], v[124:127], v[28:31], v[140:143]
    v_mfma_f32_16x16x32_bf16 v[152:155], v[124:127], v[52:55], v[152:155]
    s_waitcnt vmcnt(1)
    v_mfma_f32_16x16x32_bf16 v[140:143], v[128:131], v[32:35], v[140:143]
    v_mfma_f32_16x16x32_bf16 v[152:155], v[128:131], v[56:59], v[152:155]
    s_waitcnt vmcnt(0)
    v_mfma_f32_16x16x32_bf16 v[140:143], v[132:135], v[36:39], v[140:143]
    v_mfma_f32_16x16x32_bf16 v[152:155], v[132:135], v[60:63], v[152:155]
    s_mul_i32 s19, s13, 81920
    s_add_u32 s19, s19, 0xca00000
    s_lshl_b32 s28, s14, 10
    s_add_u32 s28, s28, s19
    s_lshr_b32 s29, s14, 2
    s_add_u32 s29, s29, 32
    s_lshl_b32 s29, s29, 10
    s_add_u32 s29, s29, s19
    s_and_b32 s30, s14, 1
    s_lshl_b32 s30, s30, 3
    s_add_u32 s29, s29, s30
    s_bfe_u32 s30, s14, 0x10001
    v_lshrrev_b32 v9, 1, v5
    v_cmp_eq_u32 vcc, s30, v9
    v_mov_b32 v9, 0x7f000000
    s_nop 0
    v_cndmask_b32 v9, v9, v3, vcc
    v_cndmask_b32 v136, v136, v8, s[20:21]
    v_cndmask_b32 v137, v137, v8, s[22:23]
    v_cndmask_b32 v138, v138, v8, s[24:25]
    v_cndmask_b32 v139, v139, v8, s[26:27]
    v_max3_f32 v16, v136, v137, v138
    v_max3_f32 v16, v16, v139, v140
    v_max3_f32 v16, v16, v141, v142
    v_max_f32 v16, v16, v143
    v_mov_b32 v17, v16
    s_nop 1
    v_permlane16_swap_b32 v17, v16
    v_max_f32 v16, v16, v17
    v_mov_b32 v17, v16
    s_nop 1
    v_permlane32_swap_b32 v17, v16
    v_max_f32 v16, v16, v17
    v_sub_f32 v136, v136, v16
    v_sub_f32 v137, v137, v16
    v_sub_f32 v138, v138, v16
    v_sub_f32 v139, v139, v16
    v_sub_f32 v140, v140, v16
    v_sub_f32 v141, v141, v16
    v_sub_f32 v142, v142, v16
    v_sub_f32 v143, v143, v16
    v_mul_f32 v136, s18, v136
    v_mul_f32 v137, s18, v137
    v_mul_f32 v138, s18, v138
    v_mul_f32 v139, s18, v139
    v_mul_f32 v140, s18, v140
    v_mul_f32 v141, s18, v141
    v_mul_f32 v142, s18, v142
    v_mul_f32 v143, s18, v143
    v_exp_f32 v136, v136
    v_exp_f32 v137, v137
    v_exp_f32 v138, v138
    v_exp_f32 v139, v139
    v_exp_f32 v140, v140
    v_exp_f32 v141, v141
    v_exp_f32 v142, v142
    v_exp_f32 v143, v143
    v_add_f32 v18, v140, v141
    v_add_f32 v18, v18, v142
    v_add_f32 v18, v18, v143
    v_mul_f32 v18, 0.5, v18
    v_add_f32 v18, v18, v136
    v_add_f32 v18, v18, v137
    v_add_f32 v18, v18, v138
    v_add_f32 v18, v18, v139
    v_mov_b32 v17, v18
    s_nop 1
    v_permlane16_swap_b32 v17, v18
    v_add_f32 v18, v18, v17
    v_mov_b32 v17, v18
    s_nop 1
    v_permlane32_swap_b32 v17, v18
    v_add_f32 v18, v18, v17
    v_rcp_f32 v18, v18
    s_nop 0
    v_mul_f32 v136, v136, v18
    v_mul_f32 v137, v137, v18
    v_mul_f32 v138, v138, v18
    v_mul_f32 v139, v139, v18
    v_mul_f32 v140, v140, v18
    v_mul_f32 v141, v141, v18
    v_mul_f32 v142, v142, v18
    v_mul_f32 v143, v143, v18
    v_cvt_pk_bf16_f32 v20, v136, 0
    v_cvt_pk_bf16_f32 v21, v137, 0
    v_cvt_pk_bf16_f32 v22, v138, 0
    v_cvt_pk_bf16_f32 v23, v139, 0
    v_cvt_pk_bf16_f32 v24, v140, v141
    v_cvt_pk_bf16_f32 v25, v142, v143
    buffer_store_dwordx4 v[20:23], v3, s[8:11], s28 offen sc1
    buffer_store_dwordx2 v[24:25], v9, s[8:11], s29 offen sc1
    s_add_u32 s28, s28, 40960
    s_add_u32 s29, s29, 40960
    v_cndmask_b32 v148, v148, v8, s[20:21]
    v_cndmask_b32 v149, v149, v8, s[22:23]
    v_cndmask_b32 v150, v150, v8, s[24:25]
    v_cndmask_b32 v151, v151, v8, s[26:27]
    v_max3_f32 v16, v144, v145, v146
    v_max3_f32 v16, v16, v147, v148
    v_max3_f32 v16, v16, v149, v150
    v_max3_f32 v16, v16, v151, v152
    v_max3_f32 v16, v16, v153, v154
    v_max_f32 v16, v16, v155
    v_mov_b32 v17, v16
    s_nop 1
    v_permlane16_swap_b32 v17, v16
    v_max_f32 v16, v16, v17
    v_mov_b32 v17, v16
    s_nop 1
    v_permlane32_swap_b32 v17, v16
    v_max_f32 v16, v16, v17
    v_sub_f32 v144, v144, v16
    v_sub_f32 v145, v145, v16
    v_sub_f32 v146, v146, v16
    v_sub_f32 v147, v147, v16
    v_sub_f32 v148, v148, v16
    v_sub_f32 v149, v149, v16
    v_sub_f32 v150, v150, v16
    v_sub_f32 v151, v151, v16
    v_sub_f32 v152, v152, v16
    v_sub_f32 v153, v153, v16
    v_sub_f32 v154, v154, v16
    v_sub_f32 v155, v155, v16
    v_mul_f32 v144, s18, v144
    v_mul_f32 v145, s18, v145
    v_mul_f32 v146, s18, v146
    v_mul_f32 v147, s18, v147
    v_mul_f32 v148, s18, v148
    v_mul_f32 v149, s18, v149
    v_mul_f32 v150, s18, v150
    v_mul_f32 v151, s18, v151
    v_mul_f32 v152, s18, v152
    v_mul_f32 v153, s18, v153
    v_mul_f32 v154, s18, v154
    v_mul_f32 v155, s18, v155
    v_exp_f32 v144, v144
    v_exp_f32 v145, v145
    v_exp_f32 v146, v146
    v_exp_f32 v147, v147
    v_exp_f32 v148, v148
    v_exp_f32 v149, v149
    v_exp_f32 v150, v150
    v_exp_f32 v151, v151
    v_exp_f32 v152, v152
    v_exp_f32 v153, v153
    v_exp_f32 v154, v154
    v_exp_f32 v155, v155
    v_add_f32 v18, v152, v153
    v_add_f32 v18, v18, v154
    v_add_f32 v18, v18, v155
    v_mul_f32 v18, 0.5, v18
    v_add_f32 v18, v18, v144
    v_add_f32 v18, v18, v145
    v_add_f32 v18, v18, v146
    v_add_f32 v18, v18, v147
    v_add_f32 v18, v18, v148
    v_add_f32 v18, v18, v149
    v_add_f32 v18, v18, v150
    v_add_f32 v18, v18, v151
    v_mov_b32 v17, v18
    s_nop 1
    v_permlane16_swap_b32 v17, v18
    v_add_f32 v18, v18, v17
    v_mov_b32 v17, v18
    s_nop 1
    v_permlane32_swap_b32 v17, v18
    v_add_f32 v18, v18, v17
    v_rcp_f32 v18, v18
    s_nop 0
    v_mul_f32 v144, v144, v18
    v_mul_f32 v145, v145, v18
    v_mul_f32 v146, v146, v18
    v_mul_f32 v147, v147, v18
    v_mul_f32 v148, v148, v18
    v_mul_f32 v149, v149, v18
    v_mul_f32 v150, v150, v18
    v_mul_f32 v151, v151, v18
    v_mul_f32 v152, v152, v18
    v_mul_f32 v153, v153, v18
    v_mul_f32 v154, v154, v18
    v_mul_f32 v155, v155, v18
    v_cvt_pk_bf16_f32 v28, v144, v148
    v_cvt_pk_bf16_f32 v29, v145, v149
    v_cvt_pk_bf16_f32 v30, v146, v150
    v_cvt_pk_bf16_f32 v31, v147, v151
    v_cvt_pk_bf16_f32 v32, v152, v153
    v_cvt_pk_bf16_f32 v33, v154, v155
    buffer_store_dwordx4 v[28:31], v3, s[8:11], s28 offen sc1
    buffer_store_dwordx2 v[32:33], v9, s[8:11], s29 offen sc1
    s_lshl_b32 s15, s13, 7
    s_and_b32 s16, s2, 7
    s_lshl_b32 s16, s16, 2
    s_add_u32 s15, s15, s16
    s_add_u32 s15, s15, 0xe28d000
    s_waitcnt vmcnt(0) lgkmcnt(0)
    s_barrier
    v_mov_b32 v1, 0x7f000000
    v_cmp_eq_u32 vcc, 0, v0
    s_nop 1
    v_cndmask_b32 v1, v1, v0, vcc
    v_mov_b32 v2, 1
    buffer_store_dword v2, v1, s[8:11], s15 offen sc1
    s_branch w_next
pb_entry:
    s_mov_b32 s80, 0
    s_load_dwordx2 s[8:9], s[0:1], 112
    s_load_dwordx2 s[12:13], s[0:1], 0
    s_load_dwordx2 s[16:17], s[0:1], 96
    s_waitcnt lgkmcnt(0)
    s_and_b32 s9, s9, 0xffff
    s_mov_b32 s10, 0x10000000
    s_mov_b32 s11, 0x00020000
    s_and_b32 s13, s13, 0xffff
    s_mov_b32 s14, 0x280000
    s_mov_b32 s15, 0x00020000
    s_and_b32 s17, s17, 0xffff
    s_mov_b32 s18, 0x280000
    s_mov_b32 s19, 0x00020000
    v_and_b32 v1, 63, v0
    v_lshrrev_b32 v2, 6, v0
    s_nop 0
    v_readfirstlane_b32 s20, v2
    v_lshlrev_b32 v3, 4, v1
    v_and_b32 v4, 15, v1
    v_lshrrev_b32 v5, 4, v1
    s_mul_i32 s21, s2, 6554
    s_lshr_b32 s21, s21, 16
    s_mul_i32 s22, s21, 10
    s_sub_u32 s22, s2, s22
    s_lshr_b32 s23, s21, 3
    s_lshl_b32 s23, s23, 7
    v_and_b32 v6, 31, v1
    v_lshlrev_b32 v6, 2, v6
    s_cmp_ge_u32 s22, 6
    s_cselect_b32 s24, 0x2000, 0
    s_lshr_b32 s25, s21, 2
    s_lshl_b32 s25, s25, 7
    s_add_u32 s24, s24, s25
    v_add_u32 v6, s24, v6
    v_and_b32 v7, 3, v1
    v_lshlrev_b32 v7, 2, v7
    s_add_u32 s24, s23, 0x2800
    v_add_u32 v7, s24, v7
    v_cmp_gt_u32 vcc, 32, v1
    s_nop 1
    v_cndmask_b32 v6, v6, v7, vcc
    v_and_b32 v8, 7, v1
    v_lshlrev_b32 v8, 2, v8
    s_lshl_b32 s24, s21, 7
    s_add_u32 s24, s24, 0xd000
    v_add_u32 v8, s24, v8
    v_mul_u32_u24 v10, 10, v1
    v_add_u32 v10, s22, v10
    v_and_b32 v10, 0x1fc, v10
    s_lshl_b32 s24, s21, 9
    s_add_u32 s24, s24, 0x5000
    v_add_u32 v10, s24, v10
    v_cndmask_b32 v10, v8, v10, vcc
    s_mov_b32 s34, 0xe280000
    s_mov_b32 s25, 0
wf2_55:
    buffer_load_dword v7, v6, s[8:11], s34 offen sc1
    buffer_load_dword v8, v10, s[8:11], s34 offen sc1
    s_add_u32 s25, s25, 1
    s_cmp_gt_u32 s25, 2097152
    s_cbranch_scc1 rec_fail
    s_waitcnt vmcnt(0)
    v_cmp_eq_u32 vcc, 0, v7
    s_cbranch_vccz wf2d_56
    s_sleep 8
    s_branch wf2_55
    s_nop 1
wf2d_56:
    v_cmp_eq_u32 vcc, 0, v8
    s_mov_b32 s35, 1
    s_cbranch_vccz Lskip_57
    s_mov_b32 s35, 0
Lskip_57:
    s_mul_i32 s23, s21, 81920
    s_add_u32 s23, s23, 0xca00000
    s_lshl_b32 s24, s20, 13
    s_add_u32 s24, s24, s23
    s_lshl_b32 s25, s20, 11
    s_add_u32 s25, s25, s23
    s_add_u32 s25, s25, 32768
    s_lshl_b32 s26, s21, 5
    s_lshl_b32 s27, s20, 3
    s_add_u32 s26, s26, s27
    s_mul_i32 s26, s26, 40
    s_lshl_b32 s27, s22, 2
    s_add_u32 s26, s26, s27
    s_lshl_b32 s26, s26, 10
    s_add_u32 s26, s26, 0x4000000
    s_mul_i32 s28, s21, 327680
    s_mul_i32 s29, s20, 81920
    s_add_u32 s28, s28, s29
    s_lshl_b32 s29, s22, 10
    s_add_u32 s28, s28, s29
    s_add_u32 s28, s28, 0xb600000
    v_lshrrev_b32 v6, 1, v5
    v_mul_u32_u24 v6, 20480, v6
    v_lshl_add_u32 v6, v4, 4, v6
    v_and_b32 v7, 1, v5
    v_lshl_add_u32 v6, v7, 3, v6
    s_waitcnt vmcnt(6)
    s_add_u32 s30, s26, 0
    buffer_load_dwordx4 a[0:3], v3, s[8:11], s30 offen offset:0 sc1
    buffer_load_dwordx4 a[4:7], v3, s[8:11], s30 offen offset:1024 sc1
    buffer_load_dwordx4 a[8:11], v3, s[8:11], s30 offen offset:2048 sc1
    buffer_load_dwordx4 a[12:15], v3, s[8:11], s30 offen offset:3072 sc1
    s_waitcnt vmcnt(6)
    s_add_u32 s30, s26, 40960
    buffer_load_dwordx4 a[16:19], v3, s[8:11], s30 offen offset:0 sc1
    buffer_load_dwordx4 a[20:23], v3, s[8:11], s30 offen offset:1024 sc1
    buffer_load_dwordx4 a[24:27], v3, s[8:11], s30 offen offset:2048 sc1
    buffer_load_dwordx4 a[28:31], v3, s[8:11], s30 offen offset:3072 sc1
    s_waitcnt vmcnt(6)
    s_add_u32 s30, s26, 81920
    buffer_load_dwordx4 a[32:35], v3, s[8:11], s30 offen offset:0 sc1
    buffer_load_dwordx4 a[36:39], v3, s[8:11], s30 offen offset:1024 sc1
    buffer_load_dwordx4 a[40:43], v3, s[8:11], s30 offen offset:2048 sc1
    buffer_load_dwordx4 a[44:47], v3, s[8:11], s30 offen offset:3072 sc1
    s_waitcnt vmcnt(6)
    s_add_u32 s30, s26, 122880
    buffer_load_dwordx4 a[48:51], v3, s[8:11], s30 offen offset:0 sc1
    buffer_load_dwordx4 a[52:55], v3, s[8:11], s30 offen offset:1024 sc1
    buffer_load_dwordx4 a[56:59], v3, s[8:11], s30 offen offset:2048 sc1
    buffer_load_dwordx4 a[60:63], v3, s[8:11], s30 offen offset:3072 sc1
    s_waitcnt vmcnt(6)
    s_add_u32 s30, s26, 163840
    buffer_load_dwordx4 a[64:67], v3, s[8:11], s30 offen offset:0 sc1
    buffer_load_dwordx4 a[68:71], v3, s[8:11], s30 offen offset:1024 sc1
    buffer_load_dwordx4 a[72:75], v3, s[8:11], s30 offen offset:2048 sc1
    buffer_load_dwordx4 a[76:79], v3, s[8:11], s30 offen offset:3072 sc1
    s_waitcnt vmcnt(6)
    s_add_u32 s30, s26, 204800
    buffer_load_dwordx4 a[80:83], v3, s[8:11], s30 offen offset:0 sc1
    buffer_load_dwordx4 a[84:87], v3, s[8:11], s30 offen offset:1024 sc1
    buffer_load_dwordx4 a[88:91], v3, s[8:11], s30 offen offset:2048 sc1
    buffer_load_dwordx4 a[92:95], v3, s[8:11], s30 offen offset:3072 sc1
    s_waitcnt vmcnt(6)
    s_add_u32 s30, s26, 245760
    buffer_load_dwordx4 a[96:99], v3, s[8:11], s30 offen offset:0 sc1
    buffer_load_dwordx4 a[100:103], v3, s[8:11], s30 offen offset:1024 sc1
    buffer_load_dwordx4 a[104:107], v3, s[8:11], s30 offen offset:2048 sc1
    buffer_load_dwordx4 a[108:111], v3, s[8:11], s30 offen offset:3072 sc1
    s_waitcnt vmcnt(6)
    s_add_u32 s30, s26, 286720
    buffer_load_dwordx4 a[112:115], v3, s[8:11], s30 offen offset:0 sc1
    buffer_load_dwordx4 a[116:119], v3, s[8:11], s30 offen offset:1024 sc1
    buffer_load_dwordx4 a[120:123], v3, s[8:11], s30 offen offset:2048 sc1
    buffer_load_dwordx4 a[124:127], v3, s[8:11], s30 offen offset:3072 sc1
    s_cmp_eq_u32 s35, 1
    s_cbranch_scc1 pb_p
    s_mov_b32 s30, 0
wf_58:
    buffer_load_dword v7, v10, s[8:11], s34 offen sc1
    s_add_u32 s30, s30, 1
    s_cmp_gt_u32 s30, 2097152
    s_cbranch_scc1 rec_fail
    s_waitcnt vmcnt(0)
    v_cmp_eq_u32 vcc, 0, v7
    s_cbranch_vccz wfd_59
    s_sleep 3
    s_branch wf_58
    s_nop 1
wfd_59:
pb_p:
    s_waitcnt vmcnt(6)
    s_add_u32 s30, s24, 0
    buffer_load_dwordx4 v[16:19], v3, s[8:11], s30 offen sc1
    s_add_u32 s30, s24, 40960
    buffer_load_dwordx4 v[20:23], v3, s[8:11], s30 offen sc1
    s_waitcnt vmcnt(6)
    s_add_u32 s30, s24, 1024
    buffer_load_dwordx4 v[24:27], v3, s[8:11], s30 offen sc1
    s_add_u32 s30, s24, 41984
    buffer_load_dwordx4 v[28:31], v3, s[8:11], s30 offen sc1
    s_waitcnt vmcnt(6)
    s_add_u32 s30, s24, 2048
    buffer_load_dwordx4 v[32:35], v3, s[8:11], s30 offen sc1
    s_add_u32 s30, s24, 43008
    buffer_load_dwordx4 v[36:39], v3, s[8:11], s30 offen sc1
    s_waitcnt vmcnt(6)
    s_add_u32 s30, s24, 3072
    buffer_load_dwordx4 v[40:43], v3, s[8:11], s30 offen sc1
    s_add_u32 s30, s24, 44032
    buffer_load_dwordx4 v[44:47], v3, s[8:11], s30 offen sc1
    s_waitcnt vmcnt(6)
    s_add_u32 s30, s24, 4096
    buffer_load_dwordx4 v[48:51], v3, s[8:11], s30 offen sc1
    s_add_u32 s30, s24, 45056
    buffer_load_dwordx4 v[52:55], v3, s[8:11], s30 offen sc1
    s_waitcnt vmcnt(6)
    s_add_u32 s30, s24, 5120
    buffer_load_dwordx4 v[56:59], v3, s[8:11], s30 offen sc1
    s_add_u32 s30, s24, 46080
    buffer_load_dwordx4 v[60:63], v3, s[8:11], s30 offen sc1
    s_waitcnt vmcnt(6)
    s_add_u32 s30, s24, 6144
    buffer_load_dwordx4 v[64:67], v3, s[8:11], s30 offen sc1
    s_add_u32 s30, s24, 47104
    buffer_load_dwordx4 v[68:71], v3, s[8:11], s30 offen sc1
    s_waitcnt vmcnt(6)
    s_add_u32 s30, s24, 7168
    buffer_load_dwordx4 v[72:75], v3, s[8:11], s30 offen sc1
    s_add_u32 s30, s24, 48128
    buffer_load_dwordx4 v[76:79], v3, s[8:11], s30 offen sc1
    s_waitcnt vmcnt(6)
    s_add_u32 s30, s25, 0
    buffer_load_dwordx4 v[80:83], v3, s[8:11], s30 offen sc1
    s_add_u32 s30, s25, 40960
    buffer_load_dwordx4 v[84:87], v3, s[8:11], s30 offen sc1
    s_add_u32 s30, s28, 0
    buffer_load_dwordx2 a[128:129], v6, s[8:11], s30 offen offset:0 sc1
    buffer_load_dwordx2 a[132:133], v6, s[8:11], s30 offen offset:256 sc1
    buffer_load_dwordx2 a[136:137], v6, s[8:11], s30 offen offset:512 sc1
    buffer_load_dwordx2 a[140:141], v6, s[8:11], s30 offen offset:768 sc1
    s_add_u32 s30, s28, 10240
    buffer_load_dwordx2 a[130:131], v6, s[8:11], s30 offen offset:0 sc1
    buffer_load_dwordx2 a[134:135], v6, s[8:11], s30 offen offset:256 sc1
    buffer_load_dwordx2 a[138:139], v6, s[8:11], s30 offen offset:512 sc1
    buffer_load_dwordx2 a[142:143], v6, s[8:11], s30 offen offset:768 sc1
    s_waitcnt vmcnt(6)
    s_add_u32 s30, s25, 1024
    buffer_load_dwordx4 v[88:91], v3, s[8:11], s30 offen sc1
    s_add_u32 s30, s25, 41984
    buffer_load_dwordx4 v[92:95], v3, s[8:11], s30 offen sc1
    s_waitcnt vmcnt(40)
    s_add_u32 s30, s28, 40960
    buffer_load_dwordx2 a[144:145], v6, s[8:11], s30 offen offset:0 sc1
    buffer_load_dwordx2 a[148:149], v6, s[8:11], s30 offen offset:256 sc1
    buffer_load_dwordx2 a[152:153], v6, s[8:11], s30 offen offset:512 sc1
    buffer_load_dwordx2 a[156:157], v6, s[8:11], s30 offen offset:768 sc1
    s_add_u32 s30, s28, 51200
    buffer_load_dwordx2 a[146:147], v6, s[8:11], s30 offen offset:0 sc1
    buffer_load_dwordx2 a[150:151], v6, s[8:11], s30 offen offset:256 sc1
    buffer_load_dwordx2 a[154:155], v6, s[8:11], s30 offen offset:512 sc1
    buffer_load_dwordx2 a[158:159], v6, s[8:11], s30 offen offset:768 sc1
    s_waitcnt vmcnt(34)
    v_mfma_f32_16x16x32_bf16 v[96:99], a[0:3], v[16:19], 0
    v_mfma_f32_16x16x32_bf16 v[100:103], a[0:3], v[20:23], 0
    v_mfma_f32_16x16x32_bf16 v[104:107], a[4:7], v[16:19], 0
    v_mfma_f32_16x16x32_bf16 v[108:111], a[4:7], v[20:23], 0
    v_mfma_f32_16x16x32_bf16 v[112:115], a[8:11], v[16:19], 0
    v_mfma_f32_16x16x32_bf16 v[116:119], a[8:11], v[20:23], 0
    v_mfma_f32_16x16x32_bf16 v[120:123], a[12:15], v[16:19], 0
    v_mfma_f32_16x16x32_bf16 v[124:127], a[12:15], v[20:23], 0
    s_waitcnt vmcnt(32)
    v_mfma_f32_16x16x32_bf16 v[96:99], a[16:19], v[24:27], v[96:99]
    v_mfma_f32_16x16x32_bf16 v[100:103], a[16:19], v[28:31], v[100:103]
    v_mfma_f32_16x16x32_bf16 v[104:107], a[20:23], v[24:27], v[104:107]
    v_mfma_f32_16x16x32_bf16 v[108:111], a[20:23], v[28:31], v[108:111]
    v_mfma_f32_16x16x32_bf16 v[112:115], a[24:27], v[24:27], v[112:115]
    v_mfma_f32_16x16x32_bf16 v[116:119], a[24:27], v[28:31], v[116:119]
    v_mfma_f32_16x16x32_bf16 v[120:123], a[28:31], v[24:27], v[120:123]
    v_mfma_f32_16x16x32_bf16 v[124:127], a[28:31], v[28:31], v[124:127]
    s_waitcnt vmcnt(30)
    v_mfma_f32_16x16x32_bf16 v[96:99], a[32:35], v[32:35], v[96:99]
    v_mfma_f32_16x16x32_bf16 v[100:103], a[32:35], v[36:39], v[100:103]
    v_mfma_f32_16x16x32_bf16 v[104:107], a[36:39], v[32:35], v[104:107]
    v_mfma_f32_16x16x32_bf16 v[108:111], a[36:39], v[36:39], v[108:111]
    v_mfma_f32_16x16x32_bf16 v[112:115], a[40:43], v[32:35], v[112:115]
    v_mfma_f32_16x16x32_bf16 v[116:119], a[40:43], v[36:39], v[116:119]
    v_mfma_f32_16x16x32_bf16 v[120:123], a[44:47], v[32:35], v[120:123]
    v_mfma_f32_16x16x32_bf16 v[124:127], a[44:47], v[36:39], v[124:127]
    s_waitcnt vmcnt(28)
    v_mfma_f32_16x16x32_bf16 v[96:99], a[48:51], v[40:43], v[96:99]
    v_mfma_f32_16x16x32_bf16 v[100:103], a[48:51], v[44:47], v[100:103]
    v_mfma_f32_16x16x32_bf16 v[104:107], a[52:55], v[40:43], v[104:107]
    v_mfma_f32_16x16x32_bf16 v[108:111], a[52:55], v[44:47], v[108:111]
    v_mfma_f32_16x16x32_bf16 v[112:115], a[56:59], v[40:43], v[112:115]
    v_mfma_f32_16x16x32_bf16 v[116:119], a[56:59], v[44:47], v[116:119]
    v_mfma_f32_16x16x32_bf16 v[120:123], a[60:63], v[40:43], v[120:123]
    v_mfma_f32_16x16x32_bf16 v[124:127], a[60:63], v[44:47], v[124:127]
    s_waitcnt vmcnt(26)
    v_mfma_f32_16x16x32_bf16 v[96:99], a[64:67], v[48:51], v[96:99]
    v_mfma_f32_16x16x32_bf16 v[100:103], a[64:67], v[52:55], v[100:103]
    v_mfma_f32_16x16x32_bf16 v[104:107], a[68:71], v[48:51], v[104:107]
    v_mfma_f32_16x16x32_bf16 v[108:111], a[68:71], v[52:55], v[108:111]
    v_mfma_f32_16x16x32_bf16 v[112:115], a[72:75], v[48:51], v[112:115]
    v_mfma_f32_16x16x32_bf16 v[116:119], a[72:75], v[52:55], v[116:119]
    v_mfma_f32_16x16x32_bf16 v[120:123], a[76:79], v[48:51], v[120:123]
    v_mfma_f32_16x16x32_bf16 v[124:127], a[76:79], v[52:55], v[124:127]
    s_waitcnt vmcnt(24)
    v_mfma_f32_16x16x32_bf16 v[96:99], a[80:83], v[56:59], v[96:99]
    v_mfma_f32_16x16x32_bf16 v[100:103], a[80:83], v[60:63], v[100:103]
    v_mfma_f32_16x16x32_bf16 v[104:107], a[84:87], v[56:59], v[104:107]
    v_mfma_f32_16x16x32_bf16 v[108:111], a[84:87], v[60:63], v[108:111]
    v_mfma_f32_16x16x32_bf16 v[112:115], a[88:91], v[56:59], v[112:115]
    v_mfma_f32_16x16x32_bf16 v[116:119], a[88:91], v[60:63], v[116:119]
    v_mfma_f32_16x16x32_bf16 v[120:123], a[92:95], v[56:59], v[120:123]
    v_mfma_f32_16x16x32_bf16 v[124:127], a[92:95], v[60:63], v[124:127]
    s_waitcnt vmcnt(22)
    v_mfma_f32_16x16x32_bf16 v[96:99], a[96:99], v[64:67], v[96:99]
    v_mfma_f32_16x16x32_bf16 v[100:103], a[96:99], v[68:71], v[100:103]
    v_mfma_f32_16x16x32_bf16 v[104:107], a[100:103], v[64:67], v[104:107]
    v_mfma_f32_16x16x32_bf16 v[108:111], a[100:103], v[68:71], v[108:111]
    v_mfma_f32_16x16x32_bf16 v[112:115], a[104:107], v[64:67], v[112:115]
    v_mfma_f32_16x16x32_bf16 v[116:119], a[104:107], v[68:71], v[116:119]
    v_mfma_f32_16x16x32_bf16 v[120:123], a[108:111], v[64:67], v[120:123]
    v_mfma_f32_16x16x32_bf16 v[124:127], a[108:111], v[68:71], v[124:127]
    s_waitcnt vmcnt(20)
    v_mfma_f32_16x16x32_bf16 v[96:99], a[112:115], v[72:75], v[96:99]
    v_mfma_f32_16x16x32_bf16 v[100:103], a[112:115], v[76:79], v[100:103]
    v_mfma_f32_16x16x32_bf16 v[104:107], a[116:119], v[72:75], v[104:107]
    v_mfma_f32_16x16x32_bf16 v[108:111], a[116:119], v[76:79], v[108:111]
    v_mfma_f32_16x16x32_bf16 v[112:115], a[120:123], v[72:75], v[112:115]
    v_mfma_f32_16x16x32_bf16 v[116:119], a[120:123], v[76:79], v[116:119]
    v_mfma_f32_16x16x32_bf16 v[120:123], a[124:127], v[72:75], v[120:123]
    v_mfma_f32_16x16x32_bf16 v[124:127], a[124:127], v[76:79], v[124:127]
    s_waitcnt vmcnt(10)
    v_mfma_f32_16x16x32_bf16 v[96:99], a[128:131], v[80:83], v[96:99]
    v_mfma_f32_16x16x32_bf16 v[100:103], a[128:131], v[84:87], v[100:103]
    v_mfma_f32_16x16x32_bf16 v[104:107], a[132:135], v[80:83], v[104:107]
    v_mfma_f32_16x16x32_bf16 v[108:111], a[132:135], v[84:87], v[108:111]
    v_mfma_f32_16x16x32_bf16 v[112:115], a[136:139], v[80:83], v[112:115]
    v_mfma_f32_16x16x32_bf16 v[116:119], a[136:139], v[84:87], v[116:119]
    v_mfma_f32_16x16x32_bf16 v[120:123], a[140:143], v[80:83], v[120:123]
    v_mfma_f32_16x16x32_bf16 v[124:127], a[140:143], v[84:87], v[124:127]
    s_waitcnt vmcnt(0)
    v_mfma_f32_16x16x32_bf16 v[96:99], a[144:147], v[88:91], v[96:99]
    v_mfma_f32_16x16x32_bf16 v[100:103], a[144:147], v[92:95], v[100:103]
    v_mfma_f32_16x16x32_bf16 v[104:107], a[148:151], v[88:91], v[104:107]
    v_mfma_f32_16x16x32_bf16 v[108:111], a[148:151], v[92:95], v[108:111]
    v_mfma_f32_16x16x32_bf16 v[112:115], a[152:155], v[88:91], v[112:115]
    v_mfma_f32_16x16x32_bf16 v[116:119], a[152:155], v[92:95], v[116:119]
    v_mfma_f32_16x16x32_bf16 v[120:123], a[156:159], v[88:91], v[120:123]
    v_mfma_f32_16x16x32_bf16 v[124:127], a[156:159], v[92:95], v[124:127]
    s_lshl_b32 s27, s22, 2
    s_add_u32 s27, s27, s20
    s_mul_i32 s30, s21, 80
    s_add_u32 s30, s30, s27
    s_lshl_b32 s30, s30, 9
    s_add_u32 s30, s30, 0x500000
    s_add_u32 s31, s30, 20480
    v_lshlrev_b32 v6, 3, v1
    v_mul_u32_u24 v7, 1280, v4
    v_lshl_add_u32 v7, v5, 3, v7
    s_mul_i32 s32, s21, 40960
    s_lshl_b32 s33, s27, 5
    s_add_u32 s32, s32, s33
    s_add_u32 s33, s32, 20480
    buffer_load_dwordx2 v[8:9], v6, s[8:11], s30 offen sc1
    buffer_load_dwordx2 v[10:11], v6, s[8:11], s31 offen sc1
    buffer_load_dwordx2 v[12:13], v7, s[12:15], s32 offen
    buffer_load_dwordx2 v[14:15], v7, s[12:15], s33 offen
    v_lshl_add_u32 v16, v2, 13, v3
    ds_write_b128 v16, v[96:99] offset:0
    ds_write_b128 v16, v[100:103] offset:1024
    ds_write_b128 v16, v[104:107] offset:2048
    ds_write_b128 v16, v[108:111] offset:3072
    ds_write_b128 v16, v[112:115] offset:4096
    ds_write_b128 v16, v[116:119] offset:5120
    ds_write_b128 v16, v[120:123] offset:6144
    ds_write_b128 v16, v[124:127] offset:7168
    s_waitcnt lgkmcnt(0)
    s_barrier
    v_lshl_add_u32 v16, v2, 11, v3
    ds_read_b128 v[20:23], v16 offset:0
    ds_read_b128 v[24:27], v16 offset:8192
    ds_read_b128 v[28:31], v16 offset:16384
    ds_read_b128 v[32:35], v16 offset:24576
    ds_read_b128 v[36:39], v16 offset:1024
    ds_read_b128 v[40:43], v16 offset:9216
    ds_read_b128 v[44:47], v16 offset:17408
    ds_read_b128 v[48:51], v16 offset:25600
    s_waitcnt lgkmcnt(0) vmcnt(0)
    v_add_f32 v20, v20, v24
    v_add_f32 v28, v28, v32
    v_add_f32 v21, v21, v25
    v_add_f32 v29, v29, v33
    v_add_f32 v22, v22, v26
    v_add_f32 v30, v30, v34
    v_add_f32 v23, v23, v27
    v_add_f32 v31, v31, v35
    v_add_f32 v20, v20, v28
    v_add_f32 v21, v21, v29
    v_add_f32 v22, v22, v30
    v_add_f32 v23, v23, v31
    v_cvt_pk_bf16_f32 v24, v20, v21
    v_cvt_pk_bf16_f32 v25, v22, v23
    v_lshlrev_b32 v20, 16, v24
    v_and_b32 v21, 0xffff0000, v24
    v_lshlrev_b32 v22, 16, v25
    v_and_b32 v23, 0xffff0000, v25
    v_lshlrev_b32 v28, 16, v8
    v_and_b32 v29, 0xffff0000, v8
    v_lshlrev_b32 v30, 16, v9
    v_and_b32 v31, 0xffff0000, v9
    v_mul_f32 v20, v20, v28
    v_mul_f32 v21, v21, v29
    v_mul_f32 v22, v22, v30
    v_mul_f32 v23, v23, v31
    v_cvt_pk_bf16_f32 v24, v20, v21
    v_cvt_pk_bf16_f32 v25, v22, v23
    v_lshlrev_b32 v20, 16, v24
    v_and_b32 v21, 0xffff0000, v24
    v_lshlrev_b32 v22, 16, v25
    v_and_b32 v23, 0xffff0000, v25
    v_lshlrev_b32 v28, 16, v12
    v_and_b32 v29, 0xffff0000, v12
    v_lshlrev_b32 v30, 16, v13
    v_and_b32 v31, 0xffff0000, v13
    v_add_f32 v20, v20, v28
    v_add_f32 v21, v21, v29
    v_add_f32 v22, v22, v30
    v_add_f32 v23, v23, v31
    v_cvt_pk_bf16_f32 v24, v20, v21
    v_cvt_pk_bf16_f32 v25, v22, v23
    buffer_store_dwordx2 v[24:25], v7, s[16:19], s32 offen
    v_add_f32 v36, v36, v40
    v_add_f32 v44, v44, v48
    v_add_f32 v37, v37, v41
    v_add_f32 v45, v45, v49
    v_add_f32 v38, v38, v42
    v_add_f32 v46, v46, v50
    v_add_f32 v39, v39, v43
    v_add_f32 v47, v47, v51
    v_add_f32 v36, v36, v44
    v_add_f32 v37, v37, v45
    v_add_f32 v38, v38, v46
    v_add_f32 v39, v39, v47
    v_cvt_pk_bf16_f32 v40, v36, v37
    v_cvt_pk_bf16_f32 v41, v38, v39
    v_lshlrev_b32 v36, 16, v40
    v_and_b32 v37, 0xffff0000, v40
    v_lshlrev_b32 v38, 16, v41
    v_and_b32 v39, 0xffff0000, v41
    v_lshlrev_b32 v44, 16, v10
    v_and_b32 v45, 0xffff0000, v10
    v_lshlrev_b32 v46, 16, v11
    v_and_b32 v47, 0xffff0000, v11
    v_mul_f32 v36, v36, v44
    v_mul_f32 v37, v37, v45
    v_mul_f32 v38, v38, v46
    v_mul_f32 v39, v39, v47
    v_cvt_pk_bf16_f32 v40, v36, v37
    v_cvt_pk_bf16_f32 v41, v38, v39
    v_lshlrev_b32 v36, 16, v40
    v_and_b32 v37, 0xffff0000, v40
    v_lshlrev_b32 v38, 16, v41
    v_and_b32 v39, 0xffff0000, v41
    v_lshlrev_b32 v44, 16, v14
    v_and_b32 v45, 0xffff0000, v14
    v_lshlrev_b32 v46, 16, v15
    v_and_b32 v47, 0xffff0000, v15
    v_add_f32 v36, v36, v44
    v_add_f32 v37, v37, v45
    v_add_f32 v38, v38, v46
    v_add_f32 v39, v39, v47
    v_cvt_pk_bf16_f32 v40, v36, v37
    v_cvt_pk_bf16_f32 v41, v38, v39
    buffer_store_dwordx2 v[40:41], v7, s[16:19], s33 offen
    s_barrier
    s_branch w_next
rec_entry:
    s_mov_b32 s24, s97
    s_load_dwordx2 s[8:9], s[0:1], 112
    s_load_dwordx2 s[12:13], s[0:1], 16
    s_load_dwordx2 s[16:17], s[0:1], 24
    s_load_dwordx2 s[20:21], s[0:1], 104
    s_load_dwordx2 s[76:77], s[0:1], 8
    s_waitcnt lgkmcnt(0)
    s_and_b32 s9, s9, 0xffff
    s_mov_b32 s10, 0x10000000
    s_mov_b32 s11, 0x00020000
    s_and_b32 s13, s13, 0xffff
    s_mov_b32 s14, 0x780000
    s_mov_b32 s15, 0x00020000
    s_and_b32 s17, s17, 0xffff
    s_mov_b32 s18, 0x780000
    s_mov_b32 s19, 0x00020000
    s_and_b32 s21, s21, 0xffff
    s_mov_b32 s22, 0x100
    s_mov_b32 s23, 0x00020000
    s_and_b32 s77, s77, 0xffff
    s_mov_b32 s78, 0x2800
    s_mov_b32 s79, 0x00020000
    s_getreg_b32 s27, hwreg(HW_REG_XCC_ID)
    s_and_b32 s27, s27, 3
    s_lshl_b32 s27, s27, 16
    s_mov_b32 s26, 0
    s_mov_b32 s86, 3
    s_mov_b32 s87, 0
    v_and_b32 v1, 63, v0
    v_lshrrev_b32 v2, 6, v0
    s_nop 0
    v_readfirstlane_b32 s25, v2
    v_lshlrev_b32 v3, 4, v1
    v_and_b32 v4, 15, v1
    v_lshrrev_b32 v5, 4, v1
    v_mov_b32 v6, 0x4444
    v_mov_b32 v7, 0xeeee
    v_and_b32 v8, 2, v4
    v_cmp_eq_u32 vcc, 0, v8
    s_nop 1
    v_cndmask_b32 v6, v7, v6, vcc
    v_lshlrev_b32 v7, 8, v5
    v_lshl_add_u32 v7, v8, 6, v7
    v_lshrrev_b32 v8, 2, v4
    v_lshl_add_u32 v7, v8, 5, v7
    v_and_b32 v8, 1, v4
    v_lshl_add_u32 v7, v8, 4, v7
    v_lshl_add_u32 v8, v2, 10, v3
    v_lshlrev_b32 v10, 3, v1
    v_lshl_add_u32 v10, v2, 9, v10
    v_add_u32 v9, 0x4000, v10
    s_cmp_ge_u32 s24, 32
    s_cbranch_scc1 rec_col
    s_cmp_lg_u32 s25, 0
    s_cbranch_scc1 sc_nocal
    s_and_b32 s72, s24, 1
    s_lshl_b32 s72, s72, 21
    s_lshr_b32 s30, s24, 1
    s_mul_i32 s30, s30, 0x10180
    s_add_u32 s72, s72, s30
    v_mov_b32 v16, 0
    s_mov_b32 s70, -1
    s_mov_b32 s71, -1
    s_add_u32 s31, s72, 0xd000000
    s_memtime s[64:65]
    s_waitcnt lgkmcnt(0)
    buffer_load_dword v17, v16, s[8:11], s31 offen sc1
    s_waitcnt vmcnt(0)
    s_memtime s[66:67]
    s_waitcnt lgkmcnt(0)
    s_sub_u32 s68, s66, s64
    s_cmp_lt_u32 s68, 340
    s_cselect_b32 s68, -1, s68
    s_min_u32 s70, s70, s68
    s_add_u32 s31, s72, 0xd002000
    s_memtime s[64:65]
    s_waitcnt lgkmcnt(0)
    buffer_load_dword v17, v16, s[8:11], s31 offen sc1
    s_waitcnt vmcnt(0)
    s_memtime s[66:67]
    s_waitcnt lgkmcnt(0)
    s_sub_u32 s68, s66, s64
    s_cmp_lt_u32 s68, 340
    s_cselect_b32 s68, -1, s68
    s_min_u32 s71, s71, s68
    s_add_u32 s31, s72, 0xd004000
    s_memtime s[64:65]
    s_waitcnt lgkmcnt(0)
    buffer_load_dword v17, v16, s[8:11], s31 offen sc1
    s_waitcnt vmcnt(0)
    s_memtime s[66:67]
    s_waitcnt lgkmcnt(0)
    s_sub_u32 s68, s66, s64
    s_cmp_lt_u32 s68, 340
    s_cselect_b32 s68, -1, s68
    s_min_u32 s70, s70, s68
    s_add_u32 s31, s72, 0xd006000
    s_memtime s[64:65]
    s_waitcnt lgkmcnt(0)
    buffer_load_dword v17, v16, s[8:11], s31 offen sc1
    s_waitcnt vmcnt(0)
    s_memtime s[66:67]
    s_waitcnt lgkmcnt(0)
    s_sub_u32 s68, s66, s64
    s_cmp_lt_u32 s68, 340
    s_cselect_b32 s68, -1, s68
    s_min_u32 s71, s71, s68
    s_add_u32 s31, s72, 0xd008000
    s_memtime s[64:65]
    s_waitcnt lgkmcnt(0)
    buffer_load_dword v17, v16, s[8:11], s31 offen sc1
    s_waitcnt vmcnt(0)
    s_memtime s[66:67]
    s_waitcnt lgkmcnt(0)
    s_sub_u32 s68, s66, s64
    s_cmp_lt_u32 s68, 340
    s_cselect_b32 s68, -1, s68
    s_min_u32 s70, s70, s68
    s_add_u32 s31, s72, 0xd00a000
    s_memtime s[64:65]
    s_waitcnt lgkmcnt(0)
    buffer_load_dword v17, v16, s[8:11], s31 offen sc1
    s_waitcnt vmcnt(0)
    s_memtime s[66:67]
    s_waitcnt lgkmcnt(0)
    s_sub_u32 s68, s66, s64
    s_cmp_lt_u32 s68, 340
    s_cselect_b32 s68, -1, s68
    s_min_u32 s71, s71, s68
    s_add_u32 s31, s72, 0xd00c000
    s_memtime s[64:65]
    s_waitcnt lgkmcnt(0)
    buffer_load_dword v17, v16, s[8:11], s31 offen sc1
    s_waitcnt vmcnt(0)
    s_memtime s[66:67]
    s_waitcnt lgkmcnt(0)
    s_sub_u32 s68, s66, s64
    s_cmp_lt_u32 s68, 340
    s_cselect_b32 s68, -1, s68
    s_min_u32 s70, s70, s68
    s_add_u32 s31, s72, 0xd00e000
    s_memtime s[64:65]
    s_waitcnt lgkmcnt(0)
    buffer_load_dword v17, v16, s[8:11], s31 offen sc1
    s_waitcnt vmcnt(0)
    s_memtime s[66:67]
    s_waitcnt lgkmcnt(0)
    s_sub_u32 s68, s66, s64
    s_cmp_lt_u32 s68, 340
    s_cselect_b32 s68, -1, s68
    s_min_u32 s71, s71, s68
    s_cmp_lt_u32 s71, s70
    s_cselect_b32 s30, 1, 0
    s_add_u32 s30, s30, 256
    s_and_b32 s31, s24, 1
    s_lshl_b32 s31, s31, 2
    s_add_u32 s31, s31, 8
    v_mov_b32 v16, 0x7f000000
    v_cmp_eq_u32 vcc, 0, v0
    s_nop 1
    v_cndmask_b32 v16, v16, v0, vcc
    v_mov_b32 v17, s30
    buffer_atomic_add v17, v16, s[20:23], s31 offen
    s_nop 0
sc_nocal:
    v_add_u32 v16, 0, v1
    v_mul_u32_u24 v17, 2731, v16
    v_lshrrev_b32 v17, 16, v17
    v_mul_u32_u24 v18, 24, v17
    v_sub_u32 v18, v16, v18
    v_lshrrev_b32 v19, 1, v18
    v_bfe_u32 v20, v17, 1, 2
    v_xor_b32 v19, v19, v20
    v_lshlrev_b32 v19, 5, v19
    v_and_b32 v18, 1, v18
    v_lshl_add_u32 v19, v18, 4, v19
    v_lshl_add_u32 v17, v2, 4, v17
    v_mul_u32_u24 v17, 12288, v17
    v_add_u32 v11, v17, v19
    v_add_u32 v16, 64, v1
    v_mul_u32_u24 v17, 2731, v16
    v_lshrrev_b32 v17, 16, v17
    v_mul_u32_u24 v18, 24, v17
    v_sub_u32 v18, v16, v18
    v_lshrrev_b32 v19, 1, v18
    v_bfe_u32 v20, v17, 1, 2
    v_xor_b32 v19, v19, v20
    v_lshlrev_b32 v19, 5, v19
    v_and_b32 v18, 1, v18
    v_lshl_add_u32 v19, v18, 4, v19
    v_lshl_add_u32 v17, v2, 4, v17
    v_mul_u32_u24 v17, 12288, v17
    v_add_u32 v12, v17, v19
    v_add_u32 v16, 128, v1
    v_mul_u32_u24 v17, 2731, v16
    v_lshrrev_b32 v17, 16, v17
    v_mul_u32_u24 v18, 24, v17
    v_sub_u32 v18, v16, v18
    v_lshrrev_b32 v19, 1, v18
    v_bfe_u32 v20, v17, 1, 2
    v_xor_b32 v19, v19, v20
    v_lshlrev_b32 v19, 5, v19
    v_and_b32 v18, 1, v18
    v_lshl_add_u32 v19, v18, 4, v19
    v_lshl_add_u32 v17, v2, 4, v17
    v_mul_u32_u24 v17, 12288, v17
    v_add_u32 v13, v17, v19
    v_lshrrev_b32 v16, 1, v5
    v_lshlrev_b32 v16, 4, v16
    v_and_b32 v17, 1, v5
    v_lshl_add_u32 v16, v17, 2, v16
    v_bfe_u32 v18, v1, 3, 1
    v_lshl_add_u32 v16, v18, 3, v16
    v_bfe_u32 v18, v1, 2, 1
    v_add_u32 v16, v16, v18
    v_and_b32 v18, 3, v1
    v_mov_b32 v19, v2
    v_lshl_add_u32 v26, v17, 1, 0
    v_add_u32 v27, 0, v19
    v_xor_b32 v27, v27, v26
    v_lshlrev_b32 v27, 5, v27
    v_lshl_add_u32 v27, v18, 3, v27
    v_add_u32 v26, 0, v16
    v_mul_u32_u24 v26, 384, v26
    v_add_u32 v20, v26, v27
    v_lshl_add_u32 v26, v17, 1, 1
    v_add_u32 v27, 0, v19
    v_xor_b32 v27, v27, v26
    v_lshlrev_b32 v27, 5, v27
    v_lshl_add_u32 v27, v18, 3, v27
    v_add_u32 v26, 2, v16
    v_mul_u32_u24 v26, 384, v26
    v_add_u32 v21, v26, v27
    v_lshl_add_u32 v26, v17, 1, 0
    v_add_u32 v27, 4, v19
    v_xor_b32 v27, v27, v26
    v_lshlrev_b32 v27, 5, v27
    v_lshl_add_u32 v27, v18, 3, v27
    v_add_u32 v26, 0, v16
    v_mul_u32_u24 v26, 384, v26
    v_add_u32 v22, v26, v27
    v_lshl_add_u32 v26, v17, 1, 1
    v_add_u32 v27, 4, v19
    v_xor_b32 v27, v27, v26
    v_lshlrev_b32 v27, 5, v27
    v_lshl_add_u32 v27, v18, 3, v27
    v_add_u32 v26, 2, v16
    v_mul_u32_u24 v26, 384, v26
    v_add_u32 v23, v26, v27
    v_lshl_add_u32 v26, v17, 1, 0
    v_add_u32 v27, 8, v19
    v_xor_b32 v27, v27, v26
    v_lshlrev_b32 v27, 5, v27
    v_lshl_add_u32 v27, v18, 3, v27
    v_add_u32 v26, 0, v16
    v_mul_u32_u24 v26, 384, v26
    v_add_u32 v24, v26, v27
    v_lshl_add_u32 v26, v17, 1, 1
    v_add_u32 v27, 8, v19
    v_xor_b32 v27, v27, v26
    v_lshlrev_b32 v27, 5, v27
    v_lshl_add_u32 v27, v18, 3, v27
    v_add_u32 v26, 2, v16
    v_mul_u32_u24 v26, 384, v26
    v_add_u32 v25, v26, v27
    s_mul_i32 s40, s24, 384
    s_mul_i32 s30, s25, 6144
    s_add_u32 m0, s30, 0
    s_add_u32 s31, s40, 0
    s_add_u32 s32, s31, 98304
    buffer_load_dwordx4 v11, s[12:15], s31 offen lds
    s_add_u32 m0, m0, 1024
    s_nop 0
    buffer_load_dwordx4 v12, s[12:15], s31 offen lds
    s_add_u32 m0, m0, 1024
    s_nop 0
    buffer_load_dwordx4 v13, s[12:15], s31 offen lds
    s_add_u32 m0, m0, 1024
    s_nop 0
    buffer_load_dwordx4 v11, s[12:15], s32 offen lds
    s_add_u32 m0, m0, 1024
    s_nop 0
    buffer_load_dwordx4 v12, s[12:15], s32 offen lds
    s_add_u32 m0, m0, 1024
    s_nop 0
    buffer_load_dwordx4 v13, s[12:15], s32 offen lds
    s_mul_i32 s30, s25, 6144
    s_add_u32 m0, s30, 24576
    s_add_u32 s31, s40, 0
    s_add_u32 s32, s31, 98304
    buffer_load_dwordx4 v11, s[16:19], s31 offen lds
    s_add_u32 m0, m0, 1024
    s_nop 0
    buffer_load_dwordx4 v12, s[16:19], s31 offen lds
    s_add_u32 m0, m0, 1024
    s_nop 0
    buffer_load_dwordx4 v13, s[16:19], s31 offen lds
    s_add_u32 m0, m0, 1024
    s_nop 0
    buffer_load_dwordx4 v11, s[16:19], s32 offen lds
    s_add_u32 m0, m0, 1024
    s_nop 0
    buffer_load_dwordx4 v12, s[16:19], s32 offen lds
    s_add_u32 m0, m0, 1024
    s_nop 0
    buffer_load_dwordx4 v13, s[16:19], s32 offen lds
    s_mul_i32 s30, s25, 6144
    s_add_u32 m0, s30, 49152
    s_add_u32 s31, s40, 786432
    s_add_u32 s32, s31, 98304
    buffer_load_dwordx4 v11, s[12:15], s31 offen lds
    s_add_u32 m0, m0, 1024
    s_nop 0
    buffer_load_dwordx4 v12, s[12:15], s31 offen lds
    s_add_u32 m0, m0, 1024
    s_nop 0
    buffer_load_dwordx4 v13, s[12:15], s31 offen lds
    s_add_u32 m0, m0, 1024
    s_nop 0
    buffer_load_dwordx4 v11, s[12:15], s32 offen lds
    s_add_u32 m0, m0, 1024
    s_nop 0
    buffer_load_dwordx4 v12, s[12:15], s32 offen lds
    s_add_u32 m0, m0, 1024
    s_nop 0
    buffer_load_dwordx4 v13, s[12:15], s32 offen lds
    s_mul_i32 s30, s25, 6144
    s_add_u32 m0, s30, 73728
    s_add_u32 s31, s40, 786432
    s_add_u32 s32, s31, 98304
    buffer_load_dwordx4 v11, s[16:19], s31 offen lds
    s_add_u32 m0, m0, 1024
    s_nop 0
    buffer_load_dwordx4 v12, s[16:19], s31 offen lds
    s_add_u32 m0, m0, 1024
    s_nop 0
    buffer_load_dwordx4 v13, s[16:19], s31 offen lds
    s_add_u32 m0, m0, 1024
    s_nop 0
    buffer_load_dwordx4 v11, s[16:19], s32 offen lds
    s_add_u32 m0, m0, 1024
    s_nop 0
    buffer_load_dwordx4 v12, s[16:19], s32 offen lds
    s_add_u32 m0, m0, 1024
    s_nop 0
    buffer_load_dwordx4 v13, s[16:19], s32 offen lds
    s_waitcnt vmcnt(12)
    s_barrier
    ds_read_b64_tr_b16 a[0:1], v20 offset:0
    ds_read_b64_tr_b16 a[2:3], v21 offset:0
    ds_read_b64_tr_b16 a[4:5], v20 offset:12288
    ds_read_b64_tr_b16 a[6:7], v21 offset:12288
    ds_read_b64_tr_b16 a[64:65], v22 offset:0
    ds_read_b64_tr_b16 a[66:67], v23 offset:0
    ds_read_b64_tr_b16 a[68:69], v22 offset:12288
    ds_read_b64_tr_b16 a[70:71], v23 offset:12288
    ds_read_b64_tr_b16 a[128:129], v24 offset:0
    ds_read_b64_tr_b16 a[130:131], v25 offset:0
    ds_read_b64_tr_b16 a[132:133], v24 offset:12288
    ds_read_b64_tr_b16 a[134:135], v25 offset:12288
    ds_read_b64_tr_b16 a[192:193], v20 offset:24576
    ds_read_b64_tr_b16 a[194:195], v21 offset:24576
    ds_read_b64_tr_b16 a[196:197], v20 offset:36864
    ds_read_b64_tr_b16 a[198:199], v21 offset:36864
    ds_read_b64_tr_b16 v[128:129], v22 offset:24576
    ds_read_b64_tr_b16 v[130:131], v23 offset:24576
    ds_read_b64_tr_b16 v[132:133], v22 offset:36864
    ds_read_b64_tr_b16 v[134:135], v23 offset:36864
    ds_read_b64_tr_b16 v[192:193], v24 offset:24576
    ds_read_b64_tr_b16 v[194:195], v25 offset:24576
    ds_read_b64_tr_b16 v[196:197], v24 offset:36864
    ds_read_b64_tr_b16 v[198:199], v25 offset:36864
    s_waitcnt lgkmcnt(0)
    s_barrier
    s_mul_i32 s30, s25, 6144
    s_add_u32 m0, s30, 0
    s_add_u32 s31, s40, 1572864
    s_add_u32 s32, s31, 98304
    buffer_load_dwordx4 v11, s[12:15], s31 offen lds
    s_add_u32 m0, m0, 1024
    s_nop 0
    buffer_load_dwordx4 v12, s[12:15], s31 offen lds
    s_add_u32 m0, m0, 1024
    s_nop 0
    buffer_load_dwordx4 v13, s[12:15], s31 offen lds
    s_add_u32 m0, m0, 1024
    s_nop 0
    buffer_load_dwordx4 v11, s[12:15], s32 offen lds
    s_add_u32 m0, m0, 1024
    s_nop 0
    buffer_load_dwordx4 v12, s[12:15], s32 offen lds
    s_add_u32 m0, m0, 1024
    s_nop 0
    buffer_load_dwordx4 v13, s[12:15], s32 offen lds
    s_mul_i32 s30, s25, 6144
    s_add_u32 m0, s30, 24576
    s_add_u32 s31, s40, 1572864
    s_add_u32 s32, s31, 98304
    buffer_load_dwordx4 v11, s[16:19], s31 offen lds
    s_add_u32 m0, m0, 1024
    s_nop 0
    buffer_load_dwordx4 v12, s[16:19], s31 offen lds
    s_add_u32 m0, m0, 1024
    s_nop 0
    buffer_load_dwordx4 v13, s[16:19], s31 offen lds
    s_add_u32 m0, m0, 1024
    s_nop 0
    buffer_load_dwordx4 v11, s[16:19], s32 offen lds
    s_add_u32 m0, m0, 1024
    s_nop 0
    buffer_load_dwordx4 v12, s[16:19], s32 offen lds
    s_add_u32 m0, m0, 1024
    s_nop 0
    buffer_load_dwordx4 v13, s[16:19], s32 offen lds
    s_waitcnt vmcnt(12)
    s_barrier
    ds_read_b64_tr_b16 a[8:9], v20 offset:49152
    ds_read_b64_tr_b16 a[10:11], v21 offset:49152
    ds_read_b64_tr_b16 a[12:13], v20 offset:61440
    ds_read_b64_tr_b16 a[14:15], v21 offset:61440
    ds_read_b64_tr_b16 a[72:73], v22 offset:49152
    ds_read_b64_tr_b16 a[74:75], v23 offset:49152
    ds_read_b64_tr_b16 a[76:77], v22 offset:61440
    ds_read_b64_tr_b16 a[78:79], v23 offset:61440
    ds_read_b64_tr_b16 a[136:137], v24 offset:49152
    ds_read_b64_tr_b16 a[138:139], v25 offset:49152
    ds_read_b64_tr_b16 a[140:141], v24 offset:61440
    ds_read_b64_tr_b16 a[142:143], v25 offset:61440
    v_add_u32 v26, 73728, v20
    ds_read_b64_tr_b16 a[200:201], v26
    v_add_u32 v26, 73728, v21
    ds_read_b64_tr_b16 a[202:203], v26
    v_add_u32 v26, 86016, v20
    ds_read_b64_tr_b16 a[204:205], v26
    v_add_u32 v26, 86016, v21
    ds_read_b64_tr_b16 a[206:207], v26
    v_add_u32 v26, 73728, v22
    ds_read_b64_tr_b16 v[136:137], v26
    v_add_u32 v26, 73728, v23
    ds_read_b64_tr_b16 v[138:139], v26
    v_add_u32 v26, 86016, v22
    ds_read_b64_tr_b16 v[140:141], v26
    v_add_u32 v26, 86016, v23
    ds_read_b64_tr_b16 v[142:143], v26
    v_add_u32 v26, 73728, v24
    ds_read_b64_tr_b16 v[200:201], v26
    v_add_u32 v26, 73728, v25
    ds_read_b64_tr_b16 v[202:203], v26
    v_add_u32 v26, 86016, v24
    ds_read_b64_tr_b16 v[204:205], v26
    v_add_u32 v26, 86016, v25
    ds_read_b64_tr_b16 v[206:207], v26
    s_waitcnt lgkmcnt(0)
    s_barrier
    s_mul_i32 s30, s25, 6144
    s_add_u32 m0, s30, 49152
    s_add_u32 s31, s40, 2359296
    s_add_u32 s32, s31, 98304
    buffer_load_dwordx4 v11, s[12:15], s31 offen lds
    s_add_u32 m0, m0, 1024
    s_nop 0
    buffer_load_dwordx4 v12, s[12:15], s31 offen lds
    s_add_u32 m0, m0, 1024
    s_nop 0
    buffer_load_dwordx4 v13, s[12:15], s31 offen lds
    s_add_u32 m0, m0, 1024
    s_nop 0
    buffer_load_dwordx4 v11, s[12:15], s32 offen lds
    s_add_u32 m0, m0, 1024
    s_nop 0
    buffer_load_dwordx4 v12, s[12:15], s32 offen lds
    s_add_u32 m0, m0, 1024
    s_nop 0
    buffer_load_dwordx4 v13, s[12:15], s32 offen lds
    s_mul_i32 s30, s25, 6144
    s_add_u32 m0, s30, 73728
    s_add_u32 s31, s40, 2359296
    s_add_u32 s32, s31, 98304
    buffer_load_dwordx4 v11, s[16:19], s31 offen lds
    s_add_u32 m0, m0, 1024
    s_nop 0
    buffer_load_dwordx4 v12, s[16:19], s31 offen lds
    s_add_u32 m0, m0, 1024
    s_nop 0
    buffer_load_dwordx4 v13, s[16:19], s31 offen lds
    s_add_u32 m0, m0, 1024
    s_nop 0
    buffer_load_dwordx4 v11, s[16:19], s32 offen lds
    s_add_u32 m0, m0, 1024
    s_nop 0
    buffer_load_dwordx4 v12, s[16:19], s32 offen lds
    s_add_u32 m0, m0, 1024
    s_nop 0
    buffer_load_dwordx4 v13, s[16:19], s32 offen lds
    s_waitcnt vmcnt(12)
    s_barrier
    ds_read_b64_tr_b16 a[16:17], v20 offset:0
    ds_read_b64_tr_b16 a[18:19], v21 offset:0
    ds_read_b64_tr_b16 a[20:21], v20 offset:12288
    ds_read_b64_tr_b16 a[22:23], v21 offset:12288
    ds_read_b64_tr_b16 a[80:81], v22 offset:0
    ds_read_b64_tr_b16 a[82:83], v23 offset:0
    ds_read_b64_tr_b16 a[84:85], v22 offset:12288
    ds_read_b64_tr_b16 a[86:87], v23 offset:12288
    ds_read_b64_tr_b16 a[144:145], v24 offset:0
    ds_read_b64_tr_b16 a[146:147], v25 offset:0
    ds_read_b64_tr_b16 a[148:149], v24 offset:12288
    ds_read_b64_tr_b16 a[150:151], v25 offset:12288
    ds_read_b64_tr_b16 a[208:209], v20 offset:24576
    ds_read_b64_tr_b16 a[210:211], v21 offset:24576
    ds_read_b64_tr_b16 a[212:213], v20 offset:36864
    ds_read_b64_tr_b16 a[214:215], v21 offset:36864
    ds_read_b64_tr_b16 v[144:145], v22 offset:24576
    ds_read_b64_tr_b16 v[146:147], v23 offset:24576
    ds_read_b64_tr_b16 v[148:149], v22 offset:36864
    ds_read_b64_tr_b16 v[150:151], v23 offset:36864
    ds_read_b64_tr_b16 v[208:209], v24 offset:24576
    ds_read_b64_tr_b16 v[210:211], v25 offset:24576
    ds_read_b64_tr_b16 v[212:213], v24 offset:36864
    ds_read_b64_tr_b16 v[214:215], v25 offset:36864
    s_waitcnt lgkmcnt(0)
    s_barrier
    v_mov_b32 v96, 0
    s_mov_b32 s33, 0
    s_nop 0
wc_60:
    buffer_load_dword v97, v96, s[20:23], 0 offen offset:8 sc1
    s_add_u32 s33, s33, 1
    s_cmp_gt_u32 s33, 2097152
    s_cbranch_scc1 rec_fail
    s_waitcnt vmcnt(0)
    v_cmp_gt_u32 vcc, 4096, v97
    s_cbranch_vccz wcd_61
    s_sleep 4
    s_branch wc_60
    s_nop 1
wcd_61:
    v_readfirstlane_b32 s34, v97
    s_nop 0
    s_and_b32 s34, s34, 0xff
    s_cmp_gt_u32 s34, 8
    s_cselect_b32 s34, 0x2000, 0
    s_add_u32 s34, s34, 0xd000000
    s_lshr_b32 s30, s24, 3
    s_lshl_b32 s30, s30, 16
    s_bfe_u32 s31, s24, 0x20001
    s_lshl_b32 s31, s31, 14
    s_add_u32 s30, s30, s31
    s_and_b32 s31, s24, 1
    s_lshl_b32 s31, s31, 12
    s_add_u32 s41, s30, s31
    v_lshlrev_b32 v99, 4, v0
    s_and_b32 s30, s24, 7
    s_lshl_b32 s30, s30, 8
    v_mov_b32 v96, v0
    v_add_u32 v96, s30, v96
    v_and_b32 v97, 7, v96
    v_mul_u32_u24 v97, 1280, v97
    v_lshrrev_b32 v98, 3, v96
    v_lshl_add_u32 v97, v98, 4, v97
    v_cmp_gt_u32 vcc, 640, v96
    v_mov_b32 v98, 0x7f000000
    s_nop 0
    v_cndmask_b32 v97, v98, v97, vcc
    buffer_load_dwordx4 v[32:35], v97, s[76:79], 0 offen
    v_mov_b32 v36, -1
    v_mov_b32 v37, -1
    v_mov_b32 v38, -1
    v_mov_b32 v39, -1
    s_add_u32 s30, s34, s41
    s_add_u32 s31, s30, 0x40000
    buffer_store_dwordx4 v[36:39], v99, s[8:11], s31 offen sc1
    s_add_u32 s31, s30, 0x80000
    buffer_store_dwordx4 v[36:39], v99, s[8:11], s31 offen sc1
    s_add_u32 s31, s30, 0xc0000
    buffer_store_dwordx4 v[36:39], v99, s[8:11], s31 offen sc1
    s_add_u32 s31, s30, 0x100000
    buffer_store_dwordx4 v[36:39], v99, s[8:11], s31 offen sc1
    s_add_u32 s31, s30, 0x140000
    buffer_store_dwordx4 v[36:39], v99, s[8:11], s31 offen sc1
    s_add_u32 s31, s30, 0x180000
    buffer_store_dwordx4 v[36:39], v99, s[8:11], s31 offen sc1
    s_add_u32 s31, s30, 0x1c0000
    buffer_store_dwordx4 v[36:39], v99, s[8:11], s31 offen sc1
    s_waitcnt vmcnt(7)
    v_min_u32 v32, 0xfffffffe, v32
    v_cndmask_b32 v32, v36, v32, vcc
    v_min_u32 v33, 0xfffffffe, v33
    v_cndmask_b32 v33, v36, v33, vcc
    v_min_u32 v34, 0xfffffffe, v34
    v_cndmask_b32 v34, v36, v34, vcc
    v_min_u32 v35, 0xfffffffe, v35
    v_cndmask_b32 v35, v36, v35, vcc
    buffer_store_dwordx4 v[32:35], v99, s[8:11], s30 offen sc1
    v_mov_b32 v96, 0
    s_mov_b32 s33, 0
    s_nop 0
wc_62:
    buffer_load_dword v97, v96, s[20:23], 0 offen offset:4 sc1
    s_add_u32 s33, s33, 1
    s_cmp_gt_u32 s33, 2097152
    s_cbranch_scc1 rec_fail
    s_waitcnt vmcnt(0)
    v_cmp_gt_u32 vcc, 16, v97
    s_cbranch_vccz wcd_63
    s_sleep 4
    s_branch wc_62
    s_nop 1
wcd_63:
    s_lshl_b32 s30, s24, 2
    s_add_u32 s30, s30, 0xe28f800
    s_waitcnt vmcnt(0) lgkmcnt(0)
    s_barrier
    v_mov_b32 v96, 0x7f000000
    v_cmp_eq_u32 vcc, 0, v0
    s_nop 1
    v_cndmask_b32 v96, v96, v0, vcc
    v_mov_b32 v97, 1
    buffer_store_dword v97, v96, s[8:11], s30 offen sc1
    s_mul_i32 s30, s25, 6144
    s_add_u32 m0, s30, 0
    s_add_u32 s31, s40, 3145728
    s_add_u32 s32, s31, 98304
    buffer_load_dwordx4 v11, s[12:15], s31 offen lds
    s_add_u32 m0, m0, 1024
    s_nop 0
    buffer_load_dwordx4 v12, s[12:15], s31 offen lds
    s_add_u32 m0, m0, 1024
    s_nop 0
    buffer_load_dwordx4 v13, s[12:15], s31 offen lds
    s_add_u32 m0, m0, 1024
    s_nop 0
    buffer_load_dwordx4 v11, s[12:15], s32 offen lds
    s_add_u32 m0, m0, 1024
    s_nop 0
    buffer_load_dwordx4 v12, s[12:15], s32 offen lds
    s_add_u32 m0, m0, 1024
    s_nop 0
    buffer_load_dwordx4 v13, s[12:15], s32 offen lds
    s_mul_i32 s30, s25, 6144
    s_add_u32 m0, s30, 24576
    s_add_u32 s31, s40, 3145728
    s_add_u32 s32, s31, 98304
    buffer_load_dwordx4 v11, s[16:19], s31 offen lds
    s_add_u32 m0, m0, 1024
    s_nop 0
    buffer_load_dwordx4 v12, s[16:19], s31 offen lds
    s_add_u32 m0, m0, 1024
    s_nop 0
    buffer_load_dwordx4 v13, s[16:19], s31 offen lds
    s_add_u32 m0, m0, 1024
    s_nop 0
    buffer_load_dwordx4 v11, s[16:19], s32 offen lds
    s_add_u32 m0, m0, 1024
    s_nop 0
    buffer_load_dwordx4 v12, s[16:19], s32 offen lds
    s_add_u32 m0, m0, 1024
    s_nop 0
    buffer_load_dwordx4 v13, s[16:19], s32 offen lds
    s_waitcnt vmcnt(12)
    s_barrier
    ds_read_b64_tr_b16 a[24:25], v20 offset:49152
    ds_read_b64_tr_b16 a[26:27], v21 offset:49152
    ds_read_b64_tr_b16 a[28:29], v20 offset:61440
    ds_read_b64_tr_b16 a[30:31], v21 offset:61440
    ds_read_b64_tr_b16 a[88:89], v22 offset:49152
    ds_read_b64_tr_b16 a[90:91], v23 offset:49152
    ds_read_b64_tr_b16 a[92:93], v22 offset:61440
    ds_read_b64_tr_b16 a[94:95], v23 offset:61440
    ds_read_b64_tr_b16 a[152:153], v24 offset:49152
    ds_read_b64_tr_b16 a[154:155], v25 offset:49152
    ds_read_b64_tr_b16 a[156:157], v24 offset:61440
    ds_read_b64_tr_b16 a[158:159], v25 offset:61440
    v_add_u32 v26, 73728, v20
    ds_read_b64_tr_b16 a[216:217], v26
    v_add_u32 v26, 73728, v21
    ds_read_b64_tr_b16 a[218:219], v26
    v_add_u32 v26, 86016, v20
    ds_read_b64_tr_b16 a[220:221], v26
    v_add_u32 v26, 86016, v21
    ds_read_b64_tr_b16 a[222:223], v26
    v_add_u32 v26, 73728, v22
    ds_read_b64_tr_b16 v[152:153], v26
    v_add_u32 v26, 73728, v23
    ds_read_b64_tr_b16 v[154:155], v26
    v_add_u32 v26, 86016, v22
    ds_read_b64_tr_b16 v[156:157], v26
    v_add_u32 v26, 86016, v23
    ds_read_b64_tr_b16 v[158:159], v26
    v_add_u32 v26, 73728, v24
    ds_read_b64_tr_b16 v[216:217], v26
    v_add_u32 v26, 73728, v25
    ds_read_b64_tr_b16 v[218:219], v26
    v_add_u32 v26, 86016, v24
    ds_read_b64_tr_b16 v[220:221], v26
    v_add_u32 v26, 86016, v25
    ds_read_b64_tr_b16 v[222:223], v26
    s_waitcnt lgkmcnt(0)
    s_barrier
    s_mul_i32 s30, s25, 6144
    s_add_u32 m0, s30, 49152
    s_add_u32 s31, s40, 3932160
    s_add_u32 s32, s31, 98304
    buffer_load_dwordx4 v11, s[12:15], s31 offen lds
    s_add_u32 m0, m0, 1024
    s_nop 0
    buffer_load_dwordx4 v12, s[12:15], s31 offen lds
    s_add_u32 m0, m0, 1024
    s_nop 0
    buffer_load_dwordx4 v13, s[12:15], s31 offen lds
    s_add_u32 m0, m0, 1024
    s_nop 0
    buffer_load_dwordx4 v11, s[12:15], s32 offen lds
    s_add_u32 m0, m0, 1024
    s_nop 0
    buffer_load_dwordx4 v12, s[12:15], s32 offen lds
    s_add_u32 m0, m0, 1024
    s_nop 0
    buffer_load_dwordx4 v13, s[12:15], s32 offen lds
    s_mul_i32 s30, s25, 6144
    s_add_u32 m0, s30, 73728
    s_add_u32 s31, s40, 3932160
    s_add_u32 s32, s31, 98304
    buffer_load_dwordx4 v11, s[16:19], s31 offen lds
    s_add_u32 m0, m0, 1024
    s_nop 0
    buffer_load_dwordx4 v12, s[16:19], s31 offen lds
    s_add_u32 m0, m0, 1024
    s_nop 0
    buffer_load_dwordx4 v13, s[16:19], s31 offen lds
    s_add_u32 m0, m0, 1024
    s_nop 0
    buffer_load_dwordx4 v11, s[16:19], s32 offen lds
    s_add_u32 m0, m0, 1024
    s_nop 0
    buffer_load_dwordx4 v12, s[16:19], s32 offen lds
    s_add_u32 m0, m0, 1024
    s_nop 0
    buffer_load_dwordx4 v13, s[16:19], s32 offen lds
    s_waitcnt vmcnt(12)
    s_barrier
    ds_read_b64_tr_b16 a[32:33], v20 offset:0
    ds_read_b64_tr_b16 a[34:35], v21 offset:0
    ds_read_b64_tr_b16 a[36:37], v20 offset:12288
    ds_read_b64_tr_b16 a[38:39], v21 offset:12288
    ds_read_b64_tr_b16 a[96:97], v22 offset:0
    ds_read_b64_tr_b16 a[98:99], v23 offset:0
    ds_read_b64_tr_b16 a[100:101], v22 offset:12288
    ds_read_b64_tr_b16 a[102:103], v23 offset:12288
    ds_read_b64_tr_b16 a[160:161], v24 offset:0
    ds_read_b64_tr_b16 a[162:163], v25 offset:0
    ds_read_b64_tr_b16 a[164:165], v24 offset:12288
    ds_read_b64_tr_b16 a[166:167], v25 offset:12288
    ds_read_b64_tr_b16 a[224:225], v20 offset:24576
    ds_read_b64_tr_b16 a[226:227], v21 offset:24576
    ds_read_b64_tr_b16 a[228:229], v20 offset:36864
    ds_read_b64_tr_b16 a[230:231], v21 offset:36864
    ds_read_b64_tr_b16 v[160:161], v22 offset:24576
    ds_read_b64_tr_b16 v[162:163], v23 offset:24576
    ds_read_b64_tr_b16 v[164:165], v22 offset:36864
    ds_read_b64_tr_b16 v[166:167], v23 offset:36864
    ds_read_b64_tr_b16 v[224:225], v24 offset:24576
    ds_read_b64_tr_b16 v[226:227], v25 offset:24576
    ds_read_b64_tr_b16 v[228:229], v24 offset:36864
    ds_read_b64_tr_b16 v[230:231], v25 offset:36864
    s_waitcnt lgkmcnt(0)
    s_barrier
    s_mul_i32 s30, s25, 6144
    s_add_u32 m0, s30, 0
    s_add_u32 s31, s40, 4718592
    s_add_u32 s32, s31, 98304
    buffer_load_dwordx4 v11, s[12:15], s31 offen lds
    s_add_u32 m0, m0, 1024
    s_nop 0
    buffer_load_dwordx4 v12, s[12:15], s31 offen lds
    s_add_u32 m0, m0, 1024
    s_nop 0
    buffer_load_dwordx4 v13, s[12:15], s31 offen lds
    s_add_u32 m0, m0, 1024
    s_nop 0
    buffer_load_dwordx4 v11, s[12:15], s32 offen lds
    s_add_u32 m0, m0, 1024
    s_nop 0
    buffer_load_dwordx4 v12, s[12:15], s32 offen lds
    s_add_u32 m0, m0, 1024
    s_nop 0
    buffer_load_dwordx4 v13, s[12:15], s32 offen lds
    s_mul_i32 s30, s25, 6144
    s_add_u32 m0, s30, 24576
    s_add_u32 s31, s40, 4718592
    s_add_u32 s32, s31, 98304
    buffer_load_dwordx4 v11, s[16:19], s31 offen lds
    s_add_u32 m0, m0, 1024
    s_nop 0
    buffer_load_dwordx4 v12, s[16:19], s31 offen lds
    s_add_u32 m0, m0, 1024
    s_nop 0
    buffer_load_dwordx4 v13, s[16:19], s31 offen lds
    s_add_u32 m0, m0, 1024
    s_nop 0
    buffer_load_dwordx4 v11, s[16:19], s32 offen lds
    s_add_u32 m0, m0, 1024
    s_nop 0
    buffer_load_dwordx4 v12, s[16:19], s32 offen lds
    s_add_u32 m0, m0, 1024
    s_nop 0
    buffer_load_dwordx4 v13, s[16:19], s32 offen lds
    s_waitcnt vmcnt(12)
    s_barrier
    ds_read_b64_tr_b16 a[40:41], v20 offset:49152
    ds_read_b64_tr_b16 a[42:43], v21 offset:49152
    ds_read_b64_tr_b16 a[44:45], v20 offset:61440
    ds_read_b64_tr_b16 a[46:47], v21 offset:61440
    ds_read_b64_tr_b16 a[104:105], v22 offset:49152
    ds_read_b64_tr_b16 a[106:107], v23 offset:49152
    ds_read_b64_tr_b16 a[108:109], v22 offset:61440
    ds_read_b64_tr_b16 a[110:111], v23 offset:61440
    ds_read_b64_tr_b16 a[168:169], v24 offset:49152
    ds_read_b64_tr_b16 a[170:171], v25 offset:49152
    ds_read_b64_tr_b16 a[172:173], v24 offset:61440
    ds_read_b64_tr_b16 a[174:175], v25 offset:61440
    v_add_u32 v26, 73728, v20
    ds_read_b64_tr_b16 a[232:233], v26
    v_add_u32 v26, 73728, v21
    ds_read_b64_tr_b16 a[234:235], v26
    v_add_u32 v26, 86016, v20
    ds_read_b64_tr_b16 a[236:237], v26
    v_add_u32 v26, 86016, v21
    ds_read_b64_tr_b16 a[238:239], v26
    v_add_u32 v26, 73728, v22
    ds_read_b64_tr_b16 v[168:169], v26
    v_add_u32 v26, 73728, v23
    ds_read_b64_tr_b16 v[170:171], v26
    v_add_u32 v26, 86016, v22
    ds_read_b64_tr_b16 v[172:173], v26
    v_add_u32 v26, 86016, v23
    ds_read_b64_tr_b16 v[174:175], v26
    v_add_u32 v26, 73728, v24
    ds_read_b64_tr_b16 v[232:233], v26
    v_add_u32 v26, 73728, v25
    ds_read_b64_tr_b16 v[234:235], v26
    v_add_u32 v26, 86016, v24
    ds_read_b64_tr_b16 v[236:237], v26
    v_add_u32 v26, 86016, v25
    ds_read_b64_tr_b16 v[238:239], v26
    s_waitcnt lgkmcnt(0)
    s_barrier
    s_mul_i32 s30, s25, 6144
    s_add_u32 m0, s30, 49152
    s_add_u32 s31, s40, 5505024
    s_add_u32 s32, s31, 98304
    buffer_load_dwordx4 v11, s[12:15], s31 offen lds
    s_add_u32 m0, m0, 1024
    s_nop 0
    buffer_load_dwordx4 v12, s[12:15], s31 offen lds
    s_add_u32 m0, m0, 1024
    s_nop 0
    buffer_load_dwordx4 v13, s[12:15], s31 offen lds
    s_add_u32 m0, m0, 1024
    s_nop 0
    buffer_load_dwordx4 v11, s[12:15], s32 offen lds
    s_add_u32 m0, m0, 1024
    s_nop 0
    buffer_load_dwordx4 v12, s[12:15], s32 offen lds
    s_add_u32 m0, m0, 1024
    s_nop 0
    buffer_load_dwordx4 v13, s[12:15], s32 offen lds
    s_mul_i32 s30, s25, 6144
    s_add_u32 m0, s30, 73728
    s_add_u32 s31, s40, 5505024
    s_add_u32 s32, s31, 98304
    buffer_load_dwordx4 v11, s[16:19], s31 offen lds
    s_add_u32 m0, m0, 1024
    s_nop 0
    buffer_load_dwordx4 v12, s[16:19], s31 offen lds
    s_add_u32 m0, m0, 1024
    s_nop 0
    buffer_load_dwordx4 v13, s[16:19], s31 offen lds
    s_add_u32 m0, m0, 1024
    s_nop 0
    buffer_load_dwordx4 v11, s[16:19], s32 offen lds
    s_add_u32 m0, m0, 1024
    s_nop 0
    buffer_load_dwordx4 v12, s[16:19], s32 offen lds
    s_add_u32 m0, m0, 1024
    s_nop 0
    buffer_load_dwordx4 v13, s[16:19], s32 offen lds
    s_waitcnt vmcnt(12)
    s_barrier
    ds_read_b64_tr_b16 a[48:49], v20 offset:0
    ds_read_b64_tr_b16 a[50:51], v21 offset:0
    ds_read_b64_tr_b16 a[52:53], v20 offset:12288
    ds_read_b64_tr_b16 a[54:55], v21 offset:12288
    ds_read_b64_tr_b16 a[112:113], v22 offset:0
    ds_read_b64_tr_b16 a[114:115], v23 offset:0
    ds_read_b64_tr_b16 a[116:117], v22 offset:12288
    ds_read_b64_tr_b16 a[118:119], v23 offset:12288
    ds_read_b64_tr_b16 a[176:177], v24 offset:0
    ds_read_b64_tr_b16 a[178:179], v25 offset:0
    ds_read_b64_tr_b16 a[180:181], v24 offset:12288
    ds_read_b64_tr_b16 a[182:183], v25 offset:12288
    ds_read_b64_tr_b16 a[240:241], v20 offset:24576
    ds_read_b64_tr_b16 a[242:243], v21 offset:24576
    ds_read_b64_tr_b16 a[244:245], v20 offset:36864
    ds_read_b64_tr_b16 a[246:247], v21 offset:36864
    ds_read_b64_tr_b16 v[176:177], v22 offset:24576
    ds_read_b64_tr_b16 v[178:179], v23 offset:24576
    ds_read_b64_tr_b16 v[180:181], v22 offset:36864
    ds_read_b64_tr_b16 v[182:183], v23 offset:36864
    ds_read_b64_tr_b16 v[240:241], v24 offset:24576
    ds_read_b64_tr_b16 v[242:243], v25 offset:24576
    ds_read_b64_tr_b16 v[244:245], v24 offset:36864
    ds_read_b64_tr_b16 v[246:247], v25 offset:36864
    s_waitcnt lgkmcnt(0)
    s_barrier
    s_mul_i32 s30, s25, 6144
    s_add_u32 m0, s30, 0
    s_add_u32 s31, s40, 6291456
    s_add_u32 s32, s31, 98304
    buffer_load_dwordx4 v11, s[12:15], s31 offen lds
    s_add_u32 m0, m0, 1024
    s_nop 0
    buffer_load_dwordx4 v12, s[12:15], s31 offen lds
    s_add_u32 m0, m0, 1024
    s_nop 0
    buffer_load_dwordx4 v13, s[12:15], s31 offen lds
    s_add_u32 m0, m0, 1024
    s_nop 0
    buffer_load_dwordx4 v11, s[12:15], s32 offen lds
    s_add_u32 m0, m0, 1024
    s_nop 0
    buffer_load_dwordx4 v12, s[12:15], s32 offen lds
    s_add_u32 m0, m0, 1024
    s_nop 0
    buffer_load_dwordx4 v13, s[12:15], s32 offen lds
    s_mul_i32 s30, s25, 6144
    s_add_u32 m0, s30, 24576
    s_add_u32 s31, s40, 6291456
    s_add_u32 s32, s31, 98304
    buffer_load_dwordx4 v11, s[16:19], s31 offen lds
    s_add_u32 m0, m0, 1024
    s_nop 0
    buffer_load_dwordx4 v12, s[16:19], s31 offen lds
    s_add_u32 m0, m0, 1024
    s_nop 0
    buffer_load_dwordx4 v13, s[16:19], s31 offen lds
    s_add_u32 m0, m0, 1024
    s_nop 0
    buffer_load_dwordx4 v11, s[16:19], s32 offen lds
    s_add_u32 m0, m0, 1024
    s_nop 0
    buffer_load_dwordx4 v12, s[16:19], s32 offen lds
    s_add_u32 m0, m0, 1024
    s_nop 0
    buffer_load_dwordx4 v13, s[16:19], s32 offen lds
    s_waitcnt vmcnt(12)
    s_barrier
    ds_read_b64_tr_b16 a[56:57], v20 offset:49152
    ds_read_b64_tr_b16 a[58:59], v21 offset:49152
    ds_read_b64_tr_b16 a[60:61], v20 offset:61440
    ds_read_b64_tr_b16 a[62:63], v21 offset:61440
    ds_read_b64_tr_b16 a[120:121], v22 offset:49152
    ds_read_b64_tr_b16 a[122:123], v23 offset:49152
    ds_read_b64_tr_b16 a[124:125], v22 offset:61440
    ds_read_b64_tr_b16 a[126:127], v23 offset:61440
    ds_read_b64_tr_b16 a[184:185], v24 offset:49152
    ds_read_b64_tr_b16 a[186:187], v25 offset:49152
    ds_read_b64_tr_b16 a[188:189], v24 offset:61440
    ds_read_b64_tr_b16 a[190:191], v25 offset:61440
    v_add_u32 v26, 73728, v20
    ds_read_b64_tr_b16 a[248:249], v26
    v_add_u32 v26, 73728, v21
    ds_read_b64_tr_b16 a[250:251], v26
    v_add_u32 v26, 86016, v20
    ds_read_b64_tr_b16 a[252:253], v26
    v_add_u32 v26, 86016, v21
    ds_read_b64_tr_b16 a[254:255], v26
    v_add_u32 v26, 73728, v22
    ds_read_b64_tr_b16 v[184:185], v26
    v_add_u32 v26, 73728, v23
    ds_read_b64_tr_b16 v[186:187], v26
    v_add_u32 v26, 86016, v22
    ds_read_b64_tr_b16 v[188:189], v26
    v_add_u32 v26, 86016, v23
    ds_read_b64_tr_b16 v[190:191], v26
    v_add_u32 v26, 73728, v24
    ds_read_b64_tr_b16 v[248:249], v26
    v_add_u32 v26, 73728, v25
    ds_read_b64_tr_b16 v[250:251], v26
    v_add_u32 v26, 86016, v24
    ds_read_b64_tr_b16 v[252:253], v26
    v_add_u32 v26, 86016, v25
    ds_read_b64_tr_b16 v[254:255], v26
    s_waitcnt lgkmcnt(0)
    s_barrier
    s_mul_i32 s30, s25, 6144
    s_add_u32 m0, s30, 49152
    s_add_u32 s31, s40, 7077888
    s_add_u32 s32, s31, 98304
    buffer_load_dwordx4 v11, s[12:15], s31 offen lds
    s_add_u32 m0, m0, 1024
    s_nop 0
    buffer_load_dwordx4 v12, s[12:15], s31 offen lds
    s_add_u32 m0, m0, 1024
    s_nop 0
    buffer_load_dwordx4 v13, s[12:15], s31 offen lds
    s_add_u32 m0, m0, 1024
    s_nop 0
    buffer_load_dwordx4 v11, s[12:15], s32 offen lds
    s_add_u32 m0, m0, 1024
    s_nop 0
    buffer_load_dwordx4 v12, s[12:15], s32 offen lds
    s_add_u32 m0, m0, 1024
    s_nop 0
    buffer_load_dwordx4 v13, s[12:15], s32 offen lds
    s_mul_i32 s30, s25, 6144
    s_add_u32 m0, s30, 73728
    s_add_u32 s31, s40, 7077888
    s_add_u32 s32, s31, 98304
    buffer_load_dwordx4 v11, s[16:19], s31 offen lds
    s_add_u32 m0, m0, 1024
    s_nop 0
    buffer_load_dwordx4 v12, s[16:19], s31 offen lds
    s_add_u32 m0, m0, 1024
    s_nop 0
    buffer_load_dwordx4 v13, s[16:19], s31 offen lds
    s_add_u32 m0, m0, 1024
    s_nop 0
    buffer_load_dwordx4 v11, s[16:19], s32 offen lds
    s_add_u32 m0, m0, 1024
    s_nop 0
    buffer_load_dwordx4 v12, s[16:19], s32 offen lds
    s_add_u32 m0, m0, 1024
    s_nop 0
    buffer_load_dwordx4 v13, s[16:19], s32 offen lds
    s_waitcnt vmcnt(12)
    s_barrier
    ds_read_b64_tr_b16 v[32:33], v20 offset:0
    ds_read_b64_tr_b16 v[34:35], v21 offset:0
    ds_read_b64_tr_b16 v[36:37], v20 offset:12288
    ds_read_b64_tr_b16 v[38:39], v21 offset:12288
    ds_read_b64_tr_b16 v[48:49], v22 offset:0
    ds_read_b64_tr_b16 v[50:51], v23 offset:0
    ds_read_b64_tr_b16 v[52:53], v22 offset:12288
    ds_read_b64_tr_b16 v[54:55], v23 offset:12288
    ds_read_b64_tr_b16 v[64:65], v24 offset:0
    ds_read_b64_tr_b16 v[66:67], v25 offset:0
    ds_read_b64_tr_b16 v[68:69], v24 offset:12288
    ds_read_b64_tr_b16 v[70:71], v25 offset:12288
    ds_read_b64_tr_b16 v[80:81], v20 offset:24576
    ds_read_b64_tr_b16 v[82:83], v21 offset:24576
    ds_read_b64_tr_b16 v[84:85], v20 offset:36864
    ds_read_b64_tr_b16 v[86:87], v21 offset:36864
    ds_read_b64_tr_b16 v[96:97], v22 offset:24576
    ds_read_b64_tr_b16 v[98:99], v23 offset:24576
    ds_read_b64_tr_b16 v[100:101], v22 offset:36864
    ds_read_b64_tr_b16 v[102:103], v23 offset:36864
    ds_read_b64_tr_b16 v[112:113], v24 offset:24576
    ds_read_b64_tr_b16 v[114:115], v25 offset:24576
    ds_read_b64_tr_b16 v[116:117], v24 offset:36864
    ds_read_b64_tr_b16 v[118:119], v25 offset:36864
    s_waitcnt lgkmcnt(0)
    s_barrier
    s_waitcnt vmcnt(0)
    s_barrier
    ds_read_b64_tr_b16 v[40:41], v20 offset:49152
    ds_read_b64_tr_b16 v[42:43], v21 offset:49152
    ds_read_b64_tr_b16 v[44:45], v20 offset:61440
    ds_read_b64_tr_b16 v[46:47], v21 offset:61440
    ds_read_b64_tr_b16 v[56:57], v22 offset:49152
    ds_read_b64_tr_b16 v[58:59], v23 offset:49152
    ds_read_b64_tr_b16 v[60:61], v22 offset:61440
    ds_read_b64_tr_b16 v[62:63], v23 offset:61440
    ds_read_b64_tr_b16 v[72:73], v24 offset:49152
    ds_read_b64_tr_b16 v[74:75], v25 offset:49152
    ds_read_b64_tr_b16 v[76:77], v24 offset:61440
    ds_read_b64_tr_b16 v[78:79], v25 offset:61440
    v_add_u32 v26, 73728, v20
    ds_read_b64_tr_b16 v[88:89], v26
    v_add_u32 v26, 73728, v21
    ds_read_b64_tr_b16 v[90:91], v26
    v_add_u32 v26, 86016, v20
    ds_read_b64_tr_b16 v[92:93], v26
    v_add_u32 v26, 86016, v21
    ds_read_b64_tr_b16 v[94:95], v26
    v_add_u32 v26, 73728, v22
    ds_read_b64_tr_b16 v[104:105], v26
    v_add_u32 v26, 73728, v23
    ds_read_b64_tr_b16 v[106:107], v26
    v_add_u32 v26, 86016, v22
    ds_read_b64_tr_b16 v[108:109], v26
    v_add_u32 v26, 86016, v23
    ds_read_b64_tr_b16 v[110:111], v26
    v_add_u32 v26, 73728, v24
    ds_read_b64_tr_b16 v[120:121], v26
    v_add_u32 v26, 73728, v25
    ds_read_b64_tr_b16 v[122:123], v26
    v_add_u32 v26, 86016, v24
    ds_read_b64_tr_b16 v[124:125], v26
    v_add_u32 v26, 86016, v25
    ds_read_b64_tr_b16 v[126:127], v26
    s_waitcnt lgkmcnt(0)
    s_barrier
    v_mul_u32_u24 v11, 24576, v2
    v_add_u32 v11, v11, v3
    ds_write_b128 v11, v[32:35] offset:0
    ds_write_b128 v11, v[36:39] offset:1024
    ds_write_b128 v11, v[40:43] offset:2048
    ds_write_b128 v11, v[44:47] offset:3072
    ds_write_b128 v11, v[48:51] offset:4096
    ds_write_b128 v11, v[52:55] offset:5120
    ds_write_b128 v11, v[56:59] offset:6144
    ds_write_b128 v11, v[60:63] offset:7168
    ds_write_b128 v11, v[64:67] offset:8192
    ds_write_b128 v11, v[68:71] offset:9216
    ds_write_b128 v11, v[72:75] offset:10240
    ds_write_b128 v11, v[76:79] offset:11264
    ds_write_b128 v11, v[80:83] offset:12288
    ds_write_b128 v11, v[84:87] offset:13312
    ds_write_b128 v11, v[88:91] offset:14336
    ds_write_b128 v11, v[92:95] offset:15360
    ds_write_b128 v11, v[96:99] offset:16384
    ds_write_b128 v11, v[100:103] offset:17408
    ds_write_b128 v11, v[104:107] offset:18432
    ds_write_b128 v11, v[108:111] offset:19456
    ds_write_b128 v11, v[112:115] offset:20480
    ds_write_b128 v11, v[116:119] offset:21504
    ds_write_b128 v11, v[120:123] offset:22528
    ds_write_b128 v11, v[124:127] offset:23552
    s_waitcnt lgkmcnt(0)
    v_bfe_u32 v20, v4, 2, 1
    v_lshlrev_b32 v20, 9, v20
    v_lshrrev_b32 v21, 3, v4
    v_lshl_add_u32 v20, v21, 7, v20
    v_and_b32 v21, 1, v4
    v_lshl_add_u32 v20, v21, 5, v20
    v_bfe_u32 v21, v4, 1, 1
    v_lshl_add_u32 v20, v21, 2, v20
    v_lshl_add_u32 v20, v5, 3, v20
    v_add_u32 v20, 110592, v20
    v_add_u32 v21, 0, v19
    v_lshrrev_b32 v22, 2, v21
    v_lshl_add_u32 v12, v22, 10, v20
    v_bfe_u32 v22, v21, 1, 1
    v_lshl_add_u32 v12, v22, 8, v12
    v_and_b32 v22, 1, v21
    v_lshl_add_u32 v12, v22, 6, v12
    v_add_u32 v21, 4, v19
    v_lshrrev_b32 v22, 2, v21
    v_lshl_add_u32 v13, v22, 10, v20
    v_bfe_u32 v22, v21, 1, 1
    v_lshl_add_u32 v13, v22, 8, v13
    v_and_b32 v22, 1, v21
    v_lshl_add_u32 v13, v22, 6, v13
    v_add_u32 v21, 8, v19
    v_lshrrev_b32 v22, 2, v21
    v_lshl_add_u32 v14, v22, 10, v20
    v_bfe_u32 v22, v21, 1, 1
    v_lshl_add_u32 v14, v22, 8, v14
    v_and_b32 v22, 1, v21
    v_lshl_add_u32 v14, v22, 6, v14
    v_lshl_add_u32 v15, v19, 4, v4
    v_lshlrev_b32 v15, 4, v15
    v_lshl_add_u32 v15, v5, 2, v15
    v_add_u32 v15, 126976, v15
    v_lshlrev_b32 v16, 3, v1
    v_add_u32 v16, 110592, v16
    v_lshrrev_b32 v17, 2, v1
    v_lshlrev_b32 v17, 4, v17
    v_and_b32 v21, 1, v1
    v_lshl_add_u32 v17, v21, 3, v17
    v_add_u32 v17, 126976, v17
    v_lshlrev_b32 v18, 4, v4
    v_lshl_add_u32 v18, v5, 7, v18
    v_mov_b32 v21, 0x7f000000
    v_cmp_gt_u32 s[62:63], 8, v4
    s_nop 1
    v_cndmask_b32 v18, v21, v18, s[62:63]
    s_lshr_b32 s30, s24, 4
    s_lshl_b32 s30, s30, 14
    s_and_b32 s31, s24, 15
    s_lshl_b32 s31, s31, 9
    s_add_u32 s30, s30, s31
    s_add_u32 s30, s30, 0x8000
    v_lshrrev_b32 v19, 2, v4
    v_lshlrev_b32 v19, 6, v19
    v_lshl_add_u32 v19, v5, 4, v19
    v_and_b32 v22, 3, v4
    v_lshl_add_u32 v19, v22, 2, v19
    v_lshl_add_u32 v19, v2, 16, v19
    v_add_u32 v19, s30, v19
    s_lshr_b32 s30, s24, 3
    s_lshl_b32 s30, s30, 10
    s_and_b32 s31, s24, 3
    s_lshl_b32 s31, s31, 8
    s_add_u32 s30, s30, s31
    s_bfe_u32 s31, s24, 0x10002
    s_lshl_b32 s31, s31, 7
    s_add_u32 s30, s30, s31
    s_add_u32 s30, s30, 0x4800
    v_lshrrev_b32 v20, 3, v4
    v_lshlrev_b32 v20, 6, v20
    v_lshl_add_u32 v20, v5, 4, v20
    v_bfe_u32 v22, v4, 1, 2
    v_lshl_add_u32 v20, v22, 2, v20
    v_lshl_add_u32 v20, v2, 16, v20
    v_add_u32 v20, s30, v20
    v_and_b32 v22, 1, v1
    v_cmp_eq_u32 vcc, 0, v22
    s_nop 1
    v_cndmask_b32 v20, v21, v20, vcc
    v_add_u32 v7, 131072, v7
    v_add_u32 v21, 98304, v3
    v_add_u32 v22, 131072, v8
    v_add_u32 v23, 131072, v10
    s_lshr_b32 s30, s25, 1
    s_lshl_b32 s30, s30, 5
    s_add_u32 s30, s30, s24
    s_mul_i32 s35, s30, 6144
    s_and_b32 s30, s25, 1
    s_mul_i32 s30, s30, 3072
    s_add_u32 s35, s35, s30
    s_add_u32 s35, s35, 0x2800000
    s_mul_i32 s36, s25, 3072
    s_add_u32 s36, s36, 98304
    s_mul_i32 s37, s24, 3072
    s_add_u32 s37, s37, 0xaa00000
    s_mov_b32 s40, 0x3dd53b95
    v_mov_b32 v29, 0x7f000000
    v_cmp_eq_u32 vcc, 0, v0
    s_nop 1
    v_cndmask_b32 v29, v29, v0, vcc
    v_mov_b32 v30, 1
    v_mov_b32 v31, 0
    s_lshl_b32 s38, s24, 2
    s_add_u32 s39, s38, 0xe282f80
    s_add_u32 s38, s38, 0xe280800
    v_lshlrev_b32 v0, 4, v0
    v_lshlrev_b32 v24, 2, v1
    s_mov_b32 s30, 0xe28f800
    s_mov_b32 s33, 0
wf_64:
    buffer_load_dword v25, v24, s[8:11], s30 offen sc1
    s_add_u32 s33, s33, 1
    s_cmp_gt_u32 s33, 2097152
    s_cbranch_scc1 rec_fail
    s_waitcnt vmcnt(0)
    v_cmp_eq_u32 vcc, 0, v25
    s_cbranch_vccz wfd_65
    s_sleep 4
    s_branch wf_64
    s_nop 1
wfd_65:
    s_mov_b32 s30, 0xe28f8c0
    s_mov_b32 s33, 0
wf_66:
    buffer_load_dword v25, v24, s[8:11], s30 offen sc1
    s_add_u32 s33, s33, 1
    s_cmp_gt_u32 s33, 2097152
    s_cbranch_scc1 rec_fail
    s_waitcnt vmcnt(0)
    v_cmp_eq_u32 vcc, 0, v25
    s_cbranch_vccz wfd_67
    s_sleep 4
    s_branch wf_66
    s_nop 1
wfd_67:
    s_add_u32 s30, s26, 0
    s_and_b32 s30, s30, 3
    s_cmp_lg_u32 s30, 0
    s_cbranch_scc1 kxok_68
    s_mov_b32 s33, 0
wf_69:
    buffer_load_dword v28, v31, s[8:11], s38 offen sc1
    s_add_u32 s33, s33, 1
    s_cmp_gt_u32 s33, 2097152
    s_cbranch_scc1 rec_fail
    s_waitcnt vmcnt(0)
    v_cmp_eq_u32 vcc, 0, v28
    s_cbranch_vccz wfd_70
    s_sleep 2
    s_branch wf_69
    s_nop 1
wfd_70:
    s_add_u32 s38, s38, 128
kxok_68:
    s_add_u32 s30, s26, 1
    s_and_b32 s30, s30, 3
    s_cmp_lg_u32 s30, 0
    s_cbranch_scc1 Lskip_71
    buffer_load_dword v2, v31, s[8:11], s38 offen sc1
Lskip_71:
    s_mov_b32 m0, s36
    s_nop 0
    buffer_load_dwordx4 v3, s[8:11], s35 offen offset:0 sc1 lds
    buffer_load_dwordx4 v3, s[8:11], s35 offen offset:1024 sc1 lds
    buffer_load_dwordx4 v3, s[8:11], s35 offen offset:2048 sc1 lds
    s_add_u32 s35, s35, 393216
    s_xor_b32 s36, s36, 0x4000
sc_loop:
    s_add_u32 s30, s26, 0
    s_and_b32 s30, s30, 7
    s_lshl_b32 s30, s30, 18
    s_add_u32 s29, s30, s34
    s_add_u32 s28, s29, s27
    ds_read_b128 v[32:35], v11 offset:0
    ds_read_b128 v[36:39], v11 offset:1024
    ds_read_b128 v[40:43], v11 offset:2048
    ds_read_b128 v[44:47], v11 offset:3072
    ds_read_b128 v[48:51], v11 offset:4096
    ds_read_b128 v[52:55], v11 offset:5120
    v_mov_b32 v64, 0
    v_mov_b32 v65, 0
    v_mov_b32 v66, 0
    v_mov_b32 v67, 0
    v_mov_b32 v68, 0
    v_mov_b32 v69, 0
    v_mov_b32 v70, 0
    v_mov_b32 v71, 0
    v_mov_b32 v72, 0
    v_mov_b32 v73, 0
    v_mov_b32 v74, 0
    v_mov_b32 v75, 0
    v_mov_b32 v76, 0
    v_mov_b32 v77, 0
    v_mov_b32 v78, 0
    v_mov_b32 v79, 0
    v_mov_b32 v80, 0
    v_mov_b32 v81, 0
    v_mov_b32 v82, 0
    v_mov_b32 v83, 0
    v_mov_b32 v84, 0
    v_mov_b32 v85, 0
    v_mov_b32 v86, 0
    v_mov_b32 v87, 0
    v_mov_b32 v56, 0
    v_mov_b32 v57, 0
    v_mov_b32 v58, 0
    v_mov_b32 v59, 0
    v_mov_b32 v60, 0
    v_mov_b32 v61, 0
    v_mov_b32 v62, 0
    v_mov_b32 v63, 0
    s_add_u32 s32, s28, 4096
    s_mov_b32 s33, 0
    s_cmp_eq_u32 s26, 0
    s_cbranch_scc1 Lskip_73
    s_sleep 29
Lskip_73:
poll_scm_72:
    buffer_load_dwordx4 v[88:91], v8, s[8:11], s28 offen sc1
    buffer_load_dwordx4 v[92:95], v8, s[8:11], s32 offen sc1
    buffer_load_dwordx2 v[96:97], v9, s[8:11], s28 offen sc1
    s_add_u32 s33, s33, 1
    s_cmp_gt_u32 s33, 4194304
    s_cbranch_scc1 rec_fail
    s_waitcnt vmcnt(0)
    ds_write_b128 v22, v[88:91] offset:0
    ds_write_b128 v22, v[92:95] offset:4096
    ds_write_b64 v23, v[96:97] offset:8192
    v_max3_u32 v24, v88, v89, v90
    v_max3_u32 v25, v91, v92, v93
    v_max3_u32 v26, v94, v95, v96
    v_max3_u32 v27, v24, v25, v26
    v_max_u32 v28, v27, v97
    v_cmp_eq_u32 vcc, -1, v28
    s_cbranch_vccnz poll_scm_72
    s_waitcnt lgkmcnt(0)
    s_barrier
    ds_read_b128 v[88:91], v7 offset:0
    ds_read_b128 v[92:95], v7 offset:1024
    ds_read_b128 v[96:99], v7 offset:2048
    s_waitcnt lgkmcnt(2)
    v_smfmac_f32_16x16x64_bf16 v[64:67], v[88:91], a[0:7], v6
    ds_read_b128 v[100:103], v7 offset:3072
    v_smfmac_f32_16x16x64_bf16 v[68:71], v[88:91], a[64:71], v6
    ds_read_b128 v[104:107], v7 offset:4096
    s_waitcnt lgkmcnt(3)
    v_smfmac_f32_16x16x64_bf16 v[64:67], v[92:95], a[8:15], v6
    ds_read_b128 v[108:111], v7 offset:5120
    v_smfmac_f32_16x16x64_bf16 v[68:71], v[92:95], a[72:79], v6
    ds_read_b128 v[112:115], v7 offset:6144
    s_waitcnt lgkmcnt(4)
    v_smfmac_f32_16x16x64_bf16 v[64:67], v[96:99], a[16:23], v6
    ds_read_b128 v[116:119], v7 offset:7168
    v_smfmac_f32_16x16x64_bf16 v[68:71], v[96:99], a[80:87], v6
    ds_read_b128 v[120:123], v7 offset:8192
    s_waitcnt lgkmcnt(5)
    v_smfmac_f32_16x16x64_bf16 v[64:67], v[100:103], a[24:31], v6
    ds_read_b128 v[124:127], v7 offset:9216
    v_smfmac_f32_16x16x64_bf16 v[68:71], v[100:103], a[88:95], v6
    s_waitcnt lgkmcnt(5)
    v_smfmac_f32_16x16x64_bf16 v[64:67], v[104:107], a[32:39], v6
    v_smfmac_f32_16x16x64_bf16 v[68:71], v[104:107], a[96:103], v6
    s_waitcnt lgkmcnt(4)
    v_smfmac_f32_16x16x64_bf16 v[64:67], v[108:111], a[40:47], v6
    v_mov_b32 v24, 0
    v_smfmac_f32_16x16x64_bf16 v[68:71], v[108:111], a[104:111], v6
    buffer_store_dword v30, v29, s[8:11], s39 offen sc1
    v_mov_b32 v25, 0
    s_waitcnt lgkmcnt(3)
    v_smfmac_f32_16x16x64_bf16 v[64:67], v[112:115], a[48:55], v6
    s_add_u32 s39, s39, 128
    v_mov_b32 v26, 0
    v_smfmac_f32_16x16x64_bf16 v[68:71], v[112:115], a[112:119], v6
    v_mov_b32 v27, 0
    s_waitcnt lgkmcnt(2)
    v_smfmac_f32_16x16x64_bf16 v[64:67], v[116:119], a[56:63], v6
    v_smfmac_f32_16x16x64_bf16 v[68:71], v[116:119], a[120:127], v6
    s_waitcnt lgkmcnt(1)
    v_smfmac_f32_16x16x64_bf16 v[64:67], v[120:123], v[32:39], v6
    ds_read_b128 v[32:35], v11 offset:6144
    s_waitcnt lgkmcnt(1)
    v_smfmac_f32_16x16x64_bf16 v[64:67], v[124:127], v[40:47], v6
    ds_read_b128 v[36:39], v11 offset:7168
    v_smfmac_f32_16x16x64_bf16 v[68:71], v[120:123], v[48:55], v6
    ds_read_b128 v[40:43], v11 offset:8192
    v_smfmac_f32_16x16x64_bf16 v[72:75], v[88:91], a[128:135], v6
    ds_read_b128 v[44:47], v11 offset:9216
    v_smfmac_f32_16x16x64_bf16 v[72:75], v[92:95], a[136:143], v6
    ds_read_b128 v[48:51], v11 offset:10240
    s_nop 0
    v_add_f32 v64, v64, v66
    v_smfmac_f32_16x16x64_bf16 v[72:75], v[96:99], a[144:151], v6
    ds_read_b128 v[52:55], v11 offset:11264
    v_add_f32 v65, v65, v67
    v_smfmac_f32_16x16x64_bf16 v[72:75], v[100:103], a[152:159], v6
    v_cvt_pk_bf16_f32 v66, v64, v65
    v_smfmac_f32_16x16x64_bf16 v[72:75], v[104:107], a[160:167], v6
    ds_write_b32 v12, v66
    s_waitcnt lgkmcnt(5)
    v_smfmac_f32_16x16x64_bf16 v[68:71], v[124:127], v[32:39], v6
    ds_read_b128 v[32:35], v11 offset:12288
    v_smfmac_f32_16x16x64_bf16 v[72:75], v[108:111], a[168:175], v6
    ds_read_b128 v[36:39], v11 offset:13312
    v_smfmac_f32_16x16x64_bf16 v[72:75], v[112:115], a[176:183], v6
    s_waitcnt lgkmcnt(5)
    v_smfmac_f32_16x16x64_bf16 v[72:75], v[120:123], v[40:47], v6
    ds_read_b128 v[40:43], v11 offset:14336
    s_nop 0
    v_add_f32 v68, v68, v70
    v_smfmac_f32_16x16x64_bf16 v[72:75], v[116:119], a[184:191], v6
    ds_read_b128 v[44:47], v11 offset:15360
    v_add_f32 v69, v69, v71
    v_smfmac_f32_16x16x64_bf16 v[76:79], v[88:91], a[192:199], v6
    v_cvt_pk_bf16_f32 v70, v68, v69
    v_smfmac_f32_16x16x64_bf16 v[76:79], v[92:95], a[200:207], v6
    ds_write_b32 v13, v70
    s_waitcnt lgkmcnt(6)
    v_smfmac_f32_16x16x64_bf16 v[72:75], v[124:127], v[48:55], v6
    ds_read_b128 v[48:51], v11 offset:16384
    v_smfmac_f32_16x16x64_bf16 v[76:79], v[96:99], a[208:215], v6
    ds_read_b128 v[52:55], v11 offset:17408
    v_smfmac_f32_16x16x64_bf16 v[76:79], v[100:103], a[216:223], v6
    v_smfmac_f32_16x16x64_bf16 v[76:79], v[104:107], a[224:231], v6
    s_nop 2
    v_add_f32 v72, v72, v74
    s_waitcnt lgkmcnt(5)
    v_smfmac_f32_16x16x64_bf16 v[76:79], v[120:123], v[32:39], v6
    ds_read_b128 v[32:35], v11 offset:18432
    v_add_f32 v73, v73, v75
    v_smfmac_f32_16x16x64_bf16 v[76:79], v[108:111], a[232:239], v6
    ds_read_b128 v[36:39], v11 offset:19456
    v_cvt_pk_bf16_f32 v74, v72, v73
    v_smfmac_f32_16x16x64_bf16 v[76:79], v[112:115], a[240:247], v6
    ds_write_b32 v14, v74
    v_smfmac_f32_16x16x64_bf16 v[76:79], v[116:119], a[248:255], v6
    s_waitcnt lgkmcnt(6)
    v_smfmac_f32_16x16x64_bf16 v[76:79], v[124:127], v[40:47], v6
    ds_read_b128 v[40:43], v11 offset:20480
    v_smfmac_f32_16x16x64_bf16 v[80:83], v[88:91], v[128:135], v6
    ds_read_b128 v[44:47], v11 offset:21504
    v_smfmac_f32_16x16x64_bf16 v[80:83], v[92:95], v[136:143], v6
    s_waitcnt lgkmcnt(2)
    s_barrier
    v_smfmac_f32_16x16x64_bf16 v[80:83], v[120:123], v[48:55], v6
    ds_read_b64_tr_b16 v[64:65], v16 offset:0
    ds_read_b64_tr_b16 v[66:67], v16 offset:512
    v_smfmac_f32_16x16x64_bf16 v[80:83], v[96:99], v[144:151], v6
    ds_read_b64_tr_b16 v[68:69], v16 offset:1024
    ds_read_b64_tr_b16 v[70:71], v16 offset:1536
    v_smfmac_f32_16x16x64_bf16 v[80:83], v[100:103], v[152:159], v6
    ds_read_b64_tr_b16 v[72:73], v16 offset:2048
    ds_read_b64_tr_b16 v[74:75], v16 offset:2560
    v_smfmac_f32_16x16x64_bf16 v[84:87], v[88:91], v[192:199], v6
    ds_read_b128 v[48:51], v11 offset:22528
    v_add_f32 v76, v76, v78
    v_smfmac_f32_16x16x64_bf16 v[80:83], v[124:127], v[32:39], v6
    ds_read_b128 v[52:55], v11 offset:23552
    v_add_f32 v77, v77, v79
    v_smfmac_f32_16x16x64_bf16 v[84:87], v[92:95], v[200:207], v6
    ds_read_b128 v[32:35], v21 offset:0
    v_cvt_pk_bf16_f32 v78, v76, v77
    v_smfmac_f32_16x16x64_bf16 v[80:83], v[104:107], v[160:167], v6
    ds_write_b32 v15, v78 offset:0
    s_waitcnt lgkmcnt(10)
    v_smfmac_f32_16x16x64_bf16 v[84:87], v[120:123], v[40:47], v6
    ds_read_b128 v[36:39], v21 offset:1024
    v_smfmac_f32_16x16x64_bf16 v[80:83], v[108:111], v[168:175], v6
    ds_read_b128 v[88:91], v21 offset:6144
    v_smfmac_f32_16x16x64_bf16 v[84:87], v[96:99], v[208:215], v6
    ds_read_b128 v[92:95], v21 offset:7168
    v_smfmac_f32_16x16x64_bf16 v[80:83], v[112:115], v[176:183], v6
    ds_read_b128 v[40:43], v21 offset:2048
    v_smfmac_f32_16x16x64_bf16 v[84:87], v[100:103], v[216:223], v6
    ds_read_b128 v[44:47], v21 offset:3072
    v_smfmac_f32_16x16x64_bf16 v[80:83], v[116:119], v[184:191], v6
    s_waitcnt lgkmcnt(5)
    s_barrier
    v_smfmac_f32_16x16x64_bf16 v[84:87], v[124:127], v[48:55], v6
    ds_read_b64_tr_b16 v[96:97], v17 offset:0
    ds_read_b64_tr_b16 v[98:99], v17 offset:256
    v_smfmac_f32_16x16x64_bf16 v[84:87], v[104:107], v[224:231], v6
    ds_read_b64_tr_b16 v[100:101], v17 offset:512
    ds_read_b64_tr_b16 v[102:103], v17 offset:768
    v_smfmac_f32_16x16x64_bf16 v[84:87], v[108:111], v[232:239], v6
    ds_read_b128 v[48:51], v21 offset:8192
    v_add_f32 v80, v80, v82
    v_smfmac_f32_16x16x64_bf16 v[84:87], v[112:115], v[240:247], v6
    ds_read_b128 v[52:55], v21 offset:9216
    v_add_f32 v81, v81, v83
    v_smfmac_f32_16x16x64_bf16 v[84:87], v[116:119], v[248:255], v6
    ds_read_b128 v[120:123], v21 offset:4096
    v_cvt_pk_bf16_f32 v82, v80, v81
    ds_read_b128 v[124:127], v21 offset:5120
    ds_write_b32 v15, v82 offset:1024
    ds_read_b128 v[104:107], v21 offset:10240
    ds_read_b128 v[108:111], v21 offset:11264
    s_nop 1
    v_add_f32 v84, v84, v86
    v_add_f32 v85, v85, v87
    v_cvt_pk_bf16_f32 v86, v84, v85
    ds_write_b32 v15, v86 offset:2048
    s_waitcnt lgkmcnt(15)
    v_smfmac_f32_16x16x64_bf16 v[56:59], v[64:67], v[32:39], v6
    s_waitcnt lgkmcnt(14)
    v_smfmac_f32_16x16x64_bf16 v[60:63], v[64:67], v[88:95], v6
    s_waitcnt lgkmcnt(12)
    v_smfmac_f32_16x16x64_bf16 v[56:59], v[68:71], v[40:47], v6
    s_waitcnt lgkmcnt(8)
    v_smfmac_f32_16x16x64_bf16 v[24:27], v[64:67], v[96:103], v6
    s_waitcnt lgkmcnt(0)
    s_barrier
    ds_read_b64_tr_b16 v[112:113], v17 offset:1024
    ds_read_b64_tr_b16 v[114:115], v17 offset:1280
    ds_read_b64_tr_b16 v[116:117], v17 offset:1536
    ds_read_b64_tr_b16 v[118:119], v17 offset:1792
    ds_read_b64_tr_b16 v[32:33], v17 offset:2048
    ds_read_b64_tr_b16 v[34:35], v17 offset:2304
    ds_read_b64_tr_b16 v[36:37], v17 offset:2560
    ds_read_b64_tr_b16 v[38:39], v17 offset:2816
    s_cmp_eq_u32 s26, 63
    s_cbranch_scc1 sc_last
    v_smfmac_f32_16x16x64_bf16 v[60:63], v[68:71], v[48:55], v6
    v_smfmac_f32_16x16x64_bf16 v[56:59], v[72:75], v[120:127], v6
    v_smfmac_f32_16x16x64_bf16 v[60:63], v[72:75], v[104:111], v6
    s_waitcnt lgkmcnt(4)
    v_smfmac_f32_16x16x64_bf16 v[24:27], v[68:71], v[112:119], v6
    s_waitcnt lgkmcnt(0)
    v_smfmac_f32_16x16x64_bf16 v[24:27], v[72:75], v[32:39], v6
    s_nop 2
    v_add_f32 v56, v56, v58
    v_add_f32 v57, v57, v59
    v_add_f32 v60, v60, v62
    v_add_f32 v61, v61, v63
    v_max_f32 v58, v56, v60
    v_max_f32 v59, v57, v61
    v_add_f32 v24, v24, v26
    v_add_f32 v25, v25, v27
    v_max_f32 v76, v58, v24
    v_max_f32 v77, v59, v25
    s_nop 0
    v_max_f32_dpp v76, v76, v76 row_ror:8 row_mask:0xf bank_mask:0xf
    v_max_f32_dpp v77, v77, v77 row_ror:8 row_mask:0xf bank_mask:0xf
    s_nop 0
    v_max_f32_dpp v76, v76, v76 row_ror:4 row_mask:0xf bank_mask:0xf
    v_max_f32_dpp v77, v77, v77 row_ror:4 row_mask:0xf bank_mask:0xf
    s_nop 0
    v_max_f32_dpp v76, v76, v76 row_ror:2 row_mask:0xf bank_mask:0xf
    v_max_f32_dpp v77, v77, v77 row_ror:2 row_mask:0xf bank_mask:0xf
    s_nop 0
    v_max_f32_dpp v76, v76, v76 row_ror:1 row_mask:0xf bank_mask:0xf
    v_max_f32_dpp v77, v77, v77 row_ror:1 row_mask:0xf bank_mask:0xf
    v_sub_f32 v56, v56, v76
    v_sub_f32 v57, v57, v77
    v_sub_f32 v60, v60, v76
    v_sub_f32 v61, v61, v77
    v_sub_f32 v24, v24, v76
    v_sub_f32 v25, v25, v77
    v_mul_f32 v56, s40, v56
    v_mul_f32 v57, s40, v57
    v_mul_f32 v60, s40, v60
    v_mul_f32 v61, s40, v61
    v_mul_f32 v24, s40, v24
    v_mul_f32 v25, s40, v25
    v_exp_f32 v56, v56
    v_exp_f32 v57, v57
    v_exp_f32 v60, v60
    v_exp_f32 v61, v61
    v_exp_f32 v24, v24
    v_exp_f32 v25, v25
    v_add_f32 v78, v56, v60
    v_add_f32 v79, v57, v61
    v_fma_f32 v78, v24, 0.5, v78
    v_fma_f32 v79, v25, 0.5, v79
    s_nop 0
    v_add_f32_dpp v78, v78, v78 row_ror:8 row_mask:0xf bank_mask:0xf
    v_add_f32_dpp v79, v79, v79 row_ror:8 row_mask:0xf bank_mask:0xf
    s_nop 0
    v_add_f32_dpp v78, v78, v78 row_ror:4 row_mask:0xf bank_mask:0xf
    v_add_f32_dpp v79, v79, v79 row_ror:4 row_mask:0xf bank_mask:0xf
    s_nop 0
    v_add_f32_dpp v78, v78, v78 row_ror:2 row_mask:0xf bank_mask:0xf
    v_add_f32_dpp v79, v79, v79 row_ror:2 row_mask:0xf bank_mask:0xf
    s_nop 0
    v_add_f32_dpp v78, v78, v78 row_ror:1 row_mask:0xf bank_mask:0xf
    v_add_f32_dpp v79, v79, v79 row_ror:1 row_mask:0xf bank_mask:0xf
    v_rcp_f32 v78, v78
    v_rcp_f32 v79, v79
    v_mul_f32 v56, v56, v78
    v_mul_f32 v60, v60, v78
    v_mul_f32 v57, v57, v79
    v_mul_f32 v61, v61, v79
    v_cvt_pk_bf16_f32 v56, v56, v60
    v_cvt_pk_bf16_f32 v57, v57, v61
    v_min_u32 v56, 0xfffffffe, v56
    v_min_u32 v57, 0xfffffffe, v57
    buffer_store_dword v56, v19, s[8:11], s29 offen sc1
    buffer_store_dword v57, v19, s[8:11], s29 offen offset:256 sc1
    v_mul_f32 v24, v24, v78
    v_mul_f32 v25, v25, v79
    v_cndmask_b32 v24, v25, v24, s[62:63]
    s_nop 1
    v_mov_b32_dpp v25, v24 quad_perm:[1,1,3,3] row_mask:0xf bank_mask:0xf
    v_cvt_pk_bf16_f32 v24, v24, v25
    v_min_u32 v24, 0xfffffffe, v24
    buffer_store_dword v24, v20, s[8:11], s29 offen sc1
    s_cmp_eq_u32 s25, 0
    s_cbranch_scc0 Lskip_74
    buffer_store_dwordx4 v[96:99], v18, s[8:11], s37 offen offset:0 sc1
    buffer_store_dwordx4 v[100:103], v18, s[8:11], s37 offen offset:512 sc1
Lskip_74:
    s_cmp_eq_u32 s25, 1
    s_cbranch_scc0 Lskip_75
    buffer_store_dwordx4 v[112:115], v18, s[8:11], s37 offen offset:1024 sc1
    buffer_store_dwordx4 v[116:119], v18, s[8:11], s37 offen offset:1536 sc1
Lskip_75:
    s_cmp_eq_u32 s25, 2
    s_cbranch_scc0 Lskip_76
    buffer_store_dwordx4 v[32:35], v18, s[8:11], s37 offen offset:2048 sc1
    buffer_store_dwordx4 v[36:39], v18, s[8:11], s37 offen offset:2560 sc1
Lskip_76:
    s_add_u32 s37, s37, 98304
    s_add_u32 s30, s26, 6
    s_and_b32 s30, s30, 7
    s_lshl_b32 s30, s30, 18
    s_add_u32 s32, s30, s34
    s_add_u32 s32, s32, s41
    v_mov_b32 v80, -1
    v_mov_b32 v81, -1
    v_mov_b32 v82, -1
    v_mov_b32 v83, -1
    buffer_store_dwordx4 v[80:83], v0, s[8:11], s32 offen sc1
    s_add_u32 s30, s26, 1
    s_and_b32 s30, s30, 3
    s_cmp_lg_u32 s30, 0
    s_cbranch_scc1 kxok_77
    v_cmp_eq_u32 vcc, 0, v2
    s_cbranch_vccz kxpre_78
    s_mov_b32 s33, 0
    s_nop 2
wf_79:
    buffer_load_dword v28, v31, s[8:11], s38 offen sc1
    s_add_u32 s33, s33, 1
    s_cmp_gt_u32 s33, 2097152
    s_cbranch_scc1 rec_fail
    s_waitcnt vmcnt(0)
    v_cmp_eq_u32 vcc, 0, v28
    s_cbranch_vccz wfd_80
    s_sleep 2
    s_branch wf_79
    s_nop 1
wfd_80:
kxpre_78:
    s_add_u32 s38, s38, 128
kxok_77:
    s_add_u32 s30, s26, 2
    s_and_b32 s30, s30, 3
    s_cmp_lg_u32 s30, 0
    s_cbranch_scc1 Lskip_81
    buffer_load_dword v2, v31, s[8:11], s38 offen sc1
Lskip_81:
    s_mov_b32 m0, s36
    s_nop 0
    buffer_load_dwordx4 v3, s[8:11], s35 offen offset:0 sc1 lds
    buffer_load_dwordx4 v3, s[8:11], s35 offen offset:1024 sc1 lds
    buffer_load_dwordx4 v3, s[8:11], s35 offen offset:2048 sc1 lds
    s_add_u32 s35, s35, 393216
    s_xor_b32 s36, s36, 0x4000
    v_xor_b32 v21, 0x4000, v21
    s_add_u32 s26, s26, 1
    s_branch sc_loop
sc_last:
    s_waitcnt lgkmcnt(0)
    s_cmp_eq_u32 s25, 0
    s_cbranch_scc0 Lskip_82
    buffer_store_dwordx4 v[96:99], v18, s[8:11], s37 offen offset:0 sc1
    buffer_store_dwordx4 v[100:103], v18, s[8:11], s37 offen offset:512 sc1
Lskip_82:
    s_cmp_eq_u32 s25, 1
    s_cbranch_scc0 Lskip_83
    buffer_store_dwordx4 v[112:115], v18, s[8:11], s37 offen offset:1024 sc1
    buffer_store_dwordx4 v[116:119], v18, s[8:11], s37 offen offset:1536 sc1
Lskip_83:
    s_cmp_eq_u32 s25, 2
    s_cbranch_scc0 Lskip_84
    buffer_store_dwordx4 v[32:35], v18, s[8:11], s37 offen offset:2048 sc1
    buffer_store_dwordx4 v[36:39], v18, s[8:11], s37 offen offset:2560 sc1
Lskip_84:
    s_waitcnt vmcnt(0)
    s_barrier
    buffer_store_dword v30, v29, s[8:11], s39 offen sc1
    s_endpgm
rec_col:
    s_load_dwordx2 s[12:13], s[0:1], 32
    s_load_dwordx2 s[16:17], s[0:1], 40
    s_waitcnt lgkmcnt(0)
    s_and_b32 s13, s13, 0xffff
    s_mov_b32 s14, 0x780000
    s_mov_b32 s15, 0x00020000
    s_and_b32 s17, s17, 0xffff
    s_mov_b32 s18, 0x780000
    s_mov_b32 s19, 0x00020000
    s_sub_u32 s40, s24, 32
    s_and_b32 s75, s40, 3
    s_mul_i32 s75, s75, 20
    s_lshr_b32 s30, s40, 2
    s_add_u32 s75, s75, s30
    s_lshl_b32 s30, s75, 2
    s_add_u32 s31, s30, s25
    s_mul_i32 s35, s31, 6554
    s_lshr_b32 s35, s35, 16
    s_mul_i32 s32, s35, 10
    s_sub_u32 s36, s31, s32
    s_lshl_b32 s36, s36, 2
    s_mul_i32 s37, s30, 6554
    s_lshr_b32 s37, s37, 16
    s_add_u32 s30, s30, 3
    s_mul_i32 s38, s30, 6554
    s_lshr_b32 s38, s38, 16
    s_cmp_lg_u32 s35, s37
    s_cselect_b32 s32, 12288, 0
    v_mul_u32_u24 v14, 384, v4
    v_add_u32 v14, s32, v14
    v_lshrrev_b32 v15, 1, v4
    v_add_u32 v11, 0, v5
    v_xor_b32 v11, v11, v15
    v_lshl_add_u32 v28, v11, 4, v14
    v_add_u32 v30, 0x10000, v28
    v_add_u32 v11, 4, v5
    v_xor_b32 v11, v11, v15
    v_lshl_add_u32 v29, v11, 4, v14
    v_add_u32 v31, 0x10000, v29
    s_cmp_lg_u32 s38, s37
    s_mul_i32 s37, s37, 384
    s_mul_i32 s38, s38, 384
    s_cselect_b32 s38, s38, 0x7f000000
    v_mul_u32_u24 v16, 192, v2
    v_add_u32 v16, v16, v1
    v_add_u32 v16, 0, v16
    v_mul_u32_u24 v17, 2731, v16
    v_lshrrev_b32 v17, 16, v17
    v_mul_u32_u24 v18, 24, v17
    v_sub_u32 v18, v16, v18
    v_bfe_u32 v19, v17, 1, 3
    v_xor_b32 v18, v18, v19
    v_bfe_u32 v19, v17, 3, 1
    v_lshlrev_b32 v19, 4, v19
    v_and_b32 v20, 1, v17
    v_lshl_add_u32 v19, v20, 3, v19
    v_bfe_u32 v20, v17, 2, 1
    v_lshl_add_u32 v19, v20, 2, v19
    v_bfe_u32 v20, v17, 1, 1
    v_lshl_add_u32 v19, v20, 1, v19
    v_lshrrev_b32 v20, 4, v17
    v_add_u32 v19, v19, v20
    v_mul_u32_u24 v19, 12288, v19
    v_lshl_add_u32 v11, v18, 4, v19
    v_mul_u32_u24 v16, 192, v2
    v_add_u32 v16, v16, v1
    v_add_u32 v16, 64, v16
    v_mul_u32_u24 v17, 2731, v16
    v_lshrrev_b32 v17, 16, v17
    v_mul_u32_u24 v18, 24, v17
    v_sub_u32 v18, v16, v18
    v_bfe_u32 v19, v17, 1, 3
    v_xor_b32 v18, v18, v19
    v_bfe_u32 v19, v17, 3, 1
    v_lshlrev_b32 v19, 4, v19
    v_and_b32 v20, 1, v17
    v_lshl_add_u32 v19, v20, 3, v19
    v_bfe_u32 v20, v17, 2, 1
    v_lshl_add_u32 v19, v20, 2, v19
    v_bfe_u32 v20, v17, 1, 1
    v_lshl_add_u32 v19, v20, 1, v19
    v_lshrrev_b32 v20, 4, v17
    v_add_u32 v19, v19, v20
    v_mul_u32_u24 v19, 12288, v19
    v_lshl_add_u32 v12, v18, 4, v19
    v_mul_u32_u24 v16, 192, v2
    v_add_u32 v16, v16, v1
    v_add_u32 v16, 128, v16
    v_mul_u32_u24 v17, 2731, v16
    v_lshrrev_b32 v17, 16, v17
    v_mul_u32_u24 v18, 24, v17
    v_sub_u32 v18, v16, v18
    v_bfe_u32 v19, v17, 1, 3
    v_xor_b32 v18, v18, v19
    v_bfe_u32 v19, v17, 3, 1
    v_lshlrev_b32 v19, 4, v19
    v_and_b32 v20, 1, v17
    v_lshl_add_u32 v19, v20, 3, v19
    v_bfe_u32 v20, v17, 2, 1
    v_lshl_add_u32 v19, v20, 2, v19
    v_bfe_u32 v20, v17, 1, 1
    v_lshl_add_u32 v19, v20, 1, v19
    v_lshrrev_b32 v20, 4, v17
    v_add_u32 v19, v19, v20
    v_mul_u32_u24 v19, 12288, v19
    v_lshl_add_u32 v13, v18, 4, v19
    s_mul_i32 s41, s25, 3072
    v_lshrrev_b32 v14, 3, v1
    v_mul_u32_u24 v14, 1280, v14
    v_and_b32 v15, 7, v1
    v_lshl_add_u32 v14, v15, 4, v14
    s_mul_i32 s31, s35, 245760
    s_lshl_b32 s32, s36, 5
    s_add_u32 s31, s31, s32
    s_mul_i32 s32, s25, 24576
    s_mov_b32 m0, s32
    s_mov_b32 s33, 24
co_bl:
    buffer_load_dwordx4 v14, s[16:19], s31 offen lds
    s_add_u32 s31, s31, 10240
    s_add_u32 m0, m0, 1024
    s_sub_u32 s33, s33, 1
    s_cmp_lg_u32 s33, 0
    s_cbranch_scc1 co_bl
    s_add_u32 s30, s37, 0
    s_add_u32 m0, s41, 98304
    s_nop 0
    buffer_load_dwordx4 v11, s[12:15], s30 offen lds
    s_add_u32 m0, s41, 99328
    s_nop 0
    buffer_load_dwordx4 v12, s[12:15], s30 offen lds
    s_add_u32 m0, s41, 100352
    s_nop 0
    buffer_load_dwordx4 v13, s[12:15], s30 offen lds
    s_add_u32 s30, s38, 0
    s_add_u32 m0, s41, 110592
    s_nop 0
    buffer_load_dwordx4 v11, s[12:15], s30 offen lds
    s_add_u32 m0, s41, 111616
    s_nop 0
    buffer_load_dwordx4 v12, s[12:15], s30 offen lds
    s_add_u32 m0, s41, 112640
    s_nop 0
    buffer_load_dwordx4 v13, s[12:15], s30 offen lds
    v_bfe_u32 v14, v1, 2, 2
    v_lshl_add_u32 v14, v5, 3, v14
    v_lshlrev_b32 v14, 7, v14
    v_and_b32 v15, 3, v1
    v_lshl_add_u32 v14, v15, 3, v14
    v_add_u32 v14, s32, v14
    s_waitcnt vmcnt(6)
    ds_read_b64_tr_b16 v[96:97], v14 offset:0
    ds_read_b64_tr_b16 v[98:99], v14 offset:512
    ds_read_b64_tr_b16 v[100:101], v14 offset:32
    ds_read_b64_tr_b16 v[102:103], v14 offset:544
    ds_read_b64_tr_b16 v[104:105], v14 offset:64
    ds_read_b64_tr_b16 v[106:107], v14 offset:576
    ds_read_b64_tr_b16 v[108:109], v14 offset:96
    ds_read_b64_tr_b16 v[110:111], v14 offset:608
    s_waitcnt lgkmcnt(8)
    ds_read_b64_tr_b16 v[112:113], v14 offset:4096
    ds_read_b64_tr_b16 v[114:115], v14 offset:4608
    ds_read_b64_tr_b16 v[116:117], v14 offset:4128
    ds_read_b64_tr_b16 v[118:119], v14 offset:4640
    ds_read_b64_tr_b16 v[120:121], v14 offset:4160
    ds_read_b64_tr_b16 v[122:123], v14 offset:4672
    ds_read_b64_tr_b16 v[124:125], v14 offset:4192
    ds_read_b64_tr_b16 v[126:127], v14 offset:4704
    s_waitcnt lgkmcnt(8)
    ds_read_b64_tr_b16 v[128:129], v14 offset:8192
    ds_read_b64_tr_b16 v[130:131], v14 offset:8704
    ds_read_b64_tr_b16 v[132:133], v14 offset:8224
    ds_read_b64_tr_b16 v[134:135], v14 offset:8736
    ds_read_b64_tr_b16 v[136:137], v14 offset:8256
    ds_read_b64_tr_b16 v[138:139], v14 offset:8768
    ds_read_b64_tr_b16 v[140:141], v14 offset:8288
    ds_read_b64_tr_b16 v[142:143], v14 offset:8800
    s_waitcnt lgkmcnt(8)
    ds_read_b64_tr_b16 v[144:145], v14 offset:12288
    ds_read_b64_tr_b16 v[146:147], v14 offset:12800
    ds_read_b64_tr_b16 v[148:149], v14 offset:12320
    ds_read_b64_tr_b16 v[150:151], v14 offset:12832
    ds_read_b64_tr_b16 v[152:153], v14 offset:12352
    ds_read_b64_tr_b16 v[154:155], v14 offset:12864
    ds_read_b64_tr_b16 v[156:157], v14 offset:12384
    ds_read_b64_tr_b16 v[158:159], v14 offset:12896
    s_waitcnt lgkmcnt(8)
    ds_read_b64_tr_b16 v[160:161], v14 offset:16384
    ds_read_b64_tr_b16 v[162:163], v14 offset:16896
    ds_read_b64_tr_b16 v[164:165], v14 offset:16416
    ds_read_b64_tr_b16 v[166:167], v14 offset:16928
    ds_read_b64_tr_b16 v[168:169], v14 offset:16448
    ds_read_b64_tr_b16 v[170:171], v14 offset:16960
    ds_read_b64_tr_b16 v[172:173], v14 offset:16480
    ds_read_b64_tr_b16 v[174:175], v14 offset:16992
    s_waitcnt lgkmcnt(8)
    ds_read_b64_tr_b16 v[176:177], v14 offset:20480
    ds_read_b64_tr_b16 v[178:179], v14 offset:20992
    ds_read_b64_tr_b16 v[180:181], v14 offset:20512
    ds_read_b64_tr_b16 v[182:183], v14 offset:21024
    ds_read_b64_tr_b16 v[184:185], v14 offset:20544
    ds_read_b64_tr_b16 v[186:187], v14 offset:21056
    ds_read_b64_tr_b16 v[188:189], v14 offset:20576
    ds_read_b64_tr_b16 v[190:191], v14 offset:21088
    s_waitcnt lgkmcnt(8)
    s_waitcnt lgkmcnt(0)
    s_barrier
    s_add_u32 s30, s37, 393216
    s_add_u32 m0, s41, 0
    s_nop 0
    buffer_load_dwordx4 v11, s[12:15], s30 offen lds
    s_add_u32 m0, s41, 1024
    s_nop 0
    buffer_load_dwordx4 v12, s[12:15], s30 offen lds
    s_add_u32 m0, s41, 2048
    s_nop 0
    buffer_load_dwordx4 v13, s[12:15], s30 offen lds
    s_add_u32 s30, s38, 393216
    s_add_u32 m0, s41, 12288
    s_nop 0
    buffer_load_dwordx4 v11, s[12:15], s30 offen lds
    s_add_u32 m0, s41, 13312
    s_nop 0
    buffer_load_dwordx4 v12, s[12:15], s30 offen lds
    s_add_u32 m0, s41, 14336
    s_nop 0
    buffer_load_dwordx4 v13, s[12:15], s30 offen lds
    s_add_u32 s30, s37, 786432
    s_add_u32 m0, s41, 24576
    s_nop 0
    buffer_load_dwordx4 v11, s[12:15], s30 offen lds
    s_add_u32 m0, s41, 25600
    s_nop 0
    buffer_load_dwordx4 v12, s[12:15], s30 offen lds
    s_add_u32 m0, s41, 26624
    s_nop 0
    buffer_load_dwordx4 v13, s[12:15], s30 offen lds
    s_add_u32 s30, s38, 786432
    s_add_u32 m0, s41, 36864
    s_nop 0
    buffer_load_dwordx4 v11, s[12:15], s30 offen lds
    s_add_u32 m0, s41, 37888
    s_nop 0
    buffer_load_dwordx4 v12, s[12:15], s30 offen lds
    s_add_u32 m0, s41, 38912
    s_nop 0
    buffer_load_dwordx4 v13, s[12:15], s30 offen lds
    s_add_u32 s30, s37, 1179648
    s_add_u32 m0, s41, 49152
    s_nop 0
    buffer_load_dwordx4 v11, s[12:15], s30 offen lds
    s_add_u32 m0, s41, 50176
    s_nop 0
    buffer_load_dwordx4 v12, s[12:15], s30 offen lds
    s_add_u32 m0, s41, 51200
    s_nop 0
    buffer_load_dwordx4 v13, s[12:15], s30 offen lds
    s_add_u32 s30, s38, 1179648
    s_add_u32 m0, s41, 61440
    s_nop 0
    buffer_load_dwordx4 v11, s[12:15], s30 offen lds
    s_add_u32 m0, s41, 62464
    s_nop 0
    buffer_load_dwordx4 v12, s[12:15], s30 offen lds
    s_add_u32 m0, s41, 63488
    s_nop 0
    buffer_load_dwordx4 v13, s[12:15], s30 offen lds
    v_mov_b32 v32, 0
    s_mov_b32 s33, 0
    s_nop 0
wc_85:
    buffer_load_dword v33, v32, s[20:23], 0 offen offset:8 sc1
    s_add_u32 s33, s33, 1
    s_cmp_gt_u32 s33, 2097152
    s_cbranch_scc1 rec_fail
    s_waitcnt vmcnt(0)
    v_cmp_gt_u32 vcc, 4096, v33
    s_cbranch_vccz wcd_86
    s_sleep 4
    s_branch wc_85
    s_nop 1
wcd_86:
    v_readfirstlane_b32 s34, v33
    s_nop 0
    s_and_b32 s34, s34, 0xff
    s_cmp_gt_u32 s34, 8
    s_cselect_b32 s34, 0x2000, 0
    s_add_u32 s34, s34, 0xd000000
    v_mov_b32 v32, 0
    s_mov_b32 s33, 0
    s_nop 0
wc_87:
    buffer_load_dword v33, v32, s[20:23], 0 offen offset:12 sc1
    s_add_u32 s33, s33, 1
    s_cmp_gt_u32 s33, 2097152
    s_cbranch_scc1 rec_fail
    s_waitcnt vmcnt(0)
    v_cmp_gt_u32 vcc, 4096, v33
    s_cbranch_vccz wcd_88
    s_sleep 4
    s_branch wc_87
    s_nop 1
wcd_88:
    v_readfirstlane_b32 s74, v33
    s_nop 0
    s_and_b32 s74, s74, 0xff
    s_cmp_gt_u32 s74, 8
    s_cselect_b32 s74, 0x2000, 0
    s_add_u32 s74, s74, 0xd200000
    v_lshlrev_b32 v34, 3, v2
    v_lshrrev_b32 v35, 3, v4
    v_lshl_add_u32 v34, v35, 2, v34
    v_add_u32 v34, v34, v5
    v_mul_u32_u24 v34, 10240, v34
    v_and_b32 v35, 7, v4
    v_lshl_add_u32 v34, v35, 4, v34
    s_lshl_b32 s30, s40, 7
    v_add_u32 v34, s30, v34
    v_lshrrev_b32 v35, 13, v34
    v_lshlrev_b32 v35, 13, v35
    v_add_u32 v34, v34, v35
    v_mov_b32 v36, -1
    v_mov_b32 v37, -1
    v_mov_b32 v38, -1
    v_mov_b32 v39, -1
    s_add_u32 s30, s74, 0x0
    buffer_store_dwordx4 v[36:39], v34, s[8:11], s30 offen sc1
    s_add_u32 s30, s74, 0xa0000
    buffer_store_dwordx4 v[36:39], v34, s[8:11], s30 offen sc1
    s_add_u32 s30, s74, 0x140000
    buffer_store_dwordx4 v[36:39], v34, s[8:11], s30 offen sc1
    v_mov_b32 v32, 0
    s_mov_b32 s33, 0
    s_nop 0
wc_89:
    buffer_load_dword v33, v32, s[20:23], 0 offen offset:4 sc1
    s_add_u32 s33, s33, 1
    s_cmp_gt_u32 s33, 2097152
    s_cbranch_scc1 rec_fail
    s_waitcnt vmcnt(0)
    v_cmp_gt_u32 vcc, 16, v33
    s_cbranch_vccz wcd_90
    s_sleep 4
    s_branch wc_89
    s_nop 1
wcd_90:
    s_lshl_b32 s30, s24, 2
    s_add_u32 s30, s30, 0xe28f800
    s_waitcnt vmcnt(0) lgkmcnt(0)
    s_barrier
    v_mov_b32 v32, 0x7f000000
    v_cmp_eq_u32 vcc, 0, v0
    s_nop 1
    v_cndmask_b32 v32, v32, v0, vcc
    v_mov_b32 v33, 1
    buffer_store_dword v33, v32, s[8:11], s30 offen sc1
    s_waitcnt vmcnt(18)
    s_barrier
    ds_read_b128 v[16:19], v30 offset:32768
    ds_read_b128 v[20:23], v30 offset:38912
    s_waitcnt lgkmcnt(1)
    v_mfma_f32_16x16x32_bf16 v[32:35], v[16:19], v[96:99], 0
    ds_read_b128 v[24:27], v31 offset:32768
    s_add_u32 s30, s37, 1572864
    v_mfma_f32_16x16x32_bf16 v[36:39], v[16:19], v[100:103], 0
    s_add_u32 m0, s41, 73728
    s_nop 0
    buffer_load_dwordx4 v11, s[12:15], s30 offen lds
    v_mfma_f32_16x16x32_bf16 v[40:43], v[16:19], v[104:107], 0
    s_add_u32 m0, s41, 74752
    s_nop 0
    buffer_load_dwordx4 v12, s[12:15], s30 offen lds
    v_mfma_f32_16x16x32_bf16 v[44:47], v[16:19], v[108:111], 0
    s_add_u32 m0, s41, 75776
    s_waitcnt lgkmcnt(1)
    v_mfma_f32_16x16x32_bf16 v[48:51], v[20:23], v[96:99], 0
    ds_read_b128 v[16:19], v31 offset:38912
    buffer_load_dwordx4 v13, s[12:15], s30 offen lds
    v_mfma_f32_16x16x32_bf16 v[52:55], v[20:23], v[100:103], 0
    s_add_u32 s30, s38, 1572864
    s_add_u32 m0, s41, 86016
    v_mfma_f32_16x16x32_bf16 v[56:59], v[20:23], v[104:107], 0
    buffer_load_dwordx4 v11, s[12:15], s30 offen lds
    s_add_u32 m0, s41, 87040
    v_mfma_f32_16x16x32_bf16 v[60:63], v[20:23], v[108:111], 0
    buffer_load_dwordx4 v12, s[12:15], s30 offen lds
    s_waitcnt lgkmcnt(1)
    v_mfma_f32_16x16x32_bf16 v[32:35], v[24:27], v[112:115], v[32:35]
    ds_read_b128 v[20:23], v30 offset:32896
    s_add_u32 m0, s41, 88064
    v_mfma_f32_16x16x32_bf16 v[36:39], v[24:27], v[116:119], v[36:39]
    buffer_load_dwordx4 v13, s[12:15], s30 offen lds
    v_mfma_f32_16x16x32_bf16 v[40:43], v[24:27], v[120:123], v[40:43]
    v_mfma_f32_16x16x32_bf16 v[44:47], v[24:27], v[124:127], v[44:47]
    s_waitcnt lgkmcnt(1)
    v_mfma_f32_16x16x32_bf16 v[48:51], v[16:19], v[112:115], v[48:51]
    ds_read_b128 v[24:27], v30 offset:39040
    v_mfma_f32_16x16x32_bf16 v[52:55], v[16:19], v[116:119], v[52:55]
    v_mfma_f32_16x16x32_bf16 v[56:59], v[16:19], v[120:123], v[56:59]
    v_mfma_f32_16x16x32_bf16 v[60:63], v[16:19], v[124:127], v[60:63]
    s_waitcnt lgkmcnt(1)
    v_mfma_f32_16x16x32_bf16 v[32:35], v[20:23], v[128:131], v[32:35]
    ds_read_b128 v[16:19], v31 offset:32896
    v_mfma_f32_16x16x32_bf16 v[36:39], v[20:23], v[132:135], v[36:39]
    v_mfma_f32_16x16x32_bf16 v[40:43], v[20:23], v[136:139], v[40:43]
    v_mfma_f32_16x16x32_bf16 v[44:47], v[20:23], v[140:143], v[44:47]
    s_waitcnt lgkmcnt(1)
    v_mfma_f32_16x16x32_bf16 v[48:51], v[24:27], v[128:131], v[48:51]
    ds_read_b128 v[20:23], v31 offset:39040
    v_mfma_f32_16x16x32_bf16 v[52:55], v[24:27], v[132:135], v[52:55]
    v_mfma_f32_16x16x32_bf16 v[56:59], v[24:27], v[136:139], v[56:59]
    v_mfma_f32_16x16x32_bf16 v[60:63], v[24:27], v[140:143], v[60:63]
    s_waitcnt lgkmcnt(1)
    v_mfma_f32_16x16x32_bf16 v[32:35], v[16:19], v[144:147], v[32:35]
    ds_read_b128 v[24:27], v30 offset:33024
    v_mfma_f32_16x16x32_bf16 v[36:39], v[16:19], v[148:151], v[36:39]
    v_mfma_f32_16x16x32_bf16 v[40:43], v[16:19], v[152:155], v[40:43]
    v_mfma_f32_16x16x32_bf16 v[44:47], v[16:19], v[156:159], v[44:47]
    s_waitcnt lgkmcnt(1)
    v_mfma_f32_16x16x32_bf16 v[48:51], v[20:23], v[144:147], v[48:51]
    ds_read_b128 v[16:19], v30 offset:39168
    v_mfma_f32_16x16x32_bf16 v[52:55], v[20:23], v[148:151], v[52:55]
    v_mfma_f32_16x16x32_bf16 v[56:59], v[20:23], v[152:155], v[56:59]
    v_mfma_f32_16x16x32_bf16 v[60:63], v[20:23], v[156:159], v[60:63]
    s_waitcnt lgkmcnt(1)
    v_mfma_f32_16x16x32_bf16 v[32:35], v[24:27], v[160:163], v[32:35]
    ds_read_b128 v[20:23], v31 offset:33024
    v_mfma_f32_16x16x32_bf16 v[36:39], v[24:27], v[164:167], v[36:39]
    v_mfma_f32_16x16x32_bf16 v[40:43], v[24:27], v[168:171], v[40:43]
    v_mfma_f32_16x16x32_bf16 v[44:47], v[24:27], v[172:175], v[44:47]
    s_waitcnt lgkmcnt(1)
    v_mfma_f32_16x16x32_bf16 v[48:51], v[16:19], v[160:163], v[48:51]
    ds_read_b128 v[24:27], v31 offset:39168
    v_mfma_f32_16x16x32_bf16 v[52:55], v[16:19], v[164:167], v[52:55]
    v_mfma_f32_16x16x32_bf16 v[56:59], v[16:19], v[168:171], v[56:59]
    v_mfma_f32_16x16x32_bf16 v[60:63], v[16:19], v[172:175], v[60:63]
    s_waitcnt lgkmcnt(1)
    v_mfma_f32_16x16x32_bf16 v[32:35], v[20:23], v[176:179], v[32:35]
    v_mfma_f32_16x16x32_bf16 v[36:39], v[20:23], v[180:183], v[36:39]
    v_mfma_f32_16x16x32_bf16 v[40:43], v[20:23], v[184:187], v[40:43]
    v_mfma_f32_16x16x32_bf16 v[44:47], v[20:23], v[188:191], v[44:47]
    s_waitcnt lgkmcnt(0)
    v_mfma_f32_16x16x32_bf16 v[48:51], v[24:27], v[176:179], v[48:51]
    v_mfma_f32_16x16x32_bf16 v[52:55], v[24:27], v[180:183], v[52:55]
    v_mfma_f32_16x16x32_bf16 v[56:59], v[24:27], v[184:187], v[56:59]
    v_mfma_f32_16x16x32_bf16 v[60:63], v[24:27], v[188:191], v[60:63]
    s_waitcnt vmcnt(18)
    s_barrier
    ds_read_b128 v[16:19], v28 offset:0
    ds_read_b128 v[20:23], v28 offset:6144
    s_waitcnt lgkmcnt(1)
    v_mfma_f32_16x16x32_bf16 v[64:67], v[16:19], v[96:99], 0
    ds_read_b128 v[24:27], v29 offset:0
    s_add_u32 s30, s37, 1966080
    v_mfma_f32_16x16x32_bf16 v[68:71], v[16:19], v[100:103], 0
    s_add_u32 m0, s41, 98304
    s_nop 0
    buffer_load_dwordx4 v11, s[12:15], s30 offen lds
    v_mfma_f32_16x16x32_bf16 v[72:75], v[16:19], v[104:107], 0
    s_add_u32 m0, s41, 99328
    s_nop 0
    buffer_load_dwordx4 v12, s[12:15], s30 offen lds
    v_mfma_f32_16x16x32_bf16 v[76:79], v[16:19], v[108:111], 0
    s_add_u32 m0, s41, 100352
    s_waitcnt lgkmcnt(1)
    v_mfma_f32_16x16x32_bf16 v[80:83], v[20:23], v[96:99], 0
    ds_read_b128 v[16:19], v29 offset:6144
    buffer_load_dwordx4 v13, s[12:15], s30 offen lds
    v_mfma_f32_16x16x32_bf16 v[84:87], v[20:23], v[100:103], 0
    s_add_u32 s30, s38, 1966080
    s_add_u32 m0, s41, 110592
    v_mfma_f32_16x16x32_bf16 v[88:91], v[20:23], v[104:107], 0
    buffer_load_dwordx4 v11, s[12:15], s30 offen lds
    s_add_u32 m0, s41, 111616
    v_mfma_f32_16x16x32_bf16 v[92:95], v[20:23], v[108:111], 0
    buffer_load_dwordx4 v12, s[12:15], s30 offen lds
    s_waitcnt lgkmcnt(1)
    v_mfma_f32_16x16x32_bf16 v[64:67], v[24:27], v[112:115], v[64:67]
    ds_read_b128 v[20:23], v28 offset:128
    s_add_u32 m0, s41, 112640
    v_mfma_f32_16x16x32_bf16 v[68:71], v[24:27], v[116:119], v[68:71]
    buffer_load_dwordx4 v13, s[12:15], s30 offen lds
    v_cvt_pk_bf16_f32 v32, v32, v48
    v_mfma_f32_16x16x32_bf16 v[72:75], v[24:27], v[120:123], v[72:75]
    v_cvt_pk_bf16_f32 v33, v33, v49
    v_cvt_pk_bf16_f32 v34, v34, v50
    v_mfma_f32_16x16x32_bf16 v[76:79], v[24:27], v[124:127], v[76:79]
    v_cvt_pk_bf16_f32 v35, v35, v51
    s_waitcnt lgkmcnt(1)
    v_mfma_f32_16x16x32_bf16 v[80:83], v[16:19], v[112:115], v[80:83]
    ds_read_b128 v[24:27], v28 offset:6272
    v_accvgpr_write_b32 a0, v32
    v_mfma_f32_16x16x32_bf16 v[84:87], v[16:19], v[116:119], v[84:87]
    v_accvgpr_write_b32 a1, v33
    v_accvgpr_write_b32 a2, v34
    v_mfma_f32_16x16x32_bf16 v[88:91], v[16:19], v[120:123], v[88:91]
    v_accvgpr_write_b32 a3, v35
    v_cvt_pk_bf16_f32 v36, v36, v52
    v_mfma_f32_16x16x32_bf16 v[92:95], v[16:19], v[124:127], v[92:95]
    v_cvt_pk_bf16_f32 v37, v37, v53
    s_waitcnt lgkmcnt(1)
    v_mfma_f32_16x16x32_bf16 v[64:67], v[20:23], v[128:131], v[64:67]
    ds_read_b128 v[16:19], v29 offset:128
    v_cvt_pk_bf16_f32 v38, v38, v54
    v_mfma_f32_16x16x32_bf16 v[68:71], v[20:23], v[132:135], v[68:71]
    v_cvt_pk_bf16_f32 v39, v39, v55
    v_accvgpr_write_b32 a8, v36
    v_mfma_f32_16x16x32_bf16 v[72:75], v[20:23], v[136:139], v[72:75]
    v_accvgpr_write_b32 a9, v37
    v_accvgpr_write_b32 a10, v38
    v_mfma_f32_16x16x32_bf16 v[76:79], v[20:23], v[140:143], v[76:79]
    v_accvgpr_write_b32 a11, v39
    s_waitcnt lgkmcnt(1)
    v_mfma_f32_16x16x32_bf16 v[80:83], v[24:27], v[128:131], v[80:83]
    ds_read_b128 v[20:23], v29 offset:6272
    v_cvt_pk_bf16_f32 v40, v40, v56
    v_mfma_f32_16x16x32_bf16 v[84:87], v[24:27], v[132:135], v[84:87]
    v_cvt_pk_bf16_f32 v41, v41, v57
    v_cvt_pk_bf16_f32 v42, v42, v58
    v_mfma_f32_16x16x32_bf16 v[88:91], v[24:27], v[136:139], v[88:91]
    v_cvt_pk_bf16_f32 v43, v43, v59
    v_accvgpr_write_b32 a16, v40
    v_mfma_f32_16x16x32_bf16 v[92:95], v[24:27], v[140:143], v[92:95]
    v_accvgpr_write_b32 a17, v41
    s_waitcnt lgkmcnt(1)
    v_mfma_f32_16x16x32_bf16 v[64:67], v[16:19], v[144:147], v[64:67]
    ds_read_b128 v[24:27], v28 offset:256
    v_accvgpr_write_b32 a18, v42
    v_mfma_f32_16x16x32_bf16 v[68:71], v[16:19], v[148:151], v[68:71]
    v_accvgpr_write_b32 a19, v43
    v_cvt_pk_bf16_f32 v44, v44, v60
    v_mfma_f32_16x16x32_bf16 v[72:75], v[16:19], v[152:155], v[72:75]
    v_cvt_pk_bf16_f32 v45, v45, v61
    v_cvt_pk_bf16_f32 v46, v46, v62
    v_mfma_f32_16x16x32_bf16 v[76:79], v[16:19], v[156:159], v[76:79]
    v_cvt_pk_bf16_f32 v47, v47, v63
    s_waitcnt lgkmcnt(1)
    v_mfma_f32_16x16x32_bf16 v[80:83], v[20:23], v[144:147], v[80:83]
    ds_read_b128 v[16:19], v28 offset:6400
    v_accvgpr_write_b32 a24, v44
    v_mfma_f32_16x16x32_bf16 v[84:87], v[20:23], v[148:151], v[84:87]
    v_accvgpr_write_b32 a25, v45
    v_accvgpr_write_b32 a26, v46
    v_mfma_f32_16x16x32_bf16 v[88:91], v[20:23], v[152:155], v[88:91]
    v_accvgpr_write_b32 a27, v47
    v_mfma_f32_16x16x32_bf16 v[92:95], v[20:23], v[156:159], v[92:95]
    s_waitcnt lgkmcnt(1)
    v_mfma_f32_16x16x32_bf16 v[64:67], v[24:27], v[160:163], v[64:67]
    ds_read_b128 v[20:23], v29 offset:256
    v_mfma_f32_16x16x32_bf16 v[68:71], v[24:27], v[164:167], v[68:71]
    v_mfma_f32_16x16x32_bf16 v[72:75], v[24:27], v[168:171], v[72:75]
    v_mfma_f32_16x16x32_bf16 v[76:79], v[24:27], v[172:175], v[76:79]
    s_waitcnt lgkmcnt(1)
    v_mfma_f32_16x16x32_bf16 v[80:83], v[16:19], v[160:163], v[80:83]
    ds_read_b128 v[24:27], v29 offset:6400
    v_mfma_f32_16x16x32_bf16 v[84:87], v[16:19], v[164:167], v[84:87]
    v_mfma_f32_16x16x32_bf16 v[88:91], v[16:19], v[168:171], v[88:91]
    v_mfma_f32_16x16x32_bf16 v[92:95], v[16:19], v[172:175], v[92:95]
    s_waitcnt lgkmcnt(1)
    v_mfma_f32_16x16x32_bf16 v[64:67], v[20:23], v[176:179], v[64:67]
    v_mfma_f32_16x16x32_bf16 v[68:71], v[20:23], v[180:183], v[68:71]
    v_mfma_f32_16x16x32_bf16 v[72:75], v[20:23], v[184:187], v[72:75]
    v_mfma_f32_16x16x32_bf16 v[76:79], v[20:23], v[188:191], v[76:79]
    s_waitcnt lgkmcnt(0)
    v_mfma_f32_16x16x32_bf16 v[80:83], v[24:27], v[176:179], v[80:83]
    v_mfma_f32_16x16x32_bf16 v[84:87], v[24:27], v[180:183], v[84:87]
    v_mfma_f32_16x16x32_bf16 v[88:91], v[24:27], v[184:187], v[88:91]
    v_mfma_f32_16x16x32_bf16 v[92:95], v[24:27], v[188:191], v[92:95]
    s_waitcnt vmcnt(18)
    s_barrier
    ds_read_b128 v[16:19], v28 offset:24576
    ds_read_b128 v[20:23], v28 offset:30720
    s_waitcnt lgkmcnt(1)
    v_mfma_f32_16x16x32_bf16 v[32:35], v[16:19], v[96:99], 0
    ds_read_b128 v[24:27], v29 offset:24576
    s_add_u32 s30, s37, 2359296
    v_mfma_f32_16x16x32_bf16 v[36:39], v[16:19], v[100:103], 0
    s_add_u32 m0, s41, 0
    s_nop 0
    buffer_load_dwordx4 v11, s[12:15], s30 offen lds
    v_mfma_f32_16x16x32_bf16 v[40:43], v[16:19], v[104:107], 0
    s_add_u32 m0, s41, 1024
    s_nop 0
    buffer_load_dwordx4 v12, s[12:15], s30 offen lds
    v_mfma_f32_16x16x32_bf16 v[44:47], v[16:19], v[108:111], 0
    s_add_u32 m0, s41, 2048
    s_waitcnt lgkmcnt(1)
    v_mfma_f32_16x16x32_bf16 v[48:51], v[20:23], v[96:99], 0
    ds_read_b128 v[16:19], v29 offset:30720
    buffer_load_dwordx4 v13, s[12:15], s30 offen lds
    v_mfma_f32_16x16x32_bf16 v[52:55], v[20:23], v[100:103], 0
    s_add_u32 s30, s38, 2359296
    s_add_u32 m0, s41, 12288
    v_mfma_f32_16x16x32_bf16 v[56:59], v[20:23], v[104:107], 0
    buffer_load_dwordx4 v11, s[12:15], s30 offen lds
    s_add_u32 m0, s41, 13312
    v_mfma_f32_16x16x32_bf16 v[60:63], v[20:23], v[108:111], 0
    buffer_load_dwordx4 v12, s[12:15], s30 offen lds
    s_waitcnt lgkmcnt(1)
    v_mfma_f32_16x16x32_bf16 v[32:35], v[24:27], v[112:115], v[32:35]
    ds_read_b128 v[20:23], v28 offset:24704
    s_add_u32 m0, s41, 14336
    v_mfma_f32_16x16x32_bf16 v[36:39], v[24:27], v[116:119], v[36:39]
    buffer_load_dwordx4 v13, s[12:15], s30 offen lds
    v_cvt_pk_bf16_f32 v64, v64, v80
    v_mfma_f32_16x16x32_bf16 v[40:43], v[24:27], v[120:123], v[40:43]
    v_cvt_pk_bf16_f32 v65, v65, v81
    v_cvt_pk_bf16_f32 v66, v66, v82
    v_mfma_f32_16x16x32_bf16 v[44:47], v[24:27], v[124:127], v[44:47]
    v_cvt_pk_bf16_f32 v67, v67, v83
    s_waitcnt lgkmcnt(1)
    v_mfma_f32_16x16x32_bf16 v[48:51], v[16:19], v[112:115], v[48:51]
    ds_read_b128 v[24:27], v28 offset:30848
    v_accvgpr_write_b32 a4, v64
    v_mfma_f32_16x16x32_bf16 v[52:55], v[16:19], v[116:119], v[52:55]
    v_accvgpr_write_b32 a5, v65
    v_accvgpr_write_b32 a6, v66
    v_mfma_f32_16x16x32_bf16 v[56:59], v[16:19], v[120:123], v[56:59]
    v_accvgpr_write_b32 a7, v67
    v_cvt_pk_bf16_f32 v68, v68, v84
    v_mfma_f32_16x16x32_bf16 v[60:63], v[16:19], v[124:127], v[60:63]
    v_cvt_pk_bf16_f32 v69, v69, v85
    s_waitcnt lgkmcnt(1)
    v_mfma_f32_16x16x32_bf16 v[32:35], v[20:23], v[128:131], v[32:35]
    ds_read_b128 v[16:19], v29 offset:24704
    v_cvt_pk_bf16_f32 v70, v70, v86
    v_mfma_f32_16x16x32_bf16 v[36:39], v[20:23], v[132:135], v[36:39]
    v_cvt_pk_bf16_f32 v71, v71, v87
    v_accvgpr_write_b32 a12, v68
    v_mfma_f32_16x16x32_bf16 v[40:43], v[20:23], v[136:139], v[40:43]
    v_accvgpr_write_b32 a13, v69
    v_accvgpr_write_b32 a14, v70
    v_mfma_f32_16x16x32_bf16 v[44:47], v[20:23], v[140:143], v[44:47]
    v_accvgpr_write_b32 a15, v71
    s_waitcnt lgkmcnt(1)
    v_mfma_f32_16x16x32_bf16 v[48:51], v[24:27], v[128:131], v[48:51]
    ds_read_b128 v[20:23], v29 offset:30848
    v_cvt_pk_bf16_f32 v72, v72, v88
    v_mfma_f32_16x16x32_bf16 v[52:55], v[24:27], v[132:135], v[52:55]
    v_cvt_pk_bf16_f32 v73, v73, v89
    v_cvt_pk_bf16_f32 v74, v74, v90
    v_mfma_f32_16x16x32_bf16 v[56:59], v[24:27], v[136:139], v[56:59]
    v_cvt_pk_bf16_f32 v75, v75, v91
    v_accvgpr_write_b32 a20, v72
    v_mfma_f32_16x16x32_bf16 v[60:63], v[24:27], v[140:143], v[60:63]
    v_accvgpr_write_b32 a21, v73
    s_waitcnt lgkmcnt(1)
    v_mfma_f32_16x16x32_bf16 v[32:35], v[16:19], v[144:147], v[32:35]
    ds_read_b128 v[24:27], v28 offset:24832
    v_accvgpr_write_b32 a22, v74
    v_mfma_f32_16x16x32_bf16 v[36:39], v[16:19], v[148:151], v[36:39]
    v_accvgpr_write_b32 a23, v75
    v_cvt_pk_bf16_f32 v76, v76, v92
    v_mfma_f32_16x16x32_bf16 v[40:43], v[16:19], v[152:155], v[40:43]
    v_cvt_pk_bf16_f32 v77, v77, v93
    v_cvt_pk_bf16_f32 v78, v78, v94
    v_mfma_f32_16x16x32_bf16 v[44:47], v[16:19], v[156:159], v[44:47]
    v_cvt_pk_bf16_f32 v79, v79, v95
    s_waitcnt lgkmcnt(1)
    v_mfma_f32_16x16x32_bf16 v[48:51], v[20:23], v[144:147], v[48:51]
    ds_read_b128 v[16:19], v28 offset:30976
    v_accvgpr_write_b32 a28, v76
    v_mfma_f32_16x16x32_bf16 v[52:55], v[20:23], v[148:151], v[52:55]
    v_accvgpr_write_b32 a29, v77
    v_accvgpr_write_b32 a30, v78
    v_mfma_f32_16x16x32_bf16 v[56:59], v[20:23], v[152:155], v[56:59]
    v_accvgpr_write_b32 a31, v79
    v_mfma_f32_16x16x32_bf16 v[60:63], v[20:23], v[156:159], v[60:63]
    s_waitcnt lgkmcnt(1)
    v_mfma_f32_16x16x32_bf16 v[32:35], v[24:27], v[160:163], v[32:35]
    ds_read_b128 v[20:23], v29 offset:24832
    v_mfma_f32_16x16x32_bf16 v[36:39], v[24:27], v[164:167], v[36:39]
    v_mfma_f32_16x16x32_bf16 v[40:43], v[24:27], v[168:171], v[40:43]
    v_mfma_f32_16x16x32_bf16 v[44:47], v[24:27], v[172:175], v[44:47]
    s_waitcnt lgkmcnt(1)
    v_mfma_f32_16x16x32_bf16 v[48:51], v[16:19], v[160:163], v[48:51]
    ds_read_b128 v[24:27], v29 offset:30976
    v_mfma_f32_16x16x32_bf16 v[52:55], v[16:19], v[164:167], v[52:55]
    v_mfma_f32_16x16x32_bf16 v[56:59], v[16:19], v[168:171], v[56:59]
    v_mfma_f32_16x16x32_bf16 v[60:63], v[16:19], v[172:175], v[60:63]
    s_waitcnt lgkmcnt(1)
    v_mfma_f32_16x16x32_bf16 v[32:35], v[20:23], v[176:179], v[32:35]
    v_mfma_f32_16x16x32_bf16 v[36:39], v[20:23], v[180:183], v[36:39]
    v_mfma_f32_16x16x32_bf16 v[40:43], v[20:23], v[184:187], v[40:43]
    v_mfma_f32_16x16x32_bf16 v[44:47], v[20:23], v[188:191], v[44:47]
    s_waitcnt lgkmcnt(0)
    v_mfma_f32_16x16x32_bf16 v[48:51], v[24:27], v[176:179], v[48:51]
    v_mfma_f32_16x16x32_bf16 v[52:55], v[24:27], v[180:183], v[52:55]
    v_mfma_f32_16x16x32_bf16 v[56:59], v[24:27], v[184:187], v[56:59]
    v_mfma_f32_16x16x32_bf16 v[60:63], v[24:27], v[188:191], v[60:63]
    s_waitcnt vmcnt(18)
    s_barrier
    ds_read_b128 v[16:19], v28 offset:49152
    ds_read_b128 v[20:23], v28 offset:55296
    s_waitcnt lgkmcnt(1)
    v_mfma_f32_16x16x32_bf16 v[64:67], v[16:19], v[96:99], 0
    ds_read_b128 v[24:27], v29 offset:49152
    s_add_u32 s30, s37, 2752512
    v_mfma_f32_16x16x32_bf16 v[68:71], v[16:19], v[100:103], 0
    s_add_u32 m0, s41, 24576
    s_nop 0
    buffer_load_dwordx4 v11, s[12:15], s30 offen lds
    v_mfma_f32_16x16x32_bf16 v[72:75], v[16:19], v[104:107], 0
    s_add_u32 m0, s41, 25600
    s_nop 0
    buffer_load_dwordx4 v12, s[12:15], s30 offen lds
    v_mfma_f32_16x16x32_bf16 v[76:79], v[16:19], v[108:111], 0
    s_add_u32 m0, s41, 26624
    s_waitcnt lgkmcnt(1)
    v_mfma_f32_16x16x32_bf16 v[80:83], v[20:23], v[96:99], 0
    ds_read_b128 v[16:19], v29 offset:55296
    buffer_load_dwordx4 v13, s[12:15], s30 offen lds
    v_mfma_f32_16x16x32_bf16 v[84:87], v[20:23], v[100:103], 0
    s_add_u32 s30, s38, 2752512
    s_add_u32 m0, s41, 36864
    v_mfma_f32_16x16x32_bf16 v[88:91], v[20:23], v[104:107], 0
    buffer_load_dwordx4 v11, s[12:15], s30 offen lds
    s_add_u32 m0, s41, 37888
    v_mfma_f32_16x16x32_bf16 v[92:95], v[20:23], v[108:111], 0
    buffer_load_dwordx4 v12, s[12:15], s30 offen lds
    s_waitcnt lgkmcnt(1)
    v_mfma_f32_16x16x32_bf16 v[64:67], v[24:27], v[112:115], v[64:67]
    ds_read_b128 v[20:23], v28 offset:49280
    s_add_u32 m0, s41, 38912
    v_mfma_f32_16x16x32_bf16 v[68:71], v[24:27], v[116:119], v[68:71]
    buffer_load_dwordx4 v13, s[12:15], s30 offen lds
    v_cvt_pk_bf16_f32 v32, v32, v48
    v_mfma_f32_16x16x32_bf16 v[72:75], v[24:27], v[120:123], v[72:75]
    v_cvt_pk_bf16_f32 v33, v33, v49
    v_cvt_pk_bf16_f32 v34, v34, v50
    v_mfma_f32_16x16x32_bf16 v[76:79], v[24:27], v[124:127], v[76:79]
    v_cvt_pk_bf16_f32 v35, v35, v51
    s_waitcnt lgkmcnt(1)
    v_mfma_f32_16x16x32_bf16 v[80:83], v[16:19], v[112:115], v[80:83]
    ds_read_b128 v[24:27], v28 offset:55424
    v_accvgpr_write_b32 a32, v32
    v_mfma_f32_16x16x32_bf16 v[84:87], v[16:19], v[116:119], v[84:87]
    v_accvgpr_write_b32 a33, v33
    v_accvgpr_write_b32 a34, v34
    v_mfma_f32_16x16x32_bf16 v[88:91], v[16:19], v[120:123], v[88:91]
    v_accvgpr_write_b32 a35, v35
    v_cvt_pk_bf16_f32 v36, v36, v52
    v_mfma_f32_16x16x32_bf16 v[92:95], v[16:19], v[124:127], v[92:95]
    v_cvt_pk_bf16_f32 v37, v37, v53
    s_waitcnt lgkmcnt(1)
    v_mfma_f32_16x16x32_bf16 v[64:67], v[20:23], v[128:131], v[64:67]
    ds_read_b128 v[16:19], v29 offset:49280
    v_cvt_pk_bf16_f32 v38, v38, v54
    v_mfma_f32_16x16x32_bf16 v[68:71], v[20:23], v[132:135], v[68:71]
    v_cvt_pk_bf16_f32 v39, v39, v55
    v_accvgpr_write_b32 a40, v36
    v_mfma_f32_16x16x32_bf16 v[72:75], v[20:23], v[136:139], v[72:75]
    v_accvgpr_write_b32 a41, v37
    v_accvgpr_write_b32 a42, v38
    v_mfma_f32_16x16x32_bf16 v[76:79], v[20:23], v[140:143], v[76:79]
    v_accvgpr_write_b32 a43, v39
    s_waitcnt lgkmcnt(1)
    v_mfma_f32_16x16x32_bf16 v[80:83], v[24:27], v[128:131], v[80:83]
    ds_read_b128 v[20:23], v29 offset:55424
    v_cvt_pk_bf16_f32 v40, v40, v56
    v_mfma_f32_16x16x32_bf16 v[84:87], v[24:27], v[132:135], v[84:87]
    v_cvt_pk_bf16_f32 v41, v41, v57
    v_cvt_pk_bf16_f32 v42, v42, v58
    v_mfma_f32_16x16x32_bf16 v[88:91], v[24:27], v[136:139], v[88:91]
    v_cvt_pk_bf16_f32 v43, v43, v59
    v_accvgpr_write_b32 a48, v40
    v_mfma_f32_16x16x32_bf16 v[92:95], v[24:27], v[140:143], v[92:95]
    v_accvgpr_write_b32 a49, v41
    s_waitcnt lgkmcnt(1)
    v_mfma_f32_16x16x32_bf16 v[64:67], v[16:19], v[144:147], v[64:67]
    ds_read_b128 v[24:27], v28 offset:49408
    v_accvgpr_write_b32 a50, v42
    v_mfma_f32_16x16x32_bf16 v[68:71], v[16:19], v[148:151], v[68:71]
    v_accvgpr_write_b32 a51, v43
    v_cvt_pk_bf16_f32 v44, v44, v60
    v_mfma_f32_16x16x32_bf16 v[72:75], v[16:19], v[152:155], v[72:75]
    v_cvt_pk_bf16_f32 v45, v45, v61
    v_cvt_pk_bf16_f32 v46, v46, v62
    v_mfma_f32_16x16x32_bf16 v[76:79], v[16:19], v[156:159], v[76:79]
    v_cvt_pk_bf16_f32 v47, v47, v63
    s_waitcnt lgkmcnt(1)
    v_mfma_f32_16x16x32_bf16 v[80:83], v[20:23], v[144:147], v[80:83]
    ds_read_b128 v[16:19], v28 offset:55552
    v_accvgpr_write_b32 a56, v44
    v_mfma_f32_16x16x32_bf16 v[84:87], v[20:23], v[148:151], v[84:87]
    v_accvgpr_write_b32 a57, v45
    v_accvgpr_write_b32 a58, v46
    v_mfma_f32_16x16x32_bf16 v[88:91], v[20:23], v[152:155], v[88:91]
    v_accvgpr_write_b32 a59, v47
    v_mfma_f32_16x16x32_bf16 v[92:95], v[20:23], v[156:159], v[92:95]
    s_waitcnt lgkmcnt(1)
    v_mfma_f32_16x16x32_bf16 v[64:67], v[24:27], v[160:163], v[64:67]
    ds_read_b128 v[20:23], v29 offset:49408
    v_mfma_f32_16x16x32_bf16 v[68:71], v[24:27], v[164:167], v[68:71]
    v_mfma_f32_16x16x32_bf16 v[72:75], v[24:27], v[168:171], v[72:75]
    v_mfma_f32_16x16x32_bf16 v[76:79], v[24:27], v[172:175], v[76:79]
    s_waitcnt lgkmcnt(1)
    v_mfma_f32_16x16x32_bf16 v[80:83], v[16:19], v[160:163], v[80:83]
    ds_read_b128 v[24:27], v29 offset:55552
    v_mfma_f32_16x16x32_bf16 v[84:87], v[16:19], v[164:167], v[84:87]
    v_mfma_f32_16x16x32_bf16 v[88:91], v[16:19], v[168:171], v[88:91]
    v_mfma_f32_16x16x32_bf16 v[92:95], v[16:19], v[172:175], v[92:95]
    s_waitcnt lgkmcnt(1)
    v_mfma_f32_16x16x32_bf16 v[64:67], v[20:23], v[176:179], v[64:67]
    v_mfma_f32_16x16x32_bf16 v[68:71], v[20:23], v[180:183], v[68:71]
    v_mfma_f32_16x16x32_bf16 v[72:75], v[20:23], v[184:187], v[72:75]
    v_mfma_f32_16x16x32_bf16 v[76:79], v[20:23], v[188:191], v[76:79]
    s_waitcnt lgkmcnt(0)
    v_mfma_f32_16x16x32_bf16 v[80:83], v[24:27], v[176:179], v[80:83]
    v_mfma_f32_16x16x32_bf16 v[84:87], v[24:27], v[180:183], v[84:87]
    v_mfma_f32_16x16x32_bf16 v[88:91], v[24:27], v[184:187], v[88:91]
    v_mfma_f32_16x16x32_bf16 v[92:95], v[24:27], v[188:191], v[92:95]
    s_waitcnt vmcnt(18)
    s_barrier
    ds_read_b128 v[16:19], v30 offset:8192
    ds_read_b128 v[20:23], v30 offset:14336
    s_waitcnt lgkmcnt(1)
    v_mfma_f32_16x16x32_bf16 v[32:35], v[16:19], v[96:99], 0
    ds_read_b128 v[24:27], v31 offset:8192
    s_add_u32 s30, s37, 3145728
    v_mfma_f32_16x16x32_bf16 v[36:39], v[16:19], v[100:103], 0
    s_add_u32 m0, s41, 49152
    s_nop 0
    buffer_load_dwordx4 v11, s[12:15], s30 offen lds
    v_mfma_f32_16x16x32_bf16 v[40:43], v[16:19], v[104:107], 0
    s_add_u32 m0, s41, 50176
    s_nop 0
    buffer_load_dwordx4 v12, s[12:15], s30 offen lds
    v_mfma_f32_16x16x32_bf16 v[44:47], v[16:19], v[108:111], 0
    s_add_u32 m0, s41, 51200
    s_waitcnt lgkmcnt(1)
    v_mfma_f32_16x16x32_bf16 v[48:51], v[20:23], v[96:99], 0
    ds_read_b128 v[16:19], v31 offset:14336
    buffer_load_dwordx4 v13, s[12:15], s30 offen lds
    v_mfma_f32_16x16x32_bf16 v[52:55], v[20:23], v[100:103], 0
    s_add_u32 s30, s38, 3145728
    s_add_u32 m0, s41, 61440
    v_mfma_f32_16x16x32_bf16 v[56:59], v[20:23], v[104:107], 0
    buffer_load_dwordx4 v11, s[12:15], s30 offen lds
    s_add_u32 m0, s41, 62464
    v_mfma_f32_16x16x32_bf16 v[60:63], v[20:23], v[108:111], 0
    buffer_load_dwordx4 v12, s[12:15], s30 offen lds
    s_waitcnt lgkmcnt(1)
    v_mfma_f32_16x16x32_bf16 v[32:35], v[24:27], v[112:115], v[32:35]
    ds_read_b128 v[20:23], v30 offset:8320
    s_add_u32 m0, s41, 63488
    v_mfma_f32_16x16x32_bf16 v[36:39], v[24:27], v[116:119], v[36:39]
    buffer_load_dwordx4 v13, s[12:15], s30 offen lds
    v_cvt_pk_bf16_f32 v64, v64, v80
    v_mfma_f32_16x16x32_bf16 v[40:43], v[24:27], v[120:123], v[40:43]
    v_cvt_pk_bf16_f32 v65, v65, v81
    v_cvt_pk_bf16_f32 v66, v66, v82
    v_mfma_f32_16x16x32_bf16 v[44:47], v[24:27], v[124:127], v[44:47]
    v_cvt_pk_bf16_f32 v67, v67, v83
    s_waitcnt lgkmcnt(1)
    v_mfma_f32_16x16x32_bf16 v[48:51], v[16:19], v[112:115], v[48:51]
    ds_read_b128 v[24:27], v30 offset:14464
    v_accvgpr_write_b32 a36, v64
    v_mfma_f32_16x16x32_bf16 v[52:55], v[16:19], v[116:119], v[52:55]
    v_accvgpr_write_b32 a37, v65
    v_accvgpr_write_b32 a38, v66
    v_mfma_f32_16x16x32_bf16 v[56:59], v[16:19], v[120:123], v[56:59]
    v_accvgpr_write_b32 a39, v67
    v_cvt_pk_bf16_f32 v68, v68, v84
    v_mfma_f32_16x16x32_bf16 v[60:63], v[16:19], v[124:127], v[60:63]
    v_cvt_pk_bf16_f32 v69, v69, v85
    s_waitcnt lgkmcnt(1)
    v_mfma_f32_16x16x32_bf16 v[32:35], v[20:23], v[128:131], v[32:35]
    ds_read_b128 v[16:19], v31 offset:8320
    v_cvt_pk_bf16_f32 v70, v70, v86
    v_mfma_f32_16x16x32_bf16 v[36:39], v[20:23], v[132:135], v[36:39]
    v_cvt_pk_bf16_f32 v71, v71, v87
    v_accvgpr_write_b32 a44, v68
    v_mfma_f32_16x16x32_bf16 v[40:43], v[20:23], v[136:139], v[40:43]
    v_accvgpr_write_b32 a45, v69
    v_accvgpr_write_b32 a46, v70
    v_mfma_f32_16x16x32_bf16 v[44:47], v[20:23], v[140:143], v[44:47]
    v_accvgpr_write_b32 a47, v71
    s_waitcnt lgkmcnt(1)
    v_mfma_f32_16x16x32_bf16 v[48:51], v[24:27], v[128:131], v[48:51]
    ds_read_b128 v[20:23], v31 offset:14464
    v_cvt_pk_bf16_f32 v72, v72, v88
    v_mfma_f32_16x16x32_bf16 v[52:55], v[24:27], v[132:135], v[52:55]
    v_cvt_pk_bf16_f32 v73, v73, v89
    v_cvt_pk_bf16_f32 v74, v74, v90
    v_mfma_f32_16x16x32_bf16 v[56:59], v[24:27], v[136:139], v[56:59]
    v_cvt_pk_bf16_f32 v75, v75, v91
    v_accvgpr_write_b32 a52, v72
    v_mfma_f32_16x16x32_bf16 v[60:63], v[24:27], v[140:143], v[60:63]
    v_accvgpr_write_b32 a53, v73
    s_waitcnt lgkmcnt(1)
    v_mfma_f32_16x16x32_bf16 v[32:35], v[16:19], v[144:147], v[32:35]
    ds_read_b128 v[24:27], v30 offset:8448
    v_accvgpr_write_b32 a54, v74
    v_mfma_f32_16x16x32_bf16 v[36:39], v[16:19], v[148:151], v[36:39]
    v_accvgpr_write_b32 a55, v75
    v_cvt_pk_bf16_f32 v76, v76, v92
    v_mfma_f32_16x16x32_bf16 v[40:43], v[16:19], v[152:155], v[40:43]
    v_cvt_pk_bf16_f32 v77, v77, v93
    v_cvt_pk_bf16_f32 v78, v78, v94
    v_mfma_f32_16x16x32_bf16 v[44:47], v[16:19], v[156:159], v[44:47]
    v_cvt_pk_bf16_f32 v79, v79, v95
    s_waitcnt lgkmcnt(1)
    v_mfma_f32_16x16x32_bf16 v[48:51], v[20:23], v[144:147], v[48:51]
    ds_read_b128 v[16:19], v30 offset:14592
    v_accvgpr_write_b32 a60, v76
    v_mfma_f32_16x16x32_bf16 v[52:55], v[20:23], v[148:151], v[52:55]
    v_accvgpr_write_b32 a61, v77
    v_accvgpr_write_b32 a62, v78
    v_mfma_f32_16x16x32_bf16 v[56:59], v[20:23], v[152:155], v[56:59]
    v_accvgpr_write_b32 a63, v79
    v_mfma_f32_16x16x32_bf16 v[60:63], v[20:23], v[156:159], v[60:63]
    s_waitcnt lgkmcnt(1)
    v_mfma_f32_16x16x32_bf16 v[32:35], v[24:27], v[160:163], v[32:35]
    ds_read_b128 v[20:23], v31 offset:8448
    v_mfma_f32_16x16x32_bf16 v[36:39], v[24:27], v[164:167], v[36:39]
    v_mfma_f32_16x16x32_bf16 v[40:43], v[24:27], v[168:171], v[40:43]
    v_mfma_f32_16x16x32_bf16 v[44:47], v[24:27], v[172:175], v[44:47]
    s_waitcnt lgkmcnt(1)
    v_mfma_f32_16x16x32_bf16 v[48:51], v[16:19], v[160:163], v[48:51]
    ds_read_b128 v[24:27], v31 offset:14592
    v_mfma_f32_16x16x32_bf16 v[52:55], v[16:19], v[164:167], v[52:55]
    v_mfma_f32_16x16x32_bf16 v[56:59], v[16:19], v[168:171], v[56:59]
    v_mfma_f32_16x16x32_bf16 v[60:63], v[16:19], v[172:175], v[60:63]
    s_waitcnt lgkmcnt(1)
    v_mfma_f32_16x16x32_bf16 v[32:35], v[20:23], v[176:179], v[32:35]
    v_mfma_f32_16x16x32_bf16 v[36:39], v[20:23], v[180:183], v[36:39]
    v_mfma_f32_16x16x32_bf16 v[40:43], v[20:23], v[184:187], v[40:43]
    v_mfma_f32_16x16x32_bf16 v[44:47], v[20:23], v[188:191], v[44:47]
    s_waitcnt lgkmcnt(0)
    v_mfma_f32_16x16x32_bf16 v[48:51], v[24:27], v[176:179], v[48:51]
    v_mfma_f32_16x16x32_bf16 v[52:55], v[24:27], v[180:183], v[52:55]
    v_mfma_f32_16x16x32_bf16 v[56:59], v[24:27], v[184:187], v[56:59]
    v_mfma_f32_16x16x32_bf16 v[60:63], v[24:27], v[188:191], v[60:63]
    s_waitcnt vmcnt(18)
    s_barrier
    ds_read_b128 v[16:19], v30 offset:32768
    ds_read_b128 v[20:23], v30 offset:38912
    s_waitcnt lgkmcnt(1)
    v_mfma_f32_16x16x32_bf16 v[64:67], v[16:19], v[96:99], 0
    ds_read_b128 v[24:27], v31 offset:32768
    s_add_u32 s30, s37, 3538944
    v_mfma_f32_16x16x32_bf16 v[68:71], v[16:19], v[100:103], 0
    s_add_u32 m0, s41, 73728
    s_nop 0
    buffer_load_dwordx4 v11, s[12:15], s30 offen lds
    v_mfma_f32_16x16x32_bf16 v[72:75], v[16:19], v[104:107], 0
    s_add_u32 m0, s41, 74752
    s_nop 0
    buffer_load_dwordx4 v12, s[12:15], s30 offen lds
    v_mfma_f32_16x16x32_bf16 v[76:79], v[16:19], v[108:111], 0
    s_add_u32 m0, s41, 75776
    s_waitcnt lgkmcnt(1)
    v_mfma_f32_16x16x32_bf16 v[80:83], v[20:23], v[96:99], 0
    ds_read_b128 v[16:19], v31 offset:38912
    buffer_load_dwordx4 v13, s[12:15], s30 offen lds
    v_mfma_f32_16x16x32_bf16 v[84:87], v[20:23], v[100:103], 0
    s_add_u32 s30, s38, 3538944
    s_add_u32 m0, s41, 86016
    v_mfma_f32_16x16x32_bf16 v[88:91], v[20:23], v[104:107], 0
    buffer_load_dwordx4 v11, s[12:15], s30 offen lds
    s_add_u32 m0, s41, 87040
    v_mfma_f32_16x16x32_bf16 v[92:95], v[20:23], v[108:111], 0
    buffer_load_dwordx4 v12, s[12:15], s30 offen lds
    s_waitcnt lgkmcnt(1)
    v_mfma_f32_16x16x32_bf16 v[64:67], v[24:27], v[112:115], v[64:67]
    ds_read_b128 v[20:23], v30 offset:32896
    s_add_u32 m0, s41, 88064
    v_mfma_f32_16x16x32_bf16 v[68:71], v[24:27], v[116:119], v[68:71]
    buffer_load_dwordx4 v13, s[12:15], s30 offen lds
    v_cvt_pk_bf16_f32 v32, v32, v48
    v_mfma_f32_16x16x32_bf16 v[72:75], v[24:27], v[120:123], v[72:75]
    v_cvt_pk_bf16_f32 v33, v33, v49
    v_cvt_pk_bf16_f32 v34, v34, v50
    v_mfma_f32_16x16x32_bf16 v[76:79], v[24:27], v[124:127], v[76:79]
    v_cvt_pk_bf16_f32 v35, v35, v51
    s_waitcnt lgkmcnt(1)
    v_mfma_f32_16x16x32_bf16 v[80:83], v[16:19], v[112:115], v[80:83]
    ds_read_b128 v[24:27], v30 offset:39040
    v_accvgpr_write_b32 a64, v32
    v_mfma_f32_16x16x32_bf16 v[84:87], v[16:19], v[116:119], v[84:87]
    v_accvgpr_write_b32 a65, v33
    v_accvgpr_write_b32 a66, v34
    v_mfma_f32_16x16x32_bf16 v[88:91], v[16:19], v[120:123], v[88:91]
    v_accvgpr_write_b32 a67, v35
    v_cvt_pk_bf16_f32 v36, v36, v52
    v_mfma_f32_16x16x32_bf16 v[92:95], v[16:19], v[124:127], v[92:95]
    v_cvt_pk_bf16_f32 v37, v37, v53
    s_waitcnt lgkmcnt(1)
    v_mfma_f32_16x16x32_bf16 v[64:67], v[20:23], v[128:131], v[64:67]
    ds_read_b128 v[16:19], v31 offset:32896
    v_cvt_pk_bf16_f32 v38, v38, v54
    v_mfma_f32_16x16x32_bf16 v[68:71], v[20:23], v[132:135], v[68:71]
    v_cvt_pk_bf16_f32 v39, v39, v55
    v_accvgpr_write_b32 a72, v36
    v_mfma_f32_16x16x32_bf16 v[72:75], v[20:23], v[136:139], v[72:75]
    v_accvgpr_write_b32 a73, v37
    v_accvgpr_write_b32 a74, v38
    v_mfma_f32_16x16x32_bf16 v[76:79], v[20:23], v[140:143], v[76:79]
    v_accvgpr_write_b32 a75, v39
    s_waitcnt lgkmcnt(1)
    v_mfma_f32_16x16x32_bf16 v[80:83], v[24:27], v[128:131], v[80:83]
    ds_read_b128 v[20:23], v31 offset:39040
    v_cvt_pk_bf16_f32 v40, v40, v56
    v_mfma_f32_16x16x32_bf16 v[84:87], v[24:27], v[132:135], v[84:87]
    v_cvt_pk_bf16_f32 v41, v41, v57
    v_cvt_pk_bf16_f32 v42, v42, v58
    v_mfma_f32_16x16x32_bf16 v[88:91], v[24:27], v[136:139], v[88:91]
    v_cvt_pk_bf16_f32 v43, v43, v59
    v_accvgpr_write_b32 a80, v40
    v_mfma_f32_16x16x32_bf16 v[92:95], v[24:27], v[140:143], v[92:95]
    v_accvgpr_write_b32 a81, v41
    s_waitcnt lgkmcnt(1)
    v_mfma_f32_16x16x32_bf16 v[64:67], v[16:19], v[144:147], v[64:67]
    ds_read_b128 v[24:27], v30 offset:33024
    v_accvgpr_write_b32 a82, v42
    v_mfma_f32_16x16x32_bf16 v[68:71], v[16:19], v[148:151], v[68:71]
    v_accvgpr_write_b32 a83, v43
    v_cvt_pk_bf16_f32 v44, v44, v60
    v_mfma_f32_16x16x32_bf16 v[72:75], v[16:19], v[152:155], v[72:75]
    v_cvt_pk_bf16_f32 v45, v45, v61
    v_cvt_pk_bf16_f32 v46, v46, v62
    v_mfma_f32_16x16x32_bf16 v[76:79], v[16:19], v[156:159], v[76:79]
    v_cvt_pk_bf16_f32 v47, v47, v63
    s_waitcnt lgkmcnt(1)
    v_mfma_f32_16x16x32_bf16 v[80:83], v[20:23], v[144:147], v[80:83]
    ds_read_b128 v[16:19], v30 offset:39168
    v_accvgpr_write_b32 a88, v44
    v_mfma_f32_16x16x32_bf16 v[84:87], v[20:23], v[148:151], v[84:87]
    v_accvgpr_write_b32 a89, v45
    v_accvgpr_write_b32 a90, v46
    v_mfma_f32_16x16x32_bf16 v[88:91], v[20:23], v[152:155], v[88:91]
    v_accvgpr_write_b32 a91, v47
    v_mfma_f32_16x16x32_bf16 v[92:95], v[20:23], v[156:159], v[92:95]
    s_waitcnt lgkmcnt(1)
    v_mfma_f32_16x16x32_bf16 v[64:67], v[24:27], v[160:163], v[64:67]
    ds_read_b128 v[20:23], v31 offset:33024
    v_mfma_f32_16x16x32_bf16 v[68:71], v[24:27], v[164:167], v[68:71]
    v_mfma_f32_16x16x32_bf16 v[72:75], v[24:27], v[168:171], v[72:75]
    v_mfma_f32_16x16x32_bf16 v[76:79], v[24:27], v[172:175], v[76:79]
    s_waitcnt lgkmcnt(1)
    v_mfma_f32_16x16x32_bf16 v[80:83], v[16:19], v[160:163], v[80:83]
    ds_read_b128 v[24:27], v31 offset:39168
    v_mfma_f32_16x16x32_bf16 v[84:87], v[16:19], v[164:167], v[84:87]
    v_mfma_f32_16x16x32_bf16 v[88:91], v[16:19], v[168:171], v[88:91]
    v_mfma_f32_16x16x32_bf16 v[92:95], v[16:19], v[172:175], v[92:95]
    s_waitcnt lgkmcnt(1)
    v_mfma_f32_16x16x32_bf16 v[64:67], v[20:23], v[176:179], v[64:67]
    v_mfma_f32_16x16x32_bf16 v[68:71], v[20:23], v[180:183], v[68:71]
    v_mfma_f32_16x16x32_bf16 v[72:75], v[20:23], v[184:187], v[72:75]
    v_mfma_f32_16x16x32_bf16 v[76:79], v[20:23], v[188:191], v[76:79]
    s_waitcnt lgkmcnt(0)
    v_mfma_f32_16x16x32_bf16 v[80:83], v[24:27], v[176:179], v[80:83]
    v_mfma_f32_16x16x32_bf16 v[84:87], v[24:27], v[180:183], v[84:87]
    v_mfma_f32_16x16x32_bf16 v[88:91], v[24:27], v[184:187], v[88:91]
    v_mfma_f32_16x16x32_bf16 v[92:95], v[24:27], v[188:191], v[92:95]
    s_waitcnt vmcnt(18)
    s_barrier
    ds_read_b128 v[16:19], v28 offset:0
    ds_read_b128 v[20:23], v28 offset:6144
    s_waitcnt lgkmcnt(1)
    v_mfma_f32_16x16x32_bf16 v[32:35], v[16:19], v[96:99], 0
    ds_read_b128 v[24:27], v29 offset:0
    s_add_u32 s30, s37, 3932160
    v_mfma_f32_16x16x32_bf16 v[36:39], v[16:19], v[100:103], 0
    s_add_u32 m0, s41, 98304
    s_nop 0
    buffer_load_dwordx4 v11, s[12:15], s30 offen lds
    v_mfma_f32_16x16x32_bf16 v[40:43], v[16:19], v[104:107], 0
    s_add_u32 m0, s41, 99328
    s_nop 0
    buffer_load_dwordx4 v12, s[12:15], s30 offen lds
    v_mfma_f32_16x16x32_bf16 v[44:47], v[16:19], v[108:111], 0
    s_add_u32 m0, s41, 100352
    s_waitcnt lgkmcnt(1)
    v_mfma_f32_16x16x32_bf16 v[48:51], v[20:23], v[96:99], 0
    ds_read_b128 v[16:19], v29 offset:6144
    buffer_load_dwordx4 v13, s[12:15], s30 offen lds
    v_mfma_f32_16x16x32_bf16 v[52:55], v[20:23], v[100:103], 0
    s_add_u32 s30, s38, 3932160
    s_add_u32 m0, s41, 110592
    v_mfma_f32_16x16x32_bf16 v[56:59], v[20:23], v[104:107], 0
    buffer_load_dwordx4 v11, s[12:15], s30 offen lds
    s_add_u32 m0, s41, 111616
    v_mfma_f32_16x16x32_bf16 v[60:63], v[20:23], v[108:111], 0
    buffer_load_dwordx4 v12, s[12:15], s30 offen lds
    s_waitcnt lgkmcnt(1)
    v_mfma_f32_16x16x32_bf16 v[32:35], v[24:27], v[112:115], v[32:35]
    ds_read_b128 v[20:23], v28 offset:128
    s_add_u32 m0, s41, 112640
    v_mfma_f32_16x16x32_bf16 v[36:39], v[24:27], v[116:119], v[36:39]
    buffer_load_dwordx4 v13, s[12:15], s30 offen lds
    v_cvt_pk_bf16_f32 v64, v64, v80
    v_mfma_f32_16x16x32_bf16 v[40:43], v[24:27], v[120:123], v[40:43]
    v_cvt_pk_bf16_f32 v65, v65, v81
    v_cvt_pk_bf16_f32 v66, v66, v82
    v_mfma_f32_16x16x32_bf16 v[44:47], v[24:27], v[124:127], v[44:47]
    v_cvt_pk_bf16_f32 v67, v67, v83
    s_waitcnt lgkmcnt(1)
    v_mfma_f32_16x16x32_bf16 v[48:51], v[16:19], v[112:115], v[48:51]
    ds_read_b128 v[24:27], v28 offset:6272
    v_accvgpr_write_b32 a68, v64
    v_mfma_f32_16x16x32_bf16 v[52:55], v[16:19], v[116:119], v[52:55]
    v_accvgpr_write_b32 a69, v65
    v_accvgpr_write_b32 a70, v66
    v_mfma_f32_16x16x32_bf16 v[56:59], v[16:19], v[120:123], v[56:59]
    v_accvgpr_write_b32 a71, v67
    v_cvt_pk_bf16_f32 v68, v68, v84
    v_mfma_f32_16x16x32_bf16 v[60:63], v[16:19], v[124:127], v[60:63]
    v_cvt_pk_bf16_f32 v69, v69, v85
    s_waitcnt lgkmcnt(1)
    v_mfma_f32_16x16x32_bf16 v[32:35], v[20:23], v[128:131], v[32:35]
    ds_read_b128 v[16:19], v29 offset:128
    v_cvt_pk_bf16_f32 v70, v70, v86
    v_mfma_f32_16x16x32_bf16 v[36:39], v[20:23], v[132:135], v[36:39]
    v_cvt_pk_bf16_f32 v71, v71, v87
    v_accvgpr_write_b32 a76, v68
    v_mfma_f32_16x16x32_bf16 v[40:43], v[20:23], v[136:139], v[40:43]
    v_accvgpr_write_b32 a77, v69
    v_accvgpr_write_b32 a78, v70
    v_mfma_f32_16x16x32_bf16 v[44:47], v[20:23], v[140:143], v[44:47]
    v_accvgpr_write_b32 a79, v71
    s_waitcnt lgkmcnt(1)
    v_mfma_f32_16x16x32_bf16 v[48:51], v[24:27], v[128:131], v[48:51]
    ds_read_b128 v[20:23], v29 offset:6272
    v_cvt_pk_bf16_f32 v72, v72, v88
    v_mfma_f32_16x16x32_bf16 v[52:55], v[24:27], v[132:135], v[52:55]
    v_cvt_pk_bf16_f32 v73, v73, v89
    v_cvt_pk_bf16_f32 v74, v74, v90
    v_mfma_f32_16x16x32_bf16 v[56:59], v[24:27], v[136:139], v[56:59]
    v_cvt_pk_bf16_f32 v75, v75, v91
    v_accvgpr_write_b32 a84, v72
    v_mfma_f32_16x16x32_bf16 v[60:63], v[24:27], v[140:143], v[60:63]
    v_accvgpr_write_b32 a85, v73
    s_waitcnt lgkmcnt(1)
    v_mfma_f32_16x16x32_bf16 v[32:35], v[16:19], v[144:147], v[32:35]
    ds_read_b128 v[24:27], v28 offset:256
    v_accvgpr_write_b32 a86, v74
    v_mfma_f32_16x16x32_bf16 v[36:39], v[16:19], v[148:151], v[36:39]
    v_accvgpr_write_b32 a87, v75
    v_cvt_pk_bf16_f32 v76, v76, v92
    v_mfma_f32_16x16x32_bf16 v[40:43], v[16:19], v[152:155], v[40:43]
    v_cvt_pk_bf16_f32 v77, v77, v93
    v_cvt_pk_bf16_f32 v78, v78, v94
    v_mfma_f32_16x16x32_bf16 v[44:47], v[16:19], v[156:159], v[44:47]
    v_cvt_pk_bf16_f32 v79, v79, v95
    s_waitcnt lgkmcnt(1)
    v_mfma_f32_16x16x32_bf16 v[48:51], v[20:23], v[144:147], v[48:51]
    ds_read_b128 v[16:19], v28 offset:6400
    v_accvgpr_write_b32 a92, v76
    v_mfma_f32_16x16x32_bf16 v[52:55], v[20:23], v[148:151], v[52:55]
    v_accvgpr_write_b32 a93, v77
    v_accvgpr_write_b32 a94, v78
    v_mfma_f32_16x16x32_bf16 v[56:59], v[20:23], v[152:155], v[56:59]
    v_accvgpr_write_b32 a95, v79
    v_mfma_f32_16x16x32_bf16 v[60:63], v[20:23], v[156:159], v[60:63]
    s_waitcnt lgkmcnt(1)
    v_mfma_f32_16x16x32_bf16 v[32:35], v[24:27], v[160:163], v[32:35]
    ds_read_b128 v[20:23], v29 offset:256
    v_mfma_f32_16x16x32_bf16 v[36:39], v[24:27], v[164:167], v[36:39]
    v_mfma_f32_16x16x32_bf16 v[40:43], v[24:27], v[168:171], v[40:43]
    v_mfma_f32_16x16x32_bf16 v[44:47], v[24:27], v[172:175], v[44:47]
    s_waitcnt lgkmcnt(1)
    v_mfma_f32_16x16x32_bf16 v[48:51], v[16:19], v[160:163], v[48:51]
    ds_read_b128 v[24:27], v29 offset:6400
    v_mfma_f32_16x16x32_bf16 v[52:55], v[16:19], v[164:167], v[52:55]
    v_mfma_f32_16x16x32_bf16 v[56:59], v[16:19], v[168:171], v[56:59]
    v_mfma_f32_16x16x32_bf16 v[60:63], v[16:19], v[172:175], v[60:63]
    s_waitcnt lgkmcnt(1)
    v_mfma_f32_16x16x32_bf16 v[32:35], v[20:23], v[176:179], v[32:35]
    v_mfma_f32_16x16x32_bf16 v[36:39], v[20:23], v[180:183], v[36:39]
    v_mfma_f32_16x16x32_bf16 v[40:43], v[20:23], v[184:187], v[40:43]
    v_mfma_f32_16x16x32_bf16 v[44:47], v[20:23], v[188:191], v[44:47]
    s_waitcnt lgkmcnt(0)
    v_mfma_f32_16x16x32_bf16 v[48:51], v[24:27], v[176:179], v[48:51]
    v_mfma_f32_16x16x32_bf16 v[52:55], v[24:27], v[180:183], v[52:55]
    v_mfma_f32_16x16x32_bf16 v[56:59], v[24:27], v[184:187], v[56:59]
    v_mfma_f32_16x16x32_bf16 v[60:63], v[24:27], v[188:191], v[60:63]
    s_waitcnt vmcnt(18)
    s_barrier
    ds_read_b128 v[16:19], v28 offset:24576
    ds_read_b128 v[20:23], v28 offset:30720
    s_waitcnt lgkmcnt(1)
    v_mfma_f32_16x16x32_bf16 v[64:67], v[16:19], v[96:99], 0
    ds_read_b128 v[24:27], v29 offset:24576
    s_add_u32 s30, s37, 4325376
    v_mfma_f32_16x16x32_bf16 v[68:71], v[16:19], v[100:103], 0
    s_add_u32 m0, s41, 0
    s_nop 0
    buffer_load_dwordx4 v11, s[12:15], s30 offen lds
    v_mfma_f32_16x16x32_bf16 v[72:75], v[16:19], v[104:107], 0
    s_add_u32 m0, s41, 1024
    s_nop 0
    buffer_load_dwordx4 v12, s[12:15], s30 offen lds
    v_mfma_f32_16x16x32_bf16 v[76:79], v[16:19], v[108:111], 0
    s_add_u32 m0, s41, 2048
    s_waitcnt lgkmcnt(1)
    v_mfma_f32_16x16x32_bf16 v[80:83], v[20:23], v[96:99], 0
    ds_read_b128 v[16:19], v29 offset:30720
    buffer_load_dwordx4 v13, s[12:15], s30 offen lds
    v_mfma_f32_16x16x32_bf16 v[84:87], v[20:23], v[100:103], 0
    s_add_u32 s30, s38, 4325376
    s_add_u32 m0, s41, 12288
    v_mfma_f32_16x16x32_bf16 v[88:91], v[20:23], v[104:107], 0
    buffer_load_dwordx4 v11, s[12:15], s30 offen lds
    s_add_u32 m0, s41, 13312
    v_mfma_f32_16x16x32_bf16 v[92:95], v[20:23], v[108:111], 0
    buffer_load_dwordx4 v12, s[12:15], s30 offen lds
    s_waitcnt lgkmcnt(1)
    v_mfma_f32_16x16x32_bf16 v[64:67], v[24:27], v[112:115], v[64:67]
    ds_read_b128 v[20:23], v28 offset:24704
    s_add_u32 m0, s41, 14336
    v_mfma_f32_16x16x32_bf16 v[68:71], v[24:27], v[116:119], v[68:71]
    buffer_load_dwordx4 v13, s[12:15], s30 offen lds
    v_cvt_pk_bf16_f32 v32, v32, v48
    v_mfma_f32_16x16x32_bf16 v[72:75], v[24:27], v[120:123], v[72:75]
    v_cvt_pk_bf16_f32 v33, v33, v49
    v_cvt_pk_bf16_f32 v34, v34, v50
    v_mfma_f32_16x16x32_bf16 v[76:79], v[24:27], v[124:127], v[76:79]
    v_cvt_pk_bf16_f32 v35, v35, v51
    s_waitcnt lgkmcnt(1)
    v_mfma_f32_16x16x32_bf16 v[80:83], v[16:19], v[112:115], v[80:83]
    ds_read_b128 v[24:27], v28 offset:30848
    v_accvgpr_write_b32 a96, v32
    v_mfma_f32_16x16x32_bf16 v[84:87], v[16:19], v[116:119], v[84:87]
    v_accvgpr_write_b32 a97, v33
    v_accvgpr_write_b32 a98, v34
    v_mfma_f32_16x16x32_bf16 v[88:91], v[16:19], v[120:123], v[88:91]
    v_accvgpr_write_b32 a99, v35
    v_cvt_pk_bf16_f32 v36, v36, v52
    v_mfma_f32_16x16x32_bf16 v[92:95], v[16:19], v[124:127], v[92:95]
    v_cvt_pk_bf16_f32 v37, v37, v53
    s_waitcnt lgkmcnt(1)
    v_mfma_f32_16x16x32_bf16 v[64:67], v[20:23], v[128:131], v[64:67]
    ds_read_b128 v[16:19], v29 offset:24704
    v_cvt_pk_bf16_f32 v38, v38, v54
    v_mfma_f32_16x16x32_bf16 v[68:71], v[20:23], v[132:135], v[68:71]
    v_cvt_pk_bf16_f32 v39, v39, v55
    v_accvgpr_write_b32 a104, v36
    v_mfma_f32_16x16x32_bf16 v[72:75], v[20:23], v[136:139], v[72:75]
    v_accvgpr_write_b32 a105, v37
    v_accvgpr_write_b32 a106, v38
    v_mfma_f32_16x16x32_bf16 v[76:79], v[20:23], v[140:143], v[76:79]
    v_accvgpr_write_b32 a107, v39
    s_waitcnt lgkmcnt(1)
    v_mfma_f32_16x16x32_bf16 v[80:83], v[24:27], v[128:131], v[80:83]
    ds_read_b128 v[20:23], v29 offset:30848
    v_cvt_pk_bf16_f32 v40, v40, v56
    v_mfma_f32_16x16x32_bf16 v[84:87], v[24:27], v[132:135], v[84:87]
    v_cvt_pk_bf16_f32 v41, v41, v57
    v_cvt_pk_bf16_f32 v42, v42, v58
    v_mfma_f32_16x16x32_bf16 v[88:91], v[24:27], v[136:139], v[88:91]
    v_cvt_pk_bf16_f32 v43, v43, v59
    v_accvgpr_write_b32 a112, v40
    v_mfma_f32_16x16x32_bf16 v[92:95], v[24:27], v[140:143], v[92:95]
    v_accvgpr_write_b32 a113, v41
    s_waitcnt lgkmcnt(1)
    v_mfma_f32_16x16x32_bf16 v[64:67], v[16:19], v[144:147], v[64:67]
    ds_read_b128 v[24:27], v28 offset:24832
    v_accvgpr_write_b32 a114, v42
    v_mfma_f32_16x16x32_bf16 v[68:71], v[16:19], v[148:151], v[68:71]
    v_accvgpr_write_b32 a115, v43
    v_cvt_pk_bf16_f32 v44, v44, v60
    v_mfma_f32_16x16x32_bf16 v[72:75], v[16:19], v[152:155], v[72:75]
    v_cvt_pk_bf16_f32 v45, v45, v61
    v_cvt_pk_bf16_f32 v46, v46, v62
    v_mfma_f32_16x16x32_bf16 v[76:79], v[16:19], v[156:159], v[76:79]
    v_cvt_pk_bf16_f32 v47, v47, v63
    s_waitcnt lgkmcnt(1)
    v_mfma_f32_16x16x32_bf16 v[80:83], v[20:23], v[144:147], v[80:83]
    ds_read_b128 v[16:19], v28 offset:30976
    v_accvgpr_write_b32 a120, v44
    v_mfma_f32_16x16x32_bf16 v[84:87], v[20:23], v[148:151], v[84:87]
    v_accvgpr_write_b32 a121, v45
    v_accvgpr_write_b32 a122, v46
    v_mfma_f32_16x16x32_bf16 v[88:91], v[20:23], v[152:155], v[88:91]
    v_accvgpr_write_b32 a123, v47
    v_mfma_f32_16x16x32_bf16 v[92:95], v[20:23], v[156:159], v[92:95]
    s_waitcnt lgkmcnt(1)
    v_mfma_f32_16x16x32_bf16 v[64:67], v[24:27], v[160:163], v[64:67]
    ds_read_b128 v[20:23], v29 offset:24832
    v_mfma_f32_16x16x32_bf16 v[68:71], v[24:27], v[164:167], v[68:71]
    v_mfma_f32_16x16x32_bf16 v[72:75], v[24:27], v[168:171], v[72:75]
    v_mfma_f32_16x16x32_bf16 v[76:79], v[24:27], v[172:175], v[76:79]
    s_waitcnt lgkmcnt(1)
    v_mfma_f32_16x16x32_bf16 v[80:83], v[16:19], v[160:163], v[80:83]
    ds_read_b128 v[24:27], v29 offset:30976
    v_mfma_f32_16x16x32_bf16 v[84:87], v[16:19], v[164:167], v[84:87]
    v_mfma_f32_16x16x32_bf16 v[88:91], v[16:19], v[168:171], v[88:91]
    v_mfma_f32_16x16x32_bf16 v[92:95], v[16:19], v[172:175], v[92:95]
    s_waitcnt lgkmcnt(1)
    v_mfma_f32_16x16x32_bf16 v[64:67], v[20:23], v[176:179], v[64:67]
    v_mfma_f32_16x16x32_bf16 v[68:71], v[20:23], v[180:183], v[68:71]
    v_mfma_f32_16x16x32_bf16 v[72:75], v[20:23], v[184:187], v[72:75]
    v_mfma_f32_16x16x32_bf16 v[76:79], v[20:23], v[188:191], v[76:79]
    s_waitcnt lgkmcnt(0)
    v_mfma_f32_16x16x32_bf16 v[80:83], v[24:27], v[176:179], v[80:83]
    v_mfma_f32_16x16x32_bf16 v[84:87], v[24:27], v[180:183], v[84:87]
    v_mfma_f32_16x16x32_bf16 v[88:91], v[24:27], v[184:187], v[88:91]
    v_mfma_f32_16x16x32_bf16 v[92:95], v[24:27], v[188:191], v[92:95]
    s_waitcnt vmcnt(18)
    s_barrier
    ds_read_b128 v[16:19], v28 offset:49152
    ds_read_b128 v[20:23], v28 offset:55296
    s_waitcnt lgkmcnt(1)
    v_mfma_f32_16x16x32_bf16 v[32:35], v[16:19], v[96:99], 0
    ds_read_b128 v[24:27], v29 offset:49152
    s_add_u32 s30, s37, 4718592
    v_mfma_f32_16x16x32_bf16 v[36:39], v[16:19], v[100:103], 0
    s_add_u32 m0, s41, 24576
    s_nop 0
    buffer_load_dwordx4 v11, s[12:15], s30 offen lds
    v_mfma_f32_16x16x32_bf16 v[40:43], v[16:19], v[104:107], 0
    s_add_u32 m0, s41, 25600
    s_nop 0
    buffer_load_dwordx4 v12, s[12:15], s30 offen lds
    v_mfma_f32_16x16x32_bf16 v[44:47], v[16:19], v[108:111], 0
    s_add_u32 m0, s41, 26624
    s_waitcnt lgkmcnt(1)
    v_mfma_f32_16x16x32_bf16 v[48:51], v[20:23], v[96:99], 0
    ds_read_b128 v[16:19], v29 offset:55296
    buffer_load_dwordx4 v13, s[12:15], s30 offen lds
    v_mfma_f32_16x16x32_bf16 v[52:55], v[20:23], v[100:103], 0
    s_add_u32 s30, s38, 4718592
    s_add_u32 m0, s41, 36864
    v_mfma_f32_16x16x32_bf16 v[56:59], v[20:23], v[104:107], 0
    buffer_load_dwordx4 v11, s[12:15], s30 offen lds
    s_add_u32 m0, s41, 37888
    v_mfma_f32_16x16x32_bf16 v[60:63], v[20:23], v[108:111], 0
    buffer_load_dwordx4 v12, s[12:15], s30 offen lds
    s_waitcnt lgkmcnt(1)
    v_mfma_f32_16x16x32_bf16 v[32:35], v[24:27], v[112:115], v[32:35]
    ds_read_b128 v[20:23], v28 offset:49280
    s_add_u32 m0, s41, 38912
    v_mfma_f32_16x16x32_bf16 v[36:39], v[24:27], v[116:119], v[36:39]
    buffer_load_dwordx4 v13, s[12:15], s30 offen lds
    v_cvt_pk_bf16_f32 v64, v64, v80
    v_mfma_f32_16x16x32_bf16 v[40:43], v[24:27], v[120:123], v[40:43]
    v_cvt_pk_bf16_f32 v65, v65, v81
    v_cvt_pk_bf16_f32 v66, v66, v82
    v_mfma_f32_16x16x32_bf16 v[44:47], v[24:27], v[124:127], v[44:47]
    v_cvt_pk_bf16_f32 v67, v67, v83
    s_waitcnt lgkmcnt(1)
    v_mfma_f32_16x16x32_bf16 v[48:51], v[16:19], v[112:115], v[48:51]
    ds_read_b128 v[24:27], v28 offset:55424
    v_accvgpr_write_b32 a100, v64
    v_mfma_f32_16x16x32_bf16 v[52:55], v[16:19], v[116:119], v[52:55]
    v_accvgpr_write_b32 a101, v65
    v_accvgpr_write_b32 a102, v66
    v_mfma_f32_16x16x32_bf16 v[56:59], v[16:19], v[120:123], v[56:59]
    v_accvgpr_write_b32 a103, v67
    v_cvt_pk_bf16_f32 v68, v68, v84
    v_mfma_f32_16x16x32_bf16 v[60:63], v[16:19], v[124:127], v[60:63]
    v_cvt_pk_bf16_f32 v69, v69, v85
    s_waitcnt lgkmcnt(1)
    v_mfma_f32_16x16x32_bf16 v[32:35], v[20:23], v[128:131], v[32:35]
    ds_read_b128 v[16:19], v29 offset:49280
    v_cvt_pk_bf16_f32 v70, v70, v86
    v_mfma_f32_16x16x32_bf16 v[36:39], v[20:23], v[132:135], v[36:39]
    v_cvt_pk_bf16_f32 v71, v71, v87
    v_accvgpr_write_b32 a108, v68
    v_mfma_f32_16x16x32_bf16 v[40:43], v[20:23], v[136:139], v[40:43]
    v_accvgpr_write_b32 a109, v69
    v_accvgpr_write_b32 a110, v70
    v_mfma_f32_16x16x32_bf16 v[44:47], v[20:23], v[140:143], v[44:47]
    v_accvgpr_write_b32 a111, v71
    s_waitcnt lgkmcnt(1)
    v_mfma_f32_16x16x32_bf16 v[48:51], v[24:27], v[128:131], v[48:51]
    ds_read_b128 v[20:23], v29 offset:55424
    v_cvt_pk_bf16_f32 v72, v72, v88
    v_mfma_f32_16x16x32_bf16 v[52:55], v[24:27], v[132:135], v[52:55]
    v_cvt_pk_bf16_f32 v73, v73, v89
    v_cvt_pk_bf16_f32 v74, v74, v90
    v_mfma_f32_16x16x32_bf16 v[56:59], v[24:27], v[136:139], v[56:59]
    v_cvt_pk_bf16_f32 v75, v75, v91
    v_accvgpr_write_b32 a116, v72
    v_mfma_f32_16x16x32_bf16 v[60:63], v[24:27], v[140:143], v[60:63]
    v_accvgpr_write_b32 a117, v73
    s_waitcnt lgkmcnt(1)
    v_mfma_f32_16x16x32_bf16 v[32:35], v[16:19], v[144:147], v[32:35]
    ds_read_b128 v[24:27], v28 offset:49408
    v_accvgpr_write_b32 a118, v74
    v_mfma_f32_16x16x32_bf16 v[36:39], v[16:19], v[148:151], v[36:39]
    v_accvgpr_write_b32 a119, v75
    v_cvt_pk_bf16_f32 v76, v76, v92
    v_mfma_f32_16x16x32_bf16 v[40:43], v[16:19], v[152:155], v[40:43]
    v_cvt_pk_bf16_f32 v77, v77, v93
    v_cvt_pk_bf16_f32 v78, v78, v94
    v_mfma_f32_16x16x32_bf16 v[44:47], v[16:19], v[156:159], v[44:47]
    v_cvt_pk_bf16_f32 v79, v79, v95
    s_waitcnt lgkmcnt(1)
    v_mfma_f32_16x16x32_bf16 v[48:51], v[20:23], v[144:147], v[48:51]
    ds_read_b128 v[16:19], v28 offset:55552
    v_accvgpr_write_b32 a124, v76
    v_mfma_f32_16x16x32_bf16 v[52:55], v[20:23], v[148:151], v[52:55]
    v_accvgpr_write_b32 a125, v77
    v_accvgpr_write_b32 a126, v78
    v_mfma_f32_16x16x32_bf16 v[56:59], v[20:23], v[152:155], v[56:59]
    v_accvgpr_write_b32 a127, v79
    v_mfma_f32_16x16x32_bf16 v[60:63], v[20:23], v[156:159], v[60:63]
    s_waitcnt lgkmcnt(1)
    v_mfma_f32_16x16x32_bf16 v[32:35], v[24:27], v[160:163], v[32:35]
    ds_read_b128 v[20:23], v29 offset:49408
    v_mfma_f32_16x16x32_bf16 v[36:39], v[24:27], v[164:167], v[36:39]
    v_mfma_f32_16x16x32_bf16 v[40:43], v[24:27], v[168:171], v[40:43]
    v_mfma_f32_16x16x32_bf16 v[44:47], v[24:27], v[172:175], v[44:47]
    s_waitcnt lgkmcnt(1)
    v_mfma_f32_16x16x32_bf16 v[48:51], v[16:19], v[160:163], v[48:51]
    ds_read_b128 v[24:27], v29 offset:55552
    v_mfma_f32_16x16x32_bf16 v[52:55], v[16:19], v[164:167], v[52:55]
    v_mfma_f32_16x16x32_bf16 v[56:59], v[16:19], v[168:171], v[56:59]
    v_mfma_f32_16x16x32_bf16 v[60:63], v[16:19], v[172:175], v[60:63]
    s_waitcnt lgkmcnt(1)
    v_mfma_f32_16x16x32_bf16 v[32:35], v[20:23], v[176:179], v[32:35]
    v_mfma_f32_16x16x32_bf16 v[36:39], v[20:23], v[180:183], v[36:39]
    v_mfma_f32_16x16x32_bf16 v[40:43], v[20:23], v[184:187], v[40:43]
    v_mfma_f32_16x16x32_bf16 v[44:47], v[20:23], v[188:191], v[44:47]
    s_waitcnt lgkmcnt(0)
    v_mfma_f32_16x16x32_bf16 v[48:51], v[24:27], v[176:179], v[48:51]
    v_mfma_f32_16x16x32_bf16 v[52:55], v[24:27], v[180:183], v[52:55]
    v_mfma_f32_16x16x32_bf16 v[56:59], v[24:27], v[184:187], v[56:59]
    v_mfma_f32_16x16x32_bf16 v[60:63], v[24:27], v[188:191], v[60:63]
    s_waitcnt vmcnt(18)
    s_barrier
    ds_read_b128 v[16:19], v30 offset:8192
    ds_read_b128 v[20:23], v30 offset:14336
    s_waitcnt lgkmcnt(1)
    v_mfma_f32_16x16x32_bf16 v[64:67], v[16:19], v[96:99], 0
    ds_read_b128 v[24:27], v31 offset:8192
    s_add_u32 s30, s37, 5111808
    v_mfma_f32_16x16x32_bf16 v[68:71], v[16:19], v[100:103], 0
    s_add_u32 m0, s41, 49152
    s_nop 0
    buffer_load_dwordx4 v11, s[12:15], s30 offen lds
    v_mfma_f32_16x16x32_bf16 v[72:75], v[16:19], v[104:107], 0
    s_add_u32 m0, s41, 50176
    s_nop 0
    buffer_load_dwordx4 v12, s[12:15], s30 offen lds
    v_mfma_f32_16x16x32_bf16 v[76:79], v[16:19], v[108:111], 0
    s_add_u32 m0, s41, 51200
    s_waitcnt lgkmcnt(1)
    v_mfma_f32_16x16x32_bf16 v[80:83], v[20:23], v[96:99], 0
    ds_read_b128 v[16:19], v31 offset:14336
    buffer_load_dwordx4 v13, s[12:15], s30 offen lds
    v_mfma_f32_16x16x32_bf16 v[84:87], v[20:23], v[100:103], 0
    s_add_u32 s30, s38, 5111808
    s_add_u32 m0, s41, 61440
    v_mfma_f32_16x16x32_bf16 v[88:91], v[20:23], v[104:107], 0
    buffer_load_dwordx4 v11, s[12:15], s30 offen lds
    s_add_u32 m0, s41, 62464
    v_mfma_f32_16x16x32_bf16 v[92:95], v[20:23], v[108:111], 0
    buffer_load_dwordx4 v12, s[12:15], s30 offen lds
    s_waitcnt lgkmcnt(1)
    v_mfma_f32_16x16x32_bf16 v[64:67], v[24:27], v[112:115], v[64:67]
    ds_read_b128 v[20:23], v30 offset:8320
    s_add_u32 m0, s41, 63488
    v_mfma_f32_16x16x32_bf16 v[68:71], v[24:27], v[116:119], v[68:71]
    buffer_load_dwordx4 v13, s[12:15], s30 offen lds
    v_cvt_pk_bf16_f32 v32, v32, v48
    v_mfma_f32_16x16x32_bf16 v[72:75], v[24:27], v[120:123], v[72:75]
    v_cvt_pk_bf16_f32 v33, v33, v49
    v_cvt_pk_bf16_f32 v34, v34, v50
    v_mfma_f32_16x16x32_bf16 v[76:79], v[24:27], v[124:127], v[76:79]
    v_cvt_pk_bf16_f32 v35, v35, v51
    s_waitcnt lgkmcnt(1)
    v_mfma_f32_16x16x32_bf16 v[80:83], v[16:19], v[112:115], v[80:83]
    ds_read_b128 v[24:27], v30 offset:14464
    v_accvgpr_write_b32 a128, v32
    v_mfma_f32_16x16x32_bf16 v[84:87], v[16:19], v[116:119], v[84:87]
    v_accvgpr_write_b32 a129, v33
    v_accvgpr_write_b32 a130, v34
    v_mfma_f32_16x16x32_bf16 v[88:91], v[16:19], v[120:123], v[88:91]
    v_accvgpr_write_b32 a131, v35
    v_cvt_pk_bf16_f32 v36, v36, v52
    v_mfma_f32_16x16x32_bf16 v[92:95], v[16:19], v[124:127], v[92:95]
    v_cvt_pk_bf16_f32 v37, v37, v53
    s_waitcnt lgkmcnt(1)
    v_mfma_f32_16x16x32_bf16 v[64:67], v[20:23], v[128:131], v[64:67]
    ds_read_b128 v[16:19], v31 offset:8320
    v_cvt_pk_bf16_f32 v38, v38, v54
    v_mfma_f32_16x16x32_bf16 v[68:71], v[20:23], v[132:135], v[68:71]
    v_cvt_pk_bf16_f32 v39, v39, v55
    v_accvgpr_write_b32 a136, v36
    v_mfma_f32_16x16x32_bf16 v[72:75], v[20:23], v[136:139], v[72:75]
    v_accvgpr_write_b32 a137, v37
    v_accvgpr_write_b32 a138, v38
    v_mfma_f32_16x16x32_bf16 v[76:79], v[20:23], v[140:143], v[76:79]
    v_accvgpr_write_b32 a139, v39
    s_waitcnt lgkmcnt(1)
    v_mfma_f32_16x16x32_bf16 v[80:83], v[24:27], v[128:131], v[80:83]
    ds_read_b128 v[20:23], v31 offset:14464
    v_cvt_pk_bf16_f32 v40, v40, v56
    v_mfma_f32_16x16x32_bf16 v[84:87], v[24:27], v[132:135], v[84:87]
    v_cvt_pk_bf16_f32 v41, v41, v57
    v_cvt_pk_bf16_f32 v42, v42, v58
    v_mfma_f32_16x16x32_bf16 v[88:91], v[24:27], v[136:139], v[88:91]
    v_cvt_pk_bf16_f32 v43, v43, v59
    v_accvgpr_write_b32 a144, v40
    v_mfma_f32_16x16x32_bf16 v[92:95], v[24:27], v[140:143], v[92:95]
    v_accvgpr_write_b32 a145, v41
    s_waitcnt lgkmcnt(1)
    v_mfma_f32_16x16x32_bf16 v[64:67], v[16:19], v[144:147], v[64:67]
    ds_read_b128 v[24:27], v30 offset:8448
    v_accvgpr_write_b32 a146, v42
    v_mfma_f32_16x16x32_bf16 v[68:71], v[16:19], v[148:151], v[68:71]
    v_accvgpr_write_b32 a147, v43
    v_cvt_pk_bf16_f32 v44, v44, v60
    v_mfma_f32_16x16x32_bf16 v[72:75], v[16:19], v[152:155], v[72:75]
    v_cvt_pk_bf16_f32 v45, v45, v61
    v_cvt_pk_bf16_f32 v46, v46, v62
    v_mfma_f32_16x16x32_bf16 v[76:79], v[16:19], v[156:159], v[76:79]
    v_cvt_pk_bf16_f32 v47, v47, v63
    s_waitcnt lgkmcnt(1)
    v_mfma_f32_16x16x32_bf16 v[80:83], v[20:23], v[144:147], v[80:83]
    ds_read_b128 v[16:19], v30 offset:14592
    v_accvgpr_write_b32 a152, v44
    v_mfma_f32_16x16x32_bf16 v[84:87], v[20:23], v[148:151], v[84:87]
    v_accvgpr_write_b32 a153, v45
    v_accvgpr_write_b32 a154, v46
    v_mfma_f32_16x16x32_bf16 v[88:91], v[20:23], v[152:155], v[88:91]
    v_accvgpr_write_b32 a155, v47
    v_mfma_f32_16x16x32_bf16 v[92:95], v[20:23], v[156:159], v[92:95]
    s_waitcnt lgkmcnt(1)
    v_mfma_f32_16x16x32_bf16 v[64:67], v[24:27], v[160:163], v[64:67]
    ds_read_b128 v[20:23], v31 offset:8448
    v_mfma_f32_16x16x32_bf16 v[68:71], v[24:27], v[164:167], v[68:71]
    v_mfma_f32_16x16x32_bf16 v[72:75], v[24:27], v[168:171], v[72:75]
    v_mfma_f32_16x16x32_bf16 v[76:79], v[24:27], v[172:175], v[76:79]
    s_waitcnt lgkmcnt(1)
    v_mfma_f32_16x16x32_bf16 v[80:83], v[16:19], v[160:163], v[80:83]
    ds_read_b128 v[24:27], v31 offset:14592
    v_mfma_f32_16x16x32_bf16 v[84:87], v[16:19], v[164:167], v[84:87]
    v_mfma_f32_16x16x32_bf16 v[88:91], v[16:19], v[168:171], v[88:91]
    v_mfma_f32_16x16x32_bf16 v[92:95], v[16:19], v[172:175], v[92:95]
    s_waitcnt lgkmcnt(1)
    v_mfma_f32_16x16x32_bf16 v[64:67], v[20:23], v[176:179], v[64:67]
    v_mfma_f32_16x16x32_bf16 v[68:71], v[20:23], v[180:183], v[68:71]
    v_mfma_f32_16x16x32_bf16 v[72:75], v[20:23], v[184:187], v[72:75]
    v_mfma_f32_16x16x32_bf16 v[76:79], v[20:23], v[188:191], v[76:79]
    s_waitcnt lgkmcnt(0)
    v_mfma_f32_16x16x32_bf16 v[80:83], v[24:27], v[176:179], v[80:83]
    v_mfma_f32_16x16x32_bf16 v[84:87], v[24:27], v[180:183], v[84:87]
    v_mfma_f32_16x16x32_bf16 v[88:91], v[24:27], v[184:187], v[88:91]
    v_mfma_f32_16x16x32_bf16 v[92:95], v[24:27], v[188:191], v[92:95]
    s_waitcnt vmcnt(18)
    s_barrier
    ds_read_b128 v[16:19], v30 offset:32768
    ds_read_b128 v[20:23], v30 offset:38912
    s_waitcnt lgkmcnt(1)
    v_mfma_f32_16x16x32_bf16 v[32:35], v[16:19], v[96:99], 0
    ds_read_b128 v[24:27], v31 offset:32768
    s_add_u32 s30, s37, 5505024
    v_mfma_f32_16x16x32_bf16 v[36:39], v[16:19], v[100:103], 0
    s_add_u32 m0, s41, 73728
    s_nop 0
    buffer_load_dwordx4 v11, s[12:15], s30 offen lds
    v_mfma_f32_16x16x32_bf16 v[40:43], v[16:19], v[104:107], 0
    s_add_u32 m0, s41, 74752
    s_nop 0
    buffer_load_dwordx4 v12, s[12:15], s30 offen lds
    v_mfma_f32_16x16x32_bf16 v[44:47], v[16:19], v[108:111], 0
    s_add_u32 m0, s41, 75776
    s_waitcnt lgkmcnt(1)
    v_mfma_f32_16x16x32_bf16 v[48:51], v[20:23], v[96:99], 0
    ds_read_b128 v[16:19], v31 offset:38912
    buffer_load_dwordx4 v13, s[12:15], s30 offen lds
    v_mfma_f32_16x16x32_bf16 v[52:55], v[20:23], v[100:103], 0
    s_add_u32 s30, s38, 5505024
    s_add_u32 m0, s41, 86016
    v_mfma_f32_16x16x32_bf16 v[56:59], v[20:23], v[104:107], 0
    buffer_load_dwordx4 v11, s[12:15], s30 offen lds
    s_add_u32 m0, s41, 87040
    v_mfma_f32_16x16x32_bf16 v[60:63], v[20:23], v[108:111], 0
    buffer_load_dwordx4 v12, s[12:15], s30 offen lds
    s_waitcnt lgkmcnt(1)
    v_mfma_f32_16x16x32_bf16 v[32:35], v[24:27], v[112:115], v[32:35]
    ds_read_b128 v[20:23], v30 offset:32896
    s_add_u32 m0, s41, 88064
    v_mfma_f32_16x16x32_bf16 v[36:39], v[24:27], v[116:119], v[36:39]
    buffer_load_dwordx4 v13, s[12:15], s30 offen lds
    v_cvt_pk_bf16_f32 v64, v64, v80
    v_mfma_f32_16x16x32_bf16 v[40:43], v[24:27], v[120:123], v[40:43]
    v_cvt_pk_bf16_f32 v65, v65, v81
    v_cvt_pk_bf16_f32 v66, v66, v82
    v_mfma_f32_16x16x32_bf16 v[44:47], v[24:27], v[124:127], v[44:47]
    v_cvt_pk_bf16_f32 v67, v67, v83
    s_waitcnt lgkmcnt(1)
    v_mfma_f32_16x16x32_bf16 v[48:51], v[16:19], v[112:115], v[48:51]
    ds_read_b128 v[24:27], v30 offset:39040
    v_accvgpr_write_b32 a132, v64
    v_mfma_f32_16x16x32_bf16 v[52:55], v[16:19], v[116:119], v[52:55]
    v_accvgpr_write_b32 a133, v65
    v_accvgpr_write_b32 a134, v66
    v_mfma_f32_16x16x32_bf16 v[56:59], v[16:19], v[120:123], v[56:59]
    v_accvgpr_write_b32 a135, v67
    v_cvt_pk_bf16_f32 v68, v68, v84
    v_mfma_f32_16x16x32_bf16 v[60:63], v[16:19], v[124:127], v[60:63]
    v_cvt_pk_bf16_f32 v69, v69, v85
    s_waitcnt lgkmcnt(1)
    v_mfma_f32_16x16x32_bf16 v[32:35], v[20:23], v[128:131], v[32:35]
    ds_read_b128 v[16:19], v31 offset:32896
    v_cvt_pk_bf16_f32 v70, v70, v86
    v_mfma_f32_16x16x32_bf16 v[36:39], v[20:23], v[132:135], v[36:39]
    v_cvt_pk_bf16_f32 v71, v71, v87
    v_accvgpr_write_b32 a140, v68
    v_mfma_f32_16x16x32_bf16 v[40:43], v[20:23], v[136:139], v[40:43]
    v_accvgpr_write_b32 a141, v69
    v_accvgpr_write_b32 a142, v70
    v_mfma_f32_16x16x32_bf16 v[44:47], v[20:23], v[140:143], v[44:47]
    v_accvgpr_write_b32 a143, v71
    s_waitcnt lgkmcnt(1)
    v_mfma_f32_16x16x32_bf16 v[48:51], v[24:27], v[128:131], v[48:51]
    ds_read_b128 v[20:23], v31 offset:39040
    v_cvt_pk_bf16_f32 v72, v72, v88
    v_mfma_f32_16x16x32_bf16 v[52:55], v[24:27], v[132:135], v[52:55]
    v_cvt_pk_bf16_f32 v73, v73, v89
    v_cvt_pk_bf16_f32 v74, v74, v90
    v_mfma_f32_16x16x32_bf16 v[56:59], v[24:27], v[136:139], v[56:59]
    v_cvt_pk_bf16_f32 v75, v75, v91
    v_accvgpr_write_b32 a148, v72
    v_mfma_f32_16x16x32_bf16 v[60:63], v[24:27], v[140:143], v[60:63]
    v_accvgpr_write_b32 a149, v73
    s_waitcnt lgkmcnt(1)
    v_mfma_f32_16x16x32_bf16 v[32:35], v[16:19], v[144:147], v[32:35]
    ds_read_b128 v[24:27], v30 offset:33024
    v_accvgpr_write_b32 a150, v74
    v_mfma_f32_16x16x32_bf16 v[36:39], v[16:19], v[148:151], v[36:39]
    v_accvgpr_write_b32 a151, v75
    v_cvt_pk_bf16_f32 v76, v76, v92
    v_mfma_f32_16x16x32_bf16 v[40:43], v[16:19], v[152:155], v[40:43]
    v_cvt_pk_bf16_f32 v77, v77, v93
    v_cvt_pk_bf16_f32 v78, v78, v94
    v_mfma_f32_16x16x32_bf16 v[44:47], v[16:19], v[156:159], v[44:47]
    v_cvt_pk_bf16_f32 v79, v79, v95
    s_waitcnt lgkmcnt(1)
    v_mfma_f32_16x16x32_bf16 v[48:51], v[20:23], v[144:147], v[48:51]
    ds_read_b128 v[16:19], v30 offset:39168
    v_accvgpr_write_b32 a156, v76
    v_mfma_f32_16x16x32_bf16 v[52:55], v[20:23], v[148:151], v[52:55]
    v_accvgpr_write_b32 a157, v77
    v_accvgpr_write_b32 a158, v78
    v_mfma_f32_16x16x32_bf16 v[56:59], v[20:23], v[152:155], v[56:59]
    v_accvgpr_write_b32 a159, v79
    v_mfma_f32_16x16x32_bf16 v[60:63], v[20:23], v[156:159], v[60:63]
    s_waitcnt lgkmcnt(1)
    v_mfma_f32_16x16x32_bf16 v[32:35], v[24:27], v[160:163], v[32:35]
    ds_read_b128 v[20:23], v31 offset:33024
    v_mfma_f32_16x16x32_bf16 v[36:39], v[24:27], v[164:167], v[36:39]
    v_mfma_f32_16x16x32_bf16 v[40:43], v[24:27], v[168:171], v[40:43]
    v_mfma_f32_16x16x32_bf16 v[44:47], v[24:27], v[172:175], v[44:47]
    s_waitcnt lgkmcnt(1)
    v_mfma_f32_16x16x32_bf16 v[48:51], v[16:19], v[160:163], v[48:51]
    ds_read_b128 v[24:27], v31 offset:39168
    v_mfma_f32_16x16x32_bf16 v[52:55], v[16:19], v[164:167], v[52:55]
    v_mfma_f32_16x16x32_bf16 v[56:59], v[16:19], v[168:171], v[56:59]
    v_mfma_f32_16x16x32_bf16 v[60:63], v[16:19], v[172:175], v[60:63]
    s_waitcnt lgkmcnt(1)
    v_mfma_f32_16x16x32_bf16 v[32:35], v[20:23], v[176:179], v[32:35]
    v_mfma_f32_16x16x32_bf16 v[36:39], v[20:23], v[180:183], v[36:39]
    v_mfma_f32_16x16x32_bf16 v[40:43], v[20:23], v[184:187], v[40:43]
    v_mfma_f32_16x16x32_bf16 v[44:47], v[20:23], v[188:191], v[44:47]
    s_waitcnt lgkmcnt(0)
    v_mfma_f32_16x16x32_bf16 v[48:51], v[24:27], v[176:179], v[48:51]
    v_mfma_f32_16x16x32_bf16 v[52:55], v[24:27], v[180:183], v[52:55]
    v_mfma_f32_16x16x32_bf16 v[56:59], v[24:27], v[184:187], v[56:59]
    v_mfma_f32_16x16x32_bf16 v[60:63], v[24:27], v[188:191], v[60:63]
    s_waitcnt vmcnt(18)
    s_barrier
    ds_read_b128 v[16:19], v28 offset:0
    ds_read_b128 v[20:23], v28 offset:6144
    s_waitcnt lgkmcnt(1)
    v_mfma_f32_16x16x32_bf16 v[64:67], v[16:19], v[96:99], 0
    ds_read_b128 v[24:27], v29 offset:0
    s_add_u32 s30, s37, 5898240
    v_mfma_f32_16x16x32_bf16 v[68:71], v[16:19], v[100:103], 0
    s_add_u32 m0, s41, 98304
    s_nop 0
    buffer_load_dwordx4 v11, s[12:15], s30 offen lds
    v_mfma_f32_16x16x32_bf16 v[72:75], v[16:19], v[104:107], 0
    s_add_u32 m0, s41, 99328
    s_nop 0
    buffer_load_dwordx4 v12, s[12:15], s30 offen lds
    v_mfma_f32_16x16x32_bf16 v[76:79], v[16:19], v[108:111], 0
    s_add_u32 m0, s41, 100352
    s_waitcnt lgkmcnt(1)
    v_mfma_f32_16x16x32_bf16 v[80:83], v[20:23], v[96:99], 0
    ds_read_b128 v[16:19], v29 offset:6144
    buffer_load_dwordx4 v13, s[12:15], s30 offen lds
    v_mfma_f32_16x16x32_bf16 v[84:87], v[20:23], v[100:103], 0
    s_add_u32 s30, s38, 5898240
    s_add_u32 m0, s41, 110592
    v_mfma_f32_16x16x32_bf16 v[88:91], v[20:23], v[104:107], 0
    buffer_load_dwordx4 v11, s[12:15], s30 offen lds
    s_add_u32 m0, s41, 111616
    v_mfma_f32_16x16x32_bf16 v[92:95], v[20:23], v[108:111], 0
    buffer_load_dwordx4 v12, s[12:15], s30 offen lds
    s_waitcnt lgkmcnt(1)
    v_mfma_f32_16x16x32_bf16 v[64:67], v[24:27], v[112:115], v[64:67]
    ds_read_b128 v[20:23], v28 offset:128
    s_add_u32 m0, s41, 112640
    v_mfma_f32_16x16x32_bf16 v[68:71], v[24:27], v[116:119], v[68:71]
    buffer_load_dwordx4 v13, s[12:15], s30 offen lds
    v_cvt_pk_bf16_f32 v32, v32, v48
    v_mfma_f32_16x16x32_bf16 v[72:75], v[24:27], v[120:123], v[72:75]
    v_cvt_pk_bf16_f32 v33, v33, v49
    v_cvt_pk_bf16_f32 v34, v34, v50
    v_mfma_f32_16x16x32_bf16 v[76:79], v[24:27], v[124:127], v[76:79]
    v_cvt_pk_bf16_f32 v35, v35, v51
    s_waitcnt lgkmcnt(1)
    v_mfma_f32_16x16x32_bf16 v[80:83], v[16:19], v[112:115], v[80:83]
    ds_read_b128 v[24:27], v28 offset:6272
    v_accvgpr_write_b32 a160, v32
    v_mfma_f32_16x16x32_bf16 v[84:87], v[16:19], v[116:119], v[84:87]
    v_accvgpr_write_b32 a161, v33
    v_accvgpr_write_b32 a162, v34
    v_mfma_f32_16x16x32_bf16 v[88:91], v[16:19], v[120:123], v[88:91]
    v_accvgpr_write_b32 a163, v35
    v_cvt_pk_bf16_f32 v36, v36, v52
    v_mfma_f32_16x16x32_bf16 v[92:95], v[16:19], v[124:127], v[92:95]
    v_cvt_pk_bf16_f32 v37, v37, v53
    s_waitcnt lgkmcnt(1)
    v_mfma_f32_16x16x32_bf16 v[64:67], v[20:23], v[128:131], v[64:67]
    ds_read_b128 v[16:19], v29 offset:128
    v_cvt_pk_bf16_f32 v38, v38, v54
    v_mfma_f32_16x16x32_bf16 v[68:71], v[20:23], v[132:135], v[68:71]
    v_cvt_pk_bf16_f32 v39, v39, v55
    v_accvgpr_write_b32 a168, v36
    v_mfma_f32_16x16x32_bf16 v[72:75], v[20:23], v[136:139], v[72:75]
    v_accvgpr_write_b32 a169, v37
    v_accvgpr_write_b32 a170, v38
    v_mfma_f32_16x16x32_bf16 v[76:79], v[20:23], v[140:143], v[76:79]
    v_accvgpr_write_b32 a171, v39
    s_waitcnt lgkmcnt(1)
    v_mfma_f32_16x16x32_bf16 v[80:83], v[24:27], v[128:131], v[80:83]
    ds_read_b128 v[20:23], v29 offset:6272
    v_cvt_pk_bf16_f32 v40, v40, v56
    v_mfma_f32_16x16x32_bf16 v[84:87], v[24:27], v[132:135], v[84:87]
    v_cvt_pk_bf16_f32 v41, v41, v57
    v_cvt_pk_bf16_f32 v42, v42, v58
    v_mfma_f32_16x16x32_bf16 v[88:91], v[24:27], v[136:139], v[88:91]
    v_cvt_pk_bf16_f32 v43, v43, v59
    v_accvgpr_write_b32 a176, v40
    v_mfma_f32_16x16x32_bf16 v[92:95], v[24:27], v[140:143], v[92:95]
    v_accvgpr_write_b32 a177, v41
    s_waitcnt lgkmcnt(1)
    v_mfma_f32_16x16x32_bf16 v[64:67], v[16:19], v[144:147], v[64:67]
    ds_read_b128 v[24:27], v28 offset:256
    v_accvgpr_write_b32 a178, v42
    v_mfma_f32_16x16x32_bf16 v[68:71], v[16:19], v[148:151], v[68:71]
    v_accvgpr_write_b32 a179, v43
    v_cvt_pk_bf16_f32 v44, v44, v60
    v_mfma_f32_16x16x32_bf16 v[72:75], v[16:19], v[152:155], v[72:75]
    v_cvt_pk_bf16_f32 v45, v45, v61
    v_cvt_pk_bf16_f32 v46, v46, v62
    v_mfma_f32_16x16x32_bf16 v[76:79], v[16:19], v[156:159], v[76:79]
    v_cvt_pk_bf16_f32 v47, v47, v63
    s_waitcnt lgkmcnt(1)
    v_mfma_f32_16x16x32_bf16 v[80:83], v[20:23], v[144:147], v[80:83]
    ds_read_b128 v[16:19], v28 offset:6400
    v_accvgpr_write_b32 a184, v44
    v_mfma_f32_16x16x32_bf16 v[84:87], v[20:23], v[148:151], v[84:87]
    v_accvgpr_write_b32 a185, v45
    v_accvgpr_write_b32 a186, v46
    v_mfma_f32_16x16x32_bf16 v[88:91], v[20:23], v[152:155], v[88:91]
    v_accvgpr_write_b32 a187, v47
    v_mfma_f32_16x16x32_bf16 v[92:95], v[20:23], v[156:159], v[92:95]
    s_waitcnt lgkmcnt(1)
    v_mfma_f32_16x16x32_bf16 v[64:67], v[24:27], v[160:163], v[64:67]
    ds_read_b128 v[20:23], v29 offset:256
    v_mfma_f32_16x16x32_bf16 v[68:71], v[24:27], v[164:167], v[68:71]
    v_mfma_f32_16x16x32_bf16 v[72:75], v[24:27], v[168:171], v[72:75]
    v_mfma_f32_16x16x32_bf16 v[76:79], v[24:27], v[172:175], v[76:79]
    s_waitcnt lgkmcnt(1)
    v_mfma_f32_16x16x32_bf16 v[80:83], v[16:19], v[160:163], v[80:83]
    ds_read_b128 v[24:27], v29 offset:6400
    v_mfma_f32_16x16x32_bf16 v[84:87], v[16:19], v[164:167], v[84:87]
    v_mfma_f32_16x16x32_bf16 v[88:91], v[16:19], v[168:171], v[88:91]
    v_mfma_f32_16x16x32_bf16 v[92:95], v[16:19], v[172:175], v[92:95]
    s_waitcnt lgkmcnt(1)
    v_mfma_f32_16x16x32_bf16 v[64:67], v[20:23], v[176:179], v[64:67]
    v_mfma_f32_16x16x32_bf16 v[68:71], v[20:23], v[180:183], v[68:71]
    v_mfma_f32_16x16x32_bf16 v[72:75], v[20:23], v[184:187], v[72:75]
    v_mfma_f32_16x16x32_bf16 v[76:79], v[20:23], v[188:191], v[76:79]
    s_waitcnt lgkmcnt(0)
    v_mfma_f32_16x16x32_bf16 v[80:83], v[24:27], v[176:179], v[80:83]
    v_mfma_f32_16x16x32_bf16 v[84:87], v[24:27], v[180:183], v[84:87]
    v_mfma_f32_16x16x32_bf16 v[88:91], v[24:27], v[184:187], v[88:91]
    v_mfma_f32_16x16x32_bf16 v[92:95], v[24:27], v[188:191], v[92:95]
    s_waitcnt vmcnt(18)
    s_barrier
    ds_read_b128 v[16:19], v28 offset:24576
    ds_read_b128 v[20:23], v28 offset:30720
    s_waitcnt lgkmcnt(1)
    v_mfma_f32_16x16x32_bf16 v[32:35], v[16:19], v[96:99], 0
    ds_read_b128 v[24:27], v29 offset:24576
    s_add_u32 s30, s37, 6291456
    v_mfma_f32_16x16x32_bf16 v[36:39], v[16:19], v[100:103], 0
    s_add_u32 m0, s41, 0
    s_nop 0
    buffer_load_dwordx4 v11, s[12:15], s30 offen lds
    v_mfma_f32_16x16x32_bf16 v[40:43], v[16:19], v[104:107], 0
    s_add_u32 m0, s41, 1024
    s_nop 0
    buffer_load_dwordx4 v12, s[12:15], s30 offen lds
    v_mfma_f32_16x16x32_bf16 v[44:47], v[16:19], v[108:111], 0
    s_add_u32 m0, s41, 2048
    s_waitcnt lgkmcnt(1)
    v_mfma_f32_16x16x32_bf16 v[48:51], v[20:23], v[96:99], 0
    ds_read_b128 v[16:19], v29 offset:30720
    buffer_load_dwordx4 v13, s[12:15], s30 offen lds
    v_mfma_f32_16x16x32_bf16 v[52:55], v[20:23], v[100:103], 0
    s_add_u32 s30, s38, 6291456
    s_add_u32 m0, s41, 12288
    v_mfma_f32_16x16x32_bf16 v[56:59], v[20:23], v[104:107], 0
    buffer_load_dwordx4 v11, s[12:15], s30 offen lds
    s_add_u32 m0, s41, 13312
    v_mfma_f32_16x16x32_bf16 v[60:63], v[20:23], v[108:111], 0
    buffer_load_dwordx4 v12, s[12:15], s30 offen lds
    s_waitcnt lgkmcnt(1)
    v_mfma_f32_16x16x32_bf16 v[32:35], v[24:27], v[112:115], v[32:35]
    ds_read_b128 v[20:23], v28 offset:24704
    s_add_u32 m0, s41, 14336
    v_mfma_f32_16x16x32_bf16 v[36:39], v[24:27], v[116:119], v[36:39]
    buffer_load_dwordx4 v13, s[12:15], s30 offen lds
    v_cvt_pk_bf16_f32 v64, v64, v80
    v_mfma_f32_16x16x32_bf16 v[40:43], v[24:27], v[120:123], v[40:43]
    v_cvt_pk_bf16_f32 v65, v65, v81
    v_cvt_pk_bf16_f32 v66, v66, v82
    v_mfma_f32_16x16x32_bf16 v[44:47], v[24:27], v[124:127], v[44:47]
    v_cvt_pk_bf16_f32 v67, v67, v83
    s_waitcnt lgkmcnt(1)
    v_mfma_f32_16x16x32_bf16 v[48:51], v[16:19], v[112:115], v[48:51]
    ds_read_b128 v[24:27], v28 offset:30848
    v_accvgpr_write_b32 a164, v64
    v_mfma_f32_16x16x32_bf16 v[52:55], v[16:19], v[116:119], v[52:55]
    v_accvgpr_write_b32 a165, v65
    v_accvgpr_write_b32 a166, v66
    v_mfma_f32_16x16x32_bf16 v[56:59], v[16:19], v[120:123], v[56:59]
    v_accvgpr_write_b32 a167, v67
    v_cvt_pk_bf16_f32 v68, v68, v84
    v_mfma_f32_16x16x32_bf16 v[60:63], v[16:19], v[124:127], v[60:63]
    v_cvt_pk_bf16_f32 v69, v69, v85
    s_waitcnt lgkmcnt(1)
    v_mfma_f32_16x16x32_bf16 v[32:35], v[20:23], v[128:131], v[32:35]
    ds_read_b128 v[16:19], v29 offset:24704
    v_cvt_pk_bf16_f32 v70, v70, v86
    v_mfma_f32_16x16x32_bf16 v[36:39], v[20:23], v[132:135], v[36:39]
    v_cvt_pk_bf16_f32 v71, v71, v87
    v_accvgpr_write_b32 a172, v68
    v_mfma_f32_16x16x32_bf16 v[40:43], v[20:23], v[136:139], v[40:43]
    v_accvgpr_write_b32 a173, v69
    v_accvgpr_write_b32 a174, v70
    v_mfma_f32_16x16x32_bf16 v[44:47], v[20:23], v[140:143], v[44:47]
    v_accvgpr_write_b32 a175, v71
    s_waitcnt lgkmcnt(1)
    v_mfma_f32_16x16x32_bf16 v[48:51], v[24:27], v[128:131], v[48:51]
    ds_read_b128 v[20:23], v29 offset:30848
    v_cvt_pk_bf16_f32 v72, v72, v88
    v_mfma_f32_16x16x32_bf16 v[52:55], v[24:27], v[132:135], v[52:55]
    v_cvt_pk_bf16_f32 v73, v73, v89
    v_cvt_pk_bf16_f32 v74, v74, v90
    v_mfma_f32_16x16x32_bf16 v[56:59], v[24:27], v[136:139], v[56:59]
    v_cvt_pk_bf16_f32 v75, v75, v91
    v_accvgpr_write_b32 a180, v72
    v_mfma_f32_16x16x32_bf16 v[60:63], v[24:27], v[140:143], v[60:63]
    v_accvgpr_write_b32 a181, v73
    s_waitcnt lgkmcnt(1)
    v_mfma_f32_16x16x32_bf16 v[32:35], v[16:19], v[144:147], v[32:35]
    ds_read_b128 v[24:27], v28 offset:24832
    v_accvgpr_write_b32 a182, v74
    v_mfma_f32_16x16x32_bf16 v[36:39], v[16:19], v[148:151], v[36:39]
    v_accvgpr_write_b32 a183, v75
    v_cvt_pk_bf16_f32 v76, v76, v92
    v_mfma_f32_16x16x32_bf16 v[40:43], v[16:19], v[152:155], v[40:43]
    v_cvt_pk_bf16_f32 v77, v77, v93
    v_cvt_pk_bf16_f32 v78, v78, v94
    v_mfma_f32_16x16x32_bf16 v[44:47], v[16:19], v[156:159], v[44:47]
    v_cvt_pk_bf16_f32 v79, v79, v95
    s_waitcnt lgkmcnt(1)
    v_mfma_f32_16x16x32_bf16 v[48:51], v[20:23], v[144:147], v[48:51]
    ds_read_b128 v[16:19], v28 offset:30976
    v_accvgpr_write_b32 a188, v76
    v_mfma_f32_16x16x32_bf16 v[52:55], v[20:23], v[148:151], v[52:55]
    v_accvgpr_write_b32 a189, v77
    v_accvgpr_write_b32 a190, v78
    v_mfma_f32_16x16x32_bf16 v[56:59], v[20:23], v[152:155], v[56:59]
    v_accvgpr_write_b32 a191, v79
    v_mfma_f32_16x16x32_bf16 v[60:63], v[20:23], v[156:159], v[60:63]
    s_waitcnt lgkmcnt(1)
    v_mfma_f32_16x16x32_bf16 v[32:35], v[24:27], v[160:163], v[32:35]
    ds_read_b128 v[20:23], v29 offset:24832
    v_mfma_f32_16x16x32_bf16 v[36:39], v[24:27], v[164:167], v[36:39]
    v_mfma_f32_16x16x32_bf16 v[40:43], v[24:27], v[168:171], v[40:43]
    v_mfma_f32_16x16x32_bf16 v[44:47], v[24:27], v[172:175], v[44:47]
    s_waitcnt lgkmcnt(1)
    v_mfma_f32_16x16x32_bf16 v[48:51], v[16:19], v[160:163], v[48:51]
    ds_read_b128 v[24:27], v29 offset:30976
    v_mfma_f32_16x16x32_bf16 v[52:55], v[16:19], v[164:167], v[52:55]
    v_mfma_f32_16x16x32_bf16 v[56:59], v[16:19], v[168:171], v[56:59]
    v_mfma_f32_16x16x32_bf16 v[60:63], v[16:19], v[172:175], v[60:63]
    s_waitcnt lgkmcnt(1)
    v_mfma_f32_16x16x32_bf16 v[32:35], v[20:23], v[176:179], v[32:35]
    v_mfma_f32_16x16x32_bf16 v[36:39], v[20:23], v[180:183], v[36:39]
    v_mfma_f32_16x16x32_bf16 v[40:43], v[20:23], v[184:187], v[40:43]
    v_mfma_f32_16x16x32_bf16 v[44:47], v[20:23], v[188:191], v[44:47]
    s_waitcnt lgkmcnt(0)
    v_mfma_f32_16x16x32_bf16 v[48:51], v[24:27], v[176:179], v[48:51]
    v_mfma_f32_16x16x32_bf16 v[52:55], v[24:27], v[180:183], v[52:55]
    v_mfma_f32_16x16x32_bf16 v[56:59], v[24:27], v[184:187], v[56:59]
    v_mfma_f32_16x16x32_bf16 v[60:63], v[24:27], v[188:191], v[60:63]
    s_waitcnt vmcnt(18)
    s_barrier
    ds_read_b128 v[16:19], v28 offset:49152
    ds_read_b128 v[20:23], v28 offset:55296
    s_waitcnt lgkmcnt(1)
    v_mfma_f32_16x16x32_bf16 v[64:67], v[16:19], v[96:99], 0
    ds_read_b128 v[24:27], v29 offset:49152
    s_add_u32 s30, s37, 6684672
    v_mfma_f32_16x16x32_bf16 v[68:71], v[16:19], v[100:103], 0
    s_add_u32 m0, s41, 24576
    s_nop 0
    buffer_load_dwordx4 v11, s[12:15], s30 offen lds
    v_mfma_f32_16x16x32_bf16 v[72:75], v[16:19], v[104:107], 0
    s_add_u32 m0, s41, 25600
    s_nop 0
    buffer_load_dwordx4 v12, s[12:15], s30 offen lds
    v_mfma_f32_16x16x32_bf16 v[76:79], v[16:19], v[108:111], 0
    s_add_u32 m0, s41, 26624
    s_waitcnt lgkmcnt(1)
    v_mfma_f32_16x16x32_bf16 v[80:83], v[20:23], v[96:99], 0
    ds_read_b128 v[16:19], v29 offset:55296
    buffer_load_dwordx4 v13, s[12:15], s30 offen lds
    v_mfma_f32_16x16x32_bf16 v[84:87], v[20:23], v[100:103], 0
    s_add_u32 s30, s38, 6684672
    s_add_u32 m0, s41, 36864
    v_mfma_f32_16x16x32_bf16 v[88:91], v[20:23], v[104:107], 0
    buffer_load_dwordx4 v11, s[12:15], s30 offen lds
    s_add_u32 m0, s41, 37888
    v_mfma_f32_16x16x32_bf16 v[92:95], v[20:23], v[108:111], 0
    buffer_load_dwordx4 v12, s[12:15], s30 offen lds
    s_waitcnt lgkmcnt(1)
    v_mfma_f32_16x16x32_bf16 v[64:67], v[24:27], v[112:115], v[64:67]
    ds_read_b128 v[20:23], v28 offset:49280
    s_add_u32 m0, s41, 38912
    v_mfma_f32_16x16x32_bf16 v[68:71], v[24:27], v[116:119], v[68:71]
    buffer_load_dwordx4 v13, s[12:15], s30 offen lds
    v_cvt_pk_bf16_f32 v32, v32, v48
    v_mfma_f32_16x16x32_bf16 v[72:75], v[24:27], v[120:123], v[72:75]
    v_cvt_pk_bf16_f32 v33, v33, v49
    v_cvt_pk_bf16_f32 v34, v34, v50
    v_mfma_f32_16x16x32_bf16 v[76:79], v[24:27], v[124:127], v[76:79]
    v_cvt_pk_bf16_f32 v35, v35, v51
    s_waitcnt lgkmcnt(1)
    v_mfma_f32_16x16x32_bf16 v[80:83], v[16:19], v[112:115], v[80:83]
    ds_read_b128 v[24:27], v28 offset:55424
    v_accvgpr_write_b32 a192, v32
    v_mfma_f32_16x16x32_bf16 v[84:87], v[16:19], v[116:119], v[84:87]
    v_accvgpr_write_b32 a193, v33
    v_accvgpr_write_b32 a194, v34
    v_mfma_f32_16x16x32_bf16 v[88:91], v[16:19], v[120:123], v[88:91]
    v_accvgpr_write_b32 a195, v35
    v_cvt_pk_bf16_f32 v36, v36, v52
    v_mfma_f32_16x16x32_bf16 v[92:95], v[16:19], v[124:127], v[92:95]
    v_cvt_pk_bf16_f32 v37, v37, v53
    s_waitcnt lgkmcnt(1)
    v_mfma_f32_16x16x32_bf16 v[64:67], v[20:23], v[128:131], v[64:67]
    ds_read_b128 v[16:19], v29 offset:49280
    v_cvt_pk_bf16_f32 v38, v38, v54
    v_mfma_f32_16x16x32_bf16 v[68:71], v[20:23], v[132:135], v[68:71]
    v_cvt_pk_bf16_f32 v39, v39, v55
    v_accvgpr_write_b32 a200, v36
    v_mfma_f32_16x16x32_bf16 v[72:75], v[20:23], v[136:139], v[72:75]
    v_accvgpr_write_b32 a201, v37
    v_accvgpr_write_b32 a202, v38
    v_mfma_f32_16x16x32_bf16 v[76:79], v[20:23], v[140:143], v[76:79]
    v_accvgpr_write_b32 a203, v39
    s_waitcnt lgkmcnt(1)
    v_mfma_f32_16x16x32_bf16 v[80:83], v[24:27], v[128:131], v[80:83]
    ds_read_b128 v[20:23], v29 offset:55424
    v_cvt_pk_bf16_f32 v40, v40, v56
    v_mfma_f32_16x16x32_bf16 v[84:87], v[24:27], v[132:135], v[84:87]
    v_cvt_pk_bf16_f32 v41, v41, v57
    v_cvt_pk_bf16_f32 v42, v42, v58
    v_mfma_f32_16x16x32_bf16 v[88:91], v[24:27], v[136:139], v[88:91]
    v_cvt_pk_bf16_f32 v43, v43, v59
    v_accvgpr_write_b32 a208, v40
    v_mfma_f32_16x16x32_bf16 v[92:95], v[24:27], v[140:143], v[92:95]
    v_accvgpr_write_b32 a209, v41
    s_waitcnt lgkmcnt(1)
    v_mfma_f32_16x16x32_bf16 v[64:67], v[16:19], v[144:147], v[64:67]
    ds_read_b128 v[24:27], v28 offset:49408
    v_accvgpr_write_b32 a210, v42
    v_mfma_f32_16x16x32_bf16 v[68:71], v[16:19], v[148:151], v[68:71]
    v_accvgpr_write_b32 a211, v43
    v_cvt_pk_bf16_f32 v44, v44, v60
    v_mfma_f32_16x16x32_bf16 v[72:75], v[16:19], v[152:155], v[72:75]
    v_cvt_pk_bf16_f32 v45, v45, v61
    v_cvt_pk_bf16_f32 v46, v46, v62
    v_mfma_f32_16x16x32_bf16 v[76:79], v[16:19], v[156:159], v[76:79]
    v_cvt_pk_bf16_f32 v47, v47, v63
    s_waitcnt lgkmcnt(1)
    v_mfma_f32_16x16x32_bf16 v[80:83], v[20:23], v[144:147], v[80:83]
    ds_read_b128 v[16:19], v28 offset:55552
    v_accvgpr_write_b32 a216, v44
    v_mfma_f32_16x16x32_bf16 v[84:87], v[20:23], v[148:151], v[84:87]
    v_accvgpr_write_b32 a217, v45
    v_accvgpr_write_b32 a218, v46
    v_mfma_f32_16x16x32_bf16 v[88:91], v[20:23], v[152:155], v[88:91]
    v_accvgpr_write_b32 a219, v47
    v_mfma_f32_16x16x32_bf16 v[92:95], v[20:23], v[156:159], v[92:95]
    s_waitcnt lgkmcnt(1)
    v_mfma_f32_16x16x32_bf16 v[64:67], v[24:27], v[160:163], v[64:67]
    ds_read_b128 v[20:23], v29 offset:49408
    v_mfma_f32_16x16x32_bf16 v[68:71], v[24:27], v[164:167], v[68:71]
    v_mfma_f32_16x16x32_bf16 v[72:75], v[24:27], v[168:171], v[72:75]
    v_mfma_f32_16x16x32_bf16 v[76:79], v[24:27], v[172:175], v[76:79]
    s_waitcnt lgkmcnt(1)
    v_mfma_f32_16x16x32_bf16 v[80:83], v[16:19], v[160:163], v[80:83]
    ds_read_b128 v[24:27], v29 offset:55552
    v_mfma_f32_16x16x32_bf16 v[84:87], v[16:19], v[164:167], v[84:87]
    v_mfma_f32_16x16x32_bf16 v[88:91], v[16:19], v[168:171], v[88:91]
    v_mfma_f32_16x16x32_bf16 v[92:95], v[16:19], v[172:175], v[92:95]
    s_waitcnt lgkmcnt(1)
    v_mfma_f32_16x16x32_bf16 v[64:67], v[20:23], v[176:179], v[64:67]
    v_mfma_f32_16x16x32_bf16 v[68:71], v[20:23], v[180:183], v[68:71]
    v_mfma_f32_16x16x32_bf16 v[72:75], v[20:23], v[184:187], v[72:75]
    v_mfma_f32_16x16x32_bf16 v[76:79], v[20:23], v[188:191], v[76:79]
    s_waitcnt lgkmcnt(0)
    v_mfma_f32_16x16x32_bf16 v[80:83], v[24:27], v[176:179], v[80:83]
    v_mfma_f32_16x16x32_bf16 v[84:87], v[24:27], v[180:183], v[84:87]
    v_mfma_f32_16x16x32_bf16 v[88:91], v[24:27], v[184:187], v[88:91]
    v_mfma_f32_16x16x32_bf16 v[92:95], v[24:27], v[188:191], v[92:95]
    s_waitcnt vmcnt(18)
    s_barrier
    ds_read_b128 v[16:19], v30 offset:8192
    ds_read_b128 v[20:23], v30 offset:14336
    s_waitcnt lgkmcnt(1)
    v_mfma_f32_16x16x32_bf16 v[32:35], v[16:19], v[96:99], 0
    ds_read_b128 v[24:27], v31 offset:8192
    s_add_u32 s30, s37, 7077888
    v_mfma_f32_16x16x32_bf16 v[36:39], v[16:19], v[100:103], 0
    s_add_u32 m0, s41, 49152
    s_nop 0
    buffer_load_dwordx4 v11, s[12:15], s30 offen lds
    v_mfma_f32_16x16x32_bf16 v[40:43], v[16:19], v[104:107], 0
    s_add_u32 m0, s41, 50176
    s_nop 0
    buffer_load_dwordx4 v12, s[12:15], s30 offen lds
    v_mfma_f32_16x16x32_bf16 v[44:47], v[16:19], v[108:111], 0
    s_add_u32 m0, s41, 51200
    s_waitcnt lgkmcnt(1)
    v_mfma_f32_16x16x32_bf16 v[48:51], v[20:23], v[96:99], 0
    ds_read_b128 v[16:19], v31 offset:14336
    buffer_load_dwordx4 v13, s[12:15], s30 offen lds
    v_mfma_f32_16x16x32_bf16 v[52:55], v[20:23], v[100:103], 0
    s_add_u32 s30, s38, 7077888
    s_add_u32 m0, s41, 61440
    v_mfma_f32_16x16x32_bf16 v[56:59], v[20:23], v[104:107], 0
    buffer_load_dwordx4 v11, s[12:15], s30 offen lds
    s_add_u32 m0, s41, 62464
    v_mfma_f32_16x16x32_bf16 v[60:63], v[20:23], v[108:111], 0
    buffer_load_dwordx4 v12, s[12:15], s30 offen lds
    s_waitcnt lgkmcnt(1)
    v_mfma_f32_16x16x32_bf16 v[32:35], v[24:27], v[112:115], v[32:35]
    ds_read_b128 v[20:23], v30 offset:8320
    s_add_u32 m0, s41, 63488
    v_mfma_f32_16x16x32_bf16 v[36:39], v[24:27], v[116:119], v[36:39]
    buffer_load_dwordx4 v13, s[12:15], s30 offen lds
    v_cvt_pk_bf16_f32 v64, v64, v80
    v_mfma_f32_16x16x32_bf16 v[40:43], v[24:27], v[120:123], v[40:43]
    v_cvt_pk_bf16_f32 v65, v65, v81
    v_cvt_pk_bf16_f32 v66, v66, v82
    v_mfma_f32_16x16x32_bf16 v[44:47], v[24:27], v[124:127], v[44:47]
    v_cvt_pk_bf16_f32 v67, v67, v83
    s_waitcnt lgkmcnt(1)
    v_mfma_f32_16x16x32_bf16 v[48:51], v[16:19], v[112:115], v[48:51]
    ds_read_b128 v[24:27], v30 offset:14464
    v_accvgpr_write_b32 a196, v64
    v_mfma_f32_16x16x32_bf16 v[52:55], v[16:19], v[116:119], v[52:55]
    v_accvgpr_write_b32 a197, v65
    v_accvgpr_write_b32 a198, v66
    v_mfma_f32_16x16x32_bf16 v[56:59], v[16:19], v[120:123], v[56:59]
    v_accvgpr_write_b32 a199, v67
    v_cvt_pk_bf16_f32 v68, v68, v84
    v_mfma_f32_16x16x32_bf16 v[60:63], v[16:19], v[124:127], v[60:63]
    v_cvt_pk_bf16_f32 v69, v69, v85
    s_waitcnt lgkmcnt(1)
    v_mfma_f32_16x16x32_bf16 v[32:35], v[20:23], v[128:131], v[32:35]
    ds_read_b128 v[16:19], v31 offset:8320
    v_cvt_pk_bf16_f32 v70, v70, v86
    v_mfma_f32_16x16x32_bf16 v[36:39], v[20:23], v[132:135], v[36:39]
    v_cvt_pk_bf16_f32 v71, v71, v87
    v_accvgpr_write_b32 a204, v68
    v_mfma_f32_16x16x32_bf16 v[40:43], v[20:23], v[136:139], v[40:43]
    v_accvgpr_write_b32 a205, v69
    v_accvgpr_write_b32 a206, v70
    v_mfma_f32_16x16x32_bf16 v[44:47], v[20:23], v[140:143], v[44:47]
    v_accvgpr_write_b32 a207, v71
    s_waitcnt lgkmcnt(1)
    v_mfma_f32_16x16x32_bf16 v[48:51], v[24:27], v[128:131], v[48:51]
    ds_read_b128 v[20:23], v31 offset:14464
    v_cvt_pk_bf16_f32 v72, v72, v88
    v_mfma_f32_16x16x32_bf16 v[52:55], v[24:27], v[132:135], v[52:55]
    v_cvt_pk_bf16_f32 v73, v73, v89
    v_cvt_pk_bf16_f32 v74, v74, v90
    v_mfma_f32_16x16x32_bf16 v[56:59], v[24:27], v[136:139], v[56:59]
    v_cvt_pk_bf16_f32 v75, v75, v91
    v_accvgpr_write_b32 a212, v72
    v_mfma_f32_16x16x32_bf16 v[60:63], v[24:27], v[140:143], v[60:63]
    v_accvgpr_write_b32 a213, v73
    s_waitcnt lgkmcnt(1)
    v_mfma_f32_16x16x32_bf16 v[32:35], v[16:19], v[144:147], v[32:35]
    ds_read_b128 v[24:27], v30 offset:8448
    v_accvgpr_write_b32 a214, v74
    v_mfma_f32_16x16x32_bf16 v[36:39], v[16:19], v[148:151], v[36:39]
    v_accvgpr_write_b32 a215, v75
    v_cvt_pk_bf16_f32 v76, v76, v92
    v_mfma_f32_16x16x32_bf16 v[40:43], v[16:19], v[152:155], v[40:43]
    v_cvt_pk_bf16_f32 v77, v77, v93
    v_cvt_pk_bf16_f32 v78, v78, v94
    v_mfma_f32_16x16x32_bf16 v[44:47], v[16:19], v[156:159], v[44:47]
    v_cvt_pk_bf16_f32 v79, v79, v95
    s_waitcnt lgkmcnt(1)
    v_mfma_f32_16x16x32_bf16 v[48:51], v[20:23], v[144:147], v[48:51]
    ds_read_b128 v[16:19], v30 offset:14592
    v_accvgpr_write_b32 a220, v76
    v_mfma_f32_16x16x32_bf16 v[52:55], v[20:23], v[148:151], v[52:55]
    v_accvgpr_write_b32 a221, v77
    v_accvgpr_write_b32 a222, v78
    v_mfma_f32_16x16x32_bf16 v[56:59], v[20:23], v[152:155], v[56:59]
    v_accvgpr_write_b32 a223, v79
    v_mfma_f32_16x16x32_bf16 v[60:63], v[20:23], v[156:159], v[60:63]
    s_waitcnt lgkmcnt(1)
    v_mfma_f32_16x16x32_bf16 v[32:35], v[24:27], v[160:163], v[32:35]
    ds_read_b128 v[20:23], v31 offset:8448
    v_mfma_f32_16x16x32_bf16 v[36:39], v[24:27], v[164:167], v[36:39]
    v_mfma_f32_16x16x32_bf16 v[40:43], v[24:27], v[168:171], v[40:43]
    v_mfma_f32_16x16x32_bf16 v[44:47], v[24:27], v[172:175], v[44:47]
    s_waitcnt lgkmcnt(1)
    v_mfma_f32_16x16x32_bf16 v[48:51], v[16:19], v[160:163], v[48:51]
    ds_read_b128 v[24:27], v31 offset:14592
    v_mfma_f32_16x16x32_bf16 v[52:55], v[16:19], v[164:167], v[52:55]
    v_mfma_f32_16x16x32_bf16 v[56:59], v[16:19], v[168:171], v[56:59]
    v_mfma_f32_16x16x32_bf16 v[60:63], v[16:19], v[172:175], v[60:63]
    s_waitcnt lgkmcnt(1)
    v_mfma_f32_16x16x32_bf16 v[32:35], v[20:23], v[176:179], v[32:35]
    v_mfma_f32_16x16x32_bf16 v[36:39], v[20:23], v[180:183], v[36:39]
    v_mfma_f32_16x16x32_bf16 v[40:43], v[20:23], v[184:187], v[40:43]
    v_mfma_f32_16x16x32_bf16 v[44:47], v[20:23], v[188:191], v[44:47]
    s_waitcnt lgkmcnt(0)
    v_mfma_f32_16x16x32_bf16 v[48:51], v[24:27], v[176:179], v[48:51]
    v_mfma_f32_16x16x32_bf16 v[52:55], v[24:27], v[180:183], v[52:55]
    v_mfma_f32_16x16x32_bf16 v[56:59], v[24:27], v[184:187], v[56:59]
    v_mfma_f32_16x16x32_bf16 v[60:63], v[24:27], v[188:191], v[60:63]
    s_waitcnt vmcnt(18)
    s_barrier
    ds_read_b128 v[16:19], v30 offset:32768
    ds_read_b128 v[20:23], v30 offset:38912
    s_waitcnt lgkmcnt(1)
    v_mfma_f32_16x16x32_bf16 v[64:67], v[16:19], v[96:99], 0
    ds_read_b128 v[24:27], v31 offset:32768
    s_add_u32 s30, s37, 7471104
    v_mfma_f32_16x16x32_bf16 v[68:71], v[16:19], v[100:103], 0
    s_add_u32 m0, s41, 73728
    s_nop 0
    buffer_load_dwordx4 v11, s[12:15], s30 offen lds
    v_mfma_f32_16x16x32_bf16 v[72:75], v[16:19], v[104:107], 0
    s_add_u32 m0, s41, 74752
    s_nop 0
    buffer_load_dwordx4 v12, s[12:15], s30 offen lds
    v_mfma_f32_16x16x32_bf16 v[76:79], v[16:19], v[108:111], 0
    s_add_u32 m0, s41, 75776
    s_waitcnt lgkmcnt(1)
    v_mfma_f32_16x16x32_bf16 v[80:83], v[20:23], v[96:99], 0
    ds_read_b128 v[16:19], v31 offset:38912
    buffer_load_dwordx4 v13, s[12:15], s30 offen lds
    v_mfma_f32_16x16x32_bf16 v[84:87], v[20:23], v[100:103], 0
    s_add_u32 s30, s38, 7471104
    s_add_u32 m0, s41, 86016
    v_mfma_f32_16x16x32_bf16 v[88:91], v[20:23], v[104:107], 0
    buffer_load_dwordx4 v11, s[12:15], s30 offen lds
    s_add_u32 m0, s41, 87040
    v_mfma_f32_16x16x32_bf16 v[92:95], v[20:23], v[108:111], 0
    buffer_load_dwordx4 v12, s[12:15], s30 offen lds
    s_waitcnt lgkmcnt(1)
    v_mfma_f32_16x16x32_bf16 v[64:67], v[24:27], v[112:115], v[64:67]
    ds_read_b128 v[20:23], v30 offset:32896
    s_add_u32 m0, s41, 88064
    v_mfma_f32_16x16x32_bf16 v[68:71], v[24:27], v[116:119], v[68:71]
    buffer_load_dwordx4 v13, s[12:15], s30 offen lds
    v_cvt_pk_bf16_f32 v32, v32, v48
    v_mfma_f32_16x16x32_bf16 v[72:75], v[24:27], v[120:123], v[72:75]
    v_cvt_pk_bf16_f32 v33, v33, v49
    v_cvt_pk_bf16_f32 v34, v34, v50
    v_mfma_f32_16x16x32_bf16 v[76:79], v[24:27], v[124:127], v[76:79]
    v_cvt_pk_bf16_f32 v35, v35, v51
    s_waitcnt lgkmcnt(1)
    v_mfma_f32_16x16x32_bf16 v[80:83], v[16:19], v[112:115], v[80:83]
    ds_read_b128 v[24:27], v30 offset:39040
    v_accvgpr_write_b32 a224, v32
    v_mfma_f32_16x16x32_bf16 v[84:87], v[16:19], v[116:119], v[84:87]
    v_accvgpr_write_b32 a225, v33
    v_accvgpr_write_b32 a226, v34
    v_mfma_f32_16x16x32_bf16 v[88:91], v[16:19], v[120:123], v[88:91]
    v_accvgpr_write_b32 a227, v35
    v_cvt_pk_bf16_f32 v36, v36, v52
    v_mfma_f32_16x16x32_bf16 v[92:95], v[16:19], v[124:127], v[92:95]
    v_cvt_pk_bf16_f32 v37, v37, v53
    s_waitcnt lgkmcnt(1)
    v_mfma_f32_16x16x32_bf16 v[64:67], v[20:23], v[128:131], v[64:67]
    ds_read_b128 v[16:19], v31 offset:32896
    v_cvt_pk_bf16_f32 v38, v38, v54
    v_mfma_f32_16x16x32_bf16 v[68:71], v[20:23], v[132:135], v[68:71]
    v_cvt_pk_bf16_f32 v39, v39, v55
    v_accvgpr_write_b32 a232, v36
    v_mfma_f32_16x16x32_bf16 v[72:75], v[20:23], v[136:139], v[72:75]
    v_accvgpr_write_b32 a233, v37
    v_accvgpr_write_b32 a234, v38
    v_mfma_f32_16x16x32_bf16 v[76:79], v[20:23], v[140:143], v[76:79]
    v_accvgpr_write_b32 a235, v39
    s_waitcnt lgkmcnt(1)
    v_mfma_f32_16x16x32_bf16 v[80:83], v[24:27], v[128:131], v[80:83]
    ds_read_b128 v[20:23], v31 offset:39040
    v_cvt_pk_bf16_f32 v40, v40, v56
    v_mfma_f32_16x16x32_bf16 v[84:87], v[24:27], v[132:135], v[84:87]
    v_cvt_pk_bf16_f32 v41, v41, v57
    v_cvt_pk_bf16_f32 v42, v42, v58
    v_mfma_f32_16x16x32_bf16 v[88:91], v[24:27], v[136:139], v[88:91]
    v_cvt_pk_bf16_f32 v43, v43, v59
    v_accvgpr_write_b32 a240, v40
    v_mfma_f32_16x16x32_bf16 v[92:95], v[24:27], v[140:143], v[92:95]
    v_accvgpr_write_b32 a241, v41
    s_waitcnt lgkmcnt(1)
    v_mfma_f32_16x16x32_bf16 v[64:67], v[16:19], v[144:147], v[64:67]
    ds_read_b128 v[24:27], v30 offset:33024
    v_accvgpr_write_b32 a242, v42
    v_mfma_f32_16x16x32_bf16 v[68:71], v[16:19], v[148:151], v[68:71]
    v_accvgpr_write_b32 a243, v43
    v_cvt_pk_bf16_f32 v44, v44, v60
    v_mfma_f32_16x16x32_bf16 v[72:75], v[16:19], v[152:155], v[72:75]
    v_cvt_pk_bf16_f32 v45, v45, v61
    v_cvt_pk_bf16_f32 v46, v46, v62
    v_mfma_f32_16x16x32_bf16 v[76:79], v[16:19], v[156:159], v[76:79]
    v_cvt_pk_bf16_f32 v47, v47, v63
    s_waitcnt lgkmcnt(1)
    v_mfma_f32_16x16x32_bf16 v[80:83], v[20:23], v[144:147], v[80:83]
    ds_read_b128 v[16:19], v30 offset:39168
    v_accvgpr_write_b32 a248, v44
    v_mfma_f32_16x16x32_bf16 v[84:87], v[20:23], v[148:151], v[84:87]
    v_accvgpr_write_b32 a249, v45
    v_accvgpr_write_b32 a250, v46
    v_mfma_f32_16x16x32_bf16 v[88:91], v[20:23], v[152:155], v[88:91]
    v_accvgpr_write_b32 a251, v47
    v_mfma_f32_16x16x32_bf16 v[92:95], v[20:23], v[156:159], v[92:95]
    s_waitcnt lgkmcnt(1)
    v_mfma_f32_16x16x32_bf16 v[64:67], v[24:27], v[160:163], v[64:67]
    ds_read_b128 v[20:23], v31 offset:33024
    v_mfma_f32_16x16x32_bf16 v[68:71], v[24:27], v[164:167], v[68:71]
    v_mfma_f32_16x16x32_bf16 v[72:75], v[24:27], v[168:171], v[72:75]
    v_mfma_f32_16x16x32_bf16 v[76:79], v[24:27], v[172:175], v[76:79]
    s_waitcnt lgkmcnt(1)
    v_mfma_f32_16x16x32_bf16 v[80:83], v[16:19], v[160:163], v[80:83]
    ds_read_b128 v[24:27], v31 offset:39168
    v_mfma_f32_16x16x32_bf16 v[84:87], v[16:19], v[164:167], v[84:87]
    v_mfma_f32_16x16x32_bf16 v[88:91], v[16:19], v[168:171], v[88:91]
    v_mfma_f32_16x16x32_bf16 v[92:95], v[16:19], v[172:175], v[92:95]
    s_waitcnt lgkmcnt(1)
    v_mfma_f32_16x16x32_bf16 v[64:67], v[20:23], v[176:179], v[64:67]
    v_mfma_f32_16x16x32_bf16 v[68:71], v[20:23], v[180:183], v[68:71]
    v_mfma_f32_16x16x32_bf16 v[72:75], v[20:23], v[184:187], v[72:75]
    v_mfma_f32_16x16x32_bf16 v[76:79], v[20:23], v[188:191], v[76:79]
    s_waitcnt lgkmcnt(0)
    v_mfma_f32_16x16x32_bf16 v[80:83], v[24:27], v[176:179], v[80:83]
    v_mfma_f32_16x16x32_bf16 v[84:87], v[24:27], v[180:183], v[84:87]
    v_mfma_f32_16x16x32_bf16 v[88:91], v[24:27], v[184:187], v[88:91]
    v_mfma_f32_16x16x32_bf16 v[92:95], v[24:27], v[188:191], v[92:95]
    s_waitcnt vmcnt(18)
    s_barrier
    ds_read_b128 v[16:19], v28 offset:0
    ds_read_b128 v[20:23], v28 offset:6144
    s_waitcnt lgkmcnt(1)
    v_mfma_f32_16x16x32_bf16 v[32:35], v[16:19], v[96:99], 0
    ds_read_b128 v[24:27], v29 offset:0
    v_cvt_pk_bf16_f32 v64, v64, v80
    v_mfma_f32_16x16x32_bf16 v[36:39], v[16:19], v[100:103], 0
    v_cvt_pk_bf16_f32 v65, v65, v81
    v_cvt_pk_bf16_f32 v66, v66, v82
    v_mfma_f32_16x16x32_bf16 v[40:43], v[16:19], v[104:107], 0
    v_cvt_pk_bf16_f32 v67, v67, v83
    v_accvgpr_write_b32 a228, v64
    v_mfma_f32_16x16x32_bf16 v[44:47], v[16:19], v[108:111], 0
    v_accvgpr_write_b32 a229, v65
    s_waitcnt lgkmcnt(1)
    v_mfma_f32_16x16x32_bf16 v[48:51], v[20:23], v[96:99], 0
    ds_read_b128 v[16:19], v29 offset:6144
    v_accvgpr_write_b32 a230, v66
    v_mfma_f32_16x16x32_bf16 v[52:55], v[20:23], v[100:103], 0
    v_accvgpr_write_b32 a231, v67
    v_cvt_pk_bf16_f32 v68, v68, v84
    v_mfma_f32_16x16x32_bf16 v[56:59], v[20:23], v[104:107], 0
    v_cvt_pk_bf16_f32 v69, v69, v85
    v_cvt_pk_bf16_f32 v70, v70, v86
    v_mfma_f32_16x16x32_bf16 v[60:63], v[20:23], v[108:111], 0
    v_cvt_pk_bf16_f32 v71, v71, v87
    s_waitcnt lgkmcnt(1)
    v_mfma_f32_16x16x32_bf16 v[32:35], v[24:27], v[112:115], v[32:35]
    ds_read_b128 v[20:23], v28 offset:128
    v_accvgpr_write_b32 a236, v68
    v_mfma_f32_16x16x32_bf16 v[36:39], v[24:27], v[116:119], v[36:39]
    v_accvgpr_write_b32 a237, v69
    v_accvgpr_write_b32 a238, v70
    v_mfma_f32_16x16x32_bf16 v[40:43], v[24:27], v[120:123], v[40:43]
    v_accvgpr_write_b32 a239, v71
    v_cvt_pk_bf16_f32 v72, v72, v88
    v_mfma_f32_16x16x32_bf16 v[44:47], v[24:27], v[124:127], v[44:47]
    v_cvt_pk_bf16_f32 v73, v73, v89
    s_waitcnt lgkmcnt(1)
    v_mfma_f32_16x16x32_bf16 v[48:51], v[16:19], v[112:115], v[48:51]
    ds_read_b128 v[24:27], v28 offset:6272
    v_cvt_pk_bf16_f32 v74, v74, v90
    v_mfma_f32_16x16x32_bf16 v[52:55], v[16:19], v[116:119], v[52:55]
    v_cvt_pk_bf16_f32 v75, v75, v91
    v_accvgpr_write_b32 a244, v72
    v_mfma_f32_16x16x32_bf16 v[56:59], v[16:19], v[120:123], v[56:59]
    v_accvgpr_write_b32 a245, v73
    v_accvgpr_write_b32 a246, v74
    v_mfma_f32_16x16x32_bf16 v[60:63], v[16:19], v[124:127], v[60:63]
    v_accvgpr_write_b32 a247, v75
    s_waitcnt lgkmcnt(1)
    v_mfma_f32_16x16x32_bf16 v[32:35], v[20:23], v[128:131], v[32:35]
    ds_read_b128 v[16:19], v29 offset:128
    v_cvt_pk_bf16_f32 v76, v76, v92
    v_mfma_f32_16x16x32_bf16 v[36:39], v[20:23], v[132:135], v[36:39]
    v_cvt_pk_bf16_f32 v77, v77, v93
    v_cvt_pk_bf16_f32 v78, v78, v94
    v_mfma_f32_16x16x32_bf16 v[40:43], v[20:23], v[136:139], v[40:43]
    v_cvt_pk_bf16_f32 v79, v79, v95
    v_accvgpr_write_b32 a252, v76
    v_mfma_f32_16x16x32_bf16 v[44:47], v[20:23], v[140:143], v[44:47]
    v_accvgpr_write_b32 a253, v77
    s_waitcnt lgkmcnt(1)
    v_mfma_f32_16x16x32_bf16 v[48:51], v[24:27], v[128:131], v[48:51]
    ds_read_b128 v[20:23], v29 offset:6272
    v_accvgpr_write_b32 a254, v78
    v_mfma_f32_16x16x32_bf16 v[52:55], v[24:27], v[132:135], v[52:55]
    v_accvgpr_write_b32 a255, v79
    v_mfma_f32_16x16x32_bf16 v[56:59], v[24:27], v[136:139], v[56:59]
    v_mfma_f32_16x16x32_bf16 v[60:63], v[24:27], v[140:143], v[60:63]
    s_waitcnt lgkmcnt(1)
    v_mfma_f32_16x16x32_bf16 v[32:35], v[16:19], v[144:147], v[32:35]
    ds_read_b128 v[24:27], v28 offset:256
    v_mfma_f32_16x16x32_bf16 v[36:39], v[16:19], v[148:151], v[36:39]
    v_mfma_f32_16x16x32_bf16 v[40:43], v[16:19], v[152:155], v[40:43]
    v_mfma_f32_16x16x32_bf16 v[44:47], v[16:19], v[156:159], v[44:47]
    s_waitcnt lgkmcnt(1)
    v_mfma_f32_16x16x32_bf16 v[48:51], v[20:23], v[144:147], v[48:51]
    ds_read_b128 v[16:19], v28 offset:6400
    v_mfma_f32_16x16x32_bf16 v[52:55], v[20:23], v[148:151], v[52:55]
    v_mfma_f32_16x16x32_bf16 v[56:59], v[20:23], v[152:155], v[56:59]
    v_mfma_f32_16x16x32_bf16 v[60:63], v[20:23], v[156:159], v[60:63]
    s_waitcnt lgkmcnt(1)
    v_mfma_f32_16x16x32_bf16 v[32:35], v[24:27], v[160:163], v[32:35]
    ds_read_b128 v[20:23], v29 offset:256
    v_mfma_f32_16x16x32_bf16 v[36:39], v[24:27], v[164:167], v[36:39]
    v_mfma_f32_16x16x32_bf16 v[40:43], v[24:27], v[168:171], v[40:43]
    v_mfma_f32_16x16x32_bf16 v[44:47], v[24:27], v[172:175], v[44:47]
    s_waitcnt lgkmcnt(1)
    v_mfma_f32_16x16x32_bf16 v[48:51], v[16:19], v[160:163], v[48:51]
    ds_read_b128 v[24:27], v29 offset:6400
    v_mfma_f32_16x16x32_bf16 v[52:55], v[16:19], v[164:167], v[52:55]
    v_mfma_f32_16x16x32_bf16 v[56:59], v[16:19], v[168:171], v[56:59]
    v_mfma_f32_16x16x32_bf16 v[60:63], v[16:19], v[172:175], v[60:63]
    s_waitcnt lgkmcnt(1)
    v_mfma_f32_16x16x32_bf16 v[32:35], v[20:23], v[176:179], v[32:35]
    v_mfma_f32_16x16x32_bf16 v[36:39], v[20:23], v[180:183], v[36:39]
    v_mfma_f32_16x16x32_bf16 v[40:43], v[20:23], v[184:187], v[40:43]
    v_mfma_f32_16x16x32_bf16 v[44:47], v[20:23], v[188:191], v[44:47]
    s_waitcnt lgkmcnt(0)
    v_mfma_f32_16x16x32_bf16 v[48:51], v[24:27], v[176:179], v[48:51]
    v_mfma_f32_16x16x32_bf16 v[52:55], v[24:27], v[180:183], v[52:55]
    v_mfma_f32_16x16x32_bf16 v[56:59], v[24:27], v[184:187], v[56:59]
    v_mfma_f32_16x16x32_bf16 v[60:63], v[24:27], v[188:191], v[60:63]
    s_waitcnt vmcnt(12)
    s_barrier
    ds_read_b128 v[16:19], v28 offset:24576
    ds_read_b128 v[20:23], v28 offset:30720
    s_waitcnt lgkmcnt(1)
    v_mfma_f32_16x16x32_bf16 v[64:67], v[16:19], v[96:99], 0
    ds_read_b128 v[24:27], v29 offset:24576
    v_cvt_pk_bf16_f32 v192, v32, v48
    v_mfma_f32_16x16x32_bf16 v[68:71], v[16:19], v[100:103], 0
    v_cvt_pk_bf16_f32 v193, v33, v49
    v_cvt_pk_bf16_f32 v194, v34, v50
    v_mfma_f32_16x16x32_bf16 v[72:75], v[16:19], v[104:107], 0
    v_cvt_pk_bf16_f32 v195, v35, v51
    v_cvt_pk_bf16_f32 v200, v36, v52
    v_mfma_f32_16x16x32_bf16 v[76:79], v[16:19], v[108:111], 0
    v_cvt_pk_bf16_f32 v201, v37, v53
    s_waitcnt lgkmcnt(1)
    v_mfma_f32_16x16x32_bf16 v[80:83], v[20:23], v[96:99], 0
    ds_read_b128 v[16:19], v29 offset:30720
    v_cvt_pk_bf16_f32 v202, v38, v54
    v_mfma_f32_16x16x32_bf16 v[84:87], v[20:23], v[100:103], 0
    v_cvt_pk_bf16_f32 v203, v39, v55
    v_cvt_pk_bf16_f32 v208, v40, v56
    v_mfma_f32_16x16x32_bf16 v[88:91], v[20:23], v[104:107], 0
    v_cvt_pk_bf16_f32 v209, v41, v57
    v_cvt_pk_bf16_f32 v210, v42, v58
    v_mfma_f32_16x16x32_bf16 v[92:95], v[20:23], v[108:111], 0
    v_cvt_pk_bf16_f32 v211, v43, v59
    s_waitcnt lgkmcnt(1)
    v_mfma_f32_16x16x32_bf16 v[64:67], v[24:27], v[112:115], v[64:67]
    ds_read_b128 v[20:23], v28 offset:24704
    v_cvt_pk_bf16_f32 v216, v44, v60
    v_mfma_f32_16x16x32_bf16 v[68:71], v[24:27], v[116:119], v[68:71]
    v_cvt_pk_bf16_f32 v217, v45, v61
    v_cvt_pk_bf16_f32 v218, v46, v62
    v_mfma_f32_16x16x32_bf16 v[72:75], v[24:27], v[120:123], v[72:75]
    v_cvt_pk_bf16_f32 v219, v47, v63
    v_mfma_f32_16x16x32_bf16 v[76:79], v[24:27], v[124:127], v[76:79]
    s_waitcnt lgkmcnt(1)
    v_mfma_f32_16x16x32_bf16 v[80:83], v[16:19], v[112:115], v[80:83]
    ds_read_b128 v[24:27], v28 offset:30848
    v_mfma_f32_16x16x32_bf16 v[84:87], v[16:19], v[116:119], v[84:87]
    v_mfma_f32_16x16x32_bf16 v[88:91], v[16:19], v[120:123], v[88:91]
    v_mfma_f32_16x16x32_bf16 v[92:95], v[16:19], v[124:127], v[92:95]
    s_waitcnt lgkmcnt(1)
    v_mfma_f32_16x16x32_bf16 v[64:67], v[20:23], v[128:131], v[64:67]
    ds_read_b128 v[16:19], v29 offset:24704
    v_mfma_f32_16x16x32_bf16 v[68:71], v[20:23], v[132:135], v[68:71]
    v_mfma_f32_16x16x32_bf16 v[72:75], v[20:23], v[136:139], v[72:75]
    v_mfma_f32_16x16x32_bf16 v[76:79], v[20:23], v[140:143], v[76:79]
    s_waitcnt lgkmcnt(1)
    v_mfma_f32_16x16x32_bf16 v[80:83], v[24:27], v[128:131], v[80:83]
    ds_read_b128 v[20:23], v29 offset:30848
    v_mfma_f32_16x16x32_bf16 v[84:87], v[24:27], v[132:135], v[84:87]
    v_mfma_f32_16x16x32_bf16 v[88:91], v[24:27], v[136:139], v[88:91]
    v_mfma_f32_16x16x32_bf16 v[92:95], v[24:27], v[140:143], v[92:95]
    s_waitcnt lgkmcnt(1)
    v_mfma_f32_16x16x32_bf16 v[64:67], v[16:19], v[144:147], v[64:67]
    ds_read_b128 v[24:27], v28 offset:24832
    v_mfma_f32_16x16x32_bf16 v[68:71], v[16:19], v[148:151], v[68:71]
    v_mfma_f32_16x16x32_bf16 v[72:75], v[16:19], v[152:155], v[72:75]
    v_mfma_f32_16x16x32_bf16 v[76:79], v[16:19], v[156:159], v[76:79]
    s_waitcnt lgkmcnt(1)
    v_mfma_f32_16x16x32_bf16 v[80:83], v[20:23], v[144:147], v[80:83]
    ds_read_b128 v[16:19], v28 offset:30976
    v_mfma_f32_16x16x32_bf16 v[84:87], v[20:23], v[148:151], v[84:87]
    v_mfma_f32_16x16x32_bf16 v[88:91], v[20:23], v[152:155], v[88:91]
    v_mfma_f32_16x16x32_bf16 v[92:95], v[20:23], v[156:159], v[92:95]
    s_waitcnt lgkmcnt(1)
    v_mfma_f32_16x16x32_bf16 v[64:67], v[24:27], v[160:163], v[64:67]
    ds_read_b128 v[20:23], v29 offset:24832
    v_mfma_f32_16x16x32_bf16 v[68:71], v[24:27], v[164:167], v[68:71]
    v_mfma_f32_16x16x32_bf16 v[72:75], v[24:27], v[168:171], v[72:75]
    v_mfma_f32_16x16x32_bf16 v[76:79], v[24:27], v[172:175], v[76:79]
    s_waitcnt lgkmcnt(1)
    v_mfma_f32_16x16x32_bf16 v[80:83], v[16:19], v[160:163], v[80:83]
    ds_read_b128 v[24:27], v29 offset:30976
    v_mfma_f32_16x16x32_bf16 v[84:87], v[16:19], v[164:167], v[84:87]
    v_mfma_f32_16x16x32_bf16 v[88:91], v[16:19], v[168:171], v[88:91]
    v_mfma_f32_16x16x32_bf16 v[92:95], v[16:19], v[172:175], v[92:95]
    s_waitcnt lgkmcnt(1)
    v_mfma_f32_16x16x32_bf16 v[64:67], v[20:23], v[176:179], v[64:67]
    v_mfma_f32_16x16x32_bf16 v[68:71], v[20:23], v[180:183], v[68:71]
    v_mfma_f32_16x16x32_bf16 v[72:75], v[20:23], v[184:187], v[72:75]
    v_mfma_f32_16x16x32_bf16 v[76:79], v[20:23], v[188:191], v[76:79]
    s_waitcnt lgkmcnt(0)
    v_mfma_f32_16x16x32_bf16 v[80:83], v[24:27], v[176:179], v[80:83]
    v_mfma_f32_16x16x32_bf16 v[84:87], v[24:27], v[180:183], v[84:87]
    v_mfma_f32_16x16x32_bf16 v[88:91], v[24:27], v[184:187], v[88:91]
    v_mfma_f32_16x16x32_bf16 v[92:95], v[24:27], v[188:191], v[92:95]
    s_waitcnt vmcnt(6)
    s_barrier
    ds_read_b128 v[16:19], v28 offset:49152
    ds_read_b128 v[20:23], v28 offset:55296
    s_waitcnt lgkmcnt(1)
    v_mfma_f32_16x16x32_bf16 v[32:35], v[16:19], v[96:99], 0
    ds_read_b128 v[24:27], v29 offset:49152
    v_cvt_pk_bf16_f32 v196, v64, v80
    v_mfma_f32_16x16x32_bf16 v[36:39], v[16:19], v[100:103], 0
    v_cvt_pk_bf16_f32 v197, v65, v81
    v_cvt_pk_bf16_f32 v198, v66, v82
    v_mfma_f32_16x16x32_bf16 v[40:43], v[16:19], v[104:107], 0
    v_cvt_pk_bf16_f32 v199, v67, v83
    v_cvt_pk_bf16_f32 v204, v68, v84
    v_mfma_f32_16x16x32_bf16 v[44:47], v[16:19], v[108:111], 0
    v_cvt_pk_bf16_f32 v205, v69, v85
    s_waitcnt lgkmcnt(1)
    v_mfma_f32_16x16x32_bf16 v[48:51], v[20:23], v[96:99], 0
    ds_read_b128 v[16:19], v29 offset:55296
    v_cvt_pk_bf16_f32 v206, v70, v86
    v_mfma_f32_16x16x32_bf16 v[52:55], v[20:23], v[100:103], 0
    v_cvt_pk_bf16_f32 v207, v71, v87
    v_cvt_pk_bf16_f32 v212, v72, v88
    v_mfma_f32_16x16x32_bf16 v[56:59], v[20:23], v[104:107], 0
    v_cvt_pk_bf16_f32 v213, v73, v89
    v_cvt_pk_bf16_f32 v214, v74, v90
    v_mfma_f32_16x16x32_bf16 v[60:63], v[20:23], v[108:111], 0
    v_cvt_pk_bf16_f32 v215, v75, v91
    s_waitcnt lgkmcnt(1)
    v_mfma_f32_16x16x32_bf16 v[32:35], v[24:27], v[112:115], v[32:35]
    ds_read_b128 v[20:23], v28 offset:49280
    v_cvt_pk_bf16_f32 v220, v76, v92
    v_mfma_f32_16x16x32_bf16 v[36:39], v[24:27], v[116:119], v[36:39]
    v_cvt_pk_bf16_f32 v221, v77, v93
    v_cvt_pk_bf16_f32 v222, v78, v94
    v_mfma_f32_16x16x32_bf16 v[40:43], v[24:27], v[120:123], v[40:43]
    v_cvt_pk_bf16_f32 v223, v79, v95
    v_mfma_f32_16x16x32_bf16 v[44:47], v[24:27], v[124:127], v[44:47]
    s_waitcnt lgkmcnt(1)
    v_mfma_f32_16x16x32_bf16 v[48:51], v[16:19], v[112:115], v[48:51]
    ds_read_b128 v[24:27], v28 offset:55424
    v_mfma_f32_16x16x32_bf16 v[52:55], v[16:19], v[116:119], v[52:55]
    v_mfma_f32_16x16x32_bf16 v[56:59], v[16:19], v[120:123], v[56:59]
    v_mfma_f32_16x16x32_bf16 v[60:63], v[16:19], v[124:127], v[60:63]
    s_waitcnt lgkmcnt(1)
    v_mfma_f32_16x16x32_bf16 v[32:35], v[20:23], v[128:131], v[32:35]
    ds_read_b128 v[16:19], v29 offset:49280
    v_mfma_f32_16x16x32_bf16 v[36:39], v[20:23], v[132:135], v[36:39]
    v_mfma_f32_16x16x32_bf16 v[40:43], v[20:23], v[136:139], v[40:43]
    v_mfma_f32_16x16x32_bf16 v[44:47], v[20:23], v[140:143], v[44:47]
    s_waitcnt lgkmcnt(1)
    v_mfma_f32_16x16x32_bf16 v[48:51], v[24:27], v[128:131], v[48:51]
    ds_read_b128 v[20:23], v29 offset:55424
    v_mfma_f32_16x16x32_bf16 v[52:55], v[24:27], v[132:135], v[52:55]
    v_mfma_f32_16x16x32_bf16 v[56:59], v[24:27], v[136:139], v[56:59]
    v_mfma_f32_16x16x32_bf16 v[60:63], v[24:27], v[140:143], v[60:63]
    s_waitcnt lgkmcnt(1)
    v_mfma_f32_16x16x32_bf16 v[32:35], v[16:19], v[144:147], v[32:35]
    ds_read_b128 v[24:27], v28 offset:49408
    v_mfma_f32_16x16x32_bf16 v[36:39], v[16:19], v[148:151], v[36:39]
    v_mfma_f32_16x16x32_bf16 v[40:43], v[16:19], v[152:155], v[40:43]
    v_mfma_f32_16x16x32_bf16 v[44:47], v[16:19], v[156:159], v[44:47]
    s_waitcnt lgkmcnt(1)
    v_mfma_f32_16x16x32_bf16 v[48:51], v[20:23], v[144:147], v[48:51]
    ds_read_b128 v[16:19], v28 offset:55552
    v_mfma_f32_16x16x32_bf16 v[52:55], v[20:23], v[148:151], v[52:55]
    v_mfma_f32_16x16x32_bf16 v[56:59], v[20:23], v[152:155], v[56:59]
    v_mfma_f32_16x16x32_bf16 v[60:63], v[20:23], v[156:159], v[60:63]
    s_waitcnt lgkmcnt(1)
    v_mfma_f32_16x16x32_bf16 v[32:35], v[24:27], v[160:163], v[32:35]
    ds_read_b128 v[20:23], v29 offset:49408
    v_mfma_f32_16x16x32_bf16 v[36:39], v[24:27], v[164:167], v[36:39]
    v_mfma_f32_16x16x32_bf16 v[40:43], v[24:27], v[168:171], v[40:43]
    v_mfma_f32_16x16x32_bf16 v[44:47], v[24:27], v[172:175], v[44:47]
    s_waitcnt lgkmcnt(1)
    v_mfma_f32_16x16x32_bf16 v[48:51], v[16:19], v[160:163], v[48:51]
    ds_read_b128 v[24:27], v29 offset:55552
    v_mfma_f32_16x16x32_bf16 v[52:55], v[16:19], v[164:167], v[52:55]
    v_mfma_f32_16x16x32_bf16 v[56:59], v[16:19], v[168:171], v[56:59]
    v_mfma_f32_16x16x32_bf16 v[60:63], v[16:19], v[172:175], v[60:63]
    s_waitcnt lgkmcnt(1)
    v_mfma_f32_16x16x32_bf16 v[32:35], v[20:23], v[176:179], v[32:35]
    v_mfma_f32_16x16x32_bf16 v[36:39], v[20:23], v[180:183], v[36:39]
    v_mfma_f32_16x16x32_bf16 v[40:43], v[20:23], v[184:187], v[40:43]
    v_mfma_f32_16x16x32_bf16 v[44:47], v[20:23], v[188:191], v[44:47]
    s_waitcnt lgkmcnt(0)
    v_mfma_f32_16x16x32_bf16 v[48:51], v[24:27], v[176:179], v[48:51]
    v_mfma_f32_16x16x32_bf16 v[52:55], v[24:27], v[180:183], v[52:55]
    v_mfma_f32_16x16x32_bf16 v[56:59], v[24:27], v[184:187], v[56:59]
    v_mfma_f32_16x16x32_bf16 v[60:63], v[24:27], v[188:191], v[60:63]
    s_waitcnt vmcnt(0)
    s_barrier
    ds_read_b128 v[16:19], v30 offset:8192
    ds_read_b128 v[20:23], v30 offset:14336
    s_waitcnt lgkmcnt(1)
    v_mfma_f32_16x16x32_bf16 v[64:67], v[16:19], v[96:99], 0
    ds_read_b128 v[24:27], v31 offset:8192
    v_cvt_pk_bf16_f32 v224, v32, v48
    v_mfma_f32_16x16x32_bf16 v[68:71], v[16:19], v[100:103], 0
    v_cvt_pk_bf16_f32 v225, v33, v49
    v_cvt_pk_bf16_f32 v226, v34, v50
    v_mfma_f32_16x16x32_bf16 v[72:75], v[16:19], v[104:107], 0
    v_cvt_pk_bf16_f32 v227, v35, v51
    v_cvt_pk_bf16_f32 v232, v36, v52
    v_mfma_f32_16x16x32_bf16 v[76:79], v[16:19], v[108:111], 0
    v_cvt_pk_bf16_f32 v233, v37, v53
    s_waitcnt lgkmcnt(1)
    v_mfma_f32_16x16x32_bf16 v[80:83], v[20:23], v[96:99], 0
    ds_read_b128 v[16:19], v31 offset:14336
    v_cvt_pk_bf16_f32 v234, v38, v54
    v_mfma_f32_16x16x32_bf16 v[84:87], v[20:23], v[100:103], 0
    v_cvt_pk_bf16_f32 v235, v39, v55
    v_cvt_pk_bf16_f32 v240, v40, v56
    v_mfma_f32_16x16x32_bf16 v[88:91], v[20:23], v[104:107], 0
    v_cvt_pk_bf16_f32 v241, v41, v57
    v_cvt_pk_bf16_f32 v242, v42, v58
    v_mfma_f32_16x16x32_bf16 v[92:95], v[20:23], v[108:111], 0
    v_cvt_pk_bf16_f32 v243, v43, v59
    s_waitcnt lgkmcnt(1)
    v_mfma_f32_16x16x32_bf16 v[64:67], v[24:27], v[112:115], v[64:67]
    ds_read_b128 v[20:23], v30 offset:8320
    v_cvt_pk_bf16_f32 v248, v44, v60
    v_mfma_f32_16x16x32_bf16 v[68:71], v[24:27], v[116:119], v[68:71]
    v_cvt_pk_bf16_f32 v249, v45, v61
    v_cvt_pk_bf16_f32 v250, v46, v62
    v_mfma_f32_16x16x32_bf16 v[72:75], v[24:27], v[120:123], v[72:75]
    v_cvt_pk_bf16_f32 v251, v47, v63
    v_mfma_f32_16x16x32_bf16 v[76:79], v[24:27], v[124:127], v[76:79]
    s_waitcnt lgkmcnt(1)
    v_mfma_f32_16x16x32_bf16 v[80:83], v[16:19], v[112:115], v[80:83]
    ds_read_b128 v[24:27], v30 offset:14464
    v_mfma_f32_16x16x32_bf16 v[84:87], v[16:19], v[116:119], v[84:87]
    v_mfma_f32_16x16x32_bf16 v[88:91], v[16:19], v[120:123], v[88:91]
    v_mfma_f32_16x16x32_bf16 v[92:95], v[16:19], v[124:127], v[92:95]
    s_waitcnt lgkmcnt(1)
    v_mfma_f32_16x16x32_bf16 v[64:67], v[20:23], v[128:131], v[64:67]
    ds_read_b128 v[16:19], v31 offset:8320
    v_mfma_f32_16x16x32_bf16 v[68:71], v[20:23], v[132:135], v[68:71]
    v_mfma_f32_16x16x32_bf16 v[72:75], v[20:23], v[136:139], v[72:75]
    v_mfma_f32_16x16x32_bf16 v[76:79], v[20:23], v[140:143], v[76:79]
    s_waitcnt lgkmcnt(1)
    v_mfma_f32_16x16x32_bf16 v[80:83], v[24:27], v[128:131], v[80:83]
    ds_read_b128 v[20:23], v31 offset:14464
    v_mfma_f32_16x16x32_bf16 v[84:87], v[24:27], v[132:135], v[84:87]
    v_mfma_f32_16x16x32_bf16 v[88:91], v[24:27], v[136:139], v[88:91]
    v_mfma_f32_16x16x32_bf16 v[92:95], v[24:27], v[140:143], v[92:95]
    s_waitcnt lgkmcnt(1)
    v_mfma_f32_16x16x32_bf16 v[64:67], v[16:19], v[144:147], v[64:67]
    ds_read_b128 v[24:27], v30 offset:8448
    v_mfma_f32_16x16x32_bf16 v[68:71], v[16:19], v[148:151], v[68:71]
    v_mfma_f32_16x16x32_bf16 v[72:75], v[16:19], v[152:155], v[72:75]
    v_mfma_f32_16x16x32_bf16 v[76:79], v[16:19], v[156:159], v[76:79]
    s_waitcnt lgkmcnt(1)
    v_mfma_f32_16x16x32_bf16 v[80:83], v[20:23], v[144:147], v[80:83]
    ds_read_b128 v[16:19], v30 offset:14592
    v_mfma_f32_16x16x32_bf16 v[84:87], v[20:23], v[148:151], v[84:87]
    v_mfma_f32_16x16x32_bf16 v[88:91], v[20:23], v[152:155], v[88:91]
    v_mfma_f32_16x16x32_bf16 v[92:95], v[20:23], v[156:159], v[92:95]
    s_waitcnt lgkmcnt(1)
    v_mfma_f32_16x16x32_bf16 v[64:67], v[24:27], v[160:163], v[64:67]
    ds_read_b128 v[20:23], v31 offset:8448
    v_mfma_f32_16x16x32_bf16 v[68:71], v[24:27], v[164:167], v[68:71]
    v_mfma_f32_16x16x32_bf16 v[72:75], v[24:27], v[168:171], v[72:75]
    v_mfma_f32_16x16x32_bf16 v[76:79], v[24:27], v[172:175], v[76:79]
    s_waitcnt lgkmcnt(1)
    v_mfma_f32_16x16x32_bf16 v[80:83], v[16:19], v[160:163], v[80:83]
    ds_read_b128 v[24:27], v31 offset:14592
    v_mfma_f32_16x16x32_bf16 v[84:87], v[16:19], v[164:167], v[84:87]
    v_mfma_f32_16x16x32_bf16 v[88:91], v[16:19], v[168:171], v[88:91]
    v_mfma_f32_16x16x32_bf16 v[92:95], v[16:19], v[172:175], v[92:95]
    s_waitcnt lgkmcnt(1)
    v_mfma_f32_16x16x32_bf16 v[64:67], v[20:23], v[176:179], v[64:67]
    v_mfma_f32_16x16x32_bf16 v[68:71], v[20:23], v[180:183], v[68:71]
    v_mfma_f32_16x16x32_bf16 v[72:75], v[20:23], v[184:187], v[72:75]
    v_mfma_f32_16x16x32_bf16 v[76:79], v[20:23], v[188:191], v[76:79]
    s_waitcnt lgkmcnt(0)
    v_mfma_f32_16x16x32_bf16 v[80:83], v[24:27], v[176:179], v[80:83]
    v_mfma_f32_16x16x32_bf16 v[84:87], v[24:27], v[180:183], v[84:87]
    v_mfma_f32_16x16x32_bf16 v[88:91], v[24:27], v[184:187], v[88:91]
    v_mfma_f32_16x16x32_bf16 v[92:95], v[24:27], v[188:191], v[92:95]
    s_nop 4
    v_cvt_pk_bf16_f32 v228, v64, v80
    v_cvt_pk_bf16_f32 v229, v65, v81
    v_cvt_pk_bf16_f32 v230, v66, v82
    v_cvt_pk_bf16_f32 v231, v67, v83
    v_cvt_pk_bf16_f32 v236, v68, v84
    v_cvt_pk_bf16_f32 v237, v69, v85
    v_cvt_pk_bf16_f32 v238, v70, v86
    v_cvt_pk_bf16_f32 v239, v71, v87
    v_cvt_pk_bf16_f32 v244, v72, v88
    v_cvt_pk_bf16_f32 v245, v73, v89
    v_cvt_pk_bf16_f32 v246, v74, v90
    v_cvt_pk_bf16_f32 v247, v75, v91
    v_cvt_pk_bf16_f32 v252, v76, v92
    v_cvt_pk_bf16_f32 v253, v77, v93
    v_cvt_pk_bf16_f32 v254, v78, v94
    v_cvt_pk_bf16_f32 v255, v79, v95
    s_barrier
    s_mul_i32 s30, s35, 40
    s_add_u32 s30, s30, s36
    s_lshl_b32 s30, s30, 8
    v_lshlrev_b32 v19, 4, v4
    v_lshl_add_u32 v19, v5, 2, v19
    v_add_u32 v19, s30, v19
    v_and_b32 v12, 7, v4
    v_lshrrev_b32 v13, 3, v4
    v_lshlrev_b32 v22, 3, v2
    v_lshl_add_u32 v22, v13, 2, v22
    v_add_u32 v22, v22, v5
    v_mul_u32_u24 v22, 10240, v22
    v_lshl_add_u32 v22, v12, 4, v22
    s_lshl_b32 s30, s40, 7
    v_add_u32 v22, s30, v22
    s_lshr_b32 s30, s40, 1
    s_lshl_b32 s30, s30, 10
    s_and_b32 s31, s40, 1
    s_lshl_b32 s31, s31, 7
    s_add_u32 s30, s30, s31
    v_lshlrev_b32 v14, 8, v5
    v_lshl_add_u32 v14, v12, 4, v14
    v_add_u32 v14, s30, v14
    v_lshl_add_u32 v15, v2, 3, v13
    v_mul_u32_u24 v15, 40960, v15
    v_add_u32 v11, v14, v15
    v_add_u32 v180, 0, v11
    v_add_u32 v181, 81920, v11
    v_add_u32 v182, 163840, v11
    v_add_u32 v183, 245760, v11
    v_and_b32 v18, 1, v2
    v_lshrrev_b32 v17, 2, v4
    v_lshlrev_b32 v17, 8, v17
    v_lshl_add_u32 v17, v5, 6, v17
    v_and_b32 v16, 3, v4
    v_lshl_add_u32 v17, v16, 4, v17
    v_lshl_add_u32 v17, v18, 12, v17
    v_lshrrev_b32 v18, 1, v2
    v_lshl_add_u32 v17, v18, 14, v17
    v_add_u32 v17, 0x8000, v17
    v_add_u32 v18, 0x4800, v8
    v_lshrrev_b32 v20, 1, v5
    v_and_b32 v21, 1, v5
    v_lshl_add_u32 v25, v2, 1, v20
    v_lshlrev_b32 v25, 8, v25
    v_lshl_add_u32 v25, v12, 5, v25
    v_lshl_add_u32 v25, v21, 4, v25
    v_add_u32 v25, 14336, v25
    v_add_u32 v26, 2048, v25
    v_cmp_eq_u32 vcc, v13, v20
    s_nop 1
    v_cndmask_b32 v25, v26, v25, vcc
    v_lshlrev_b32 v26, 2, v1
    v_add_u32 v26, 14336, v26
    s_lshl_b32 s30, s40, 7
    s_cmp_ge_u32 s40, 64
    s_cselect_b32 s31, 0x2000, 0
    s_add_u32 s30, s30, s31
    v_and_b32 v27, 3, v1
    v_lshlrev_b32 v27, 5, v27
    v_bfe_u32 v28, v1, 2, 1
    v_lshl_add_u32 v27, v28, 4, v27
    v_lshl_add_u32 v27, v5, 2, v27
    v_lshl_add_u32 v27, v2, 16, v27
    v_add_u32 v27, s30, v27
    v_cmp_eq_u32 vcc, 0, v13
    v_mov_b32 v28, 0x7f000000
    s_nop 0
    v_cndmask_b32 v27, v28, v27, vcc
    v_mov_b32 v28, -1
    v_mov_b32 v29, -1
    v_mov_b32 v30, -1
    v_mov_b32 v31, -1
    v_lshrrev_b32 v23, 13, v19
    v_lshlrev_b32 v23, 13, v23
    v_add_u32 v23, v23, v19
    v_lshrrev_b32 v24, 13, v22
    v_lshlrev_b32 v24, 13, v24
    v_add_u32 v24, v24, v22
    s_mov_b32 s73, s74
    s_mov_b32 s38, 0x4000000
    s_mov_b32 s39, 0xb600000
    v_and_b32 v140, 31, v1
    v_lshlrev_b32 v140, 2, v140
    v_mov_b32 v141, 0x7f000000
    v_cmp_eq_u32 vcc, 0, v0
    s_nop 1
    v_cndmask_b32 v141, v141, v0, vcc
    v_mov_b32 v142, 1
    s_cmp_ge_u32 s40, 48
    s_cselect_b32 s35, 0x2000, 0
    s_add_u32 s35, s35, 0xe280000
    s_lshl_b32 s37, s75, 2
    s_add_u32 s37, s37, 0xe285000
    s_mov_b32 s36, 0x7f000000
    v_lshlrev_b32 v138, 2, v1
    s_mov_b32 s30, 0xe28f800
    s_mov_b32 s33, 0
wf_91:
    buffer_load_dword v139, v138, s[8:11], s30 offen sc1
    s_add_u32 s33, s33, 1
    s_cmp_gt_u32 s33, 2097152
    s_cbranch_scc1 rec_fail
    s_waitcnt vmcnt(0)
    v_cmp_eq_u32 vcc, 0, v139
    s_cbranch_vccz wfd_92
    s_sleep 4
    s_branch wf_91
    s_nop 1
wfd_92:
    s_mov_b32 s30, 0xe28f8c0
    s_mov_b32 s33, 0
wf_93:
    buffer_load_dword v139, v138, s[8:11], s30 offen sc1
    s_add_u32 s33, s33, 1
    s_cmp_gt_u32 s33, 2097152
    s_cbranch_scc1 rec_fail
    s_waitcnt vmcnt(0)
    v_cmp_eq_u32 vcc, 0, v139
    s_cbranch_vccz wfd_94
    s_sleep 4
    s_branch wf_93
    s_nop 1
wfd_94:
    v_mov_b32 v143, 0
    s_nop 1
co_loop:
    s_add_u32 s30, s26, 0
    s_and_b32 s30, s30, 7
    s_lshl_b32 s30, s30, 18
    s_add_u32 s28, s30, s34
    s_add_u32 s28, s28, s27
    s_add_u32 s30, s26, 1
    s_and_b32 s30, s30, 7
    s_lshl_b32 s30, s30, 18
    s_add_u32 s29, s30, s34
    v_mov_b32 v72, 0
    v_mov_b32 v73, 0
    v_mov_b32 v74, 0
    v_mov_b32 v75, 0
    v_mov_b32 v76, 0
    v_mov_b32 v77, 0
    v_mov_b32 v78, 0
    v_mov_b32 v79, 0
    v_mov_b32 v80, 0
    v_mov_b32 v81, 0
    v_mov_b32 v82, 0
    v_mov_b32 v83, 0
    v_mov_b32 v84, 0
    v_mov_b32 v85, 0
    v_mov_b32 v86, 0
    v_mov_b32 v87, 0
    s_add_u32 s32, s28, 4096
    s_mov_b32 s33, 0
    s_cmp_eq_u32 s26, 0
    s_cbranch_scc1 Lskip_96
    s_sleep 8
Lskip_96:
poll_com_95:
    buffer_load_dwordx4 v[128:131], v8, s[8:11], s28 offen sc1
    buffer_load_dwordx4 v[132:135], v8, s[8:11], s32 offen sc1
    buffer_load_dwordx2 v[136:137], v9, s[8:11], s28 offen sc1
    s_add_u32 s33, s33, 1
    s_cmp_gt_u32 s33, 4194304
    s_cbranch_scc1 rec_fail
    s_waitcnt vmcnt(0)
    ds_write_b128 v8, v[128:131] offset:0
    ds_write_b128 v8, v[132:135] offset:4096
    ds_write_b64 v10, v[136:137] offset:8192
    v_max3_u32 v184, v128, v129, v130
    v_max3_u32 v185, v131, v132, v133
    v_max3_u32 v186, v134, v135, v136
    v_max3_u32 v187, v184, v185, v186
    v_max_u32 v188, v187, v137
    v_cmp_eq_u32 vcc, -1, v188
    s_cbranch_vccnz poll_com_95
    s_waitcnt lgkmcnt(0)
    s_barrier
    ds_read_b128 v[32:35], v7 offset:0
    ds_read_b128 v[36:39], v7 offset:1024
    buffer_store_dword v142, v141, s[8:11], s36 offen sc1
    s_mov_b32 s36, s37
    s_add_u32 s37, s37, 512
    s_waitcnt lgkmcnt(1)
    v_smfmac_f32_16x16x64_bf16 v[72:75], v[32:35], a[0:7], v6
    ds_read_b128 v[40:43], v7 offset:2048
    v_smfmac_f32_16x16x64_bf16 v[76:79], v[32:35], a[8:15], v6
    ds_read_b128 v[44:47], v7 offset:3072
    v_smfmac_f32_16x16x64_bf16 v[80:83], v[32:35], a[16:23], v6
    v_mov_b32 v112, v144
    v_smfmac_f32_16x16x64_bf16 v[84:87], v[32:35], a[24:31], v6
    s_waitcnt lgkmcnt(2)
    v_smfmac_f32_16x16x64_bf16 v[72:75], v[36:39], a[32:39], v6
    ds_read_b128 v[48:51], v7 offset:4096
    v_smfmac_f32_16x16x64_bf16 v[76:79], v[36:39], a[40:47], v6
    ds_read_b128 v[52:55], v7 offset:5120
    v_smfmac_f32_16x16x64_bf16 v[80:83], v[36:39], a[48:55], v6
    v_mov_b32 v113, v145
    v_smfmac_f32_16x16x64_bf16 v[84:87], v[36:39], a[56:63], v6
    s_waitcnt lgkmcnt(3)
    v_smfmac_f32_16x16x64_bf16 v[72:75], v[40:43], a[64:71], v6
    ds_read_b128 v[56:59], v7 offset:6144
    v_smfmac_f32_16x16x64_bf16 v[76:79], v[40:43], a[72:79], v6
    ds_read_b128 v[60:63], v7 offset:7168
    v_smfmac_f32_16x16x64_bf16 v[80:83], v[40:43], a[80:87], v6
    v_mov_b32 v114, v146
    v_smfmac_f32_16x16x64_bf16 v[84:87], v[40:43], a[88:95], v6
    s_waitcnt lgkmcnt(4)
    v_smfmac_f32_16x16x64_bf16 v[72:75], v[44:47], a[96:103], v6
    ds_read_b128 v[64:67], v7 offset:8192
    v_smfmac_f32_16x16x64_bf16 v[76:79], v[44:47], a[104:111], v6
    ds_read_b128 v[68:71], v7 offset:9216
    v_smfmac_f32_16x16x64_bf16 v[80:83], v[44:47], a[112:119], v6
    v_mov_b32 v115, v147
    v_smfmac_f32_16x16x64_bf16 v[84:87], v[44:47], a[120:127], v6
    s_waitcnt lgkmcnt(5)
    v_smfmac_f32_16x16x64_bf16 v[72:75], v[48:51], a[128:135], v6
    v_mov_b32 v116, v148
    v_smfmac_f32_16x16x64_bf16 v[76:79], v[48:51], a[136:143], v6
    v_mov_b32 v117, v149
    v_smfmac_f32_16x16x64_bf16 v[80:83], v[48:51], a[144:151], v6
    v_mov_b32 v118, v150
    v_smfmac_f32_16x16x64_bf16 v[84:87], v[48:51], a[152:159], v6
    s_waitcnt lgkmcnt(4)
    v_smfmac_f32_16x16x64_bf16 v[72:75], v[52:55], a[160:167], v6
    v_mov_b32 v119, v151
    v_smfmac_f32_16x16x64_bf16 v[76:79], v[52:55], a[168:175], v6
    v_mov_b32 v120, v152
    v_smfmac_f32_16x16x64_bf16 v[80:83], v[52:55], a[176:183], v6
    v_mov_b32 v121, v153
    v_smfmac_f32_16x16x64_bf16 v[84:87], v[52:55], a[184:191], v6
    s_waitcnt lgkmcnt(3)
    v_smfmac_f32_16x16x64_bf16 v[72:75], v[56:59], a[192:199], v6
    v_mov_b32 v122, v154
    v_smfmac_f32_16x16x64_bf16 v[76:79], v[56:59], a[200:207], v6
    v_mov_b32 v123, v155
    v_smfmac_f32_16x16x64_bf16 v[80:83], v[56:59], a[208:215], v6
    v_mov_b32 v124, v156
    v_smfmac_f32_16x16x64_bf16 v[84:87], v[56:59], a[216:223], v6
    s_waitcnt lgkmcnt(2)
    v_smfmac_f32_16x16x64_bf16 v[72:75], v[60:63], a[224:231], v6
    v_mov_b32 v125, v157
    v_smfmac_f32_16x16x64_bf16 v[76:79], v[60:63], a[232:239], v6
    v_mov_b32 v126, v158
    v_smfmac_f32_16x16x64_bf16 v[80:83], v[60:63], a[240:247], v6
    v_mov_b32 v127, v159
    v_smfmac_f32_16x16x64_bf16 v[84:87], v[60:63], a[248:255], v6
    s_waitcnt lgkmcnt(1)
    v_smfmac_f32_16x16x64_bf16 v[72:75], v[64:67], v[192:199], v6
    v_smfmac_f32_16x16x64_bf16 v[76:79], v[64:67], v[200:207], v6
    v_smfmac_f32_16x16x64_bf16 v[80:83], v[64:67], v[208:215], v6
    v_smfmac_f32_16x16x64_bf16 v[84:87], v[64:67], v[216:223], v6
    s_waitcnt lgkmcnt(0)
    v_smfmac_f32_16x16x64_bf16 v[72:75], v[68:71], v[224:231], v6
    v_smfmac_f32_16x16x64_bf16 v[76:79], v[68:71], v[232:239], v6
    v_smfmac_f32_16x16x64_bf16 v[80:83], v[68:71], v[240:247], v6
    v_smfmac_f32_16x16x64_bf16 v[84:87], v[68:71], v[248:255], v6
    s_nop 4
    v_add_f32 v72, v72, v74
    v_add_f32 v73, v73, v75
    v_cvt_pk_bf16_f32 v74, v72, v73
    v_min_u32 v74, 0xfffffffe, v74
    v_add_f32 v76, v76, v78
    v_add_f32 v77, v77, v79
    v_cvt_pk_bf16_f32 v78, v76, v77
    v_min_u32 v78, 0xfffffffe, v78
    v_add_f32 v80, v80, v82
    v_add_f32 v81, v81, v83
    v_cvt_pk_bf16_f32 v82, v80, v81
    v_min_u32 v82, 0xfffffffe, v82
    v_add_f32 v84, v84, v86
    v_add_f32 v85, v85, v87
    v_cvt_pk_bf16_f32 v86, v84, v85
    v_min_u32 v86, 0xfffffffe, v86
    buffer_store_dword v74, v23, s[8:11], s73 offen offset:0 sc1
    buffer_store_dword v78, v23, s[8:11], s73 offen offset:256 sc1
    buffer_store_dword v82, v23, s[8:11], s73 offen offset:512 sc1
    buffer_store_dword v86, v23, s[8:11], s73 offen offset:768 sc1
    buffer_store_dword v74, v19, s[8:11], s39 offen offset:0 sc1
    buffer_store_dword v78, v19, s[8:11], s39 offen offset:256 sc1
    buffer_store_dword v82, v19, s[8:11], s39 offen offset:512 sc1
    buffer_store_dword v86, v19, s[8:11], s39 offen offset:768 sc1
    s_cmp_eq_u32 s26, 63
    s_cbranch_scc1 co_last
    s_cmp_lg_u32 s26, 0
    s_cbranch_scc1 zfirst_97
    s_mov_b32 s33, 0
wf_98:
    buffer_load_dword v143, v140, s[8:11], s35 offen sc1
    s_add_u32 s33, s33, 1
    s_cmp_gt_u32 s33, 2097152
    s_cbranch_scc1 rec_fail
    s_waitcnt vmcnt(0)
    v_cmp_eq_u32 vcc, 0, v143
    s_cbranch_vccz wfd_99
    s_sleep 2
    s_branch wf_98
    s_nop 1
wfd_99:
    s_add_u32 s35, s35, 128
    buffer_load_dwordx4 v[144:147], v180, s[8:11], s38 offen sc1
    buffer_load_dwordx4 v[148:151], v181, s[8:11], s38 offen sc1
    buffer_load_dwordx4 v[152:155], v182, s[8:11], s38 offen sc1
    buffer_load_dwordx4 v[156:159], v183, s[8:11], s38 offen sc1
    s_add_u32 s38, s38, 1310720
    s_waitcnt vmcnt(0)
    v_mov_b32 v112, v144
    v_mov_b32 v113, v145
    v_mov_b32 v114, v146
    v_mov_b32 v115, v147
    v_mov_b32 v116, v148
    v_mov_b32 v117, v149
    v_mov_b32 v118, v150
    v_mov_b32 v119, v151
    v_mov_b32 v120, v152
    v_mov_b32 v121, v153
    v_mov_b32 v122, v154
    v_mov_b32 v123, v155
    v_mov_b32 v124, v156
    v_mov_b32 v125, v157
    v_mov_b32 v126, v158
    v_mov_b32 v127, v159
    v_mov_b32 v143, 0
    s_nop 1
zfirst_97:
    s_add_u32 s30, s26, 1
    s_and_b32 s30, s30, 0x43
    s_cmp_lg_u32 s30, 0
    s_cbranch_scc1 vook_100
    v_cmp_eq_u32 vcc, 0, v143
    s_cbranch_vccz vogo_101
    s_mov_b32 s33, 0
    s_nop 2
wf_102:
    buffer_load_dword v143, v140, s[8:11], s35 offen sc1
    s_add_u32 s33, s33, 1
    s_cmp_gt_u32 s33, 2097152
    s_cbranch_scc1 rec_fail
    s_waitcnt vmcnt(0)
    v_cmp_eq_u32 vcc, 0, v143
    s_cbranch_vccz wfd_103
    s_sleep 2
    s_branch wf_102
    s_nop 1
wfd_103:
vogo_101:
    s_add_u32 s35, s35, 128
vook_100:
    s_mov_b32 s33, 0
    s_cmp_eq_u32 s26, 0
    s_cbranch_scc1 Lskip_105
    s_sleep 21
Lskip_105:
poll_cop_104:
    buffer_load_dwordx4 v[108:111], v24, s[8:11], s73 offen sc1
    buffer_load_dwordx4 v[88:91], v17, s[8:11], s28 offen offset:0 sc1
    buffer_load_dwordx4 v[92:95], v17, s[8:11], s28 offen offset:1024 sc1
    buffer_load_dwordx4 v[96:99], v17, s[8:11], s28 offen offset:2048 sc1
    buffer_load_dwordx4 v[100:103], v17, s[8:11], s28 offen offset:3072 sc1
    buffer_load_dwordx4 v[104:107], v18, s[8:11], s28 offen sc1
    s_add_u32 s33, s33, 1
    s_cmp_gt_u32 s33, 4194304
    s_cbranch_scc1 rec_fail
    s_waitcnt vmcnt(0)
    v_mfma_f32_16x16x32_bf16 v[76:79], v[88:91], v[112:115], 0
    v_max3_u32 v128, v88, v89, v90
    v_max3_u32 v129, v91, v92, v93
    v_mfma_f32_16x16x32_bf16 v[76:79], v[92:95], v[116:119], v[76:79]
    v_max3_u32 v130, v94, v95, v96
    v_max3_u32 v131, v97, v98, v99
    v_mfma_f32_16x16x32_bf16 v[76:79], v[96:99], v[120:123], v[76:79]
    v_max3_u32 v132, v100, v101, v102
    v_max3_u32 v133, v103, v104, v105
    v_mfma_f32_16x16x32_bf16 v[76:79], v[100:103], v[124:127], v[76:79]
    v_max3_u32 v134, v106, v107, v108
    v_max3_u32 v135, v109, v110, v111
    v_mfma_f32_16x16x32_bf16 v[76:79], v[104:107], v[108:111], v[76:79]
    v_max3_u32 v136, v128, v129, v130
    v_max3_u32 v137, v131, v132, v133
    v_max_u32 v138, v134, v135
    v_max3_u32 v139, v136, v137, v138
    v_cmp_eq_u32 vcc, -1, v139
    s_cbranch_vccnz poll_cop_104
    buffer_load_dwordx4 v[144:147], v180, s[8:11], s38 offen sc1
    buffer_load_dwordx4 v[148:151], v181, s[8:11], s38 offen sc1
    buffer_load_dwordx4 v[152:155], v182, s[8:11], s38 offen sc1
    buffer_load_dwordx4 v[156:159], v183, s[8:11], s38 offen sc1
    s_add_u32 s38, s38, 1310720
    ds_write_b128 v25, v[76:79]
    s_waitcnt lgkmcnt(0)
    s_barrier
    ds_read2st64_b32 v[184:185], v26 offset0:0 offset1:1
    ds_read2st64_b32 v[186:187], v26 offset0:2 offset1:3
    ds_read2st64_b32 v[188:189], v26 offset0:4 offset1:5
    ds_read2st64_b32 v[190:191], v26 offset0:6 offset1:7
    s_waitcnt lgkmcnt(2)
    v_add_f32 v184, v184, v185
    v_add_f32 v186, v186, v187
    s_waitcnt lgkmcnt(0)
    v_add_f32 v188, v188, v189
    v_add_f32 v190, v190, v191
    v_add_f32 v184, v184, v186
    v_add_f32 v188, v188, v190
    v_add_f32 v184, v184, v188
    s_nop 1
    v_mov_b32_dpp v185, v184 row_ror:8 row_mask:0xf bank_mask:0xf
    v_cvt_pk_bf16_f32 v184, v184, v185
    v_min_u32 v184, 0xfffffffe, v184
    buffer_store_dword v184, v27, s[8:11], s29 offen sc1
    s_add_u32 s30, s26, 2
    s_and_b32 s30, s30, 3
    s_cmp_lg_u32 s30, 0
    s_cbranch_scc1 Lskip_106
    buffer_load_dword v143, v140, s[8:11], s35 offen sc1
Lskip_106:
    buffer_store_dwordx4 v[28:31], v24, s[8:11], s73 offen sc1
    s_add_u32 s73, s73, 0xa0000
    s_add_u32 s30, s74, 0x1e0000
    s_cmp_ge_u32 s73, s30
    s_cselect_b32 s73, s74, s73
    s_add_u32 s39, s39, 327680
    s_add_u32 s26, s26, 1
    s_branch co_loop
co_last:
    s_waitcnt vmcnt(0)
    s_barrier
    buffer_store_dword v142, v141, s[8:11], s36 offen sc1
    s_endpgm
rec_fail:
    s_load_dwordx2 s[20:21], s[0:1], 104
    s_waitcnt lgkmcnt(0)
    s_and_b32 s21, s21, 0xffff
    s_mov_b32 s22, 0x100
    s_mov_b32 s23, 0x00020000
    v_mov_b32 v1, 0
    v_mov_b32 v2, 0xdead
    buffer_store_dword v2, v1, s[20:23], 0 offen
    s_nop 0
rec_done:
    s_endpgm
code_end:
.section .rodata,"a"
.p2align 6
.amdhsa_kernel recurrent_scan__memory_aug_recurrent_mem_tr__mixer_channel_mlp__prompt_kernel
  .amdhsa_next_free_vgpr 512
  .amdhsa_next_free_sgpr 102
  .amdhsa_accum_offset 256
  .amdhsa_group_segment_fixed_size 0
  .amdhsa_kernarg_size 120
  .amdhsa_user_sgpr_count 2
  .amdhsa_user_sgpr_kernarg_segment_ptr 1
  .amdhsa_system_sgpr_workgroup_id_x 1
  .amdhsa_float_denorm_mode_32 3
.end_amdhsa_kernel
```
